```python
import torch

def _softmax(x, axis=-1):
    return torch.softmax(x, dim=axis)
def _gelu(x):
    return torch.nn.functional.gelu(x, approximate="tanh")
def _silu(x):
    return torch.nn.functional.silu(x)
def _sigmoid(x):
    return torch.sigmoid(x)
def _layernorm(x, axis=-1, eps=1e-5):
    m = x.mean(dim=axis, keepdim=True)
    v = x.var(dim=axis, keepdim=True, unbiased=False)
    return (x - m) / torch.sqrt(v + eps)
def _scatter_add(tgt, idx, src, axis=0):
    return tgt.clone().index_add_(axis, idx, src)
def _segment_sum(src, seg, n):
    out = torch.zeros((n,) + src.shape[1:], dtype=src.dtype)
    return out.index_add_(0, seg, src)
def _pad(x, pw):
    flat = tuple(v for pair in reversed(pw) for v in pair)
    return torch.nn.functional.pad(x, flat)

kernel_name = 'concat_heads__gqa_block_cached__gqa_block_cached__near_ridge'

def setup_inputs():

    _w = (lambda a: (lambda t: t.to(torch.bfloat16) if t.is_floating_point() else t)(torch.as_tensor(a)))
    def _A_setup():
        B, Sq, D = 16, 144, 448
        Hq, Hkv, Sk, Dh = 16, 8, 1024, 256
        assert Hq % Hkv == 0, (Hq, Hkv)
        return {
            "x": _w((lambda *s: torch.randn(*s, dtype=torch.bfloat16) * 0.8)(B, Sq, D)),
            "k_cache": _w((lambda *s: torch.randn(*s, dtype=torch.bfloat16) * 0.8)(B, Hkv, Sk, Dh)),
            "v_cache": _w((lambda *s: torch.randn(*s, dtype=torch.bfloat16) * 0.05)(B, Hkv, Sk, Dh)),
            "wq": _w((lambda *s: torch.randn(*s, dtype=torch.bfloat16) * 0.8)(D, Hq * Dh) * (D ** -0.5)),
            "wo": _w((lambda *s: torch.randn(*s, dtype=torch.bfloat16) * 0.05)(Hq * Dh, D) * ((Hq * Dh) ** -0.5)),
        }
    _A_in = _A_setup()

    def _B_setup():
        B, Sq, D = 16, 144, 448
        Hq, Hkv, Sk, Dh = 16, 8, 1024, 256
        assert Hq % Hkv == 0, (Hq, Hkv)
        return {
            "x": _w((lambda *s: torch.randn(*s, dtype=torch.bfloat16) * 0.8)(B, Sq, D)),
            "k_cache": _w((lambda *s: torch.randn(*s, dtype=torch.bfloat16) * 0.8)(B, Hkv, Sk, Dh)),
            "v_cache": _w((lambda *s: torch.randn(*s, dtype=torch.bfloat16) * 0.05)(B, Hkv, Sk, Dh)),
            "wq": _w((lambda *s: torch.randn(*s, dtype=torch.bfloat16) * 0.8)(D, Hq * Dh) * (D ** -0.5)),
            "wo": _w((lambda *s: torch.randn(*s, dtype=torch.bfloat16) * 0.05)(Hq * Dh, D) * ((Hq * Dh) ** -0.5)),
        }
    _B_in = _B_setup()

    return {
        "A_x": _A_in["x"],
        "A_k_cache": _A_in["k_cache"],
        "A_v_cache": _A_in["v_cache"],
        "A_wq": _A_in["wq"],
        "A_wo": _A_in["wo"],
        "B_x": _B_in["x"],
        "B_k_cache": _B_in["k_cache"],
        "B_v_cache": _B_in["v_cache"],
        "B_wq": _B_in["wq"],
        "B_wo": _B_in["wo"],
    }

def reference(A_x, A_k_cache, A_v_cache, A_wq, A_wo, B_x, B_k_cache, B_v_cache, B_wq, B_wo):
    def _A_ref(x, k_cache, v_cache, wq, wo):
        B, Sq, D = x.shape
        Hq, Dh = 16, 256
        Hkv = k_cache.shape[1]
        rep = Hq // Hkv
        q = (lambda x, *d: x.permute(*d))((x @ wq).reshape(B, Sq, Hq, Dh), 0, 2, 1, 3)
        k = (lambda x, n, axis: torch.repeat_interleave(x, n, dim=axis))(k_cache, rep, axis=1)
        v = (lambda x, n, axis: torch.repeat_interleave(x, n, dim=axis))(v_cache, rep, axis=1)
        scores = torch.einsum("bhqd,bhkd->bhqk", q, k) * (Dh ** -0.5)
        p = _softmax(scores, axis=-1)
        o = torch.einsum("bhqk,bhkd->bhqd", p, v)
        return (lambda x, *d: x.permute(*d))(o, 0, 2, 1, 3).reshape(B, Sq, Hq * Dh) @ wo

    def _B_ref(x, k_cache, v_cache, wq, wo):
        B, Sq, D = x.shape
        Hq, Dh = 16, 256
        Hkv = k_cache.shape[1]
        rep = Hq // Hkv
        q = (lambda x, *d: x.permute(*d))((x @ wq).reshape(B, Sq, Hq, Dh), 0, 2, 1, 3)
        k = (lambda x, n, axis: torch.repeat_interleave(x, n, dim=axis))(k_cache, rep, axis=1)
        v = (lambda x, n, axis: torch.repeat_interleave(x, n, dim=axis))(v_cache, rep, axis=1)
        scores = torch.einsum("bhqd,bhkd->bhqk", q, k) * (Dh ** -0.5)
        p = _softmax(scores, axis=-1)
        o = torch.einsum("bhqk,bhkd->bhqd", p, v)
        return (lambda x, *d: x.permute(*d))(o, 0, 2, 1, 3).reshape(B, Sq, Hq * Dh) @ wo

    a = _A_ref(A_x, A_k_cache, A_v_cache, A_wq, A_wo)
    b = _B_ref(B_x, B_k_cache, B_v_cache, B_wq, B_wo)
    return torch.concatenate([a, b], axis=-1)
```

```asm
; @launch grid=(256,1,1) block=(256,1,1) lds=163840
.amdgcn_target "amdgcn-amd-amdhsa--gfx950"
.text
.globl concat_heads__gqa_block_cached__gqa_block_cached__near_ridge_kernel
.p2align 8
.type concat_heads__gqa_block_cached__gqa_block_cached__near_ridge_kernel,@function
concat_heads__gqa_block_cached__gqa_block_cached__near_ridge_kernel:
s_cmp_ge_u32 s2, 256
s_cbranch_scc1 L_exit
v_lshrrev_b32 v1, 6, v0
s_mov_b32 s65, 0
v_readfirstlane_b32 s28, v1
L_restart:
s_and_b32 s3, s2, 7
s_lshr_b32 s56, s2, 3
s_lshr_b32 s29, s3, 2
s_bfe_u32 s57, s3, 0x10001
s_lshl_b32 s57, s57, 2
s_and_b32 s58, s56, 3
s_add_u32 s31, s57, s58
s_and_b32 s57, s3, 1
s_lshl_b32 s57, s57, 3
s_lshr_b32 s58, s56, 2
s_add_u32 s30, s57, s58
s_mul_i32 s57, s29, 40
s_load_dwordx8 s[32:39], s[0:1], s57
s_add_u32 s57, s57, 32
s_load_dwordx2 s[40:41], s[0:1], s57
s_load_dwordx2 s[42:43], s[0:1], 96
v_mbcnt_lo_u32_b32 v250, -1, 0
v_mbcnt_hi_u32_b32 v250, -1, v250
v_lshrrev_b32 v2, 4, v250
v_and_b32 v3, 15, v250
v_bfe_u32 v4, v250, 2, 2
v_and_b32 v5, 3, v250
v_lshlrev_b32 v168, 4, v250
v_add_u32 v169, 7104, v168
v_add_u32 v170, 14208, v168
v_add_u32 v171, 21312, v168
v_lshrrev_b32 v6, 5, v250
v_lshlrev_b32 v7, 3, v6
v_and_b32 v189, 31, v250
v_xor_b32 v189, v189, v7
v_lshlrev_b32 v189, 4, v189
v_lshl_add_u32 v189, v6, 9, v189
v_lshrrev_b32 v6, 3, v250
v_mul_u32_u24 v161, 896, v6
v_and_b32 v7, 6, v6
v_and_b32 v6, 7, v250
v_xor_b32 v7, v7, v6
v_lshl_add_u32 v161, v7, 4, v161
v_and_b32 v6, 6, v3
v_xor_b32 v6, v6, v2
v_lshlrev_b32 v7, 4, v6
v_and_b32 v6, 7, v3
v_lshl_add_u32 v7, v6, 7, v7
v_lshrrev_b32 v6, 3, v3
v_lshl_add_u32 v7, v6, 10, v7
v_add_u32 v163, 120832, v7
s_lshl_b32 s57, s28, 12
v_add_u32 v162, 104448, v7
v_add_u32 v162, s57, v162
v_mul_u32_u24 v7, 8712, v2
v_mul_u32_u24 v6, 1088, v4
v_add_u32 v7, v7, v6
v_lshl_add_u32 v7, v5, 4, v7
s_xor_b32 s57, s28, 0
s_lshl_b32 s57, s57, 8
v_add_u32 v164, s57, v7
s_xor_b32 s57, s28, 1
s_lshl_b32 s57, s57, 8
v_add_u32 v165, s57, v7
s_xor_b32 s57, s28, 2
s_lshl_b32 s57, s57, 8
v_add_u32 v166, s57, v7
s_xor_b32 s57, s28, 3
s_lshl_b32 s57, s57, 8
v_add_u32 v167, s57, v7
s_waitcnt lgkmcnt(0)
s_mul_i32 s57, s30, 129024
s_add_u32 s4, s32, s57
s_addc_u32 s5, s33, 0
s_mov_b32 s6, 129024
s_mov_b32 s7, 0x20000
s_lshl_b32 s57, s31, 10
s_sub_u32 s58, 3670016, s57
s_add_u32 s8, s38, s57
s_addc_u32 s9, s39, 0
s_mov_b32 s10, s58
s_mov_b32 s11, 0x20000
s_lshl_b32 s57, s30, 3
s_add_u32 s57, s57, s31
s_lshl_b32 s57, s57, 19
s_add_u32 s12, s34, s57
s_addc_u32 s13, s35, 0
s_mov_b32 s14, 524288
s_mov_b32 s15, 0x20000
s_add_u32 s16, s36, s57
s_addc_u32 s17, s37, 0
s_mov_b32 s18, 524288
s_mov_b32 s19, 0x20000
s_mul_i32 s57, s31, 458752
s_add_u32 s20, s40, s57
s_addc_u32 s21, s41, 0
s_mov_b32 s22, 458752
s_mov_b32 s23, 0x20000
s_lshl_b32 s57, s29, 4
s_add_u32 s57, s57, s30
s_lshl_b32 s57, s57, 3
s_add_u32 s57, s57, s31
s_mul_i32 s57, s57, 129024
s_add_u32 s24, s42, s57
s_addc_u32 s25, s43, 0
s_mov_b32 s26, 129024
s_mov_b32 s27, 0x20000
s_lshl_b32 s49, s28, 16
s_add_u32 s50, s49, 32768
s_mul_i32 s48, s28, 8712
s_mov_b32 s60, 0
s_mov_b32 s66, 34784
s_mul_i32 s36, s28, 28672
s_add_u32 s37, s36, 7168
s_add_u32 s38, s36, 14336
s_add_u32 s39, s36, 21504
s_and_b32 s57, s28, 1
s_add_u32 s57, s57, 16
s_mul_i32 s40, s57, 7168
s_lshl_b32 s44, s57, 10
s_add_u32 s44, s44, 104448
s_lshl_b32 s41, s28, 12
s_add_u32 s41, s41, 104448
s_mov_b32 s45, 25600
s_mov_b32 s74, 25600
s_add_u32 m0, s48, 0
s_nop 0
buffer_load_dwordx4 v168, s[8:11], s49 offen offset:0 lds
buffer_load_dwordx4 v169, s[8:11], s49 offen offset:1088 lds
buffer_load_dwordx4 v170, s[8:11], s49 offen offset:2176 lds
buffer_load_dwordx4 v171, s[8:11], s49 offen offset:3264 lds
s_add_u32 m0, s48, 4352
s_nop 0
buffer_load_dwordx4 v168, s[8:11], s50 offen offset:0 lds
buffer_load_dwordx4 v169, s[8:11], s50 offen offset:1088 lds
buffer_load_dwordx4 v170, s[8:11], s50 offen offset:2176 lds
buffer_load_dwordx4 v171, s[8:11], s50 offen offset:3264 lds
s_add_u32 m0, s41, 0
s_nop 0
buffer_load_dwordx4 v161, s[4:7], s36 offen lds
s_add_u32 m0, s41, 1024
s_nop 0
buffer_load_dwordx4 v161, s[4:7], s37 offen lds
s_add_u32 m0, s41, 2048
s_nop 0
buffer_load_dwordx4 v161, s[4:7], s38 offen lds
s_add_u32 m0, s41, 3072
s_nop 0
buffer_load_dwordx4 v161, s[4:7], s39 offen lds
s_mov_b32 m0, s44
s_nop 0
buffer_load_dwordx4 v161, s[4:7], s40 offen lds
s_add_u32 s49, s49, 262144
s_add_u32 s50, s50, 262144
s_add_u32 s60, s60, 1
s_cmp_eq_u32 s60, 3
s_cselect_b32 s56, 4294897728, s66
s_cselect_b32 s60, 0, s60
s_add_u32 s48, s48, s56
s_add_u32 s36, s36, 128
s_add_u32 s37, s37, 128
s_add_u32 s38, s38, 128
s_add_u32 s39, s39, 128
s_add_u32 s40, s40, 128
s_add_u32 s41, s41, s45
s_add_u32 s44, s44, s45
s_sub_u32 s45, 0, s45
s_add_u32 m0, s48, 0
s_nop 0
buffer_load_dwordx4 v168, s[8:11], s49 offen offset:0 lds
buffer_load_dwordx4 v169, s[8:11], s49 offen offset:1088 lds
buffer_load_dwordx4 v170, s[8:11], s49 offen offset:2176 lds
buffer_load_dwordx4 v171, s[8:11], s49 offen offset:3264 lds
s_add_u32 m0, s48, 4352
s_nop 0
buffer_load_dwordx4 v168, s[8:11], s50 offen offset:0 lds
buffer_load_dwordx4 v169, s[8:11], s50 offen offset:1088 lds
buffer_load_dwordx4 v170, s[8:11], s50 offen offset:2176 lds
buffer_load_dwordx4 v171, s[8:11], s50 offen offset:3264 lds
s_add_u32 s49, s49, 262144
s_add_u32 s50, s50, 262144
s_add_u32 s60, s60, 1
s_cmp_eq_u32 s60, 3
s_cselect_b32 s56, 4294897728, s66
s_cselect_b32 s60, 0, s60
s_add_u32 s48, s48, s56
s_cmp_eq_u32 s28, 0
s_cbranch_scc0 L_nononce
s_load_dwordx2 s[32:33], s[0:1], 88
s_memrealtime s[34:35]
s_lshl_b32 s57, s29, 4
s_add_u32 s57, s57, s30
s_lshl_b32 s57, s57, 2
v_mov_b32 v176, s57
v_mov_b32 v177, 0x1000
v_cmp_eq_u32 vcc, 0, v250
s_waitcnt lgkmcnt(0)
s_nop 1
v_cndmask_b32 v176, v177, v176, vcc
s_lshl_b32 s34, s34, 3
s_or_b32 s34, s34, 0x80000000
s_mov_b32 s75, s34
v_mov_b32 v174, s34
v_mov_b32 v175, 0
s_mov_b32 s68, s32
s_mov_b32 s69, s33
s_mov_b32 s70, 128
s_mov_b32 s71, 0x20000
buffer_atomic_cmpswap v[174:175], v176, s[68:71], 0 offen sc0 sc1
L_nononce:
v_lshlrev_b32 v6, 7, v250
s_getpc_b64 s[34:35]
L_pcbase:
s_lshr_b32 s32, s2, 3
s_and_b32 s32, s32, 3
s_lshl_b32 s32, s32, 2
s_add_u32 s32, s32, s28
s_lshl_b32 s32, s32, 13
s_min_u32 s32, s32, L_hot_end-L_pcbase-8192
s_add_u32 s34, s34, s32
s_addc_u32 s35, s35, 0
global_load_dword v244, v6, s[34:35]
v_mov_b32 v0, 0
v_mov_b32 v1, 0
v_mov_b32 v2, 0
v_mov_b32 v3, 0
v_mov_b32 v4, 0
v_mov_b32 v5, 0
v_mov_b32 v6, 0
v_mov_b32 v7, 0
v_mov_b32 v8, 0
v_mov_b32 v9, 0
v_mov_b32 v10, 0
v_mov_b32 v11, 0
v_mov_b32 v12, 0
v_mov_b32 v13, 0
v_mov_b32 v14, 0
v_mov_b32 v15, 0
v_mov_b32 v16, 0
v_mov_b32 v17, 0
v_mov_b32 v18, 0
v_mov_b32 v19, 0
v_mov_b32 v20, 0
v_mov_b32 v21, 0
v_mov_b32 v22, 0
v_mov_b32 v23, 0
v_mov_b32 v24, 0
v_mov_b32 v25, 0
v_mov_b32 v26, 0
v_mov_b32 v27, 0
v_mov_b32 v28, 0
v_mov_b32 v29, 0
v_mov_b32 v30, 0
v_mov_b32 v31, 0
v_mov_b32 v32, 0
v_mov_b32 v33, 0
v_mov_b32 v34, 0
v_mov_b32 v35, 0
v_mov_b32 v36, 0
v_mov_b32 v37, 0
v_mov_b32 v38, 0
v_mov_b32 v39, 0
v_mov_b32 v40, 0
v_mov_b32 v41, 0
v_mov_b32 v42, 0
v_mov_b32 v43, 0
v_mov_b32 v44, 0
v_mov_b32 v45, 0
v_mov_b32 v46, 0
v_mov_b32 v47, 0
v_mov_b32 v48, 0
v_mov_b32 v49, 0
v_mov_b32 v50, 0
v_mov_b32 v51, 0
v_mov_b32 v52, 0
v_mov_b32 v53, 0
v_mov_b32 v54, 0
v_mov_b32 v55, 0
v_mov_b32 v56, 0
v_mov_b32 v57, 0
v_mov_b32 v58, 0
v_mov_b32 v59, 0
v_mov_b32 v60, 0
v_mov_b32 v61, 0
v_mov_b32 v62, 0
v_mov_b32 v63, 0
v_mov_b32 v64, 0
v_mov_b32 v65, 0
v_mov_b32 v66, 0
v_mov_b32 v67, 0
v_mov_b32 v68, 0
v_mov_b32 v69, 0
v_mov_b32 v70, 0
v_mov_b32 v71, 0
v_mov_b32 v72, 0
v_mov_b32 v73, 0
v_mov_b32 v74, 0
v_mov_b32 v75, 0
v_mov_b32 v76, 0
v_mov_b32 v77, 0
v_mov_b32 v78, 0
v_mov_b32 v79, 0
v_mov_b32 v80, 0
v_mov_b32 v81, 0
v_mov_b32 v82, 0
v_mov_b32 v83, 0
v_mov_b32 v84, 0
v_mov_b32 v85, 0
v_mov_b32 v86, 0
v_mov_b32 v87, 0
v_mov_b32 v88, 0
v_mov_b32 v89, 0
v_mov_b32 v90, 0
v_mov_b32 v91, 0
v_mov_b32 v92, 0
v_mov_b32 v93, 0
v_mov_b32 v94, 0
v_mov_b32 v95, 0
v_mov_b32 v96, 0
v_mov_b32 v97, 0
v_mov_b32 v98, 0
v_mov_b32 v99, 0
v_mov_b32 v100, 0
v_mov_b32 v101, 0
v_mov_b32 v102, 0
v_mov_b32 v103, 0
v_mov_b32 v104, 0
v_mov_b32 v105, 0
v_mov_b32 v106, 0
v_mov_b32 v107, 0
v_mov_b32 v108, 0
v_mov_b32 v109, 0
v_mov_b32 v110, 0
v_mov_b32 v111, 0
v_mov_b32 v112, 0
v_mov_b32 v113, 0
v_mov_b32 v114, 0
v_mov_b32 v115, 0
v_mov_b32 v116, 0
v_mov_b32 v117, 0
v_mov_b32 v118, 0
v_mov_b32 v119, 0
v_mov_b32 v120, 0
v_mov_b32 v121, 0
v_mov_b32 v122, 0
v_mov_b32 v123, 0
v_mov_b32 v124, 0
v_mov_b32 v125, 0
v_mov_b32 v126, 0
v_mov_b32 v127, 0
v_mov_b32 v128, 0
v_mov_b32 v129, 0
v_mov_b32 v130, 0
v_mov_b32 v131, 0
v_mov_b32 v132, 0
v_mov_b32 v133, 0
v_mov_b32 v134, 0
v_mov_b32 v135, 0
v_mov_b32 v136, 0
v_mov_b32 v137, 0
v_mov_b32 v138, 0
v_mov_b32 v139, 0
v_mov_b32 v140, 0
v_mov_b32 v141, 0
v_mov_b32 v142, 0
v_mov_b32 v143, 0
v_mov_b32 v144, 0
v_mov_b32 v145, 0
v_mov_b32 v146, 0
v_mov_b32 v147, 0
v_mov_b32 v148, 0
v_mov_b32 v149, 0
v_mov_b32 v150, 0
v_mov_b32 v151, 0
v_mov_b32 v152, 0
v_mov_b32 v153, 0
v_mov_b32 v154, 0
v_mov_b32 v155, 0
v_mov_b32 v156, 0
v_mov_b32 v157, 0
v_mov_b32 v158, 0
v_mov_b32 v159, 0
v_accvgpr_write_b32 a0, 0
v_accvgpr_write_b32 a1, 0
v_accvgpr_write_b32 a2, 0
v_accvgpr_write_b32 a3, 0
v_accvgpr_write_b32 a4, 0
v_accvgpr_write_b32 a5, 0
v_accvgpr_write_b32 a6, 0
v_accvgpr_write_b32 a7, 0
v_accvgpr_write_b32 a8, 0
v_accvgpr_write_b32 a9, 0
v_accvgpr_write_b32 a10, 0
v_accvgpr_write_b32 a11, 0
v_accvgpr_write_b32 a12, 0
v_accvgpr_write_b32 a13, 0
v_accvgpr_write_b32 a14, 0
v_accvgpr_write_b32 a15, 0
v_accvgpr_write_b32 a16, 0
v_accvgpr_write_b32 a17, 0
v_accvgpr_write_b32 a18, 0
v_accvgpr_write_b32 a19, 0
v_accvgpr_write_b32 a20, 0
v_accvgpr_write_b32 a21, 0
v_accvgpr_write_b32 a22, 0
v_accvgpr_write_b32 a23, 0
v_accvgpr_write_b32 a24, 0
v_accvgpr_write_b32 a25, 0
v_accvgpr_write_b32 a26, 0
v_accvgpr_write_b32 a27, 0
v_accvgpr_write_b32 a28, 0
v_accvgpr_write_b32 a29, 0
v_accvgpr_write_b32 a30, 0
v_accvgpr_write_b32 a31, 0
v_accvgpr_write_b32 a32, 0
v_accvgpr_write_b32 a33, 0
v_accvgpr_write_b32 a34, 0
v_accvgpr_write_b32 a35, 0
v_accvgpr_write_b32 a36, 0
v_accvgpr_write_b32 a37, 0
v_accvgpr_write_b32 a38, 0
v_accvgpr_write_b32 a39, 0
v_accvgpr_write_b32 a40, 0
v_accvgpr_write_b32 a41, 0
v_accvgpr_write_b32 a42, 0
v_accvgpr_write_b32 a43, 0
v_accvgpr_write_b32 a44, 0
v_accvgpr_write_b32 a45, 0
v_accvgpr_write_b32 a46, 0
v_accvgpr_write_b32 a47, 0
v_accvgpr_write_b32 a48, 0
v_accvgpr_write_b32 a49, 0
v_accvgpr_write_b32 a50, 0
v_accvgpr_write_b32 a51, 0
v_accvgpr_write_b32 a52, 0
v_accvgpr_write_b32 a53, 0
v_accvgpr_write_b32 a54, 0
v_accvgpr_write_b32 a55, 0
v_accvgpr_write_b32 a56, 0
v_accvgpr_write_b32 a57, 0
v_accvgpr_write_b32 a58, 0
v_accvgpr_write_b32 a59, 0
v_accvgpr_write_b32 a60, 0
v_accvgpr_write_b32 a61, 0
v_accvgpr_write_b32 a62, 0
v_accvgpr_write_b32 a63, 0
v_accvgpr_write_b32 a64, 0
v_accvgpr_write_b32 a65, 0
v_accvgpr_write_b32 a66, 0
v_accvgpr_write_b32 a67, 0
v_accvgpr_write_b32 a68, 0
v_accvgpr_write_b32 a69, 0
v_accvgpr_write_b32 a70, 0
v_accvgpr_write_b32 a71, 0
v_accvgpr_write_b32 a72, 0
v_accvgpr_write_b32 a73, 0
v_accvgpr_write_b32 a74, 0
v_accvgpr_write_b32 a75, 0
v_accvgpr_write_b32 a76, 0
v_accvgpr_write_b32 a77, 0
v_accvgpr_write_b32 a78, 0
v_accvgpr_write_b32 a79, 0
v_accvgpr_write_b32 a80, 0
v_accvgpr_write_b32 a81, 0
v_accvgpr_write_b32 a82, 0
v_accvgpr_write_b32 a83, 0
v_accvgpr_write_b32 a84, 0
v_accvgpr_write_b32 a85, 0
v_accvgpr_write_b32 a86, 0
v_accvgpr_write_b32 a87, 0
v_accvgpr_write_b32 a88, 0
v_accvgpr_write_b32 a89, 0
v_accvgpr_write_b32 a90, 0
v_accvgpr_write_b32 a91, 0
v_accvgpr_write_b32 a92, 0
v_accvgpr_write_b32 a93, 0
v_accvgpr_write_b32 a94, 0
v_accvgpr_write_b32 a95, 0
v_accvgpr_write_b32 a96, 0
v_accvgpr_write_b32 a97, 0
v_accvgpr_write_b32 a98, 0
v_accvgpr_write_b32 a99, 0
v_accvgpr_write_b32 a100, 0
v_accvgpr_write_b32 a101, 0
v_accvgpr_write_b32 a102, 0
v_accvgpr_write_b32 a103, 0
v_accvgpr_write_b32 a104, 0
v_accvgpr_write_b32 a105, 0
v_accvgpr_write_b32 a106, 0
v_accvgpr_write_b32 a107, 0
v_accvgpr_write_b32 a108, 0
v_accvgpr_write_b32 a109, 0
v_accvgpr_write_b32 a110, 0
v_accvgpr_write_b32 a111, 0
v_accvgpr_write_b32 a112, 0
v_accvgpr_write_b32 a113, 0
v_accvgpr_write_b32 a114, 0
v_accvgpr_write_b32 a115, 0
v_accvgpr_write_b32 a116, 0
v_accvgpr_write_b32 a117, 0
v_accvgpr_write_b32 a118, 0
v_accvgpr_write_b32 a119, 0
v_accvgpr_write_b32 a120, 0
v_accvgpr_write_b32 a121, 0
v_accvgpr_write_b32 a122, 0
v_accvgpr_write_b32 a123, 0
v_accvgpr_write_b32 a124, 0
v_accvgpr_write_b32 a125, 0
v_accvgpr_write_b32 a126, 0
v_accvgpr_write_b32 a127, 0
s_mov_b32 s54, 0x3db8aa3b
s_mov_b32 s55, 0x3db8aa3b
s_mov_b32 s57, 0
s_mov_b32 s47, 34784
s_mov_b32 s57, 1
s_mov_b32 s46, 0
s_mul_i32 s63, s28, 4224
s_add_u32 s64, s63, 70048
s_add_u32 s63, s63, 130048
s_waitcnt vmcnt(9)
s_barrier
ds_read_b128 a[128:131], v162 offset:0
ds_read_b128 a[132:135], v162 offset:2048
ds_read_b128 a[136:139], v163 offset:0
ds_read_b64_tr_b16 a[152:153], v165 offset:0
ds_read_b64_tr_b16 a[154:155], v165 offset:4352
ds_read_b64_tr_b16 a[156:157], v165 offset:8
ds_read_b64_tr_b16 a[158:159], v165 offset:4360
ds_read_b64_tr_b16 a[160:161], v165 offset:64
ds_read_b64_tr_b16 a[162:163], v165 offset:4416
ds_read_b64_tr_b16 a[164:165], v165 offset:72
ds_read_b64_tr_b16 a[166:167], v165 offset:4424
ds_read_b64_tr_b16 a[168:169], v165 offset:128
ds_read_b64_tr_b16 a[170:171], v165 offset:4480
L_qloop:
ds_read_b64_tr_b16 a[172:173], v165 offset:136
s_waitcnt lgkmcnt(6)
v_mfma_f32_16x16x32_bf16 v[64:67], a[152:155], a[128:131], v[64:67]
s_add_u32 m0, s48, 0
ds_read_b64_tr_b16 a[174:175], v165 offset:4488
v_mfma_f32_16x16x32_bf16 v[72:75], a[152:155], a[132:135], v[72:75]
ds_read_b64_tr_b16 a[176:177], v165 offset:192
buffer_load_dwordx4 v168, s[8:11], s49 offen offset:0 lds
v_mfma_f32_16x16x32_bf16 v[68:71], a[156:159], a[128:131], v[68:71]
ds_read_b64_tr_b16 a[178:179], v165 offset:4544
v_mfma_f32_16x16x32_bf16 v[76:79], a[156:159], a[132:135], v[76:79]
s_waitcnt lgkmcnt(5)
ds_read_b64_tr_b16 a[180:181], v165 offset:200
v_mfma_f32_16x16x32_bf16 v[80:83], a[160:163], a[128:131], v[80:83]
ds_read_b64_tr_b16 a[182:183], v165 offset:4552
v_xor_b32 v162, 64, v162
v_mfma_f32_16x16x32_bf16 v[88:91], a[160:163], a[132:135], v[88:91]
ds_read_b64_tr_b16 a[152:153], v166 offset:0
buffer_load_dwordx4 v169, s[8:11], s49 offen offset:1088 lds
v_mfma_f32_16x16x32_bf16 v[84:87], a[164:167], a[128:131], v[84:87]
ds_read_b64_tr_b16 a[154:155], v166 offset:4352
v_xor_b32 v163, 64, v163
v_mfma_f32_16x16x32_bf16 v[92:95], a[164:167], a[132:135], v[92:95]
s_waitcnt lgkmcnt(5)
ds_read_b64_tr_b16 a[156:157], v166 offset:8
v_mfma_f32_16x16x32_bf16 v[96:99], a[168:171], a[128:131], v[96:99]
ds_read_b64_tr_b16 a[158:159], v166 offset:4360
v_mfma_f32_16x16x32_bf16 v[104:107], a[168:171], a[132:135], v[104:107]
ds_read_b64_tr_b16 a[160:161], v166 offset:64
v_mfma_f32_16x16x32_bf16 v[100:103], a[172:175], a[128:131], v[100:103]
ds_read_b64_tr_b16 a[162:163], v166 offset:4416
buffer_load_dwordx4 v170, s[8:11], s49 offen offset:2176 lds
v_mfma_f32_16x16x32_bf16 v[108:111], a[172:175], a[132:135], v[108:111]
s_waitcnt lgkmcnt(5)
ds_read_b64_tr_b16 a[164:165], v166 offset:72
v_mfma_f32_16x16x32_bf16 v[112:115], a[176:179], a[128:131], v[112:115]
ds_read_b64_tr_b16 a[166:167], v166 offset:4424
v_mfma_f32_16x16x32_bf16 v[120:123], a[176:179], a[132:135], v[120:123]
ds_read_b64_tr_b16 a[168:169], v166 offset:128
v_mfma_f32_16x16x32_bf16 v[116:119], a[180:183], a[128:131], v[116:119]
ds_read_b64_tr_b16 a[170:171], v166 offset:4480
v_mfma_f32_16x16x32_bf16 v[124:127], a[180:183], a[132:135], v[124:127]
s_waitcnt lgkmcnt(5)
ds_read_b64_tr_b16 a[172:173], v166 offset:136
buffer_load_dwordx4 v171, s[8:11], s49 offen offset:3264 lds
v_mfma_f32_16x16x32_bf16 a[0:3], a[152:155], a[128:131], a[0:3]
ds_read_b64_tr_b16 a[174:175], v166 offset:4488
v_mfma_f32_16x16x32_bf16 a[8:11], a[152:155], a[132:135], a[8:11]
ds_read_b64_tr_b16 a[176:177], v166 offset:192
v_mfma_f32_16x16x32_bf16 a[4:7], a[156:159], a[128:131], a[4:7]
s_add_u32 m0, s48, 4352
ds_read_b64_tr_b16 a[178:179], v166 offset:4544
v_mfma_f32_16x16x32_bf16 a[12:15], a[156:159], a[132:135], a[12:15]
s_waitcnt lgkmcnt(5)
ds_read_b64_tr_b16 a[180:181], v166 offset:200
buffer_load_dwordx4 v168, s[8:11], s50 offen offset:0 lds
v_mfma_f32_16x16x32_bf16 a[16:19], a[160:163], a[128:131], a[16:19]
ds_read_b64_tr_b16 a[182:183], v166 offset:4552
v_mfma_f32_16x16x32_bf16 a[24:27], a[160:163], a[132:135], a[24:27]
ds_read_b64_tr_b16 a[152:153], v167 offset:0
v_mfma_f32_16x16x32_bf16 a[20:23], a[164:167], a[128:131], a[20:23]
ds_read_b64_tr_b16 a[154:155], v167 offset:4352
v_mfma_f32_16x16x32_bf16 a[28:31], a[164:167], a[132:135], a[28:31]
s_waitcnt lgkmcnt(5)
ds_read_b64_tr_b16 a[156:157], v167 offset:8
v_mfma_f32_16x16x32_bf16 a[32:35], a[168:171], a[128:131], a[32:35]
ds_read_b64_tr_b16 a[158:159], v167 offset:4360
buffer_load_dwordx4 v169, s[8:11], s50 offen offset:1088 lds
v_mfma_f32_16x16x32_bf16 a[40:43], a[168:171], a[132:135], a[40:43]
ds_read_b64_tr_b16 a[160:161], v167 offset:64
v_mfma_f32_16x16x32_bf16 a[36:39], a[172:175], a[128:131], a[36:39]
ds_read_b64_tr_b16 a[162:163], v167 offset:4416
v_mfma_f32_16x16x32_bf16 a[44:47], a[172:175], a[132:135], a[44:47]
s_waitcnt lgkmcnt(5)
ds_read_b64_tr_b16 a[164:165], v167 offset:72
v_mfma_f32_16x16x32_bf16 a[48:51], a[176:179], a[128:131], a[48:51]
ds_read_b64_tr_b16 a[166:167], v167 offset:4424
v_mfma_f32_16x16x32_bf16 a[56:59], a[176:179], a[132:135], a[56:59]
ds_read_b64_tr_b16 a[168:169], v167 offset:128
buffer_load_dwordx4 v170, s[8:11], s50 offen offset:2176 lds
v_mfma_f32_16x16x32_bf16 a[52:55], a[180:183], a[128:131], a[52:55]
ds_read_b64_tr_b16 a[170:171], v167 offset:4480
v_mfma_f32_16x16x32_bf16 a[60:63], a[180:183], a[132:135], a[60:63]
s_waitcnt lgkmcnt(5)
ds_read_b64_tr_b16 a[172:173], v167 offset:136
v_mfma_f32_16x16x32_bf16 a[64:67], a[152:155], a[128:131], a[64:67]
ds_read_b64_tr_b16 a[174:175], v167 offset:4488
v_mfma_f32_16x16x32_bf16 a[72:75], a[152:155], a[132:135], a[72:75]
ds_read_b64_tr_b16 a[176:177], v167 offset:192
v_mfma_f32_16x16x32_bf16 a[68:71], a[156:159], a[128:131], a[68:71]
ds_read_b64_tr_b16 a[178:179], v167 offset:4544
buffer_load_dwordx4 v171, s[8:11], s50 offen offset:3264 lds
v_mfma_f32_16x16x32_bf16 a[76:79], a[156:159], a[132:135], a[76:79]
s_waitcnt lgkmcnt(5)
ds_read_b64_tr_b16 a[180:181], v167 offset:200
v_mfma_f32_16x16x32_bf16 a[80:83], a[160:163], a[128:131], a[80:83]
ds_read_b64_tr_b16 a[182:183], v167 offset:4552
v_mfma_f32_16x16x32_bf16 a[88:91], a[160:163], a[132:135], a[88:91]
s_add_u32 m0, s41, 0
ds_read_b64_tr_b16 a[152:153], v164 offset:0
v_mfma_f32_16x16x32_bf16 a[84:87], a[164:167], a[128:131], a[84:87]
ds_read_b64_tr_b16 a[154:155], v164 offset:4352
buffer_load_dwordx4 v161, s[4:7], s36 offen lds
v_mfma_f32_16x16x32_bf16 a[92:95], a[164:167], a[132:135], a[92:95]
s_waitcnt lgkmcnt(5)
ds_read_b64_tr_b16 a[156:157], v164 offset:8
v_mfma_f32_16x16x32_bf16 a[96:99], a[168:171], a[128:131], a[96:99]
ds_read_b64_tr_b16 a[158:159], v164 offset:4360
v_mfma_f32_16x16x32_bf16 a[104:107], a[168:171], a[132:135], a[104:107]
ds_read_b64_tr_b16 a[160:161], v164 offset:64
v_mfma_f32_16x16x32_bf16 a[100:103], a[172:175], a[128:131], a[100:103]
s_add_u32 m0, s41, 1024
ds_read_b64_tr_b16 a[162:163], v164 offset:4416
v_mfma_f32_16x16x32_bf16 a[108:111], a[172:175], a[132:135], a[108:111]
s_waitcnt lgkmcnt(5)
buffer_load_dwordx4 v161, s[4:7], s37 offen lds
ds_read_b64_tr_b16 a[164:165], v164 offset:72
v_mfma_f32_16x16x32_bf16 a[112:115], a[176:179], a[128:131], a[112:115]
ds_read_b64_tr_b16 a[166:167], v164 offset:4424
v_mfma_f32_16x16x32_bf16 a[120:123], a[176:179], a[132:135], a[120:123]
ds_read_b64_tr_b16 a[168:169], v164 offset:128
v_mfma_f32_16x16x32_bf16 a[116:119], a[180:183], a[128:131], a[116:119]
ds_read_b64_tr_b16 a[170:171], v164 offset:4480
v_mfma_f32_16x16x32_bf16 a[124:127], a[180:183], a[132:135], a[124:127]
s_waitcnt lgkmcnt(5)
s_add_u32 m0, s41, 2048
ds_read_b64_tr_b16 a[172:173], v164 offset:136
v_mfma_f32_16x16x32_bf16 v[0:3], a[152:155], a[128:131], v[0:3]
buffer_load_dwordx4 v161, s[4:7], s38 offen lds
ds_read_b64_tr_b16 a[174:175], v164 offset:4488
v_mfma_f32_16x16x32_bf16 v[8:11], a[152:155], a[132:135], v[8:11]
s_add_u32 s49, s49, 262144
ds_read_b64_tr_b16 a[176:177], v164 offset:192
v_mfma_f32_16x16x32_bf16 v[128:131], a[152:155], a[136:139], v[128:131]
s_add_u32 s50, s50, 262144
ds_read_b64_tr_b16 a[178:179], v164 offset:4544
v_mfma_f32_16x16x32_bf16 v[4:7], a[156:159], a[128:131], v[4:7]
s_add_u32 s60, s60, 1
ds_read_b64_tr_b16 a[180:181], v164 offset:200
v_add_u32 v165, s47, v165
v_mfma_f32_16x16x32_bf16 v[12:15], a[156:159], a[132:135], v[12:15]
s_cmp_eq_u32 s60, 3
ds_read_b64_tr_b16 a[182:183], v164 offset:4552
v_add_u32 v164, s47, v164
v_mfma_f32_16x16x32_bf16 v[132:135], a[156:159], a[136:139], v[132:135]
s_waitcnt lgkmcnt(5)
s_cselect_b32 s56, 4294897728, s66
v_add_u32 v166, s47, v166
v_add_u32 v167, s47, v167
v_mfma_f32_16x16x32_bf16 v[16:19], a[160:163], a[128:131], v[16:19]
s_cselect_b32 s60, 0, s60
v_mfma_f32_16x16x32_bf16 v[24:27], a[160:163], a[132:135], v[24:27]
s_add_u32 s48, s48, s56
v_mfma_f32_16x16x32_bf16 v[136:139], a[160:163], a[136:139], v[136:139]
v_mfma_f32_16x16x32_bf16 v[20:23], a[164:167], a[128:131], v[20:23]
s_waitcnt lgkmcnt(0)
s_waitcnt vmcnt(11)
s_barrier
v_mfma_f32_16x16x32_bf16 v[28:31], a[164:167], a[132:135], v[28:31]
s_add_u32 s57, s57, 1
ds_read_b128 a[140:143], v162 offset:0
v_mfma_f32_16x16x32_bf16 v[140:143], a[164:167], a[136:139], v[140:143]
s_cmp_eq_u32 s57, 3
ds_read_b128 a[144:147], v162 offset:2048
v_mfma_f32_16x16x32_bf16 v[32:35], a[168:171], a[128:131], v[32:35]
s_cselect_b32 s47, 4294897728, s66
ds_read_b128 a[148:151], v163 offset:0
v_mfma_f32_16x16x32_bf16 v[40:43], a[168:171], a[132:135], v[40:43]
s_cselect_b32 s57, 0, s57
ds_read_b64_tr_b16 a[152:153], v165 offset:0
v_mfma_f32_16x16x32_bf16 v[144:147], a[168:171], a[136:139], v[144:147]
ds_read_b64_tr_b16 a[154:155], v165 offset:4352
v_mfma_f32_16x16x32_bf16 v[36:39], a[172:175], a[128:131], v[36:39]
ds_read_b64_tr_b16 a[156:157], v165 offset:8
v_mfma_f32_16x16x32_bf16 v[44:47], a[172:175], a[132:135], v[44:47]
ds_read_b64_tr_b16 a[158:159], v165 offset:4360
v_mfma_f32_16x16x32_bf16 v[148:151], a[172:175], a[136:139], v[148:151]
ds_read_b64_tr_b16 a[160:161], v165 offset:64
v_mfma_f32_16x16x32_bf16 v[48:51], a[176:179], a[128:131], v[48:51]
ds_read_b64_tr_b16 a[162:163], v165 offset:4416
v_mfma_f32_16x16x32_bf16 v[56:59], a[176:179], a[132:135], v[56:59]
ds_read_b64_tr_b16 a[164:165], v165 offset:72
v_mfma_f32_16x16x32_bf16 v[152:155], a[176:179], a[136:139], v[152:155]
ds_read_b64_tr_b16 a[166:167], v165 offset:4424
v_mfma_f32_16x16x32_bf16 v[52:55], a[180:183], a[128:131], v[52:55]
ds_read_b64_tr_b16 a[168:169], v165 offset:128
v_mfma_f32_16x16x32_bf16 v[60:63], a[180:183], a[132:135], v[60:63]
ds_read_b64_tr_b16 a[170:171], v165 offset:4480
v_mfma_f32_16x16x32_bf16 v[156:159], a[180:183], a[136:139], v[156:159]
ds_read_b64_tr_b16 a[172:173], v165 offset:136
s_waitcnt lgkmcnt(6)
v_mfma_f32_16x16x32_bf16 v[64:67], a[152:155], a[140:143], v[64:67]
s_add_u32 m0, s41, 3072
ds_read_b64_tr_b16 a[174:175], v165 offset:4488
v_mfma_f32_16x16x32_bf16 v[72:75], a[152:155], a[144:147], v[72:75]
ds_read_b64_tr_b16 a[176:177], v165 offset:192
buffer_load_dwordx4 v161, s[4:7], s39 offen lds
v_mfma_f32_16x16x32_bf16 v[68:71], a[156:159], a[140:143], v[68:71]
ds_read_b64_tr_b16 a[178:179], v165 offset:4544
v_mfma_f32_16x16x32_bf16 v[76:79], a[156:159], a[144:147], v[76:79]
s_waitcnt lgkmcnt(5)
ds_read_b64_tr_b16 a[180:181], v165 offset:200
v_mfma_f32_16x16x32_bf16 v[80:83], a[160:163], a[140:143], v[80:83]
ds_read_b64_tr_b16 a[182:183], v165 offset:4552
v_xor_b32 v162, 64, v162
v_mfma_f32_16x16x32_bf16 v[88:91], a[160:163], a[144:147], v[88:91]
s_mov_b32 m0, s44
ds_read_b64_tr_b16 a[152:153], v166 offset:0
v_xor_b32 v163, 64, v163
v_mfma_f32_16x16x32_bf16 v[84:87], a[164:167], a[140:143], v[84:87]
ds_read_b64_tr_b16 a[154:155], v166 offset:4352
buffer_load_dwordx4 v161, s[4:7], s40 offen lds
v_mfma_f32_16x16x32_bf16 v[92:95], a[164:167], a[144:147], v[92:95]
s_waitcnt lgkmcnt(5)
ds_read_b64_tr_b16 a[156:157], v166 offset:8
v_add_u32 v162, s74, v162
v_mfma_f32_16x16x32_bf16 v[96:99], a[168:171], a[140:143], v[96:99]
ds_read_b64_tr_b16 a[158:159], v166 offset:4360
v_add_u32 v163, s74, v163
v_mfma_f32_16x16x32_bf16 v[104:107], a[168:171], a[144:147], v[104:107]
ds_read_b64_tr_b16 a[160:161], v166 offset:64
v_mfma_f32_16x16x32_bf16 v[100:103], a[172:175], a[140:143], v[100:103]
s_add_u32 m0, s48, 0
ds_read_b64_tr_b16 a[162:163], v166 offset:4416
v_mfma_f32_16x16x32_bf16 v[108:111], a[172:175], a[144:147], v[108:111]
s_waitcnt lgkmcnt(5)
ds_read_b64_tr_b16 a[164:165], v166 offset:72
buffer_load_dwordx4 v168, s[8:11], s49 offen offset:0 lds
v_mfma_f32_16x16x32_bf16 v[112:115], a[176:179], a[140:143], v[112:115]
ds_read_b64_tr_b16 a[166:167], v166 offset:4424
v_mfma_f32_16x16x32_bf16 v[120:123], a[176:179], a[144:147], v[120:123]
ds_read_b64_tr_b16 a[168:169], v166 offset:128
v_mfma_f32_16x16x32_bf16 v[116:119], a[180:183], a[140:143], v[116:119]
ds_read_b64_tr_b16 a[170:171], v166 offset:4480
v_mfma_f32_16x16x32_bf16 v[124:127], a[180:183], a[144:147], v[124:127]
s_waitcnt lgkmcnt(5)
ds_read_b64_tr_b16 a[172:173], v166 offset:136
v_mfma_f32_16x16x32_bf16 a[0:3], a[152:155], a[140:143], a[0:3]
ds_read_b64_tr_b16 a[174:175], v166 offset:4488
buffer_load_dwordx4 v169, s[8:11], s49 offen offset:1088 lds
v_mfma_f32_16x16x32_bf16 a[8:11], a[152:155], a[144:147], a[8:11]
ds_read_b64_tr_b16 a[176:177], v166 offset:192
v_mfma_f32_16x16x32_bf16 a[4:7], a[156:159], a[140:143], a[4:7]
ds_read_b64_tr_b16 a[178:179], v166 offset:4544
v_mfma_f32_16x16x32_bf16 a[12:15], a[156:159], a[144:147], a[12:15]
s_waitcnt lgkmcnt(5)
ds_read_b64_tr_b16 a[180:181], v166 offset:200
v_mfma_f32_16x16x32_bf16 a[16:19], a[160:163], a[140:143], a[16:19]
ds_read_b64_tr_b16 a[182:183], v166 offset:4552
v_mfma_f32_16x16x32_bf16 a[24:27], a[160:163], a[144:147], a[24:27]
ds_read_b64_tr_b16 a[152:153], v167 offset:0
buffer_load_dwordx4 v170, s[8:11], s49 offen offset:2176 lds
v_mfma_f32_16x16x32_bf16 a[20:23], a[164:167], a[140:143], a[20:23]
ds_read_b64_tr_b16 a[154:155], v167 offset:4352
v_mfma_f32_16x16x32_bf16 a[28:31], a[164:167], a[144:147], a[28:31]
s_waitcnt lgkmcnt(5)
ds_read_b64_tr_b16 a[156:157], v167 offset:8
v_mfma_f32_16x16x32_bf16 a[32:35], a[168:171], a[140:143], a[32:35]
ds_read_b64_tr_b16 a[158:159], v167 offset:4360
v_mfma_f32_16x16x32_bf16 a[40:43], a[168:171], a[144:147], a[40:43]
ds_read_b64_tr_b16 a[160:161], v167 offset:64
v_mfma_f32_16x16x32_bf16 a[36:39], a[172:175], a[140:143], a[36:39]
ds_read_b64_tr_b16 a[162:163], v167 offset:4416
v_mfma_f32_16x16x32_bf16 a[44:47], a[172:175], a[144:147], a[44:47]
s_waitcnt lgkmcnt(5)
ds_read_b64_tr_b16 a[164:165], v167 offset:72
buffer_load_dwordx4 v171, s[8:11], s49 offen offset:3264 lds
v_mfma_f32_16x16x32_bf16 a[48:51], a[176:179], a[140:143], a[48:51]
ds_read_b64_tr_b16 a[166:167], v167 offset:4424
v_mfma_f32_16x16x32_bf16 a[56:59], a[176:179], a[144:147], a[56:59]
ds_read_b64_tr_b16 a[168:169], v167 offset:128
v_mfma_f32_16x16x32_bf16 a[52:55], a[180:183], a[140:143], a[52:55]
ds_read_b64_tr_b16 a[170:171], v167 offset:4480
v_mfma_f32_16x16x32_bf16 a[60:63], a[180:183], a[144:147], a[60:63]
s_waitcnt lgkmcnt(5)
s_add_u32 m0, s48, 4352
ds_read_b64_tr_b16 a[172:173], v167 offset:136
v_mfma_f32_16x16x32_bf16 a[64:67], a[152:155], a[140:143], a[64:67]
ds_read_b64_tr_b16 a[174:175], v167 offset:4488
buffer_load_dwordx4 v168, s[8:11], s50 offen offset:0 lds
v_mfma_f32_16x16x32_bf16 a[72:75], a[152:155], a[144:147], a[72:75]
ds_read_b64_tr_b16 a[176:177], v167 offset:192
v_mfma_f32_16x16x32_bf16 a[68:71], a[156:159], a[140:143], a[68:71]
ds_read_b64_tr_b16 a[178:179], v167 offset:4544
v_mfma_f32_16x16x32_bf16 a[76:79], a[156:159], a[144:147], a[76:79]
s_waitcnt lgkmcnt(5)
ds_read_b64_tr_b16 a[180:181], v167 offset:200
v_mfma_f32_16x16x32_bf16 a[80:83], a[160:163], a[140:143], a[80:83]
ds_read_b64_tr_b16 a[182:183], v167 offset:4552
v_mfma_f32_16x16x32_bf16 a[88:91], a[160:163], a[144:147], a[88:91]
ds_read_b64_tr_b16 a[152:153], v164 offset:0
buffer_load_dwordx4 v169, s[8:11], s50 offen offset:1088 lds
v_mfma_f32_16x16x32_bf16 a[84:87], a[164:167], a[140:143], a[84:87]
ds_read_b64_tr_b16 a[154:155], v164 offset:4352
v_mfma_f32_16x16x32_bf16 a[92:95], a[164:167], a[144:147], a[92:95]
s_waitcnt lgkmcnt(5)
ds_read_b64_tr_b16 a[156:157], v164 offset:8
v_mfma_f32_16x16x32_bf16 a[96:99], a[168:171], a[140:143], a[96:99]
ds_read_b64_tr_b16 a[158:159], v164 offset:4360
v_mfma_f32_16x16x32_bf16 a[104:107], a[168:171], a[144:147], a[104:107]
ds_read_b64_tr_b16 a[160:161], v164 offset:64
v_mfma_f32_16x16x32_bf16 a[100:103], a[172:175], a[140:143], a[100:103]
ds_read_b64_tr_b16 a[162:163], v164 offset:4416
buffer_load_dwordx4 v170, s[8:11], s50 offen offset:2176 lds
v_mfma_f32_16x16x32_bf16 a[108:111], a[172:175], a[144:147], a[108:111]
s_waitcnt lgkmcnt(5)
ds_read_b64_tr_b16 a[164:165], v164 offset:72
v_mfma_f32_16x16x32_bf16 a[112:115], a[176:179], a[140:143], a[112:115]
ds_read_b64_tr_b16 a[166:167], v164 offset:4424
v_mfma_f32_16x16x32_bf16 a[120:123], a[176:179], a[144:147], a[120:123]
ds_read_b64_tr_b16 a[168:169], v164 offset:128
v_mfma_f32_16x16x32_bf16 a[116:119], a[180:183], a[140:143], a[116:119]
ds_read_b64_tr_b16 a[170:171], v164 offset:4480
v_mfma_f32_16x16x32_bf16 a[124:127], a[180:183], a[144:147], a[124:127]
s_waitcnt lgkmcnt(5)
buffer_load_dwordx4 v171, s[8:11], s50 offen offset:3264 lds
ds_read_b64_tr_b16 a[172:173], v164 offset:136
v_mfma_f32_16x16x32_bf16 v[0:3], a[152:155], a[140:143], v[0:3]
s_add_u32 s49, s49, 262144
ds_read_b64_tr_b16 a[174:175], v164 offset:4488
v_mfma_f32_16x16x32_bf16 v[8:11], a[152:155], a[144:147], v[8:11]
s_add_u32 s50, s50, 262144
ds_read_b64_tr_b16 a[176:177], v164 offset:192
v_mfma_f32_16x16x32_bf16 v[128:131], a[152:155], a[148:151], v[128:131]
s_add_u32 s60, s60, 1
ds_read_b64_tr_b16 a[178:179], v164 offset:4544
v_mfma_f32_16x16x32_bf16 v[4:7], a[156:159], a[140:143], v[4:7]
s_cmp_eq_u32 s60, 3
ds_read_b64_tr_b16 a[180:181], v164 offset:200
v_add_u32 v165, s47, v165
v_mfma_f32_16x16x32_bf16 v[12:15], a[156:159], a[144:147], v[12:15]
s_cselect_b32 s56, 4294897728, s66
ds_read_b64_tr_b16 a[182:183], v164 offset:4552
v_add_u32 v164, s47, v164
v_mfma_f32_16x16x32_bf16 v[132:135], a[156:159], a[148:151], v[132:135]
s_waitcnt lgkmcnt(5)
s_cselect_b32 s60, 0, s60
v_add_u32 v166, s47, v166
v_add_u32 v167, s47, v167
v_mfma_f32_16x16x32_bf16 v[16:19], a[160:163], a[140:143], v[16:19]
s_add_u32 s48, s48, s56
v_mfma_f32_16x16x32_bf16 v[24:27], a[160:163], a[144:147], v[24:27]
s_add_u32 s36, s36, 128
v_mfma_f32_16x16x32_bf16 v[136:139], a[160:163], a[148:151], v[136:139]
s_add_u32 s37, s37, 128
v_mfma_f32_16x16x32_bf16 v[20:23], a[164:167], a[140:143], v[20:23]
s_waitcnt lgkmcnt(0)
s_waitcnt vmcnt(8)
s_barrier
v_mfma_f32_16x16x32_bf16 v[28:31], a[164:167], a[144:147], v[28:31]
s_add_u32 s38, s38, 128
ds_read_b128 a[128:131], v162 offset:0
v_mfma_f32_16x16x32_bf16 v[140:143], a[164:167], a[148:151], v[140:143]
s_add_u32 s39, s39, 128
ds_read_b128 a[132:135], v162 offset:2048
v_mfma_f32_16x16x32_bf16 v[32:35], a[168:171], a[140:143], v[32:35]
s_add_u32 s40, s40, 128
ds_read_b128 a[136:139], v163 offset:0
v_mfma_f32_16x16x32_bf16 v[40:43], a[168:171], a[144:147], v[40:43]
s_add_u32 s41, s41, s45
ds_read_b64_tr_b16 a[152:153], v165 offset:0
v_mfma_f32_16x16x32_bf16 v[144:147], a[168:171], a[148:151], v[144:147]
s_add_u32 s44, s44, s45
ds_read_b64_tr_b16 a[154:155], v165 offset:4352
v_mfma_f32_16x16x32_bf16 v[36:39], a[172:175], a[140:143], v[36:39]
s_sub_u32 s45, 0, s45
ds_read_b64_tr_b16 a[156:157], v165 offset:8
v_mfma_f32_16x16x32_bf16 v[44:47], a[172:175], a[144:147], v[44:47]
s_sub_u32 s74, 0, s74
s_add_u32 s57, s57, 1
ds_read_b64_tr_b16 a[158:159], v165 offset:4360
v_mfma_f32_16x16x32_bf16 v[148:151], a[172:175], a[148:151], v[148:151]
s_cmp_eq_u32 s57, 3
s_cselect_b32 s47, 4294897728, s66
ds_read_b64_tr_b16 a[160:161], v165 offset:64
v_mfma_f32_16x16x32_bf16 v[48:51], a[176:179], a[140:143], v[48:51]
s_cselect_b32 s57, 0, s57
ds_read_b64_tr_b16 a[162:163], v165 offset:4416
v_mfma_f32_16x16x32_bf16 v[56:59], a[176:179], a[144:147], v[56:59]
ds_read_b64_tr_b16 a[164:165], v165 offset:72
v_mfma_f32_16x16x32_bf16 v[152:155], a[176:179], a[148:151], v[152:155]
ds_read_b64_tr_b16 a[166:167], v165 offset:4424
v_mfma_f32_16x16x32_bf16 v[52:55], a[180:183], a[140:143], v[52:55]
ds_read_b64_tr_b16 a[168:169], v165 offset:128
v_mfma_f32_16x16x32_bf16 v[60:63], a[180:183], a[144:147], v[60:63]
ds_read_b64_tr_b16 a[170:171], v165 offset:4480
v_mfma_f32_16x16x32_bf16 v[156:159], a[180:183], a[148:151], v[156:159]
s_add_u32 s46, s46, 1
s_cmp_lt_u32 s46, 6
s_cbranch_scc1 L_qloop
s_lshl_b32 s49, s28, 12
s_add_u32 s50, s49, 16384
s_add_u32 s51, s49, 32768
s_add_u32 s52, s49, 49152
ds_read_b64_tr_b16 a[172:173], v165 offset:136
s_waitcnt lgkmcnt(6)
v_mfma_f32_16x16x32_bf16 v[64:67], a[152:155], a[128:131], v[64:67]
s_add_u32 m0, s63, 0
ds_read_b64_tr_b16 a[174:175], v165 offset:4488
v_mfma_f32_16x16x32_bf16 v[72:75], a[152:155], a[132:135], v[72:75]
ds_read_b64_tr_b16 a[176:177], v165 offset:192
buffer_load_dwordx4 v189, s[12:15], s49 offen offset:0 nt lds
v_mfma_f32_16x16x32_bf16 v[68:71], a[156:159], a[128:131], v[68:71]
ds_read_b64_tr_b16 a[178:179], v165 offset:4544
v_mfma_f32_16x16x32_bf16 v[76:79], a[156:159], a[132:135], v[76:79]
s_waitcnt lgkmcnt(5)
ds_read_b64_tr_b16 a[180:181], v165 offset:200
v_mfma_f32_16x16x32_bf16 v[80:83], a[160:163], a[128:131], v[80:83]
ds_read_b64_tr_b16 a[182:183], v165 offset:4552
v_xor_b32 v162, 64, v162
v_mfma_f32_16x16x32_bf16 v[88:91], a[160:163], a[132:135], v[88:91]
ds_read_b64_tr_b16 a[152:153], v166 offset:0
v_xor_b32 v163, 64, v163
v_mfma_f32_16x16x32_bf16 v[84:87], a[164:167], a[128:131], v[84:87]
ds_read_b64_tr_b16 a[154:155], v166 offset:4352
v_mfma_f32_16x16x32_bf16 v[92:95], a[164:167], a[132:135], v[92:95]
s_waitcnt lgkmcnt(5)
s_add_u32 m0, s63, 32
ds_read_b64_tr_b16 a[156:157], v166 offset:8
v_mfma_f32_16x16x32_bf16 v[96:99], a[168:171], a[128:131], v[96:99]
ds_read_b64_tr_b16 a[158:159], v166 offset:4360
buffer_load_dwordx4 v189, s[12:15], s49 offen offset:1024 nt lds
v_mfma_f32_16x16x32_bf16 v[104:107], a[168:171], a[132:135], v[104:107]
ds_read_b64_tr_b16 a[160:161], v166 offset:64
v_mfma_f32_16x16x32_bf16 v[100:103], a[172:175], a[128:131], v[100:103]
ds_read_b64_tr_b16 a[162:163], v166 offset:4416
v_mfma_f32_16x16x32_bf16 v[108:111], a[172:175], a[132:135], v[108:111]
s_waitcnt lgkmcnt(5)
ds_read_b64_tr_b16 a[164:165], v166 offset:72
v_mfma_f32_16x16x32_bf16 v[112:115], a[176:179], a[128:131], v[112:115]
ds_read_b64_tr_b16 a[166:167], v166 offset:4424
v_mfma_f32_16x16x32_bf16 v[120:123], a[176:179], a[132:135], v[120:123]
ds_read_b64_tr_b16 a[168:169], v166 offset:128
v_mfma_f32_16x16x32_bf16 v[116:119], a[180:183], a[128:131], v[116:119]
s_add_u32 m0, s63, 64
ds_read_b64_tr_b16 a[170:171], v166 offset:4480
v_mfma_f32_16x16x32_bf16 v[124:127], a[180:183], a[132:135], v[124:127]
s_waitcnt lgkmcnt(5)
ds_read_b64_tr_b16 a[172:173], v166 offset:136
buffer_load_dwordx4 v189, s[12:15], s49 offen offset:2048 nt lds
v_mfma_f32_16x16x32_bf16 a[0:3], a[152:155], a[128:131], a[0:3]
ds_read_b64_tr_b16 a[174:175], v166 offset:4488
v_mfma_f32_16x16x32_bf16 a[8:11], a[152:155], a[132:135], a[8:11]
ds_read_b64_tr_b16 a[176:177], v166 offset:192
v_mfma_f32_16x16x32_bf16 a[4:7], a[156:159], a[128:131], a[4:7]
ds_read_b64_tr_b16 a[178:179], v166 offset:4544
v_mfma_f32_16x16x32_bf16 a[12:15], a[156:159], a[132:135], a[12:15]
s_waitcnt lgkmcnt(5)
ds_read_b64_tr_b16 a[180:181], v166 offset:200
v_mfma_f32_16x16x32_bf16 a[16:19], a[160:163], a[128:131], a[16:19]
ds_read_b64_tr_b16 a[182:183], v166 offset:4552
v_mfma_f32_16x16x32_bf16 a[24:27], a[160:163], a[132:135], a[24:27]
s_add_u32 m0, s63, 96
ds_read_b64_tr_b16 a[152:153], v167 offset:0
v_mfma_f32_16x16x32_bf16 a[20:23], a[164:167], a[128:131], a[20:23]
ds_read_b64_tr_b16 a[154:155], v167 offset:4352
buffer_load_dwordx4 v189, s[12:15], s49 offen offset:3072 nt lds
v_mfma_f32_16x16x32_bf16 a[28:31], a[164:167], a[132:135], a[28:31]
s_waitcnt lgkmcnt(5)
ds_read_b64_tr_b16 a[156:157], v167 offset:8
v_mfma_f32_16x16x32_bf16 a[32:35], a[168:171], a[128:131], a[32:35]
ds_read_b64_tr_b16 a[158:159], v167 offset:4360
v_mfma_f32_16x16x32_bf16 a[40:43], a[168:171], a[132:135], a[40:43]
ds_read_b64_tr_b16 a[160:161], v167 offset:64
v_mfma_f32_16x16x32_bf16 a[36:39], a[172:175], a[128:131], a[36:39]
ds_read_b64_tr_b16 a[162:163], v167 offset:4416
v_mfma_f32_16x16x32_bf16 a[44:47], a[172:175], a[132:135], a[44:47]
s_waitcnt lgkmcnt(5)
ds_read_b64_tr_b16 a[164:165], v167 offset:72
v_mfma_f32_16x16x32_bf16 a[48:51], a[176:179], a[128:131], a[48:51]
s_add_u32 m0, s63, 16896
ds_read_b64_tr_b16 a[166:167], v167 offset:4424
v_mfma_f32_16x16x32_bf16 a[56:59], a[176:179], a[132:135], a[56:59]
ds_read_b64_tr_b16 a[168:169], v167 offset:128
buffer_load_dwordx4 v189, s[12:15], s50 offen offset:0 nt lds
v_mfma_f32_16x16x32_bf16 a[52:55], a[180:183], a[128:131], a[52:55]
ds_read_b64_tr_b16 a[170:171], v167 offset:4480
v_mfma_f32_16x16x32_bf16 a[60:63], a[180:183], a[132:135], a[60:63]
s_waitcnt lgkmcnt(5)
ds_read_b64_tr_b16 a[172:173], v167 offset:136
v_mfma_f32_16x16x32_bf16 a[64:67], a[152:155], a[128:131], a[64:67]
ds_read_b64_tr_b16 a[174:175], v167 offset:4488
v_mfma_f32_16x16x32_bf16 a[72:75], a[152:155], a[132:135], a[72:75]
ds_read_b64_tr_b16 a[176:177], v167 offset:192
v_mfma_f32_16x16x32_bf16 a[68:71], a[156:159], a[128:131], a[68:71]
ds_read_b64_tr_b16 a[178:179], v167 offset:4544
v_mfma_f32_16x16x32_bf16 a[76:79], a[156:159], a[132:135], a[76:79]
s_waitcnt lgkmcnt(5)
s_add_u32 m0, s63, 16928
ds_read_b64_tr_b16 a[180:181], v167 offset:200
v_mfma_f32_16x16x32_bf16 a[80:83], a[160:163], a[128:131], a[80:83]
ds_read_b64_tr_b16 a[182:183], v167 offset:4552
buffer_load_dwordx4 v189, s[12:15], s50 offen offset:1024 nt lds
v_mfma_f32_16x16x32_bf16 a[88:91], a[160:163], a[132:135], a[88:91]
ds_read_b64_tr_b16 a[152:153], v164 offset:0
v_mfma_f32_16x16x32_bf16 a[84:87], a[164:167], a[128:131], a[84:87]
ds_read_b64_tr_b16 a[154:155], v164 offset:4352
v_mfma_f32_16x16x32_bf16 a[92:95], a[164:167], a[132:135], a[92:95]
s_waitcnt lgkmcnt(5)
ds_read_b64_tr_b16 a[156:157], v164 offset:8
v_mfma_f32_16x16x32_bf16 a[96:99], a[168:171], a[128:131], a[96:99]
ds_read_b64_tr_b16 a[158:159], v164 offset:4360
v_mfma_f32_16x16x32_bf16 a[104:107], a[168:171], a[132:135], a[104:107]
ds_read_b64_tr_b16 a[160:161], v164 offset:64
v_mfma_f32_16x16x32_bf16 a[100:103], a[172:175], a[128:131], a[100:103]
s_add_u32 m0, s63, 16960
ds_read_b64_tr_b16 a[162:163], v164 offset:4416
v_mfma_f32_16x16x32_bf16 a[108:111], a[172:175], a[132:135], a[108:111]
s_waitcnt lgkmcnt(5)
buffer_load_dwordx4 v189, s[12:15], s50 offen offset:2048 nt lds
ds_read_b64_tr_b16 a[164:165], v164 offset:72
v_mfma_f32_16x16x32_bf16 a[112:115], a[176:179], a[128:131], a[112:115]
ds_read_b64_tr_b16 a[166:167], v164 offset:4424
v_mfma_f32_16x16x32_bf16 a[120:123], a[176:179], a[132:135], a[120:123]
ds_read_b64_tr_b16 a[168:169], v164 offset:128
v_mfma_f32_16x16x32_bf16 a[116:119], a[180:183], a[128:131], a[116:119]
ds_read_b64_tr_b16 a[170:171], v164 offset:4480
v_mfma_f32_16x16x32_bf16 a[124:127], a[180:183], a[132:135], a[124:127]
s_waitcnt lgkmcnt(5)
ds_read_b64_tr_b16 a[172:173], v164 offset:136
v_mfma_f32_16x16x32_bf16 v[0:3], a[152:155], a[128:131], v[0:3]
ds_read_b64_tr_b16 a[174:175], v164 offset:4488
v_mfma_f32_16x16x32_bf16 v[8:11], a[152:155], a[132:135], v[8:11]
s_add_u32 m0, s63, 16992
ds_read_b64_tr_b16 a[176:177], v164 offset:192
v_mfma_f32_16x16x32_bf16 v[128:131], a[152:155], a[136:139], v[128:131]
buffer_load_dwordx4 v189, s[12:15], s50 offen offset:3072 nt lds
ds_read_b64_tr_b16 a[178:179], v164 offset:4544
v_mfma_f32_16x16x32_bf16 v[4:7], a[156:159], a[128:131], v[4:7]
ds_read_b64_tr_b16 a[180:181], v164 offset:200
v_add_u32 v165, s47, v165
v_mfma_f32_16x16x32_bf16 v[12:15], a[156:159], a[132:135], v[12:15]
ds_read_b64_tr_b16 a[182:183], v164 offset:4552
v_add_u32 v164, s47, v164
v_mfma_f32_16x16x32_bf16 v[132:135], a[156:159], a[136:139], v[132:135]
s_waitcnt lgkmcnt(5)
v_add_u32 v166, s47, v166
v_add_u32 v167, s47, v167
v_mfma_f32_16x16x32_bf16 v[16:19], a[160:163], a[128:131], v[16:19]
v_mfma_f32_16x16x32_bf16 v[24:27], a[160:163], a[132:135], v[24:27]
v_mfma_f32_16x16x32_bf16 v[136:139], a[160:163], a[136:139], v[136:139]
v_mfma_f32_16x16x32_bf16 v[20:23], a[164:167], a[128:131], v[20:23]
s_waitcnt lgkmcnt(0)
s_waitcnt vmcnt(8)
s_barrier
v_mfma_f32_16x16x32_bf16 v[28:31], a[164:167], a[132:135], v[28:31]
s_add_u32 s57, s57, 1
ds_read_b128 a[140:143], v162 offset:0
v_mfma_f32_16x16x32_bf16 v[140:143], a[164:167], a[136:139], v[140:143]
s_cmp_eq_u32 s57, 3
ds_read_b128 a[144:147], v162 offset:2048
v_mfma_f32_16x16x32_bf16 v[32:35], a[168:171], a[128:131], v[32:35]
s_cselect_b32 s47, 4294897728, s66
ds_read_b128 a[148:151], v163 offset:0
v_mfma_f32_16x16x32_bf16 v[40:43], a[168:171], a[132:135], v[40:43]
s_cselect_b32 s57, 0, s57
ds_read_b64_tr_b16 a[152:153], v165 offset:0
v_mfma_f32_16x16x32_bf16 v[144:147], a[168:171], a[136:139], v[144:147]
ds_read_b64_tr_b16 a[154:155], v165 offset:4352
v_mfma_f32_16x16x32_bf16 v[36:39], a[172:175], a[128:131], v[36:39]
ds_read_b64_tr_b16 a[156:157], v165 offset:8
v_mfma_f32_16x16x32_bf16 v[44:47], a[172:175], a[132:135], v[44:47]
ds_read_b64_tr_b16 a[158:159], v165 offset:4360
v_mfma_f32_16x16x32_bf16 v[148:151], a[172:175], a[136:139], v[148:151]
ds_read_b64_tr_b16 a[160:161], v165 offset:64
v_mfma_f32_16x16x32_bf16 v[48:51], a[176:179], a[128:131], v[48:51]
ds_read_b64_tr_b16 a[162:163], v165 offset:4416
v_mfma_f32_16x16x32_bf16 v[56:59], a[176:179], a[132:135], v[56:59]
ds_read_b64_tr_b16 a[164:165], v165 offset:72
v_mfma_f32_16x16x32_bf16 v[152:155], a[176:179], a[136:139], v[152:155]
ds_read_b64_tr_b16 a[166:167], v165 offset:4424
v_mfma_f32_16x16x32_bf16 v[52:55], a[180:183], a[128:131], v[52:55]
ds_read_b64_tr_b16 a[168:169], v165 offset:128
v_mfma_f32_16x16x32_bf16 v[60:63], a[180:183], a[132:135], v[60:63]
ds_read_b64_tr_b16 a[170:171], v165 offset:4480
v_mfma_f32_16x16x32_bf16 v[156:159], a[180:183], a[136:139], v[156:159]
ds_read_b64_tr_b16 a[172:173], v165 offset:136
s_waitcnt lgkmcnt(6)
v_mfma_f32_16x16x32_bf16 v[64:67], a[152:155], a[140:143], v[64:67]
s_add_u32 m0, s63, 4294837248
ds_read_b64_tr_b16 a[174:175], v165 offset:4488
v_mfma_f32_16x16x32_bf16 v[72:75], a[152:155], a[144:147], v[72:75]
ds_read_b64_tr_b16 a[176:177], v165 offset:192
buffer_load_dwordx4 v189, s[12:15], s51 offen offset:0 nt lds
v_mfma_f32_16x16x32_bf16 v[68:71], a[156:159], a[140:143], v[68:71]
ds_read_b64_tr_b16 a[178:179], v165 offset:4544
v_mfma_f32_16x16x32_bf16 v[76:79], a[156:159], a[144:147], v[76:79]
s_waitcnt lgkmcnt(5)
ds_read_b64_tr_b16 a[180:181], v165 offset:200
v_mfma_f32_16x16x32_bf16 v[80:83], a[160:163], a[140:143], v[80:83]
ds_read_b64_tr_b16 a[182:183], v165 offset:4552
v_mfma_f32_16x16x32_bf16 v[88:91], a[160:163], a[144:147], v[88:91]
ds_read_b64_tr_b16 a[152:153], v166 offset:0
v_mfma_f32_16x16x32_bf16 v[84:87], a[164:167], a[140:143], v[84:87]
ds_read_b64_tr_b16 a[154:155], v166 offset:4352
v_mfma_f32_16x16x32_bf16 v[92:95], a[164:167], a[144:147], v[92:95]
s_waitcnt lgkmcnt(5)
ds_read_b64_tr_b16 a[156:157], v166 offset:8
v_mfma_f32_16x16x32_bf16 v[96:99], a[168:171], a[140:143], v[96:99]
s_add_u32 m0, s63, 4294837280
ds_read_b64_tr_b16 a[158:159], v166 offset:4360
v_mfma_f32_16x16x32_bf16 v[104:107], a[168:171], a[144:147], v[104:107]
ds_read_b64_tr_b16 a[160:161], v166 offset:64
buffer_load_dwordx4 v189, s[12:15], s51 offen offset:1024 nt lds
v_mfma_f32_16x16x32_bf16 v[100:103], a[172:175], a[140:143], v[100:103]
ds_read_b64_tr_b16 a[162:163], v166 offset:4416
v_mfma_f32_16x16x32_bf16 v[108:111], a[172:175], a[144:147], v[108:111]
s_waitcnt lgkmcnt(5)
ds_read_b64_tr_b16 a[164:165], v166 offset:72
v_mfma_f32_16x16x32_bf16 v[112:115], a[176:179], a[140:143], v[112:115]
ds_read_b64_tr_b16 a[166:167], v166 offset:4424
v_mfma_f32_16x16x32_bf16 v[120:123], a[176:179], a[144:147], v[120:123]
ds_read_b64_tr_b16 a[168:169], v166 offset:128
v_mfma_f32_16x16x32_bf16 v[116:119], a[180:183], a[140:143], v[116:119]
ds_read_b64_tr_b16 a[170:171], v166 offset:4480
v_mfma_f32_16x16x32_bf16 v[124:127], a[180:183], a[144:147], v[124:127]
s_waitcnt lgkmcnt(5)
ds_read_b64_tr_b16 a[172:173], v166 offset:136
v_mfma_f32_16x16x32_bf16 a[0:3], a[152:155], a[140:143], a[0:3]
s_add_u32 m0, s63, 4294837312
ds_read_b64_tr_b16 a[174:175], v166 offset:4488
v_mfma_f32_16x16x32_bf16 a[8:11], a[152:155], a[144:147], a[8:11]
ds_read_b64_tr_b16 a[176:177], v166 offset:192
buffer_load_dwordx4 v189, s[12:15], s51 offen offset:2048 nt lds
v_mfma_f32_16x16x32_bf16 a[4:7], a[156:159], a[140:143], a[4:7]
ds_read_b64_tr_b16 a[178:179], v166 offset:4544
v_mfma_f32_16x16x32_bf16 a[12:15], a[156:159], a[144:147], a[12:15]
s_waitcnt lgkmcnt(5)
ds_read_b64_tr_b16 a[180:181], v166 offset:200
v_mfma_f32_16x16x32_bf16 a[16:19], a[160:163], a[140:143], a[16:19]
ds_read_b64_tr_b16 a[182:183], v166 offset:4552
v_mfma_f32_16x16x32_bf16 a[24:27], a[160:163], a[144:147], a[24:27]
ds_read_b64_tr_b16 a[152:153], v167 offset:0
v_mfma_f32_16x16x32_bf16 a[20:23], a[164:167], a[140:143], a[20:23]
ds_read_b64_tr_b16 a[154:155], v167 offset:4352
v_mfma_f32_16x16x32_bf16 a[28:31], a[164:167], a[144:147], a[28:31]
s_waitcnt lgkmcnt(5)
ds_read_b64_tr_b16 a[156:157], v167 offset:8
v_mfma_f32_16x16x32_bf16 a[32:35], a[168:171], a[140:143], a[32:35]
s_add_u32 m0, s63, 4294837344
ds_read_b64_tr_b16 a[158:159], v167 offset:4360
v_mfma_f32_16x16x32_bf16 a[40:43], a[168:171], a[144:147], a[40:43]
ds_read_b64_tr_b16 a[160:161], v167 offset:64
buffer_load_dwordx4 v189, s[12:15], s51 offen offset:3072 nt lds
v_mfma_f32_16x16x32_bf16 a[36:39], a[172:175], a[140:143], a[36:39]
ds_read_b64_tr_b16 a[162:163], v167 offset:4416
v_mfma_f32_16x16x32_bf16 a[44:47], a[172:175], a[144:147], a[44:47]
s_waitcnt lgkmcnt(5)
ds_read_b64_tr_b16 a[164:165], v167 offset:72
v_mfma_f32_16x16x32_bf16 a[48:51], a[176:179], a[140:143], a[48:51]
ds_read_b64_tr_b16 a[166:167], v167 offset:4424
v_mfma_f32_16x16x32_bf16 a[56:59], a[176:179], a[144:147], a[56:59]
ds_read_b64_tr_b16 a[168:169], v167 offset:128
v_mfma_f32_16x16x32_bf16 a[52:55], a[180:183], a[140:143], a[52:55]
ds_read_b64_tr_b16 a[170:171], v167 offset:4480
v_mfma_f32_16x16x32_bf16 a[60:63], a[180:183], a[144:147], a[60:63]
s_waitcnt lgkmcnt(5)
ds_read_b64_tr_b16 a[172:173], v167 offset:136
v_mfma_f32_16x16x32_bf16 a[64:67], a[152:155], a[140:143], a[64:67]
s_add_u32 m0, s63, 4294854144
ds_read_b64_tr_b16 a[174:175], v167 offset:4488
v_mfma_f32_16x16x32_bf16 a[72:75], a[152:155], a[144:147], a[72:75]
ds_read_b64_tr_b16 a[176:177], v167 offset:192
buffer_load_dwordx4 v189, s[12:15], s52 offen offset:0 nt lds
v_mfma_f32_16x16x32_bf16 a[68:71], a[156:159], a[140:143], a[68:71]
ds_read_b64_tr_b16 a[178:179], v167 offset:4544
v_mfma_f32_16x16x32_bf16 a[76:79], a[156:159], a[144:147], a[76:79]
s_waitcnt lgkmcnt(5)
ds_read_b64_tr_b16 a[180:181], v167 offset:200
v_mfma_f32_16x16x32_bf16 a[80:83], a[160:163], a[140:143], a[80:83]
ds_read_b64_tr_b16 a[182:183], v167 offset:4552
v_mfma_f32_16x16x32_bf16 a[88:91], a[160:163], a[144:147], a[88:91]
ds_read_b64_tr_b16 a[152:153], v164 offset:0
v_mfma_f32_16x16x32_bf16 a[84:87], a[164:167], a[140:143], a[84:87]
ds_read_b64_tr_b16 a[154:155], v164 offset:4352
v_mfma_f32_16x16x32_bf16 a[92:95], a[164:167], a[144:147], a[92:95]
s_waitcnt lgkmcnt(5)
ds_read_b64_tr_b16 a[156:157], v164 offset:8
v_mfma_f32_16x16x32_bf16 a[96:99], a[168:171], a[140:143], a[96:99]
s_add_u32 m0, s63, 4294854176
ds_read_b64_tr_b16 a[158:159], v164 offset:4360
v_mfma_f32_16x16x32_bf16 a[104:107], a[168:171], a[144:147], a[104:107]
buffer_load_dwordx4 v189, s[12:15], s52 offen offset:1024 nt lds
ds_read_b64_tr_b16 a[160:161], v164 offset:64
v_mfma_f32_16x16x32_bf16 a[100:103], a[172:175], a[140:143], a[100:103]
ds_read_b64_tr_b16 a[162:163], v164 offset:4416
v_mfma_f32_16x16x32_bf16 a[108:111], a[172:175], a[144:147], a[108:111]
s_waitcnt lgkmcnt(5)
ds_read_b64_tr_b16 a[164:165], v164 offset:72
v_mfma_f32_16x16x32_bf16 a[112:115], a[176:179], a[140:143], a[112:115]
ds_read_b64_tr_b16 a[166:167], v164 offset:4424
v_mfma_f32_16x16x32_bf16 a[120:123], a[176:179], a[144:147], a[120:123]
ds_read_b64_tr_b16 a[168:169], v164 offset:128
v_mfma_f32_16x16x32_bf16 a[116:119], a[180:183], a[140:143], a[116:119]
ds_read_b64_tr_b16 a[170:171], v164 offset:4480
v_mfma_f32_16x16x32_bf16 a[124:127], a[180:183], a[144:147], a[124:127]
s_waitcnt lgkmcnt(5)
ds_read_b64_tr_b16 a[172:173], v164 offset:136
v_mfma_f32_16x16x32_bf16 v[0:3], a[152:155], a[140:143], v[0:3]
s_add_u32 m0, s63, 4294854208
ds_read_b64_tr_b16 a[174:175], v164 offset:4488
v_mfma_f32_16x16x32_bf16 v[8:11], a[152:155], a[144:147], v[8:11]
buffer_load_dwordx4 v189, s[12:15], s52 offen offset:2048 nt lds
ds_read_b64_tr_b16 a[176:177], v164 offset:192
v_mfma_f32_16x16x32_bf16 v[128:131], a[152:155], a[148:151], v[128:131]
ds_read_b64_tr_b16 a[178:179], v164 offset:4544
v_mfma_f32_16x16x32_bf16 v[4:7], a[156:159], a[140:143], v[4:7]
ds_read_b64_tr_b16 a[180:181], v164 offset:200
v_mfma_f32_16x16x32_bf16 v[12:15], a[156:159], a[144:147], v[12:15]
ds_read_b64_tr_b16 a[182:183], v164 offset:4552
v_mfma_f32_16x16x32_bf16 v[132:135], a[156:159], a[148:151], v[132:135]
s_waitcnt lgkmcnt(5)
v_mfma_f32_16x16x32_bf16 v[16:19], a[160:163], a[140:143], v[16:19]
v_mfma_f32_16x16x32_bf16 v[24:27], a[160:163], a[144:147], v[24:27]
v_mfma_f32_16x16x32_bf16 v[136:139], a[160:163], a[148:151], v[136:139]
s_add_u32 m0, s63, 4294854240
v_mfma_f32_16x16x32_bf16 v[20:23], a[164:167], a[140:143], v[20:23]
buffer_load_dwordx4 v189, s[12:15], s52 offen offset:3072 nt lds
v_mfma_f32_16x16x32_bf16 v[28:31], a[164:167], a[144:147], v[28:31]
v_mfma_f32_16x16x32_bf16 v[140:143], a[164:167], a[148:151], v[140:143]
v_mfma_f32_16x16x32_bf16 v[32:35], a[168:171], a[140:143], v[32:35]
v_mfma_f32_16x16x32_bf16 v[40:43], a[168:171], a[144:147], v[40:43]
v_mfma_f32_16x16x32_bf16 v[144:147], a[168:171], a[148:151], v[144:147]
s_waitcnt lgkmcnt(0)
v_mfma_f32_16x16x32_bf16 v[36:39], a[172:175], a[140:143], v[36:39]
v_mfma_f32_16x16x32_bf16 v[44:47], a[172:175], a[144:147], v[44:47]
v_mfma_f32_16x16x32_bf16 v[148:151], a[172:175], a[148:151], v[148:151]
v_mfma_f32_16x16x32_bf16 v[48:51], a[176:179], a[140:143], v[48:51]
v_mfma_f32_16x16x32_bf16 v[56:59], a[176:179], a[144:147], v[56:59]
v_mfma_f32_16x16x32_bf16 v[152:155], a[176:179], a[148:151], v[152:155]
v_mfma_f32_16x16x32_bf16 v[52:55], a[180:183], a[140:143], v[52:55]
v_mfma_f32_16x16x32_bf16 v[60:63], a[180:183], a[144:147], v[60:63]
v_mfma_f32_16x16x32_bf16 v[156:159], a[180:183], a[148:151], v[156:159]
s_waitcnt lgkmcnt(0)
s_barrier
s_cmp_eq_u32 s28, 0
s_cbranch_scc0 L_nononce2
v_readfirstlane_b32 s35, v174
s_cmp_eq_u32 s35, 0
s_cselect_b32 s35, s75, s35
v_mov_b32 v174, s35
v_mov_b32 v175, 124928
ds_write_b32 v175, v174
L_nononce2:
s_add_u32 s58, s63, 4294837248
s_add_u32 s59, s64, 4294931040
s_mov_b32 s45, s64
v_lshlrev_b32 v240, 4, v250
s_lshl_b32 s56, s28, 12
s_add_u32 s56, s56, 104448
v_add_u32 v240, s56, v240
s_add_u32 m0, s64, 0
v_pk_mul_f32 v[128:129], v[128:129], s[54:55]
buffer_load_dwordx4 v189, s[16:19], s49 offen offset:0 nt lds
v_pk_mul_f32 v[130:131], v[130:131], s[54:55]
v_cvt_pk_bf16_f32 v128, v128, v129
v_cvt_pk_bf16_f32 v129, v130, v131
ds_write_b64 v240, v[128:129] offset:0
v_pk_mul_f32 v[132:133], v[132:133], s[54:55]
v_pk_mul_f32 v[134:135], v[134:135], s[54:55]
v_cvt_pk_bf16_f32 v132, v132, v133
v_cvt_pk_bf16_f32 v133, v134, v135
ds_write_b64 v240, v[132:133] offset:8
v_pk_mul_f32 v[136:137], v[136:137], s[54:55]
v_pk_mul_f32 v[138:139], v[138:139], s[54:55]
v_cvt_pk_bf16_f32 v136, v136, v137
v_cvt_pk_bf16_f32 v137, v138, v139
ds_write_b64 v240, v[136:137] offset:1024
v_pk_mul_f32 v[140:141], v[140:141], s[54:55]
v_pk_mul_f32 v[142:143], v[142:143], s[54:55]
v_cvt_pk_bf16_f32 v140, v140, v141
v_cvt_pk_bf16_f32 v141, v142, v143
ds_write_b64 v240, v[140:141] offset:1032
v_pk_mul_f32 v[144:145], v[144:145], s[54:55]
v_pk_mul_f32 v[146:147], v[146:147], s[54:55]
v_cvt_pk_bf16_f32 v144, v144, v145
v_cvt_pk_bf16_f32 v145, v146, v147
ds_write_b64 v240, v[144:145] offset:2048
v_pk_mul_f32 v[148:149], v[148:149], s[54:55]
v_pk_mul_f32 v[150:151], v[150:151], s[54:55]
v_cvt_pk_bf16_f32 v148, v148, v149
v_cvt_pk_bf16_f32 v149, v150, v151
ds_write_b64 v240, v[148:149] offset:2056
v_pk_mul_f32 v[152:153], v[152:153], s[54:55]
v_pk_mul_f32 v[154:155], v[154:155], s[54:55]
v_cvt_pk_bf16_f32 v152, v152, v153
v_cvt_pk_bf16_f32 v153, v154, v155
ds_write_b64 v240, v[152:153] offset:3072
v_pk_mul_f32 v[156:157], v[156:157], s[54:55]
v_pk_mul_f32 v[158:159], v[158:159], s[54:55]
v_cvt_pk_bf16_f32 v156, v156, v157
v_cvt_pk_bf16_f32 v157, v158, v159
ds_write_b64 v240, v[156:157] offset:3080
v_pk_mul_f32 v[0:1], v[0:1], s[54:55]
v_pk_mul_f32 v[2:3], v[2:3], s[54:55]
v_pk_mul_f32 v[4:5], v[4:5], s[54:55]
v_pk_mul_f32 v[6:7], v[6:7], s[54:55]
v_cvt_pk_bf16_f32 v0, v0, v1
v_cvt_pk_bf16_f32 v1, v2, v3
v_cvt_pk_bf16_f32 v2, v4, v5
v_cvt_pk_bf16_f32 v3, v6, v7
v_pk_mul_f32 v[8:9], v[8:9], s[54:55]
v_pk_mul_f32 v[10:11], v[10:11], s[54:55]
v_pk_mul_f32 v[12:13], v[12:13], s[54:55]
v_pk_mul_f32 v[14:15], v[14:15], s[54:55]
v_cvt_pk_bf16_f32 v4, v8, v9
v_cvt_pk_bf16_f32 v5, v10, v11
v_cvt_pk_bf16_f32 v6, v12, v13
v_cvt_pk_bf16_f32 v7, v14, v15
v_pk_mul_f32 v[16:17], v[16:17], s[54:55]
v_pk_mul_f32 v[18:19], v[18:19], s[54:55]
v_pk_mul_f32 v[20:21], v[20:21], s[54:55]
v_pk_mul_f32 v[22:23], v[22:23], s[54:55]
v_cvt_pk_bf16_f32 v8, v16, v17
v_cvt_pk_bf16_f32 v9, v18, v19
v_cvt_pk_bf16_f32 v10, v20, v21
v_cvt_pk_bf16_f32 v11, v22, v23
v_pk_mul_f32 v[24:25], v[24:25], s[54:55]
v_pk_mul_f32 v[26:27], v[26:27], s[54:55]
v_pk_mul_f32 v[28:29], v[28:29], s[54:55]
v_pk_mul_f32 v[30:31], v[30:31], s[54:55]
v_cvt_pk_bf16_f32 v12, v24, v25
v_cvt_pk_bf16_f32 v13, v26, v27
v_cvt_pk_bf16_f32 v14, v28, v29
v_cvt_pk_bf16_f32 v15, v30, v31
v_pk_mul_f32 v[32:33], v[32:33], s[54:55]
v_pk_mul_f32 v[34:35], v[34:35], s[54:55]
v_pk_mul_f32 v[36:37], v[36:37], s[54:55]
v_pk_mul_f32 v[38:39], v[38:39], s[54:55]
v_cvt_pk_bf16_f32 v16, v32, v33
v_cvt_pk_bf16_f32 v17, v34, v35
v_cvt_pk_bf16_f32 v18, v36, v37
v_cvt_pk_bf16_f32 v19, v38, v39
v_pk_mul_f32 v[40:41], v[40:41], s[54:55]
v_pk_mul_f32 v[42:43], v[42:43], s[54:55]
v_pk_mul_f32 v[44:45], v[44:45], s[54:55]
v_pk_mul_f32 v[46:47], v[46:47], s[54:55]
s_add_u32 m0, s64, 32
v_cvt_pk_bf16_f32 v20, v40, v41
buffer_load_dwordx4 v189, s[16:19], s49 offen offset:1024 nt lds
v_cvt_pk_bf16_f32 v21, v42, v43
v_cvt_pk_bf16_f32 v22, v44, v45
v_cvt_pk_bf16_f32 v23, v46, v47
v_pk_mul_f32 v[48:49], v[48:49], s[54:55]
v_pk_mul_f32 v[50:51], v[50:51], s[54:55]
v_pk_mul_f32 v[52:53], v[52:53], s[54:55]
v_pk_mul_f32 v[54:55], v[54:55], s[54:55]
v_cvt_pk_bf16_f32 v24, v48, v49
v_cvt_pk_bf16_f32 v25, v50, v51
v_cvt_pk_bf16_f32 v26, v52, v53
v_cvt_pk_bf16_f32 v27, v54, v55
v_pk_mul_f32 v[56:57], v[56:57], s[54:55]
v_pk_mul_f32 v[58:59], v[58:59], s[54:55]
v_pk_mul_f32 v[60:61], v[60:61], s[54:55]
v_pk_mul_f32 v[62:63], v[62:63], s[54:55]
v_cvt_pk_bf16_f32 v28, v56, v57
v_cvt_pk_bf16_f32 v29, v58, v59
v_cvt_pk_bf16_f32 v30, v60, v61
v_cvt_pk_bf16_f32 v31, v62, v63
v_pk_mul_f32 v[64:65], v[64:65], s[54:55]
v_pk_mul_f32 v[66:67], v[66:67], s[54:55]
v_pk_mul_f32 v[68:69], v[68:69], s[54:55]
v_pk_mul_f32 v[70:71], v[70:71], s[54:55]
v_cvt_pk_bf16_f32 v32, v64, v65
v_cvt_pk_bf16_f32 v33, v66, v67
v_cvt_pk_bf16_f32 v34, v68, v69
v_cvt_pk_bf16_f32 v35, v70, v71
v_pk_mul_f32 v[72:73], v[72:73], s[54:55]
v_pk_mul_f32 v[74:75], v[74:75], s[54:55]
v_pk_mul_f32 v[76:77], v[76:77], s[54:55]
v_pk_mul_f32 v[78:79], v[78:79], s[54:55]
v_cvt_pk_bf16_f32 v36, v72, v73
v_cvt_pk_bf16_f32 v37, v74, v75
v_cvt_pk_bf16_f32 v38, v76, v77
v_cvt_pk_bf16_f32 v39, v78, v79
v_pk_mul_f32 v[80:81], v[80:81], s[54:55]
v_pk_mul_f32 v[82:83], v[82:83], s[54:55]
v_pk_mul_f32 v[84:85], v[84:85], s[54:55]
v_pk_mul_f32 v[86:87], v[86:87], s[54:55]
v_cvt_pk_bf16_f32 v40, v80, v81
v_cvt_pk_bf16_f32 v41, v82, v83
v_cvt_pk_bf16_f32 v42, v84, v85
v_cvt_pk_bf16_f32 v43, v86, v87
v_pk_mul_f32 v[88:89], v[88:89], s[54:55]
v_pk_mul_f32 v[90:91], v[90:91], s[54:55]
v_pk_mul_f32 v[92:93], v[92:93], s[54:55]
v_pk_mul_f32 v[94:95], v[94:95], s[54:55]
v_cvt_pk_bf16_f32 v44, v88, v89
v_cvt_pk_bf16_f32 v45, v90, v91
v_cvt_pk_bf16_f32 v46, v92, v93
v_cvt_pk_bf16_f32 v47, v94, v95
v_pk_mul_f32 v[96:97], v[96:97], s[54:55]
v_pk_mul_f32 v[98:99], v[98:99], s[54:55]
v_pk_mul_f32 v[100:101], v[100:101], s[54:55]
v_pk_mul_f32 v[102:103], v[102:103], s[54:55]
v_cvt_pk_bf16_f32 v48, v96, v97
v_cvt_pk_bf16_f32 v49, v98, v99
v_cvt_pk_bf16_f32 v50, v100, v101
v_cvt_pk_bf16_f32 v51, v102, v103
v_pk_mul_f32 v[104:105], v[104:105], s[54:55]
v_pk_mul_f32 v[106:107], v[106:107], s[54:55]
v_pk_mul_f32 v[108:109], v[108:109], s[54:55]
v_pk_mul_f32 v[110:111], v[110:111], s[54:55]
v_cvt_pk_bf16_f32 v52, v104, v105
v_cvt_pk_bf16_f32 v53, v106, v107
v_cvt_pk_bf16_f32 v54, v108, v109
v_cvt_pk_bf16_f32 v55, v110, v111
v_pk_mul_f32 v[112:113], v[112:113], s[54:55]
v_pk_mul_f32 v[114:115], v[114:115], s[54:55]
v_pk_mul_f32 v[116:117], v[116:117], s[54:55]
v_pk_mul_f32 v[118:119], v[118:119], s[54:55]
v_cvt_pk_bf16_f32 v56, v112, v113
v_cvt_pk_bf16_f32 v57, v114, v115
v_cvt_pk_bf16_f32 v58, v116, v117
v_cvt_pk_bf16_f32 v59, v118, v119
v_pk_mul_f32 v[120:121], v[120:121], s[54:55]
v_pk_mul_f32 v[122:123], v[122:123], s[54:55]
v_pk_mul_f32 v[124:125], v[124:125], s[54:55]
v_pk_mul_f32 v[126:127], v[126:127], s[54:55]
v_cvt_pk_bf16_f32 v60, v120, v121
v_cvt_pk_bf16_f32 v61, v122, v123
v_cvt_pk_bf16_f32 v62, v124, v125
v_cvt_pk_bf16_f32 v63, v126, v127
s_add_u32 m0, s64, 64
v_accvgpr_read_b32 v192, a0
buffer_load_dwordx4 v189, s[16:19], s49 offen offset:2048 nt lds
v_accvgpr_read_b32 v193, a1
v_accvgpr_read_b32 v194, a2
v_accvgpr_read_b32 v195, a3
v_accvgpr_read_b32 v196, a4
v_accvgpr_read_b32 v197, a5
v_accvgpr_read_b32 v198, a6
v_accvgpr_read_b32 v199, a7
v_pk_mul_f32 v[192:193], v[192:193], s[54:55]
v_pk_mul_f32 v[194:195], v[194:195], s[54:55]
v_pk_mul_f32 v[196:197], v[196:197], s[54:55]
v_pk_mul_f32 v[198:199], v[198:199], s[54:55]
v_cvt_pk_bf16_f32 v64, v192, v193
v_cvt_pk_bf16_f32 v65, v194, v195
v_cvt_pk_bf16_f32 v66, v196, v197
v_cvt_pk_bf16_f32 v67, v198, v199
v_accvgpr_read_b32 v200, a8
v_accvgpr_read_b32 v201, a9
v_accvgpr_read_b32 v202, a10
v_accvgpr_read_b32 v203, a11
v_accvgpr_read_b32 v204, a12
v_accvgpr_read_b32 v205, a13
v_accvgpr_read_b32 v206, a14
v_accvgpr_read_b32 v207, a15
v_pk_mul_f32 v[200:201], v[200:201], s[54:55]
v_pk_mul_f32 v[202:203], v[202:203], s[54:55]
v_pk_mul_f32 v[204:205], v[204:205], s[54:55]
v_pk_mul_f32 v[206:207], v[206:207], s[54:55]
v_cvt_pk_bf16_f32 v68, v200, v201
v_cvt_pk_bf16_f32 v69, v202, v203
v_cvt_pk_bf16_f32 v70, v204, v205
v_cvt_pk_bf16_f32 v71, v206, v207
v_accvgpr_read_b32 v192, a16
v_accvgpr_read_b32 v193, a17
v_accvgpr_read_b32 v194, a18
v_accvgpr_read_b32 v195, a19
v_accvgpr_read_b32 v196, a20
v_accvgpr_read_b32 v197, a21
v_accvgpr_read_b32 v198, a22
v_accvgpr_read_b32 v199, a23
v_pk_mul_f32 v[192:193], v[192:193], s[54:55]
v_pk_mul_f32 v[194:195], v[194:195], s[54:55]
v_pk_mul_f32 v[196:197], v[196:197], s[54:55]
v_pk_mul_f32 v[198:199], v[198:199], s[54:55]
v_cvt_pk_bf16_f32 v72, v192, v193
v_cvt_pk_bf16_f32 v73, v194, v195
v_cvt_pk_bf16_f32 v74, v196, v197
v_cvt_pk_bf16_f32 v75, v198, v199
v_accvgpr_read_b32 v200, a24
v_accvgpr_read_b32 v201, a25
v_accvgpr_read_b32 v202, a26
v_accvgpr_read_b32 v203, a27
v_accvgpr_read_b32 v204, a28
v_accvgpr_read_b32 v205, a29
v_accvgpr_read_b32 v206, a30
v_accvgpr_read_b32 v207, a31
v_pk_mul_f32 v[200:201], v[200:201], s[54:55]
v_pk_mul_f32 v[202:203], v[202:203], s[54:55]
v_pk_mul_f32 v[204:205], v[204:205], s[54:55]
v_pk_mul_f32 v[206:207], v[206:207], s[54:55]
v_cvt_pk_bf16_f32 v76, v200, v201
v_cvt_pk_bf16_f32 v77, v202, v203
v_cvt_pk_bf16_f32 v78, v204, v205
v_cvt_pk_bf16_f32 v79, v206, v207
v_accvgpr_read_b32 v192, a32
v_accvgpr_read_b32 v193, a33
v_accvgpr_read_b32 v194, a34
v_accvgpr_read_b32 v195, a35
v_accvgpr_read_b32 v196, a36
v_accvgpr_read_b32 v197, a37
v_accvgpr_read_b32 v198, a38
v_accvgpr_read_b32 v199, a39
v_pk_mul_f32 v[192:193], v[192:193], s[54:55]
v_pk_mul_f32 v[194:195], v[194:195], s[54:55]
v_pk_mul_f32 v[196:197], v[196:197], s[54:55]
v_pk_mul_f32 v[198:199], v[198:199], s[54:55]
v_cvt_pk_bf16_f32 v80, v192, v193
v_cvt_pk_bf16_f32 v81, v194, v195
v_cvt_pk_bf16_f32 v82, v196, v197
v_cvt_pk_bf16_f32 v83, v198, v199
v_accvgpr_read_b32 v200, a40
v_accvgpr_read_b32 v201, a41
v_accvgpr_read_b32 v202, a42
v_accvgpr_read_b32 v203, a43
s_add_u32 m0, s64, 96
v_accvgpr_read_b32 v204, a44
buffer_load_dwordx4 v189, s[16:19], s49 offen offset:3072 nt lds
v_accvgpr_read_b32 v205, a45
v_accvgpr_read_b32 v206, a46
v_accvgpr_read_b32 v207, a47
v_pk_mul_f32 v[200:201], v[200:201], s[54:55]
v_pk_mul_f32 v[202:203], v[202:203], s[54:55]
v_pk_mul_f32 v[204:205], v[204:205], s[54:55]
v_pk_mul_f32 v[206:207], v[206:207], s[54:55]
v_cvt_pk_bf16_f32 v84, v200, v201
v_cvt_pk_bf16_f32 v85, v202, v203
v_cvt_pk_bf16_f32 v86, v204, v205
v_cvt_pk_bf16_f32 v87, v206, v207
v_accvgpr_read_b32 v192, a48
v_accvgpr_read_b32 v193, a49
v_accvgpr_read_b32 v194, a50
v_accvgpr_read_b32 v195, a51
v_accvgpr_read_b32 v196, a52
v_accvgpr_read_b32 v197, a53
v_accvgpr_read_b32 v198, a54
v_accvgpr_read_b32 v199, a55
v_pk_mul_f32 v[192:193], v[192:193], s[54:55]
v_pk_mul_f32 v[194:195], v[194:195], s[54:55]
v_pk_mul_f32 v[196:197], v[196:197], s[54:55]
v_pk_mul_f32 v[198:199], v[198:199], s[54:55]
v_cvt_pk_bf16_f32 v88, v192, v193
v_cvt_pk_bf16_f32 v89, v194, v195
v_cvt_pk_bf16_f32 v90, v196, v197
v_cvt_pk_bf16_f32 v91, v198, v199
v_accvgpr_read_b32 v200, a56
v_accvgpr_read_b32 v201, a57
v_accvgpr_read_b32 v202, a58
v_accvgpr_read_b32 v203, a59
v_accvgpr_read_b32 v204, a60
v_accvgpr_read_b32 v205, a61
v_accvgpr_read_b32 v206, a62
v_accvgpr_read_b32 v207, a63
v_pk_mul_f32 v[200:201], v[200:201], s[54:55]
v_pk_mul_f32 v[202:203], v[202:203], s[54:55]
v_pk_mul_f32 v[204:205], v[204:205], s[54:55]
v_pk_mul_f32 v[206:207], v[206:207], s[54:55]
v_cvt_pk_bf16_f32 v92, v200, v201
v_cvt_pk_bf16_f32 v93, v202, v203
v_cvt_pk_bf16_f32 v94, v204, v205
v_cvt_pk_bf16_f32 v95, v206, v207
v_accvgpr_read_b32 v192, a64
v_accvgpr_read_b32 v193, a65
v_accvgpr_read_b32 v194, a66
v_accvgpr_read_b32 v195, a67
v_accvgpr_read_b32 v196, a68
v_accvgpr_read_b32 v197, a69
v_accvgpr_read_b32 v198, a70
v_accvgpr_read_b32 v199, a71
v_pk_mul_f32 v[192:193], v[192:193], s[54:55]
v_pk_mul_f32 v[194:195], v[194:195], s[54:55]
v_pk_mul_f32 v[196:197], v[196:197], s[54:55]
v_pk_mul_f32 v[198:199], v[198:199], s[54:55]
v_cvt_pk_bf16_f32 v96, v192, v193
v_cvt_pk_bf16_f32 v97, v194, v195
v_cvt_pk_bf16_f32 v98, v196, v197
v_cvt_pk_bf16_f32 v99, v198, v199
v_accvgpr_read_b32 v200, a72
v_accvgpr_read_b32 v201, a73
v_accvgpr_read_b32 v202, a74
v_accvgpr_read_b32 v203, a75
v_accvgpr_read_b32 v204, a76
v_accvgpr_read_b32 v205, a77
v_accvgpr_read_b32 v206, a78
v_accvgpr_read_b32 v207, a79
v_pk_mul_f32 v[200:201], v[200:201], s[54:55]
v_pk_mul_f32 v[202:203], v[202:203], s[54:55]
v_pk_mul_f32 v[204:205], v[204:205], s[54:55]
v_pk_mul_f32 v[206:207], v[206:207], s[54:55]
v_cvt_pk_bf16_f32 v100, v200, v201
v_cvt_pk_bf16_f32 v101, v202, v203
v_cvt_pk_bf16_f32 v102, v204, v205
v_cvt_pk_bf16_f32 v103, v206, v207
v_accvgpr_read_b32 v192, a80
v_accvgpr_read_b32 v193, a81
v_accvgpr_read_b32 v194, a82
v_accvgpr_read_b32 v195, a83
v_accvgpr_read_b32 v196, a84
v_accvgpr_read_b32 v197, a85
v_accvgpr_read_b32 v198, a86
v_accvgpr_read_b32 v199, a87
v_pk_mul_f32 v[192:193], v[192:193], s[54:55]
v_pk_mul_f32 v[194:195], v[194:195], s[54:55]
v_pk_mul_f32 v[196:197], v[196:197], s[54:55]
v_pk_mul_f32 v[198:199], v[198:199], s[54:55]
v_cvt_pk_bf16_f32 v104, v192, v193
v_cvt_pk_bf16_f32 v105, v194, v195
v_cvt_pk_bf16_f32 v106, v196, v197
v_cvt_pk_bf16_f32 v107, v198, v199
v_accvgpr_read_b32 v200, a88
v_accvgpr_read_b32 v201, a89
v_accvgpr_read_b32 v202, a90
v_accvgpr_read_b32 v203, a91
v_accvgpr_read_b32 v204, a92
v_accvgpr_read_b32 v205, a93
v_accvgpr_read_b32 v206, a94
v_accvgpr_read_b32 v207, a95
v_pk_mul_f32 v[200:201], v[200:201], s[54:55]
v_pk_mul_f32 v[202:203], v[202:203], s[54:55]
v_pk_mul_f32 v[204:205], v[204:205], s[54:55]
v_pk_mul_f32 v[206:207], v[206:207], s[54:55]
v_cvt_pk_bf16_f32 v108, v200, v201
v_cvt_pk_bf16_f32 v109, v202, v203
v_cvt_pk_bf16_f32 v110, v204, v205
v_cvt_pk_bf16_f32 v111, v206, v207
v_accvgpr_read_b32 v192, a96
v_accvgpr_read_b32 v193, a97
v_accvgpr_read_b32 v194, a98
v_accvgpr_read_b32 v195, a99
v_accvgpr_read_b32 v196, a100
v_accvgpr_read_b32 v197, a101
v_accvgpr_read_b32 v198, a102
v_accvgpr_read_b32 v199, a103
v_pk_mul_f32 v[192:193], v[192:193], s[54:55]
v_pk_mul_f32 v[194:195], v[194:195], s[54:55]
v_pk_mul_f32 v[196:197], v[196:197], s[54:55]
v_pk_mul_f32 v[198:199], v[198:199], s[54:55]
v_cvt_pk_bf16_f32 v112, v192, v193
v_cvt_pk_bf16_f32 v113, v194, v195
v_cvt_pk_bf16_f32 v114, v196, v197
v_cvt_pk_bf16_f32 v115, v198, v199
v_accvgpr_read_b32 v200, a104
v_accvgpr_read_b32 v201, a105
v_accvgpr_read_b32 v202, a106
v_accvgpr_read_b32 v203, a107
v_accvgpr_read_b32 v204, a108
v_accvgpr_read_b32 v205, a109
v_accvgpr_read_b32 v206, a110
v_accvgpr_read_b32 v207, a111
v_pk_mul_f32 v[200:201], v[200:201], s[54:55]
v_pk_mul_f32 v[202:203], v[202:203], s[54:55]
v_pk_mul_f32 v[204:205], v[204:205], s[54:55]
v_pk_mul_f32 v[206:207], v[206:207], s[54:55]
v_cvt_pk_bf16_f32 v116, v200, v201
v_cvt_pk_bf16_f32 v117, v202, v203
v_cvt_pk_bf16_f32 v118, v204, v205
v_cvt_pk_bf16_f32 v119, v206, v207
v_accvgpr_read_b32 v192, a112
v_accvgpr_read_b32 v193, a113
v_accvgpr_read_b32 v194, a114
v_accvgpr_read_b32 v195, a115
v_accvgpr_read_b32 v196, a116
v_accvgpr_read_b32 v197, a117
v_accvgpr_read_b32 v198, a118
v_accvgpr_read_b32 v199, a119
v_pk_mul_f32 v[192:193], v[192:193], s[54:55]
v_pk_mul_f32 v[194:195], v[194:195], s[54:55]
v_pk_mul_f32 v[196:197], v[196:197], s[54:55]
v_pk_mul_f32 v[198:199], v[198:199], s[54:55]
v_cvt_pk_bf16_f32 v120, v192, v193
v_cvt_pk_bf16_f32 v121, v194, v195
v_cvt_pk_bf16_f32 v122, v196, v197
v_cvt_pk_bf16_f32 v123, v198, v199
v_accvgpr_read_b32 v200, a120
v_accvgpr_read_b32 v201, a121
v_accvgpr_read_b32 v202, a122
v_accvgpr_read_b32 v203, a123
v_accvgpr_read_b32 v204, a124
v_accvgpr_read_b32 v205, a125
v_accvgpr_read_b32 v206, a126
v_accvgpr_read_b32 v207, a127
v_pk_mul_f32 v[200:201], v[200:201], s[54:55]
v_pk_mul_f32 v[202:203], v[202:203], s[54:55]
v_pk_mul_f32 v[204:205], v[204:205], s[54:55]
v_pk_mul_f32 v[206:207], v[206:207], s[54:55]
v_cvt_pk_bf16_f32 v124, v200, v201
v_cvt_pk_bf16_f32 v125, v202, v203
v_cvt_pk_bf16_f32 v126, v204, v205
v_cvt_pk_bf16_f32 v127, v206, v207
s_mov_b32 s63, s58
s_mov_b32 s44, s58
s_mov_b32 s64, s59
v_mbcnt_lo_u32_b32 v191, -1, 0
v_mbcnt_hi_u32_b32 v191, -1, v191
v_lshlrev_b32 v187, 4, v191
v_add_u32 v187, 104448, v187
v_bfe_u32 v128, v191, 1, 3
v_mul_u32_u24 v185, 1056, v128
v_lshrrev_b32 v128, 4, v191
v_lshl_add_u32 v185, v128, 4, v185
v_add_u32 v185, 130048, v185
v_and_b32 v129, 1, v191
v_mul_u32_u24 v128, 384, v129
v_add_u32 v188, v185, v128
v_mul_u32_u24 v128, 640, v129
v_add_u32 v185, v185, v128
v_lshrrev_b32 v128, 3, v191
v_mul_u32_u24 v186, 1056, v128
v_and_b32 v128, 3, v191
v_lshl_add_u32 v186, v128, 3, v186
v_add_u32 v186, 70048, v186
v_bfe_u32 v129, v191, 2, 1
v_mul_u32_u24 v128, 384, v129
v_add_u32 v190, v186, v128
v_mul_u32_u24 v128, 640, v129
v_add_u32 v186, v186, v128
v_mov_b32 v180, 0
v_mov_b32 v181, 0
v_mov_b32 v182, 0
v_mov_b32 v183, 0
v_mov_b32 v184, 0
s_lshl_b32 s61, s28, 12
s_add_u32 s62, s61, 49152
s_add_u32 s61, s61, 65536
s_mov_b32 s47, 4294837248
s_mov_b32 s74, 4294931040
s_mov_b32 s46, 0
s_waitcnt vmcnt(16) lgkmcnt(0)
s_barrier
v_mov_b32 v128, 124928
ds_read_b32 v128, v128
s_waitcnt lgkmcnt(0)
v_readfirstlane_b32 s75, v128
s_cmp_eq_u32 s65, 1
s_cbranch_scc1 L_far_safe
s_cmp_eq_u32 s28, 1
s_cbranch_scc1 L_att1
s_cmp_eq_u32 s28, 2
s_cbranch_scc1 L_att2
s_cmp_eq_u32 s28, 3
s_cbranch_scc1 L_att3
L_att0:
ds_read_b128 a[224:227], v185 offset:0
ds_read_b128 a[248:251], v187 offset:0
ds_read_b128 a[252:255], v187 offset:1024
ds_read_b128 a[228:231], v185 offset:64
ds_read_b128 a[232:235], v188 offset:128
ds_read_b128 a[236:239], v188 offset:192
ds_read_b128 a[240:243], v185 offset:256
s_waitcnt lgkmcnt(6)
v_mfma_f32_16x16x32_bf16 v[128:131], a[224:227], v[0:3], 0
ds_read_b128 a[244:247], v185 offset:320
v_mfma_f32_16x16x32_bf16 v[132:135], a[224:227], v[4:7], 0
s_add_u32 m0, s45, 16896
v_mfma_f32_16x16x32_bf16 v[136:139], a[224:227], v[64:67], 0
buffer_load_dwordx4 v189, s[16:19], s50 offen offset:0 nt lds
v_mfma_f32_16x16x32_bf16 v[140:143], a[224:227], v[68:71], 0
s_waitcnt lgkmcnt(6)
v_mfma_f32_16x16x32_bf16 v[176:179], a[224:227], a[248:251], 0
s_waitcnt lgkmcnt(4)
ds_read_b128 a[248:251], v187 offset:2048
v_mfma_f32_16x16x32_bf16 v[128:131], a[228:231], v[8:11], v[128:131]
ds_read_b128 a[224:227], v188 offset:384
v_mfma_f32_16x16x32_bf16 v[132:135], a[228:231], v[12:15], v[132:135]
v_mfma_f32_16x16x32_bf16 v[136:139], a[228:231], v[72:75], v[136:139]
v_mfma_f32_16x16x32_bf16 v[140:143], a[228:231], v[76:79], v[140:143]
s_add_u32 m0, s45, 16928
v_mfma_f32_16x16x32_bf16 v[176:179], a[228:231], a[252:255], v[176:179]
s_waitcnt lgkmcnt(2)
ds_read_b128 a[252:255], v187 offset:3072
buffer_load_dwordx4 v189, s[16:19], s50 offen offset:1024 nt lds
v_mfma_f32_16x16x32_bf16 v[128:131], a[232:235], v[16:19], v[128:131]
ds_read_b128 a[228:231], v188 offset:448
v_mfma_f32_16x16x32_bf16 v[132:135], a[232:235], v[20:23], v[132:135]
v_mfma_f32_16x16x32_bf16 v[136:139], a[232:235], v[80:83], v[136:139]
v_mfma_f32_16x16x32_bf16 v[140:143], a[232:235], v[84:87], v[140:143]
s_waitcnt lgkmcnt(2)
v_mfma_f32_16x16x32_bf16 v[176:179], a[232:235], a[248:251], v[176:179]
ds_read_b128 a[248:251], v187 offset:4096
v_mfma_f32_16x16x32_bf16 v[128:131], a[236:239], v[24:27], v[128:131]
s_add_u32 m0, s45, 16960
ds_read_b128 a[232:235], v185 offset:8448
v_mfma_f32_16x16x32_bf16 v[132:135], a[236:239], v[28:31], v[132:135]
buffer_load_dwordx4 v189, s[16:19], s50 offen offset:2048 nt lds
v_mfma_f32_16x16x32_bf16 v[136:139], a[236:239], v[88:91], v[136:139]
v_mfma_f32_16x16x32_bf16 v[140:143], a[236:239], v[92:95], v[140:143]
s_waitcnt lgkmcnt(2)
v_mfma_f32_16x16x32_bf16 v[176:179], a[236:239], a[252:255], v[176:179]
ds_read_b128 a[252:255], v187 offset:5120
v_mfma_f32_16x16x32_bf16 v[128:131], a[240:243], v[32:35], v[128:131]
ds_read_b128 a[236:239], v185 offset:8512
v_mfma_f32_16x16x32_bf16 v[132:135], a[240:243], v[36:39], v[132:135]
v_mfma_f32_16x16x32_bf16 v[136:139], a[240:243], v[96:99], v[136:139]
s_add_u32 m0, s45, 16992
v_mfma_f32_16x16x32_bf16 v[140:143], a[240:243], v[100:103], v[140:143]
s_waitcnt lgkmcnt(2)
buffer_load_dwordx4 v189, s[16:19], s50 offen offset:3072 nt lds
v_mfma_f32_16x16x32_bf16 v[176:179], a[240:243], a[248:251], v[176:179]
ds_read_b128 a[248:251], v187 offset:6144
v_mfma_f32_16x16x32_bf16 v[128:131], a[244:247], v[40:43], v[128:131]
ds_read_b128 a[240:243], v188 offset:8576
v_mfma_f32_16x16x32_bf16 v[132:135], a[244:247], v[44:47], v[132:135]
v_mfma_f32_16x16x32_bf16 v[136:139], a[244:247], v[104:107], v[136:139]
v_mfma_f32_16x16x32_bf16 v[140:143], a[244:247], v[108:111], v[140:143]
s_waitcnt lgkmcnt(2)
v_mfma_f32_16x16x32_bf16 v[176:179], a[244:247], a[252:255], v[176:179]
s_add_u32 m0, s64, 0
ds_read_b128 a[252:255], v187 offset:7168
v_mfma_f32_16x16x32_bf16 v[128:131], a[224:227], v[48:51], v[128:131]
buffer_load_dwordx4 v189, s[16:19], s51 offen offset:0 nt lds
v_mfma_f32_16x16x32_bf16 v[132:135], a[224:227], v[52:55], v[132:135]
v_mfma_f32_16x16x32_bf16 v[136:139], a[224:227], v[112:115], v[136:139]
v_mfma_f32_16x16x32_bf16 v[140:143], a[224:227], v[116:119], v[140:143]
s_waitcnt lgkmcnt(1)
v_mfma_f32_16x16x32_bf16 v[176:179], a[224:227], a[248:251], v[176:179]
ds_read_b128 a[224:227], v188 offset:8640
v_mfma_f32_16x16x32_bf16 v[128:131], a[228:231], v[56:59], v[128:131]
v_mfma_f32_16x16x32_bf16 v[132:135], a[228:231], v[60:63], v[132:135]
s_add_u32 m0, s64, 32
v_mfma_f32_16x16x32_bf16 v[136:139], a[228:231], v[120:123], v[136:139]
buffer_load_dwordx4 v189, s[16:19], s51 offen offset:1024 nt lds
v_mfma_f32_16x16x32_bf16 v[140:143], a[228:231], v[124:127], v[140:143]
s_waitcnt lgkmcnt(1)
v_mfma_f32_16x16x32_bf16 v[176:179], a[228:231], a[252:255], v[176:179]
ds_read_b128 a[228:231], v185 offset:8704
v_mfma_f32_16x16x32_bf16 v[160:163], a[232:235], v[0:3], 0
v_exp_f32 v128, v128
v_mfma_f32_16x16x32_bf16 v[164:167], a[232:235], v[4:7], 0
v_exp_f32 v132, v132
v_mfma_f32_16x16x32_bf16 v[168:171], a[232:235], v[64:67], 0
v_exp_f32 v136, v136
v_mfma_f32_16x16x32_bf16 v[172:175], a[232:235], v[68:71], 0
s_add_u32 m0, s64, 64
v_exp_f32 v140, v140
v_mfma_f32_16x16x32_bf16 v[160:163], a[236:239], v[8:11], v[160:163]
v_exp_f32 v176, v176
v_mfma_f32_16x16x32_bf16 v[164:167], a[236:239], v[12:15], v[164:167]
v_exp_f32 v177, v177
v_mfma_f32_16x16x32_bf16 v[168:171], a[236:239], v[72:75], v[168:171]
buffer_load_dwordx4 v189, s[16:19], s51 offen offset:2048 nt lds
ds_read_b128 a[232:235], v185 offset:8768
v_mfma_f32_16x16x32_bf16 v[172:175], a[236:239], v[76:79], v[172:175]
v_exp_f32 v178, v178
v_mfma_f32_16x16x32_bf16 v[160:163], a[240:243], v[16:19], v[160:163]
v_exp_f32 v179, v179
v_mfma_f32_16x16x32_bf16 v[164:167], a[240:243], v[20:23], v[164:167]
v_exp_f32 v129, v129
v_mfma_f32_16x16x32_bf16 v[168:171], a[240:243], v[80:83], v[168:171]
s_add_u32 m0, s64, 96
v_exp_f32 v133, v133
v_mfma_f32_16x16x32_bf16 v[172:175], a[240:243], v[84:87], v[172:175]
s_waitcnt lgkmcnt(1)
ds_read_b128 a[236:239], v188 offset:8832
buffer_load_dwordx4 v189, s[16:19], s51 offen offset:3072 nt lds
v_mfma_f32_16x16x32_bf16 v[160:163], a[224:227], v[24:27], v[160:163]
v_exp_f32 v137, v137
v_mfma_f32_16x16x32_bf16 v[164:167], a[224:227], v[28:31], v[164:167]
v_exp_f32 v141, v141
v_mfma_f32_16x16x32_bf16 v[168:171], a[224:227], v[88:91], v[168:171]
v_exp_f32 v130, v130
v_mfma_f32_16x16x32_bf16 v[172:175], a[224:227], v[92:95], v[172:175]
ds_read_b128 a[240:243], v188 offset:8896
v_add_f32 v184, v184, v176
v_mfma_f32_16x16x32_bf16 v[160:163], a[228:231], v[32:35], v[160:163]
v_exp_f32 v134, v134
v_mfma_f32_16x16x32_bf16 v[164:167], a[228:231], v[36:39], v[164:167]
v_exp_f32 v138, v138
v_mfma_f32_16x16x32_bf16 v[168:171], a[228:231], v[96:99], v[168:171]
v_exp_f32 v142, v142
v_mfma_f32_16x16x32_bf16 v[172:175], a[228:231], v[100:103], v[172:175]
s_waitcnt lgkmcnt(1)
v_exp_f32 v131, v131
v_mfma_f32_16x16x32_bf16 v[160:163], a[232:235], v[40:43], v[160:163]
v_exp_f32 v135, v135
v_mfma_f32_16x16x32_bf16 v[164:167], a[232:235], v[44:47], v[164:167]
v_add_f32 v184, v184, v177
v_add_f32 v184, v184, v178
v_mfma_f32_16x16x32_bf16 v[168:171], a[232:235], v[104:107], v[168:171]
v_add_f32 v184, v184, v179
v_cvt_pk_bf16_f32 v176, v176, v177
v_mfma_f32_16x16x32_bf16 v[172:175], a[232:235], v[108:111], v[172:175]
v_exp_f32 v139, v139
v_mfma_f32_16x16x32_bf16 v[160:163], a[236:239], v[48:51], v[160:163]
v_exp_f32 v143, v143
v_mfma_f32_16x16x32_bf16 v[164:167], a[236:239], v[52:55], v[164:167]
v_cvt_pk_bf16_f32 v177, v178, v179
v_add_f32 v180, v180, v128
v_mfma_f32_16x16x32_bf16 v[168:171], a[236:239], v[112:115], v[168:171]
ds_write_b64 v187, v[176:177] offset:16384
v_add_f32 v180, v180, v129
v_mfma_f32_16x16x32_bf16 v[172:175], a[236:239], v[116:119], v[172:175]
s_waitcnt lgkmcnt(1)
v_cvt_pk_bf16_f32 v128, v128, v129
v_add_f32 v180, v180, v130
v_mfma_f32_16x16x32_bf16 v[160:163], a[240:243], v[56:59], v[160:163]
v_add_f32 v180, v180, v131
v_cvt_pk_bf16_f32 v129, v130, v131
v_mfma_f32_16x16x32_bf16 v[164:167], a[240:243], v[60:63], v[164:167]
v_add_f32 v181, v181, v132
v_add_f32 v181, v181, v133
v_mfma_f32_16x16x32_bf16 v[168:171], a[240:243], v[120:123], v[168:171]
v_cvt_pk_bf16_f32 v132, v132, v133
v_add_f32 v181, v181, v134
v_mfma_f32_16x16x32_bf16 v[172:175], a[240:243], v[124:127], v[172:175]
s_waitcnt lgkmcnt(0)
s_waitcnt vmcnt(8)
s_barrier
ds_read_b128 a[224:227], v185 offset:16896
ds_read_b128 a[248:251], v187 offset:0
ds_read_b128 a[252:255], v187 offset:1024
ds_read_b128 a[228:231], v185 offset:16960
ds_read_b128 a[232:235], v188 offset:17024
ds_read_b128 a[236:239], v188 offset:17088
v_add_f32 v181, v181, v135
v_cvt_pk_bf16_f32 v133, v134, v135
v_add_f32 v182, v182, v136
v_add_f32 v182, v182, v137
v_add_f32 v182, v182, v138
v_add_f32 v182, v182, v139
v_cvt_pk_bf16_f32 v136, v136, v137
v_cvt_pk_bf16_f32 v137, v138, v139
v_add_f32 v183, v183, v140
v_add_f32 v183, v183, v141
v_add_f32 v183, v183, v142
v_add_f32 v183, v183, v143
v_cvt_pk_bf16_f32 v140, v140, v141
v_cvt_pk_bf16_f32 v141, v142, v143
v_exp_f32 v160, v160
s_nop 0
v_add_f32 v180, v180, v160
v_exp_f32 v161, v161
s_nop 0
v_add_f32 v180, v180, v161
v_exp_f32 v162, v162
s_nop 0
v_add_f32 v180, v180, v162
v_exp_f32 v163, v163
s_nop 0
v_add_f32 v180, v180, v163
v_cvt_pk_bf16_f32 v130, v160, v161
v_cvt_pk_bf16_f32 v131, v162, v163
v_exp_f32 v164, v164
s_nop 0
v_add_f32 v181, v181, v164
v_exp_f32 v165, v165
s_nop 0
v_add_f32 v181, v181, v165
v_exp_f32 v166, v166
s_nop 0
v_add_f32 v181, v181, v166
v_exp_f32 v167, v167
s_nop 0
v_add_f32 v181, v181, v167
v_cvt_pk_bf16_f32 v134, v164, v165
v_cvt_pk_bf16_f32 v135, v166, v167
v_exp_f32 v168, v168
s_nop 0
v_add_f32 v182, v182, v168
v_exp_f32 v169, v169
s_nop 0
v_add_f32 v182, v182, v169
v_exp_f32 v170, v170
s_nop 0
v_add_f32 v182, v182, v170
v_exp_f32 v171, v171
s_nop 0
v_add_f32 v182, v182, v171
v_cvt_pk_bf16_f32 v138, v168, v169
v_cvt_pk_bf16_f32 v139, v170, v171
v_exp_f32 v172, v172
s_nop 0
v_add_f32 v183, v183, v172
v_exp_f32 v173, v173
s_nop 0
v_add_f32 v183, v183, v173
v_exp_f32 v174, v174
s_nop 0
v_add_f32 v183, v183, v174
v_exp_f32 v175, v175
s_nop 0
v_add_f32 v183, v183, v175
v_cvt_pk_bf16_f32 v142, v172, v173
v_cvt_pk_bf16_f32 v143, v174, v175
s_sub_u32 s63, s63, 4294837248
ds_read_b128 a[240:243], v185 offset:17152
s_waitcnt lgkmcnt(6)
v_mfma_f32_16x16x32_bf16 v[144:147], a[224:227], v[0:3], 0
ds_read_b128 a[244:247], v185 offset:17216
v_mfma_f32_16x16x32_bf16 v[148:151], a[224:227], v[4:7], 0
v_mfma_f32_16x16x32_bf16 v[152:155], a[224:227], v[64:67], 0
v_mfma_f32_16x16x32_bf16 v[156:159], a[224:227], v[68:71], 0
s_waitcnt lgkmcnt(6)
v_mfma_f32_16x16x32_bf16 v[176:179], a[224:227], a[248:251], 0
s_waitcnt lgkmcnt(4)
ds_read_b128 a[248:251], v187 offset:2048
v_mfma_f32_16x16x32_bf16 v[144:147], a[228:231], v[8:11], v[144:147]
ds_read_b128 a[224:227], v188 offset:17280
v_mfma_f32_16x16x32_bf16 v[148:151], a[228:231], v[12:15], v[148:151]
v_mfma_f32_16x16x32_bf16 v[152:155], a[228:231], v[72:75], v[152:155]
v_mfma_f32_16x16x32_bf16 v[156:159], a[228:231], v[76:79], v[156:159]
v_mfma_f32_16x16x32_bf16 v[176:179], a[228:231], a[252:255], v[176:179]
s_waitcnt lgkmcnt(2)
ds_read_b128 a[252:255], v187 offset:3072
v_mfma_f32_16x16x32_bf16 v[144:147], a[232:235], v[16:19], v[144:147]
ds_read_b128 a[228:231], v188 offset:17344
v_mfma_f32_16x16x32_bf16 v[148:151], a[232:235], v[20:23], v[148:151]
v_mfma_f32_16x16x32_bf16 v[152:155], a[232:235], v[80:83], v[152:155]
v_mfma_f32_16x16x32_bf16 v[156:159], a[232:235], v[84:87], v[156:159]
s_waitcnt lgkmcnt(2)
v_mfma_f32_16x16x32_bf16 v[176:179], a[232:235], a[248:251], v[176:179]
ds_read_b128 a[248:251], v187 offset:4096
v_mfma_f32_16x16x32_bf16 v[144:147], a[236:239], v[24:27], v[144:147]
ds_read_b128 a[232:235], v185 offset:25344
v_mfma_f32_16x16x32_bf16 v[148:151], a[236:239], v[28:31], v[148:151]
v_mfma_f32_16x16x32_bf16 v[152:155], a[236:239], v[88:91], v[152:155]
v_mfma_f32_16x16x32_bf16 v[156:159], a[236:239], v[92:95], v[156:159]
s_waitcnt lgkmcnt(2)
v_mfma_f32_16x16x32_bf16 v[176:179], a[236:239], a[252:255], v[176:179]
ds_read_b128 a[252:255], v187 offset:5120
v_mfma_f32_16x16x32_bf16 v[144:147], a[240:243], v[32:35], v[144:147]
ds_read_b128 a[236:239], v185 offset:25408
v_mfma_f32_16x16x32_bf16 v[148:151], a[240:243], v[36:39], v[148:151]
v_mfma_f32_16x16x32_bf16 v[152:155], a[240:243], v[96:99], v[152:155]
v_mfma_f32_16x16x32_bf16 v[156:159], a[240:243], v[100:103], v[156:159]
s_waitcnt lgkmcnt(2)
v_mfma_f32_16x16x32_bf16 v[176:179], a[240:243], a[248:251], v[176:179]
ds_read_b128 a[248:251], v187 offset:6144
v_mfma_f32_16x16x32_bf16 v[144:147], a[244:247], v[40:43], v[144:147]
ds_read_b128 a[240:243], v188 offset:25472
v_mfma_f32_16x16x32_bf16 v[148:151], a[244:247], v[44:47], v[148:151]
v_mfma_f32_16x16x32_bf16 v[152:155], a[244:247], v[104:107], v[152:155]
v_mfma_f32_16x16x32_bf16 v[156:159], a[244:247], v[108:111], v[156:159]
s_waitcnt lgkmcnt(2)
v_mfma_f32_16x16x32_bf16 v[176:179], a[244:247], a[252:255], v[176:179]
ds_read_b128 a[252:255], v187 offset:7168
v_mfma_f32_16x16x32_bf16 v[144:147], a[224:227], v[48:51], v[144:147]
ds_read_b64_tr_b16 a[244:245], v186 offset:32
v_mfma_f32_16x16x32_bf16 v[148:151], a[224:227], v[52:55], v[148:151]
ds_read_b64_tr_b16 a[246:247], v186 offset:8480
v_mfma_f32_16x16x32_bf16 v[152:155], a[224:227], v[112:115], v[152:155]
v_mfma_f32_16x16x32_bf16 v[156:159], a[224:227], v[116:119], v[156:159]
s_waitcnt lgkmcnt(3)
v_mfma_f32_16x16x32_bf16 v[176:179], a[224:227], a[248:251], v[176:179]
ds_read_b128 a[224:227], v188 offset:25536
v_mfma_f32_16x16x32_bf16 v[144:147], a[228:231], v[56:59], v[144:147]
ds_read_b128 a[248:251], v187 offset:16384
v_mfma_f32_16x16x32_bf16 v[148:151], a[228:231], v[60:63], v[148:151]
v_mfma_f32_16x16x32_bf16 v[152:155], a[228:231], v[120:123], v[152:155]
v_mfma_f32_16x16x32_bf16 v[156:159], a[228:231], v[124:127], v[156:159]
s_waitcnt lgkmcnt(2)
v_mfma_f32_16x16x32_bf16 v[176:179], a[228:231], a[252:255], v[176:179]
ds_read_b128 a[228:231], v185 offset:25600
v_mfma_f32_16x16x32_bf16 v[160:163], a[232:235], v[0:3], 0
v_exp_f32 v144, v144
v_mfma_f32_16x16x32_bf16 v[164:167], a[232:235], v[4:7], 0
v_exp_f32 v145, v145
v_mfma_f32_16x16x32_bf16 v[168:171], a[232:235], v[64:67], 0
v_exp_f32 v146, v146
v_mfma_f32_16x16x32_bf16 v[172:175], a[232:235], v[68:71], 0
v_exp_f32 v147, v147
v_mfma_f32_16x16x32_bf16 v[160:163], a[236:239], v[8:11], v[160:163]
v_exp_f32 v176, v176
v_mfma_f32_16x16x32_bf16 v[164:167], a[236:239], v[12:15], v[164:167]
v_exp_f32 v177, v177
v_mfma_f32_16x16x32_bf16 v[168:171], a[236:239], v[72:75], v[168:171]
v_exp_f32 v178, v178
v_mfma_f32_16x16x32_bf16 v[172:175], a[236:239], v[76:79], v[172:175]
ds_read_b128 a[232:235], v185 offset:25664
v_add_f32 v184, v184, v176
v_mfma_f32_16x16x32_bf16 v[160:163], a[240:243], v[16:19], v[160:163]
v_exp_f32 v179, v179
v_mfma_f32_16x16x32_bf16 v[164:167], a[240:243], v[20:23], v[164:167]
v_exp_f32 v148, v148
v_mfma_f32_16x16x32_bf16 v[168:171], a[240:243], v[80:83], v[168:171]
v_exp_f32 v149, v149
v_mfma_f32_16x16x32_bf16 v[172:175], a[240:243], v[84:87], v[172:175]
s_waitcnt lgkmcnt(1)
ds_read_b128 a[236:239], v188 offset:25728
v_add_f32 v184, v184, v177
v_mfma_f32_16x16x32_bf16 v[160:163], a[224:227], v[24:27], v[160:163]
v_exp_f32 v150, v150
v_mfma_f32_16x16x32_bf16 v[164:167], a[224:227], v[28:31], v[164:167]
v_exp_f32 v151, v151
v_mfma_f32_16x16x32_bf16 v[168:171], a[224:227], v[88:91], v[168:171]
v_exp_f32 v152, v152
v_mfma_f32_16x16x32_bf16 v[172:175], a[224:227], v[92:95], v[172:175]
ds_read_b128 a[240:243], v188 offset:25792
v_add_f32 v184, v184, v178
v_mfma_f32_16x16x32_bf16 v[160:163], a[228:231], v[32:35], v[160:163]
v_exp_f32 v153, v153
v_mfma_f32_16x16x32_bf16 v[164:167], a[228:231], v[36:39], v[164:167]
v_exp_f32 v154, v154
v_mfma_f32_16x16x32_bf16 v[168:171], a[228:231], v[96:99], v[168:171]
v_exp_f32 v155, v155
v_mfma_f32_16x16x32_bf16 v[172:175], a[228:231], v[100:103], v[172:175]
s_waitcnt lgkmcnt(1)
ds_read_b64_tr_b16 a[224:225], v190 offset:128
v_add_f32 v184, v184, v179
v_mfma_f32_16x16x32_bf16 v[160:163], a[232:235], v[40:43], v[160:163]
ds_read_b64_tr_b16 a[226:227], v190 offset:8576
v_cvt_pk_bf16_f32 v176, v176, v177
v_mfma_f32_16x16x32_bf16 v[164:167], a[232:235], v[44:47], v[164:167]
v_exp_f32 v156, v156
v_mfma_f32_16x16x32_bf16 v[168:171], a[232:235], v[104:107], v[168:171]
v_exp_f32 v157, v157
v_mfma_f32_16x16x32_bf16 v[172:175], a[232:235], v[108:111], v[172:175]
ds_read_b64_tr_b16 a[228:229], v190 offset:160
v_cvt_pk_bf16_f32 v177, v178, v179
v_mfma_f32_16x16x32_bf16 v[160:163], a[236:239], v[48:51], v[160:163]
ds_read_b64_tr_b16 a[230:231], v190 offset:8608
v_add_f32 v180, v180, v144
v_mfma_f32_16x16x32_bf16 v[164:167], a[236:239], v[52:55], v[164:167]
v_exp_f32 v158, v158
v_mfma_f32_16x16x32_bf16 v[168:171], a[236:239], v[112:115], v[168:171]
v_exp_f32 v159, v159
v_mfma_f32_16x16x32_bf16 v[172:175], a[236:239], v[116:119], v[172:175]
s_waitcnt lgkmcnt(2)
ds_read_b64_tr_b16 a[232:233], v190 offset:192
v_add_f32 v180, v180, v145
v_mfma_f32_16x16x32_bf16 v[160:163], a[240:243], v[56:59], v[160:163]
ds_read_b64_tr_b16 a[234:235], v190 offset:8640
v_add_f32 v180, v180, v146
v_mfma_f32_16x16x32_bf16 v[164:167], a[240:243], v[60:63], v[164:167]
ds_write_b64 v187, v[176:177] offset:18432
v_add_f32 v180, v180, v147
v_mfma_f32_16x16x32_bf16 v[168:171], a[240:243], v[120:123], v[168:171]
ds_read_b64_tr_b16 a[236:237], v190 offset:224
v_cvt_pk_bf16_f32 v144, v144, v145
v_mfma_f32_16x16x32_bf16 v[172:175], a[240:243], v[124:127], v[172:175]
ds_read_b64_tr_b16 a[238:239], v190 offset:8672
v_cvt_pk_bf16_f32 v145, v146, v147
v_mfma_f32_16x16x32_bf16 a[16:19], a[224:227], v[128:131], 0
ds_read_b128 a[252:255], v187 offset:17408
v_add_f32 v181, v181, v148
v_mfma_f32_16x16x32_bf16 a[80:83], a[224:227], v[132:135], 0
v_exp_f32 v160, v160
v_mfma_f32_16x16x32_bf16 a[144:147], a[224:227], v[136:139], 0
v_exp_f32 v161, v161
v_mfma_f32_16x16x32_bf16 v[208:211], a[224:227], v[140:143], 0
s_waitcnt lgkmcnt(3)
ds_read_b64_tr_b16 a[240:241], v186 offset:0
v_add_f32 v181, v181, v149
v_mfma_f32_16x16x32_bf16 a[20:23], a[228:231], v[128:131], 0
ds_read_b64_tr_b16 a[242:243], v186 offset:8448
v_add_f32 v181, v181, v150
v_mfma_f32_16x16x32_bf16 a[84:87], a[228:231], v[132:135], 0
v_exp_f32 v162, v162
v_mfma_f32_16x16x32_bf16 a[148:151], a[228:231], v[136:139], 0
v_exp_f32 v163, v163
v_mfma_f32_16x16x32_bf16 v[212:215], a[228:231], v[140:143], 0
v_exp_f32 v164, v164
v_mfma_f32_16x16x32_bf16 a[24:27], a[232:235], v[128:131], 0
ds_read_b64_tr_b16 a[224:225], v186 offset:64
v_add_f32 v181, v181, v151
v_mfma_f32_16x16x32_bf16 a[88:91], a[232:235], v[132:135], 0
v_exp_f32 v165, v165
v_mfma_f32_16x16x32_bf16 a[152:155], a[232:235], v[136:139], 0
v_exp_f32 v166, v166
v_mfma_f32_16x16x32_bf16 v[216:219], a[232:235], v[140:143], 0
s_waitcnt lgkmcnt(1)
v_exp_f32 v167, v167
v_mfma_f32_16x16x32_bf16 a[28:31], a[236:239], v[128:131], 0
s_add_u32 m0, s63, 0
v_cvt_pk_bf16_f32 v148, v148, v149
v_cvt_pk_bf16_f32 v149, v150, v151
v_mfma_f32_16x16x32_bf16 a[92:95], a[236:239], v[132:135], 0
v_exp_f32 v168, v168
v_mfma_f32_16x16x32_bf16 a[156:159], a[236:239], v[136:139], 0
v_exp_f32 v169, v169
v_mfma_f32_16x16x32_bf16 v[220:223], a[236:239], v[140:143], 0
ds_read_b64_tr_b16 a[226:227], v186 offset:8512
buffer_load_dwordx4 v189, s[12:15], s61 offen offset:0 nt lds
v_mfma_f32_16x16x32_bf16 a[0:3], a[240:243], v[128:131], 0
s_add_u32 m0, s63, 32
v_exp_f32 v170, v170
v_mfma_f32_16x16x32_bf16 a[64:67], a[240:243], v[132:135], 0
v_add_f32 v182, v182, v152
v_add_f32 v182, v182, v153
v_mfma_f32_16x16x32_bf16 a[128:131], a[240:243], v[136:139], 0
v_add_f32 v182, v182, v154
v_add_f32 v182, v182, v155
v_mfma_f32_16x16x32_bf16 v[192:195], a[240:243], v[140:143], 0
buffer_load_dwordx4 v189, s[12:15], s61 offen offset:1024 nt lds
ds_read_b64_tr_b16 a[228:229], v186 offset:96
v_mfma_f32_16x16x32_bf16 a[192:195], a[240:243], a[248:251], 0
s_add_u32 m0, s63, 64
v_exp_f32 v171, v171
v_mfma_f32_16x16x32_bf16 a[196:199], a[240:243], a[252:255], 0
v_cvt_pk_bf16_f32 v152, v152, v153
v_cvt_pk_bf16_f32 v153, v154, v155
v_mfma_f32_16x16x32_bf16 a[4:7], a[244:247], v[128:131], 0
ds_read_b64_tr_b16 a[230:231], v186 offset:8544
buffer_load_dwordx4 v189, s[12:15], s61 offen offset:2048 nt lds
v_mfma_f32_16x16x32_bf16 a[68:71], a[244:247], v[132:135], 0
v_exp_f32 v172, v172
v_mfma_f32_16x16x32_bf16 a[132:135], a[244:247], v[136:139], 0
s_add_u32 m0, s63, 96
v_exp_f32 v173, v173
v_mfma_f32_16x16x32_bf16 v[196:199], a[244:247], v[140:143], 0
v_exp_f32 v174, v174
v_mfma_f32_16x16x32_bf16 a[200:203], a[244:247], a[248:251], 0
v_add_f32 v183, v183, v156
v_add_f32 v183, v183, v157
v_mfma_f32_16x16x32_bf16 a[204:207], a[244:247], a[252:255], 0
s_waitcnt lgkmcnt(1)
v_add_f32 v183, v183, v158
v_add_f32 v183, v183, v159
v_mfma_f32_16x16x32_bf16 a[8:11], a[224:227], v[128:131], 0
ds_read_b64_tr_b16 a[232:233], v186 offset:256
buffer_load_dwordx4 v189, s[12:15], s61 offen offset:3072 nt lds
v_mfma_f32_16x16x32_bf16 a[72:75], a[224:227], v[132:135], 0
s_add_u32 m0, s64, 16896
ds_read_b64_tr_b16 a[234:235], v186 offset:8704
v_cvt_pk_bf16_f32 v156, v156, v157
v_mfma_f32_16x16x32_bf16 a[136:139], a[224:227], v[136:139], 0
v_cvt_pk_bf16_f32 v157, v158, v159
v_add_f32 v180, v180, v160
v_mfma_f32_16x16x32_bf16 v[200:203], a[224:227], v[140:143], 0
v_add_f32 v180, v180, v161
v_add_f32 v180, v180, v162
v_mfma_f32_16x16x32_bf16 a[208:211], a[224:227], a[248:251], 0
ds_read_b64_tr_b16 a[236:237], v186 offset:288
v_add_f32 v180, v180, v163
v_mfma_f32_16x16x32_bf16 a[212:215], a[224:227], a[252:255], 0
s_waitcnt lgkmcnt(3)
ds_read_b64_tr_b16 a[238:239], v186 offset:8736
buffer_load_dwordx4 v189, s[16:19], s62 offen offset:0 nt lds
v_mfma_f32_16x16x32_bf16 a[12:15], a[228:231], v[128:131], 0
s_add_u32 m0, s64, 16928
v_exp_f32 v175, v175
v_mfma_f32_16x16x32_bf16 a[76:79], a[228:231], v[132:135], 0
ds_read_b64_tr_b16 a[240:241], v186 offset:320
buffer_load_dwordx4 v189, s[16:19], s62 offen offset:1024 nt lds
v_mfma_f32_16x16x32_bf16 a[140:143], a[228:231], v[136:139], 0
s_add_u32 m0, s64, 16960
ds_read_b64_tr_b16 a[242:243], v186 offset:8768
v_add_f32 v181, v181, v164
v_mfma_f32_16x16x32_bf16 v[204:207], a[228:231], v[140:143], 0
ds_read_b64_tr_b16 a[224:225], v186 offset:352
buffer_load_dwordx4 v189, s[16:19], s62 offen offset:2048 nt lds
v_mfma_f32_16x16x32_bf16 a[216:219], a[228:231], a[248:251], 0
ds_read_b64_tr_b16 a[226:227], v186 offset:8800
v_add_f32 v181, v181, v165
v_mfma_f32_16x16x32_bf16 a[220:223], a[228:231], a[252:255], 0
s_waitcnt lgkmcnt(4)
ds_read_b64_tr_b16 a[228:229], v190 offset:384
v_add_f32 v181, v181, v166
v_mfma_f32_16x16x32_bf16 a[32:35], a[232:235], v[128:131], 0
s_add_u32 m0, s64, 16992
ds_read_b64_tr_b16 a[230:231], v190 offset:8832
v_add_f32 v181, v181, v167
v_mfma_f32_16x16x32_bf16 a[96:99], a[232:235], v[132:135], 0
buffer_load_dwordx4 v189, s[16:19], s62 offen offset:3072 nt lds
v_add_f32 v182, v182, v168
v_mfma_f32_16x16x32_bf16 a[160:163], a[232:235], v[136:139], 0
s_add_u32 s61, s61, 16384
v_add_f32 v182, v182, v169
v_add_f32 v182, v182, v170
v_mfma_f32_16x16x32_bf16 v[224:227], a[232:235], v[140:143], 0
s_add_u32 s62, s62, 16384
ds_read_b64_tr_b16 a[232:233], v190 offset:416
v_add_f32 v182, v182, v171
v_mfma_f32_16x16x32_bf16 a[36:39], a[236:239], v[128:131], 0
ds_read_b64_tr_b16 a[234:235], v190 offset:8864
v_add_u32 v185, 4294837248, v185
v_mfma_f32_16x16x32_bf16 a[100:103], a[236:239], v[132:135], 0
v_add_u32 v188, 4294837248, v188
v_add_f32 v183, v183, v172
v_mfma_f32_16x16x32_bf16 a[164:167], a[236:239], v[136:139], 0
v_add_f32 v183, v183, v173
v_add_f32 v183, v183, v174
v_mfma_f32_16x16x32_bf16 v[228:231], a[236:239], v[140:143], 0
s_waitcnt lgkmcnt(2)
ds_read_b64_tr_b16 a[236:237], v190 offset:448
v_add_f32 v183, v183, v175
v_mfma_f32_16x16x32_bf16 a[40:43], a[240:243], v[128:131], 0
ds_read_b64_tr_b16 a[238:239], v190 offset:8896
v_cvt_pk_bf16_f32 v146, v160, v161
v_mfma_f32_16x16x32_bf16 a[104:107], a[240:243], v[132:135], 0
v_cvt_pk_bf16_f32 v147, v162, v163
v_cvt_pk_bf16_f32 v150, v164, v165
v_mfma_f32_16x16x32_bf16 a[168:171], a[240:243], v[136:139], 0
v_cvt_pk_bf16_f32 v151, v166, v167
v_cvt_pk_bf16_f32 v154, v168, v169
v_mfma_f32_16x16x32_bf16 v[232:235], a[240:243], v[140:143], 0
ds_read_b64_tr_b16 a[240:241], v190 offset:480
v_cvt_pk_bf16_f32 v155, v170, v171
v_mfma_f32_16x16x32_bf16 a[44:47], a[224:227], v[128:131], 0
ds_read_b64_tr_b16 a[242:243], v190 offset:8928
v_cvt_pk_bf16_f32 v158, v172, v173
v_mfma_f32_16x16x32_bf16 a[108:111], a[224:227], v[132:135], 0
v_cvt_pk_bf16_f32 v159, v174, v175
v_mfma_f32_16x16x32_bf16 a[172:175], a[224:227], v[136:139], 0
v_mfma_f32_16x16x32_bf16 v[236:239], a[224:227], v[140:143], 0
v_mfma_f32_16x16x32_bf16 a[48:51], a[228:231], v[128:131], 0
v_mfma_f32_16x16x32_bf16 a[112:115], a[228:231], v[132:135], 0
v_mfma_f32_16x16x32_bf16 a[176:179], a[228:231], v[136:139], 0
v_mfma_f32_16x16x32_bf16 v[240:243], a[228:231], v[140:143], 0
s_waitcnt lgkmcnt(0)
v_mfma_f32_16x16x32_bf16 a[52:55], a[232:235], v[128:131], 0
s_waitcnt lgkmcnt(0)
s_waitcnt vmcnt(12)
s_barrier
v_mfma_f32_16x16x32_bf16 a[116:119], a[232:235], v[132:135], 0
ds_read_b128 a[224:227], v185 offset:0
v_mfma_f32_16x16x32_bf16 a[180:183], a[232:235], v[136:139], 0
ds_read_b128 a[248:251], v187 offset:0
v_mfma_f32_16x16x32_bf16 v[244:247], a[232:235], v[140:143], 0
ds_read_b128 a[252:255], v187 offset:1024
v_mfma_f32_16x16x32_bf16 a[56:59], a[236:239], v[128:131], 0
ds_read_b128 a[228:231], v185 offset:64
v_mfma_f32_16x16x32_bf16 a[120:123], a[236:239], v[132:135], 0
ds_read_b128 a[232:235], v188 offset:128
v_mfma_f32_16x16x32_bf16 a[184:187], a[236:239], v[136:139], 0
v_mfma_f32_16x16x32_bf16 v[248:251], a[236:239], v[140:143], 0
ds_read_b128 a[236:239], v188 offset:192
v_mfma_f32_16x16x32_bf16 a[60:63], a[240:243], v[128:131], 0
v_mfma_f32_16x16x32_bf16 a[124:127], a[240:243], v[132:135], 0
v_mfma_f32_16x16x32_bf16 a[188:191], a[240:243], v[136:139], 0
v_mfma_f32_16x16x32_bf16 v[252:255], a[240:243], v[140:143], 0
L_attloop0:
s_sub_u32 s64, s64, s74
ds_read_b128 a[240:243], v185 offset:256
s_waitcnt lgkmcnt(2)
v_mfma_f32_16x16x32_bf16 v[128:131], a[224:227], v[0:3], 0
ds_read_b128 a[244:247], v185 offset:320
v_mfma_f32_16x16x32_bf16 v[132:135], a[224:227], v[4:7], 0
v_mfma_f32_16x16x32_bf16 v[136:139], a[224:227], v[64:67], 0
v_mfma_f32_16x16x32_bf16 v[140:143], a[224:227], v[68:71], 0
v_mfma_f32_16x16x32_bf16 v[176:179], a[224:227], a[248:251], 0
ds_read_b128 a[248:251], v187 offset:2048
v_mfma_f32_16x16x32_bf16 v[128:131], a[228:231], v[8:11], v[128:131]
ds_read_b128 a[224:227], v188 offset:384
v_mfma_f32_16x16x32_bf16 v[132:135], a[228:231], v[12:15], v[132:135]
v_mfma_f32_16x16x32_bf16 v[136:139], a[228:231], v[72:75], v[136:139]
v_mfma_f32_16x16x32_bf16 v[140:143], a[228:231], v[76:79], v[140:143]
v_mfma_f32_16x16x32_bf16 v[176:179], a[228:231], a[252:255], v[176:179]
ds_read_b128 a[252:255], v187 offset:3072
v_mfma_f32_16x16x32_bf16 v[128:131], a[232:235], v[16:19], v[128:131]
ds_read_b128 a[228:231], v188 offset:448
v_mfma_f32_16x16x32_bf16 v[132:135], a[232:235], v[20:23], v[132:135]
v_mfma_f32_16x16x32_bf16 v[136:139], a[232:235], v[80:83], v[136:139]
v_mfma_f32_16x16x32_bf16 v[140:143], a[232:235], v[84:87], v[140:143]
s_waitcnt lgkmcnt(2)
v_mfma_f32_16x16x32_bf16 v[176:179], a[232:235], a[248:251], v[176:179]
ds_read_b128 a[248:251], v187 offset:4096
v_mfma_f32_16x16x32_bf16 v[128:131], a[236:239], v[24:27], v[128:131]
ds_read_b128 a[232:235], v185 offset:8448
v_mfma_f32_16x16x32_bf16 v[132:135], a[236:239], v[28:31], v[132:135]
v_mfma_f32_16x16x32_bf16 v[136:139], a[236:239], v[88:91], v[136:139]
v_mfma_f32_16x16x32_bf16 v[140:143], a[236:239], v[92:95], v[140:143]
s_waitcnt lgkmcnt(2)
v_mfma_f32_16x16x32_bf16 v[176:179], a[236:239], a[252:255], v[176:179]
ds_read_b128 a[252:255], v187 offset:5120
v_mfma_f32_16x16x32_bf16 v[128:131], a[240:243], v[32:35], v[128:131]
ds_read_b128 a[236:239], v185 offset:8512
v_mfma_f32_16x16x32_bf16 v[132:135], a[240:243], v[36:39], v[132:135]
v_mfma_f32_16x16x32_bf16 v[136:139], a[240:243], v[96:99], v[136:139]
v_mfma_f32_16x16x32_bf16 v[140:143], a[240:243], v[100:103], v[140:143]
s_waitcnt lgkmcnt(2)
v_mfma_f32_16x16x32_bf16 v[176:179], a[240:243], a[248:251], v[176:179]
ds_read_b128 a[248:251], v187 offset:6144
v_mfma_f32_16x16x32_bf16 v[128:131], a[244:247], v[40:43], v[128:131]
ds_read_b128 a[240:243], v188 offset:8576
v_mfma_f32_16x16x32_bf16 v[132:135], a[244:247], v[44:47], v[132:135]
v_mfma_f32_16x16x32_bf16 v[136:139], a[244:247], v[104:107], v[136:139]
v_mfma_f32_16x16x32_bf16 v[140:143], a[244:247], v[108:111], v[140:143]
s_waitcnt lgkmcnt(2)
v_mfma_f32_16x16x32_bf16 v[176:179], a[244:247], a[252:255], v[176:179]
ds_read_b128 a[252:255], v187 offset:7168
v_mfma_f32_16x16x32_bf16 v[128:131], a[224:227], v[48:51], v[128:131]
ds_read_b64_tr_b16 a[244:245], v186 offset:16928
v_mfma_f32_16x16x32_bf16 v[132:135], a[224:227], v[52:55], v[132:135]
ds_read_b64_tr_b16 a[246:247], v186 offset:25376
v_mfma_f32_16x16x32_bf16 v[136:139], a[224:227], v[112:115], v[136:139]
v_mfma_f32_16x16x32_bf16 v[140:143], a[224:227], v[116:119], v[140:143]
s_waitcnt lgkmcnt(3)
v_mfma_f32_16x16x32_bf16 v[176:179], a[224:227], a[248:251], v[176:179]
ds_read_b128 a[224:227], v188 offset:8640
v_mfma_f32_16x16x32_bf16 v[128:131], a[228:231], v[56:59], v[128:131]
ds_read_b128 a[248:251], v187 offset:18432
v_mfma_f32_16x16x32_bf16 v[132:135], a[228:231], v[60:63], v[132:135]
v_mfma_f32_16x16x32_bf16 v[136:139], a[228:231], v[120:123], v[136:139]
v_mfma_f32_16x16x32_bf16 v[140:143], a[228:231], v[124:127], v[140:143]
s_waitcnt lgkmcnt(2)
v_mfma_f32_16x16x32_bf16 v[176:179], a[228:231], a[252:255], v[176:179]
ds_read_b128 a[228:231], v185 offset:8704
v_mfma_f32_16x16x32_bf16 v[160:163], a[232:235], v[0:3], 0
v_exp_f32 v128, v128
v_mfma_f32_16x16x32_bf16 v[164:167], a[232:235], v[4:7], 0
v_exp_f32 v129, v129
v_mfma_f32_16x16x32_bf16 v[168:171], a[232:235], v[64:67], 0
v_exp_f32 v130, v130
v_mfma_f32_16x16x32_bf16 v[172:175], a[232:235], v[68:71], 0
v_exp_f32 v131, v131
v_mfma_f32_16x16x32_bf16 v[160:163], a[236:239], v[8:11], v[160:163]
v_exp_f32 v176, v176
v_mfma_f32_16x16x32_bf16 v[164:167], a[236:239], v[12:15], v[164:167]
v_exp_f32 v177, v177
v_mfma_f32_16x16x32_bf16 v[168:171], a[236:239], v[72:75], v[168:171]
v_exp_f32 v178, v178
v_mfma_f32_16x16x32_bf16 v[172:175], a[236:239], v[76:79], v[172:175]
ds_read_b128 a[232:235], v185 offset:8768
v_add_f32 v184, v184, v176
v_mfma_f32_16x16x32_bf16 v[160:163], a[240:243], v[16:19], v[160:163]
v_exp_f32 v179, v179
v_mfma_f32_16x16x32_bf16 v[164:167], a[240:243], v[20:23], v[164:167]
v_exp_f32 v132, v132
v_mfma_f32_16x16x32_bf16 v[168:171], a[240:243], v[80:83], v[168:171]
v_exp_f32 v133, v133
v_mfma_f32_16x16x32_bf16 v[172:175], a[240:243], v[84:87], v[172:175]
s_waitcnt lgkmcnt(1)
ds_read_b128 a[236:239], v188 offset:8832
v_add_f32 v184, v184, v177
v_mfma_f32_16x16x32_bf16 v[160:163], a[224:227], v[24:27], v[160:163]
v_exp_f32 v134, v134
v_mfma_f32_16x16x32_bf16 v[164:167], a[224:227], v[28:31], v[164:167]
v_exp_f32 v135, v135
v_mfma_f32_16x16x32_bf16 v[168:171], a[224:227], v[88:91], v[168:171]
v_exp_f32 v136, v136
v_mfma_f32_16x16x32_bf16 v[172:175], a[224:227], v[92:95], v[172:175]
ds_read_b128 a[240:243], v188 offset:8896
v_add_f32 v184, v184, v178
v_mfma_f32_16x16x32_bf16 v[160:163], a[228:231], v[32:35], v[160:163]
v_exp_f32 v137, v137
v_mfma_f32_16x16x32_bf16 v[164:167], a[228:231], v[36:39], v[164:167]
v_exp_f32 v138, v138
v_mfma_f32_16x16x32_bf16 v[168:171], a[228:231], v[96:99], v[168:171]
v_exp_f32 v139, v139
v_mfma_f32_16x16x32_bf16 v[172:175], a[228:231], v[100:103], v[172:175]
s_waitcnt lgkmcnt(1)
ds_read_b64_tr_b16 a[224:225], v190 offset:17024
v_add_f32 v184, v184, v179
v_mfma_f32_16x16x32_bf16 v[160:163], a[232:235], v[40:43], v[160:163]
ds_read_b64_tr_b16 a[226:227], v190 offset:25472
v_cvt_pk_bf16_f32 v176, v176, v177
v_mfma_f32_16x16x32_bf16 v[164:167], a[232:235], v[44:47], v[164:167]
v_exp_f32 v140, v140
v_mfma_f32_16x16x32_bf16 v[168:171], a[232:235], v[104:107], v[168:171]
v_exp_f32 v141, v141
v_mfma_f32_16x16x32_bf16 v[172:175], a[232:235], v[108:111], v[172:175]
ds_read_b64_tr_b16 a[228:229], v190 offset:17056
v_cvt_pk_bf16_f32 v177, v178, v179
v_mfma_f32_16x16x32_bf16 v[160:163], a[236:239], v[48:51], v[160:163]
ds_read_b64_tr_b16 a[230:231], v190 offset:25504
v_add_f32 v180, v180, v128
v_mfma_f32_16x16x32_bf16 v[164:167], a[236:239], v[52:55], v[164:167]
v_exp_f32 v142, v142
v_mfma_f32_16x16x32_bf16 v[168:171], a[236:239], v[112:115], v[168:171]
v_exp_f32 v143, v143
v_mfma_f32_16x16x32_bf16 v[172:175], a[236:239], v[116:119], v[172:175]
s_waitcnt lgkmcnt(2)
ds_read_b64_tr_b16 a[232:233], v190 offset:17088
v_add_f32 v180, v180, v129
v_mfma_f32_16x16x32_bf16 v[160:163], a[240:243], v[56:59], v[160:163]
ds_read_b64_tr_b16 a[234:235], v190 offset:25536
v_add_f32 v180, v180, v130
v_mfma_f32_16x16x32_bf16 v[164:167], a[240:243], v[60:63], v[164:167]
ds_write_b64 v187, v[176:177] offset:16384
v_add_f32 v180, v180, v131
v_mfma_f32_16x16x32_bf16 v[168:171], a[240:243], v[120:123], v[168:171]
ds_read_b64_tr_b16 a[236:237], v190 offset:17120
v_cvt_pk_bf16_f32 v128, v128, v129
v_mfma_f32_16x16x32_bf16 v[172:175], a[240:243], v[124:127], v[172:175]
ds_read_b64_tr_b16 a[238:239], v190 offset:25568
v_cvt_pk_bf16_f32 v129, v130, v131
v_mfma_f32_16x16x32_bf16 a[16:19], a[224:227], v[144:147], a[16:19]
ds_read_b128 a[252:255], v187 offset:19456
v_add_f32 v181, v181, v132
v_mfma_f32_16x16x32_bf16 a[80:83], a[224:227], v[148:151], a[80:83]
v_exp_f32 v160, v160
v_mfma_f32_16x16x32_bf16 a[144:147], a[224:227], v[152:155], a[144:147]
v_exp_f32 v161, v161
v_mfma_f32_16x16x32_bf16 v[208:211], a[224:227], v[156:159], v[208:211]
s_waitcnt lgkmcnt(3)
ds_read_b64_tr_b16 a[240:241], v186 offset:16896
v_add_f32 v181, v181, v133
v_mfma_f32_16x16x32_bf16 a[20:23], a[228:231], v[144:147], a[20:23]
ds_read_b64_tr_b16 a[242:243], v186 offset:25344
v_add_f32 v181, v181, v134
v_mfma_f32_16x16x32_bf16 a[84:87], a[228:231], v[148:151], a[84:87]
v_exp_f32 v162, v162
v_mfma_f32_16x16x32_bf16 a[148:151], a[228:231], v[152:155], a[148:151]
v_exp_f32 v163, v163
v_mfma_f32_16x16x32_bf16 v[212:215], a[228:231], v[156:159], v[212:215]
v_exp_f32 v164, v164
v_mfma_f32_16x16x32_bf16 a[24:27], a[232:235], v[144:147], a[24:27]
ds_read_b64_tr_b16 a[224:225], v186 offset:16960
v_add_f32 v181, v181, v135
v_mfma_f32_16x16x32_bf16 a[88:91], a[232:235], v[148:151], a[88:91]
v_exp_f32 v165, v165
v_mfma_f32_16x16x32_bf16 a[152:155], a[232:235], v[152:155], a[152:155]
v_exp_f32 v166, v166
v_mfma_f32_16x16x32_bf16 v[216:219], a[232:235], v[156:159], v[216:219]
s_waitcnt lgkmcnt(1)
v_exp_f32 v167, v167
v_mfma_f32_16x16x32_bf16 a[28:31], a[236:239], v[144:147], a[28:31]
s_add_u32 m0, s63, 16896
v_cvt_pk_bf16_f32 v132, v132, v133
v_cvt_pk_bf16_f32 v133, v134, v135
v_mfma_f32_16x16x32_bf16 a[92:95], a[236:239], v[148:151], a[92:95]
v_exp_f32 v168, v168
v_mfma_f32_16x16x32_bf16 a[156:159], a[236:239], v[152:155], a[156:159]
v_exp_f32 v169, v169
v_mfma_f32_16x16x32_bf16 v[220:223], a[236:239], v[156:159], v[220:223]
ds_read_b64_tr_b16 a[226:227], v186 offset:25408
buffer_load_dwordx4 v189, s[12:15], s61 offen offset:0 nt lds
v_mfma_f32_16x16x32_bf16 a[0:3], a[240:243], v[144:147], a[0:3]
s_add_u32 m0, s63, 16928
v_exp_f32 v170, v170
v_mfma_f32_16x16x32_bf16 a[64:67], a[240:243], v[148:151], a[64:67]
v_add_f32 v182, v182, v136
v_add_f32 v182, v182, v137
v_mfma_f32_16x16x32_bf16 a[128:131], a[240:243], v[152:155], a[128:131]
v_add_f32 v182, v182, v138
v_add_f32 v182, v182, v139
v_mfma_f32_16x16x32_bf16 v[192:195], a[240:243], v[156:159], v[192:195]
buffer_load_dwordx4 v189, s[12:15], s61 offen offset:1024 nt lds
ds_read_b64_tr_b16 a[228:229], v186 offset:16992
v_mfma_f32_16x16x32_bf16 a[192:195], a[240:243], a[248:251], a[192:195]
s_add_u32 m0, s63, 16960
v_exp_f32 v171, v171
v_mfma_f32_16x16x32_bf16 a[196:199], a[240:243], a[252:255], a[196:199]
v_cvt_pk_bf16_f32 v136, v136, v137
v_cvt_pk_bf16_f32 v137, v138, v139
v_mfma_f32_16x16x32_bf16 a[4:7], a[244:247], v[144:147], a[4:7]
ds_read_b64_tr_b16 a[230:231], v186 offset:25440
buffer_load_dwordx4 v189, s[12:15], s61 offen offset:2048 nt lds
v_mfma_f32_16x16x32_bf16 a[68:71], a[244:247], v[148:151], a[68:71]
v_exp_f32 v172, v172
v_mfma_f32_16x16x32_bf16 a[132:135], a[244:247], v[152:155], a[132:135]
s_add_u32 m0, s63, 16992
v_exp_f32 v173, v173
v_mfma_f32_16x16x32_bf16 v[196:199], a[244:247], v[156:159], v[196:199]
v_exp_f32 v174, v174
v_mfma_f32_16x16x32_bf16 a[200:203], a[244:247], a[248:251], a[200:203]
v_add_f32 v183, v183, v140
v_add_f32 v183, v183, v141
v_mfma_f32_16x16x32_bf16 a[204:207], a[244:247], a[252:255], a[204:207]
s_waitcnt lgkmcnt(1)
v_add_f32 v183, v183, v142
v_add_f32 v183, v183, v143
v_mfma_f32_16x16x32_bf16 a[8:11], a[224:227], v[144:147], a[8:11]
ds_read_b64_tr_b16 a[232:233], v186 offset:17152
buffer_load_dwordx4 v189, s[12:15], s61 offen offset:3072 nt lds
v_mfma_f32_16x16x32_bf16 a[72:75], a[224:227], v[148:151], a[72:75]
s_add_u32 m0, s64, 0
ds_read_b64_tr_b16 a[234:235], v186 offset:25600
v_cvt_pk_bf16_f32 v140, v140, v141
v_mfma_f32_16x16x32_bf16 a[136:139], a[224:227], v[152:155], a[136:139]
v_cvt_pk_bf16_f32 v141, v142, v143
v_add_f32 v180, v180, v160
v_mfma_f32_16x16x32_bf16 v[200:203], a[224:227], v[156:159], v[200:203]
v_add_f32 v180, v180, v161
v_add_f32 v180, v180, v162
v_mfma_f32_16x16x32_bf16 a[208:211], a[224:227], a[248:251], a[208:211]
ds_read_b64_tr_b16 a[236:237], v186 offset:17184
v_add_f32 v180, v180, v163
v_mfma_f32_16x16x32_bf16 a[212:215], a[224:227], a[252:255], a[212:215]
s_waitcnt lgkmcnt(3)
ds_read_b64_tr_b16 a[238:239], v186 offset:25632
buffer_load_dwordx4 v189, s[16:19], s62 offen offset:0 nt lds
v_mfma_f32_16x16x32_bf16 a[12:15], a[228:231], v[144:147], a[12:15]
s_add_u32 m0, s64, 32
v_exp_f32 v175, v175
v_mfma_f32_16x16x32_bf16 a[76:79], a[228:231], v[148:151], a[76:79]
ds_read_b64_tr_b16 a[240:241], v186 offset:17216
buffer_load_dwordx4 v189, s[16:19], s62 offen offset:1024 nt lds
v_mfma_f32_16x16x32_bf16 a[140:143], a[228:231], v[152:155], a[140:143]
s_add_u32 m0, s64, 64
ds_read_b64_tr_b16 a[242:243], v186 offset:25664
v_add_f32 v181, v181, v164
v_mfma_f32_16x16x32_bf16 v[204:207], a[228:231], v[156:159], v[204:207]
ds_read_b64_tr_b16 a[224:225], v186 offset:17248
buffer_load_dwordx4 v189, s[16:19], s62 offen offset:2048 nt lds
v_mfma_f32_16x16x32_bf16 a[216:219], a[228:231], a[248:251], a[216:219]
ds_read_b64_tr_b16 a[226:227], v186 offset:25696
v_add_f32 v181, v181, v165
v_mfma_f32_16x16x32_bf16 a[220:223], a[228:231], a[252:255], a[220:223]
s_waitcnt lgkmcnt(4)
ds_read_b64_tr_b16 a[228:229], v190 offset:17280
v_add_f32 v181, v181, v166
v_mfma_f32_16x16x32_bf16 a[32:35], a[232:235], v[144:147], a[32:35]
s_add_u32 m0, s64, 96
ds_read_b64_tr_b16 a[230:231], v190 offset:25728
v_add_f32 v181, v181, v167
v_mfma_f32_16x16x32_bf16 a[96:99], a[232:235], v[148:151], a[96:99]
buffer_load_dwordx4 v189, s[16:19], s62 offen offset:3072 nt lds
v_add_f32 v182, v182, v168
v_mfma_f32_16x16x32_bf16 a[160:163], a[232:235], v[152:155], a[160:163]
s_add_u32 s61, s61, 16384
v_add_f32 v182, v182, v169
v_add_f32 v182, v182, v170
v_mfma_f32_16x16x32_bf16 v[224:227], a[232:235], v[156:159], v[224:227]
s_add_u32 s62, s62, 16384
ds_read_b64_tr_b16 a[232:233], v190 offset:17312
v_add_f32 v182, v182, v171
v_mfma_f32_16x16x32_bf16 a[36:39], a[236:239], v[144:147], a[36:39]
ds_read_b64_tr_b16 a[234:235], v190 offset:25760
v_add_f32 v183, v183, v172
v_mfma_f32_16x16x32_bf16 a[100:103], a[236:239], v[148:151], a[100:103]
v_add_f32 v183, v183, v173
v_add_f32 v183, v183, v174
v_mfma_f32_16x16x32_bf16 a[164:167], a[236:239], v[152:155], a[164:167]
v_add_f32 v183, v183, v175
v_add_u32 v186, s74, v186
v_mfma_f32_16x16x32_bf16 v[228:231], a[236:239], v[156:159], v[228:231]
s_waitcnt lgkmcnt(2)
ds_read_b64_tr_b16 a[236:237], v190 offset:17344
v_cvt_pk_bf16_f32 v130, v160, v161
v_mfma_f32_16x16x32_bf16 a[40:43], a[240:243], v[144:147], a[40:43]
ds_read_b64_tr_b16 a[238:239], v190 offset:25792
v_cvt_pk_bf16_f32 v131, v162, v163
v_mfma_f32_16x16x32_bf16 a[104:107], a[240:243], v[148:151], a[104:107]
v_cvt_pk_bf16_f32 v134, v164, v165
v_cvt_pk_bf16_f32 v135, v166, v167
v_mfma_f32_16x16x32_bf16 a[168:171], a[240:243], v[152:155], a[168:171]
v_cvt_pk_bf16_f32 v138, v168, v169
v_cvt_pk_bf16_f32 v139, v170, v171
v_mfma_f32_16x16x32_bf16 v[232:235], a[240:243], v[156:159], v[232:235]
ds_read_b64_tr_b16 a[240:241], v190 offset:17376
v_cvt_pk_bf16_f32 v142, v172, v173
v_mfma_f32_16x16x32_bf16 a[44:47], a[224:227], v[144:147], a[44:47]
ds_read_b64_tr_b16 a[242:243], v190 offset:25824
v_add_u32 v190, s74, v190
v_mfma_f32_16x16x32_bf16 a[108:111], a[224:227], v[148:151], a[108:111]
v_cvt_pk_bf16_f32 v143, v174, v175
v_mfma_f32_16x16x32_bf16 a[172:175], a[224:227], v[152:155], a[172:175]
v_mfma_f32_16x16x32_bf16 v[236:239], a[224:227], v[156:159], v[236:239]
v_mfma_f32_16x16x32_bf16 a[48:51], a[228:231], v[144:147], a[48:51]
v_mfma_f32_16x16x32_bf16 a[112:115], a[228:231], v[148:151], a[112:115]
v_mfma_f32_16x16x32_bf16 a[176:179], a[228:231], v[152:155], a[176:179]
v_mfma_f32_16x16x32_bf16 v[240:243], a[228:231], v[156:159], v[240:243]
s_waitcnt lgkmcnt(0)
v_mfma_f32_16x16x32_bf16 a[52:55], a[232:235], v[144:147], a[52:55]
s_waitcnt lgkmcnt(0)
s_waitcnt vmcnt(16)
s_barrier
v_mfma_f32_16x16x32_bf16 a[116:119], a[232:235], v[148:151], a[116:119]
ds_read_b128 a[224:227], v185 offset:16896
v_mfma_f32_16x16x32_bf16 a[180:183], a[232:235], v[152:155], a[180:183]
ds_read_b128 a[248:251], v187 offset:0
v_mfma_f32_16x16x32_bf16 v[244:247], a[232:235], v[156:159], v[244:247]
ds_read_b128 a[252:255], v187 offset:1024
v_mfma_f32_16x16x32_bf16 a[56:59], a[236:239], v[144:147], a[56:59]
ds_read_b128 a[228:231], v185 offset:16960
v_mfma_f32_16x16x32_bf16 a[120:123], a[236:239], v[148:151], a[120:123]
ds_read_b128 a[232:235], v188 offset:17024
v_mfma_f32_16x16x32_bf16 a[184:187], a[236:239], v[152:155], a[184:187]
v_mfma_f32_16x16x32_bf16 v[248:251], a[236:239], v[156:159], v[248:251]
ds_read_b128 a[236:239], v188 offset:17088
v_mfma_f32_16x16x32_bf16 a[60:63], a[240:243], v[144:147], a[60:63]
v_mfma_f32_16x16x32_bf16 a[124:127], a[240:243], v[148:151], a[124:127]
v_mfma_f32_16x16x32_bf16 a[188:191], a[240:243], v[152:155], a[188:191]
v_mfma_f32_16x16x32_bf16 v[252:255], a[240:243], v[156:159], v[252:255]
s_add_u32 s63, s63, s47
ds_read_b128 a[240:243], v185 offset:17152
s_waitcnt lgkmcnt(2)
v_mfma_f32_16x16x32_bf16 v[144:147], a[224:227], v[0:3], 0
ds_read_b128 a[244:247], v185 offset:17216
v_mfma_f32_16x16x32_bf16 v[148:151], a[224:227], v[4:7], 0
v_mfma_f32_16x16x32_bf16 v[152:155], a[224:227], v[64:67], 0
v_mfma_f32_16x16x32_bf16 v[156:159], a[224:227], v[68:71], 0
v_mfma_f32_16x16x32_bf16 v[176:179], a[224:227], a[248:251], 0
ds_read_b128 a[248:251], v187 offset:2048
v_mfma_f32_16x16x32_bf16 v[144:147], a[228:231], v[8:11], v[144:147]
ds_read_b128 a[224:227], v188 offset:17280
v_mfma_f32_16x16x32_bf16 v[148:151], a[228:231], v[12:15], v[148:151]
v_mfma_f32_16x16x32_bf16 v[152:155], a[228:231], v[72:75], v[152:155]
v_mfma_f32_16x16x32_bf16 v[156:159], a[228:231], v[76:79], v[156:159]
v_mfma_f32_16x16x32_bf16 v[176:179], a[228:231], a[252:255], v[176:179]
ds_read_b128 a[252:255], v187 offset:3072
v_mfma_f32_16x16x32_bf16 v[144:147], a[232:235], v[16:19], v[144:147]
ds_read_b128 a[228:231], v188 offset:17344
v_mfma_f32_16x16x32_bf16 v[148:151], a[232:235], v[20:23], v[148:151]
v_mfma_f32_16x16x32_bf16 v[152:155], a[232:235], v[80:83], v[152:155]
v_mfma_f32_16x16x32_bf16 v[156:159], a[232:235], v[84:87], v[156:159]
s_waitcnt lgkmcnt(2)
v_mfma_f32_16x16x32_bf16 v[176:179], a[232:235], a[248:251], v[176:179]
ds_read_b128 a[248:251], v187 offset:4096
v_mfma_f32_16x16x32_bf16 v[144:147], a[236:239], v[24:27], v[144:147]
ds_read_b128 a[232:235], v185 offset:25344
v_mfma_f32_16x16x32_bf16 v[148:151], a[236:239], v[28:31], v[148:151]
v_mfma_f32_16x16x32_bf16 v[152:155], a[236:239], v[88:91], v[152:155]
v_mfma_f32_16x16x32_bf16 v[156:159], a[236:239], v[92:95], v[156:159]
s_waitcnt lgkmcnt(2)
v_mfma_f32_16x16x32_bf16 v[176:179], a[236:239], a[252:255], v[176:179]
ds_read_b128 a[252:255], v187 offset:5120
v_mfma_f32_16x16x32_bf16 v[144:147], a[240:243], v[32:35], v[144:147]
ds_read_b128 a[236:239], v185 offset:25408
v_mfma_f32_16x16x32_bf16 v[148:151], a[240:243], v[36:39], v[148:151]
v_mfma_f32_16x16x32_bf16 v[152:155], a[240:243], v[96:99], v[152:155]
v_mfma_f32_16x16x32_bf16 v[156:159], a[240:243], v[100:103], v[156:159]
s_waitcnt lgkmcnt(2)
v_mfma_f32_16x16x32_bf16 v[176:179], a[240:243], a[248:251], v[176:179]
ds_read_b128 a[248:251], v187 offset:6144
v_mfma_f32_16x16x32_bf16 v[144:147], a[244:247], v[40:43], v[144:147]
ds_read_b128 a[240:243], v188 offset:25472
v_mfma_f32_16x16x32_bf16 v[148:151], a[244:247], v[44:47], v[148:151]
v_mfma_f32_16x16x32_bf16 v[152:155], a[244:247], v[104:107], v[152:155]
v_mfma_f32_16x16x32_bf16 v[156:159], a[244:247], v[108:111], v[156:159]
s_waitcnt lgkmcnt(2)
v_mfma_f32_16x16x32_bf16 v[176:179], a[244:247], a[252:255], v[176:179]
ds_read_b128 a[252:255], v187 offset:7168
v_mfma_f32_16x16x32_bf16 v[144:147], a[224:227], v[48:51], v[144:147]
ds_read_b64_tr_b16 a[244:245], v186 offset:32
v_mfma_f32_16x16x32_bf16 v[148:151], a[224:227], v[52:55], v[148:151]
ds_read_b64_tr_b16 a[246:247], v186 offset:8480
v_mfma_f32_16x16x32_bf16 v[152:155], a[224:227], v[112:115], v[152:155]
v_mfma_f32_16x16x32_bf16 v[156:159], a[224:227], v[116:119], v[156:159]
s_waitcnt lgkmcnt(3)
v_mfma_f32_16x16x32_bf16 v[176:179], a[224:227], a[248:251], v[176:179]
ds_read_b128 a[224:227], v188 offset:25536
v_mfma_f32_16x16x32_bf16 v[144:147], a[228:231], v[56:59], v[144:147]
ds_read_b128 a[248:251], v187 offset:16384
v_mfma_f32_16x16x32_bf16 v[148:151], a[228:231], v[60:63], v[148:151]
v_mfma_f32_16x16x32_bf16 v[152:155], a[228:231], v[120:123], v[152:155]
v_mfma_f32_16x16x32_bf16 v[156:159], a[228:231], v[124:127], v[156:159]
s_waitcnt lgkmcnt(2)
v_mfma_f32_16x16x32_bf16 v[176:179], a[228:231], a[252:255], v[176:179]
ds_read_b128 a[228:231], v185 offset:25600
v_mfma_f32_16x16x32_bf16 v[160:163], a[232:235], v[0:3], 0
v_exp_f32 v144, v144
v_mfma_f32_16x16x32_bf16 v[164:167], a[232:235], v[4:7], 0
v_exp_f32 v145, v145
v_mfma_f32_16x16x32_bf16 v[168:171], a[232:235], v[64:67], 0
v_exp_f32 v146, v146
v_mfma_f32_16x16x32_bf16 v[172:175], a[232:235], v[68:71], 0
v_exp_f32 v147, v147
v_mfma_f32_16x16x32_bf16 v[160:163], a[236:239], v[8:11], v[160:163]
v_exp_f32 v176, v176
v_mfma_f32_16x16x32_bf16 v[164:167], a[236:239], v[12:15], v[164:167]
v_exp_f32 v177, v177
v_mfma_f32_16x16x32_bf16 v[168:171], a[236:239], v[72:75], v[168:171]
v_exp_f32 v178, v178
v_mfma_f32_16x16x32_bf16 v[172:175], a[236:239], v[76:79], v[172:175]
ds_read_b128 a[232:235], v185 offset:25664
v_add_f32 v184, v184, v176
v_mfma_f32_16x16x32_bf16 v[160:163], a[240:243], v[16:19], v[160:163]
v_exp_f32 v179, v179
v_mfma_f32_16x16x32_bf16 v[164:167], a[240:243], v[20:23], v[164:167]
v_exp_f32 v148, v148
v_mfma_f32_16x16x32_bf16 v[168:171], a[240:243], v[80:83], v[168:171]
v_exp_f32 v149, v149
v_mfma_f32_16x16x32_bf16 v[172:175], a[240:243], v[84:87], v[172:175]
s_waitcnt lgkmcnt(1)
ds_read_b128 a[236:239], v188 offset:25728
v_add_f32 v184, v184, v177
v_mfma_f32_16x16x32_bf16 v[160:163], a[224:227], v[24:27], v[160:163]
v_exp_f32 v150, v150
v_mfma_f32_16x16x32_bf16 v[164:167], a[224:227], v[28:31], v[164:167]
v_exp_f32 v151, v151
v_mfma_f32_16x16x32_bf16 v[168:171], a[224:227], v[88:91], v[168:171]
v_exp_f32 v152, v152
v_mfma_f32_16x16x32_bf16 v[172:175], a[224:227], v[92:95], v[172:175]
ds_read_b128 a[240:243], v188 offset:25792
v_add_f32 v184, v184, v178
v_mfma_f32_16x16x32_bf16 v[160:163], a[228:231], v[32:35], v[160:163]
v_exp_f32 v153, v153
v_mfma_f32_16x16x32_bf16 v[164:167], a[228:231], v[36:39], v[164:167]
v_exp_f32 v154, v154
v_mfma_f32_16x16x32_bf16 v[168:171], a[228:231], v[96:99], v[168:171]
v_exp_f32 v155, v155
v_mfma_f32_16x16x32_bf16 v[172:175], a[228:231], v[100:103], v[172:175]
s_waitcnt lgkmcnt(1)
ds_read_b64_tr_b16 a[224:225], v190 offset:128
v_add_f32 v184, v184, v179
v_mfma_f32_16x16x32_bf16 v[160:163], a[232:235], v[40:43], v[160:163]
ds_read_b64_tr_b16 a[226:227], v190 offset:8576
v_cvt_pk_bf16_f32 v176, v176, v177
v_mfma_f32_16x16x32_bf16 v[164:167], a[232:235], v[44:47], v[164:167]
v_exp_f32 v156, v156
v_mfma_f32_16x16x32_bf16 v[168:171], a[232:235], v[104:107], v[168:171]
v_exp_f32 v157, v157
v_mfma_f32_16x16x32_bf16 v[172:175], a[232:235], v[108:111], v[172:175]
ds_read_b64_tr_b16 a[228:229], v190 offset:160
v_cvt_pk_bf16_f32 v177, v178, v179
v_mfma_f32_16x16x32_bf16 v[160:163], a[236:239], v[48:51], v[160:163]
ds_read_b64_tr_b16 a[230:231], v190 offset:8608
v_add_f32 v180, v180, v144
v_mfma_f32_16x16x32_bf16 v[164:167], a[236:239], v[52:55], v[164:167]
v_exp_f32 v158, v158
v_mfma_f32_16x16x32_bf16 v[168:171], a[236:239], v[112:115], v[168:171]
v_exp_f32 v159, v159
v_mfma_f32_16x16x32_bf16 v[172:175], a[236:239], v[116:119], v[172:175]
s_waitcnt lgkmcnt(2)
ds_read_b64_tr_b16 a[232:233], v190 offset:192
v_add_f32 v180, v180, v145
v_mfma_f32_16x16x32_bf16 v[160:163], a[240:243], v[56:59], v[160:163]
ds_read_b64_tr_b16 a[234:235], v190 offset:8640
v_add_f32 v180, v180, v146
v_mfma_f32_16x16x32_bf16 v[164:167], a[240:243], v[60:63], v[164:167]
ds_write_b64 v187, v[176:177] offset:18432
v_add_f32 v180, v180, v147
v_mfma_f32_16x16x32_bf16 v[168:171], a[240:243], v[120:123], v[168:171]
ds_read_b64_tr_b16 a[236:237], v190 offset:224
v_cvt_pk_bf16_f32 v144, v144, v145
v_mfma_f32_16x16x32_bf16 v[172:175], a[240:243], v[124:127], v[172:175]
ds_read_b64_tr_b16 a[238:239], v190 offset:8672
v_cvt_pk_bf16_f32 v145, v146, v147
v_mfma_f32_16x16x32_bf16 a[16:19], a[224:227], v[128:131], a[16:19]
ds_read_b128 a[252:255], v187 offset:17408
v_add_f32 v181, v181, v148
v_mfma_f32_16x16x32_bf16 a[80:83], a[224:227], v[132:135], a[80:83]
v_exp_f32 v160, v160
v_mfma_f32_16x16x32_bf16 a[144:147], a[224:227], v[136:139], a[144:147]
v_exp_f32 v161, v161
v_mfma_f32_16x16x32_bf16 v[208:211], a[224:227], v[140:143], v[208:211]
s_waitcnt lgkmcnt(3)
ds_read_b64_tr_b16 a[240:241], v186 offset:0
v_add_f32 v181, v181, v149
v_mfma_f32_16x16x32_bf16 a[20:23], a[228:231], v[128:131], a[20:23]
ds_read_b64_tr_b16 a[242:243], v186 offset:8448
v_add_f32 v181, v181, v150
v_mfma_f32_16x16x32_bf16 a[84:87], a[228:231], v[132:135], a[84:87]
v_exp_f32 v162, v162
v_mfma_f32_16x16x32_bf16 a[148:151], a[228:231], v[136:139], a[148:151]
v_exp_f32 v163, v163
v_mfma_f32_16x16x32_bf16 v[212:215], a[228:231], v[140:143], v[212:215]
v_exp_f32 v164, v164
v_mfma_f32_16x16x32_bf16 a[24:27], a[232:235], v[128:131], a[24:27]
ds_read_b64_tr_b16 a[224:225], v186 offset:64
v_add_f32 v181, v181, v151
v_mfma_f32_16x16x32_bf16 a[88:91], a[232:235], v[132:135], a[88:91]
v_exp_f32 v165, v165
v_mfma_f32_16x16x32_bf16 a[152:155], a[232:235], v[136:139], a[152:155]
v_exp_f32 v166, v166
v_mfma_f32_16x16x32_bf16 v[216:219], a[232:235], v[140:143], v[216:219]
s_waitcnt lgkmcnt(1)
v_exp_f32 v167, v167
v_mfma_f32_16x16x32_bf16 a[28:31], a[236:239], v[128:131], a[28:31]
s_add_u32 m0, s63, 0
v_cvt_pk_bf16_f32 v148, v148, v149
v_cvt_pk_bf16_f32 v149, v150, v151
v_mfma_f32_16x16x32_bf16 a[92:95], a[236:239], v[132:135], a[92:95]
v_exp_f32 v168, v168
v_mfma_f32_16x16x32_bf16 a[156:159], a[236:239], v[136:139], a[156:159]
v_exp_f32 v169, v169
v_mfma_f32_16x16x32_bf16 v[220:223], a[236:239], v[140:143], v[220:223]
ds_read_b64_tr_b16 a[226:227], v186 offset:8512
buffer_load_dwordx4 v189, s[12:15], s61 offen offset:0 nt lds
v_mfma_f32_16x16x32_bf16 a[0:3], a[240:243], v[128:131], a[0:3]
s_add_u32 m0, s63, 32
v_exp_f32 v170, v170
v_mfma_f32_16x16x32_bf16 a[64:67], a[240:243], v[132:135], a[64:67]
v_add_f32 v182, v182, v152
v_add_f32 v182, v182, v153
v_mfma_f32_16x16x32_bf16 a[128:131], a[240:243], v[136:139], a[128:131]
v_add_f32 v182, v182, v154
v_add_f32 v182, v182, v155
v_mfma_f32_16x16x32_bf16 v[192:195], a[240:243], v[140:143], v[192:195]
buffer_load_dwordx4 v189, s[12:15], s61 offen offset:1024 nt lds
ds_read_b64_tr_b16 a[228:229], v186 offset:96
v_mfma_f32_16x16x32_bf16 a[192:195], a[240:243], a[248:251], a[192:195]
s_add_u32 m0, s63, 64
v_exp_f32 v171, v171
v_mfma_f32_16x16x32_bf16 a[196:199], a[240:243], a[252:255], a[196:199]
v_cvt_pk_bf16_f32 v152, v152, v153
v_cvt_pk_bf16_f32 v153, v154, v155
v_mfma_f32_16x16x32_bf16 a[4:7], a[244:247], v[128:131], a[4:7]
ds_read_b64_tr_b16 a[230:231], v186 offset:8544
buffer_load_dwordx4 v189, s[12:15], s61 offen offset:2048 nt lds
v_mfma_f32_16x16x32_bf16 a[68:71], a[244:247], v[132:135], a[68:71]
v_exp_f32 v172, v172
v_mfma_f32_16x16x32_bf16 a[132:135], a[244:247], v[136:139], a[132:135]
s_add_u32 m0, s63, 96
v_exp_f32 v173, v173
v_mfma_f32_16x16x32_bf16 v[196:199], a[244:247], v[140:143], v[196:199]
v_exp_f32 v174, v174
v_mfma_f32_16x16x32_bf16 a[200:203], a[244:247], a[248:251], a[200:203]
v_add_f32 v183, v183, v156
v_add_f32 v183, v183, v157
v_mfma_f32_16x16x32_bf16 a[204:207], a[244:247], a[252:255], a[204:207]
s_waitcnt lgkmcnt(1)
v_add_f32 v183, v183, v158
v_add_f32 v183, v183, v159
v_mfma_f32_16x16x32_bf16 a[8:11], a[224:227], v[128:131], a[8:11]
ds_read_b64_tr_b16 a[232:233], v186 offset:256
buffer_load_dwordx4 v189, s[12:15], s61 offen offset:3072 nt lds
v_mfma_f32_16x16x32_bf16 a[72:75], a[224:227], v[132:135], a[72:75]
s_add_u32 m0, s64, 16896
ds_read_b64_tr_b16 a[234:235], v186 offset:8704
v_cvt_pk_bf16_f32 v156, v156, v157
v_mfma_f32_16x16x32_bf16 a[136:139], a[224:227], v[136:139], a[136:139]
v_cvt_pk_bf16_f32 v157, v158, v159
v_add_f32 v180, v180, v160
v_mfma_f32_16x16x32_bf16 v[200:203], a[224:227], v[140:143], v[200:203]
v_add_f32 v180, v180, v161
v_add_f32 v180, v180, v162
v_mfma_f32_16x16x32_bf16 a[208:211], a[224:227], a[248:251], a[208:211]
ds_read_b64_tr_b16 a[236:237], v186 offset:288
v_add_f32 v180, v180, v163
v_mfma_f32_16x16x32_bf16 a[212:215], a[224:227], a[252:255], a[212:215]
s_waitcnt lgkmcnt(3)
ds_read_b64_tr_b16 a[238:239], v186 offset:8736
buffer_load_dwordx4 v189, s[16:19], s62 offen offset:0 nt lds
v_mfma_f32_16x16x32_bf16 a[12:15], a[228:231], v[128:131], a[12:15]
s_add_u32 m0, s64, 16928
v_exp_f32 v175, v175
v_mfma_f32_16x16x32_bf16 a[76:79], a[228:231], v[132:135], a[76:79]
ds_read_b64_tr_b16 a[240:241], v186 offset:320
buffer_load_dwordx4 v189, s[16:19], s62 offen offset:1024 nt lds
v_mfma_f32_16x16x32_bf16 a[140:143], a[228:231], v[136:139], a[140:143]
s_add_u32 m0, s64, 16960
ds_read_b64_tr_b16 a[242:243], v186 offset:8768
v_add_f32 v181, v181, v164
v_mfma_f32_16x16x32_bf16 v[204:207], a[228:231], v[140:143], v[204:207]
ds_read_b64_tr_b16 a[224:225], v186 offset:352
buffer_load_dwordx4 v189, s[16:19], s62 offen offset:2048 nt lds
v_mfma_f32_16x16x32_bf16 a[216:219], a[228:231], a[248:251], a[216:219]
ds_read_b64_tr_b16 a[226:227], v186 offset:8800
v_add_f32 v181, v181, v165
v_mfma_f32_16x16x32_bf16 a[220:223], a[228:231], a[252:255], a[220:223]
s_waitcnt lgkmcnt(4)
ds_read_b64_tr_b16 a[228:229], v190 offset:384
v_add_f32 v181, v181, v166
v_mfma_f32_16x16x32_bf16 a[32:35], a[232:235], v[128:131], a[32:35]
s_add_u32 m0, s64, 16992
ds_read_b64_tr_b16 a[230:231], v190 offset:8832
v_add_f32 v181, v181, v167
v_mfma_f32_16x16x32_bf16 a[96:99], a[232:235], v[132:135], a[96:99]
buffer_load_dwordx4 v189, s[16:19], s62 offen offset:3072 nt lds
v_add_f32 v182, v182, v168
v_mfma_f32_16x16x32_bf16 a[160:163], a[232:235], v[136:139], a[160:163]
s_add_u32 s61, s61, 16384
v_add_f32 v182, v182, v169
v_add_f32 v182, v182, v170
v_mfma_f32_16x16x32_bf16 v[224:227], a[232:235], v[140:143], v[224:227]
s_add_u32 s62, s62, 16384
ds_read_b64_tr_b16 a[232:233], v190 offset:416
v_add_f32 v182, v182, v171
v_mfma_f32_16x16x32_bf16 a[36:39], a[236:239], v[128:131], a[36:39]
ds_read_b64_tr_b16 a[234:235], v190 offset:8864
v_subrev_u32 v185, s47, v185
v_mfma_f32_16x16x32_bf16 a[100:103], a[236:239], v[132:135], a[100:103]
v_subrev_u32 v188, s47, v188
v_add_f32 v183, v183, v172
v_mfma_f32_16x16x32_bf16 a[164:167], a[236:239], v[136:139], a[164:167]
v_add_f32 v183, v183, v173
v_add_f32 v183, v183, v174
v_mfma_f32_16x16x32_bf16 v[228:231], a[236:239], v[140:143], v[228:231]
s_waitcnt lgkmcnt(2)
ds_read_b64_tr_b16 a[236:237], v190 offset:448
v_add_f32 v183, v183, v175
v_mfma_f32_16x16x32_bf16 a[40:43], a[240:243], v[128:131], a[40:43]
ds_read_b64_tr_b16 a[238:239], v190 offset:8896
v_cvt_pk_bf16_f32 v146, v160, v161
v_mfma_f32_16x16x32_bf16 a[104:107], a[240:243], v[132:135], a[104:107]
v_cvt_pk_bf16_f32 v147, v162, v163
v_cvt_pk_bf16_f32 v150, v164, v165
v_mfma_f32_16x16x32_bf16 a[168:171], a[240:243], v[136:139], a[168:171]
v_cvt_pk_bf16_f32 v151, v166, v167
v_cvt_pk_bf16_f32 v154, v168, v169
v_mfma_f32_16x16x32_bf16 v[232:235], a[240:243], v[140:143], v[232:235]
ds_read_b64_tr_b16 a[240:241], v190 offset:480
v_cvt_pk_bf16_f32 v155, v170, v171
v_mfma_f32_16x16x32_bf16 a[44:47], a[224:227], v[128:131], a[44:47]
ds_read_b64_tr_b16 a[242:243], v190 offset:8928
v_cvt_pk_bf16_f32 v158, v172, v173
v_mfma_f32_16x16x32_bf16 a[108:111], a[224:227], v[132:135], a[108:111]
v_cvt_pk_bf16_f32 v159, v174, v175
v_mfma_f32_16x16x32_bf16 a[172:175], a[224:227], v[136:139], a[172:175]
v_mfma_f32_16x16x32_bf16 v[236:239], a[224:227], v[140:143], v[236:239]
v_mfma_f32_16x16x32_bf16 a[48:51], a[228:231], v[128:131], a[48:51]
v_mfma_f32_16x16x32_bf16 a[112:115], a[228:231], v[132:135], a[112:115]
v_mfma_f32_16x16x32_bf16 a[176:179], a[228:231], v[136:139], a[176:179]
v_mfma_f32_16x16x32_bf16 v[240:243], a[228:231], v[140:143], v[240:243]
s_waitcnt lgkmcnt(0)
v_mfma_f32_16x16x32_bf16 a[52:55], a[232:235], v[128:131], a[52:55]
s_waitcnt lgkmcnt(0)
s_waitcnt vmcnt(16)
s_barrier
v_mfma_f32_16x16x32_bf16 a[116:119], a[232:235], v[132:135], a[116:119]
ds_read_b128 a[224:227], v185 offset:0
v_mfma_f32_16x16x32_bf16 a[180:183], a[232:235], v[136:139], a[180:183]
ds_read_b128 a[248:251], v187 offset:0
v_mfma_f32_16x16x32_bf16 v[244:247], a[232:235], v[140:143], v[244:247]
ds_read_b128 a[252:255], v187 offset:1024
v_mfma_f32_16x16x32_bf16 a[56:59], a[236:239], v[128:131], a[56:59]
ds_read_b128 a[228:231], v185 offset:64
v_mfma_f32_16x16x32_bf16 a[120:123], a[236:239], v[132:135], a[120:123]
ds_read_b128 a[232:235], v188 offset:128
v_mfma_f32_16x16x32_bf16 a[184:187], a[236:239], v[136:139], a[184:187]
v_mfma_f32_16x16x32_bf16 v[248:251], a[236:239], v[140:143], v[248:251]
ds_read_b128 a[236:239], v188 offset:192
v_mfma_f32_16x16x32_bf16 a[60:63], a[240:243], v[128:131], a[60:63]
v_mfma_f32_16x16x32_bf16 a[124:127], a[240:243], v[132:135], a[124:127]
v_mfma_f32_16x16x32_bf16 a[188:191], a[240:243], v[136:139], a[188:191]
v_mfma_f32_16x16x32_bf16 v[252:255], a[240:243], v[140:143], v[252:255]
s_sub_u32 s47, 0, s47
s_sub_u32 s74, 0, s74
s_add_u32 s46, s46, 1
s_cmp_lt_u32 s46, 15
s_cbranch_scc1 L_attloop0
s_lshr_b32 s56, s2, 5
s_and_b32 s56, s56, 7
s_mul_i32 s56, s56, 57344
s_add_u32 s56, s56, 0
s_waitcnt lgkmcnt(1)
ds_read_b64_tr_b16 a[224:225], v190 offset:17024
ds_read_b64_tr_b16 a[226:227], v190 offset:25472
s_waitcnt lgkmcnt(0)
v_mfma_f32_16x16x32_bf16 a[16:19], a[224:227], v[144:147], a[16:19]
ds_read_b64_tr_b16 a[228:229], v190 offset:17056
v_mfma_f32_16x16x32_bf16 a[80:83], a[224:227], v[148:151], a[80:83]
ds_read_b64_tr_b16 a[230:231], v190 offset:25504
ds_read_b64_tr_b16 a[232:233], v190 offset:17088
ds_read_b64_tr_b16 a[234:235], v190 offset:25536
v_mfma_f32_16x16x32_bf16 a[144:147], a[224:227], v[152:155], a[144:147]
ds_read_b64_tr_b16 a[236:237], v190 offset:17120
buffer_load_dwordx4 v[176:179], v189, s[20:23], s56 offen offset:0
v_mfma_f32_16x16x32_bf16 v[208:211], a[224:227], v[156:159], v[208:211]
s_waitcnt lgkmcnt(3)
ds_read_b64_tr_b16 a[238:239], v190 offset:25568
v_mfma_f32_16x16x32_bf16 a[20:23], a[228:231], v[144:147], a[20:23]
ds_read_b128 a[248:251], v187 offset:18432
v_mfma_f32_16x16x32_bf16 a[84:87], a[228:231], v[148:151], a[84:87]
ds_read_b128 a[252:255], v187 offset:19456
v_mfma_f32_16x16x32_bf16 a[148:151], a[228:231], v[152:155], a[148:151]
ds_read_b64_tr_b16 a[240:241], v186 offset:16896
buffer_load_dwordx4 v[176:179], v189, s[20:23], s56 offen offset:1024
v_mfma_f32_16x16x32_bf16 v[212:215], a[228:231], v[156:159], v[212:215]
s_waitcnt lgkmcnt(5)
ds_read_b64_tr_b16 a[242:243], v186 offset:25344
v_mfma_f32_16x16x32_bf16 a[24:27], a[232:235], v[144:147], a[24:27]
ds_read_b64_tr_b16 a[244:245], v186 offset:16928
v_mfma_f32_16x16x32_bf16 a[88:91], a[232:235], v[148:151], a[88:91]
ds_read_b64_tr_b16 a[246:247], v186 offset:25376
v_mfma_f32_16x16x32_bf16 a[152:155], a[232:235], v[152:155], a[152:155]
buffer_load_dwordx4 v[176:179], v189, s[20:23], s56 offen offset:2048
ds_read_b64_tr_b16 a[224:225], v186 offset:16960
v_mfma_f32_16x16x32_bf16 v[216:219], a[232:235], v[156:159], v[216:219]
s_waitcnt lgkmcnt(5)
ds_read_b64_tr_b16 a[226:227], v186 offset:25408
v_mfma_f32_16x16x32_bf16 a[28:31], a[236:239], v[144:147], a[28:31]
ds_read_b64_tr_b16 a[228:229], v186 offset:16992
v_mfma_f32_16x16x32_bf16 a[92:95], a[236:239], v[148:151], a[92:95]
ds_read_b64_tr_b16 a[230:231], v186 offset:25440
v_mfma_f32_16x16x32_bf16 a[156:159], a[236:239], v[152:155], a[156:159]
buffer_load_dwordx4 v[176:179], v189, s[20:23], s56 offen offset:3072
ds_read_b64_tr_b16 a[232:233], v186 offset:17152
v_mfma_f32_16x16x32_bf16 v[220:223], a[236:239], v[156:159], v[220:223]
s_waitcnt lgkmcnt(5)
s_add_u32 s56, s56, 4096
ds_read_b64_tr_b16 a[234:235], v186 offset:25600
v_mfma_f32_16x16x32_bf16 a[0:3], a[240:243], v[144:147], a[0:3]
ds_read_b64_tr_b16 a[236:237], v186 offset:17184
v_mfma_f32_16x16x32_bf16 a[64:67], a[240:243], v[148:151], a[64:67]
ds_read_b64_tr_b16 a[238:239], v186 offset:25632
v_mfma_f32_16x16x32_bf16 a[128:131], a[240:243], v[152:155], a[128:131]
buffer_load_dwordx4 v[176:179], v189, s[20:23], s56 offen offset:0
v_mfma_f32_16x16x32_bf16 v[192:195], a[240:243], v[156:159], v[192:195]
v_mfma_f32_16x16x32_bf16 a[192:195], a[240:243], a[248:251], a[192:195]
v_mfma_f32_16x16x32_bf16 a[196:199], a[240:243], a[252:255], a[196:199]
ds_read_b64_tr_b16 a[240:241], v186 offset:17216
v_mfma_f32_16x16x32_bf16 a[4:7], a[244:247], v[144:147], a[4:7]
buffer_load_dwordx4 v[176:179], v189, s[20:23], s56 offen offset:1024
ds_read_b64_tr_b16 a[242:243], v186 offset:25664
v_mfma_f32_16x16x32_bf16 a[68:71], a[244:247], v[148:151], a[68:71]
v_mfma_f32_16x16x32_bf16 a[132:135], a[244:247], v[152:155], a[132:135]
v_mfma_f32_16x16x32_bf16 v[196:199], a[244:247], v[156:159], v[196:199]
v_mfma_f32_16x16x32_bf16 a[200:203], a[244:247], a[248:251], a[200:203]
buffer_load_dwordx4 v[176:179], v189, s[20:23], s56 offen offset:2048
v_mfma_f32_16x16x32_bf16 a[204:207], a[244:247], a[252:255], a[204:207]
s_waitcnt lgkmcnt(1)
v_mfma_f32_16x16x32_bf16 a[8:11], a[224:227], v[144:147], a[8:11]
v_mfma_f32_16x16x32_bf16 a[72:75], a[224:227], v[148:151], a[72:75]
v_mfma_f32_16x16x32_bf16 a[136:139], a[224:227], v[152:155], a[136:139]
buffer_load_dwordx4 v[176:179], v189, s[20:23], s56 offen offset:3072
v_mfma_f32_16x16x32_bf16 v[200:203], a[224:227], v[156:159], v[200:203]
s_add_u32 s56, s56, 4096
v_mfma_f32_16x16x32_bf16 a[208:211], a[224:227], a[248:251], a[208:211]
v_mfma_f32_16x16x32_bf16 a[212:215], a[224:227], a[252:255], a[212:215]
ds_read_b64_tr_b16 a[224:225], v186 offset:17248
v_mfma_f32_16x16x32_bf16 a[12:15], a[228:231], v[144:147], a[12:15]
buffer_load_dwordx4 v[176:179], v189, s[20:23], s56 offen offset:0
ds_read_b64_tr_b16 a[226:227], v186 offset:25696
v_mfma_f32_16x16x32_bf16 a[76:79], a[228:231], v[148:151], a[76:79]
v_mfma_f32_16x16x32_bf16 a[140:143], a[228:231], v[152:155], a[140:143]
v_mfma_f32_16x16x32_bf16 v[204:207], a[228:231], v[156:159], v[204:207]
v_mfma_f32_16x16x32_bf16 a[216:219], a[228:231], a[248:251], a[216:219]
buffer_load_dwordx4 v[176:179], v189, s[20:23], s56 offen offset:1024
v_mfma_f32_16x16x32_bf16 a[220:223], a[228:231], a[252:255], a[220:223]
ds_read_b64_tr_b16 a[228:229], v190 offset:17280
v_mfma_f32_16x16x32_bf16 a[32:35], a[232:235], v[144:147], a[32:35]
ds_read_b64_tr_b16 a[230:231], v190 offset:25728
v_mfma_f32_16x16x32_bf16 a[96:99], a[232:235], v[148:151], a[96:99]
v_mfma_f32_16x16x32_bf16 a[160:163], a[232:235], v[152:155], a[160:163]
buffer_load_dwordx4 v[176:179], v189, s[20:23], s56 offen offset:2048
v_mfma_f32_16x16x32_bf16 v[224:227], a[232:235], v[156:159], v[224:227]
ds_read_b64_tr_b16 a[232:233], v190 offset:17312
v_mfma_f32_16x16x32_bf16 a[36:39], a[236:239], v[144:147], a[36:39]
ds_read_b64_tr_b16 a[234:235], v190 offset:25760
v_mfma_f32_16x16x32_bf16 a[100:103], a[236:239], v[148:151], a[100:103]
v_mfma_f32_16x16x32_bf16 a[164:167], a[236:239], v[152:155], a[164:167]
buffer_load_dwordx4 v[176:179], v189, s[20:23], s56 offen offset:3072
v_mfma_f32_16x16x32_bf16 v[228:231], a[236:239], v[156:159], v[228:231]
s_waitcnt lgkmcnt(2)
s_add_u32 s56, s56, 4096
ds_read_b64_tr_b16 a[236:237], v190 offset:17344
v_mfma_f32_16x16x32_bf16 a[40:43], a[240:243], v[144:147], a[40:43]
ds_read_b64_tr_b16 a[238:239], v190 offset:25792
v_mfma_f32_16x16x32_bf16 a[104:107], a[240:243], v[148:151], a[104:107]
v_mfma_f32_16x16x32_bf16 a[168:171], a[240:243], v[152:155], a[168:171]
buffer_load_dwordx4 v[176:179], v189, s[20:23], s56 offen offset:0
v_mfma_f32_16x16x32_bf16 v[232:235], a[240:243], v[156:159], v[232:235]
ds_read_b64_tr_b16 a[240:241], v190 offset:17376
v_mfma_f32_16x16x32_bf16 a[44:47], a[224:227], v[144:147], a[44:47]
ds_read_b64_tr_b16 a[242:243], v190 offset:25824
v_mfma_f32_16x16x32_bf16 a[108:111], a[224:227], v[148:151], a[108:111]
v_mfma_f32_16x16x32_bf16 a[172:175], a[224:227], v[152:155], a[172:175]
buffer_load_dwordx4 v[176:179], v189, s[20:23], s56 offen offset:1024
v_mfma_f32_16x16x32_bf16 v[236:239], a[224:227], v[156:159], v[236:239]
v_mfma_f32_16x16x32_bf16 a[48:51], a[228:231], v[144:147], a[48:51]
v_mfma_f32_16x16x32_bf16 a[112:115], a[228:231], v[148:151], a[112:115]
v_mfma_f32_16x16x32_bf16 a[176:179], a[228:231], v[152:155], a[176:179]
v_mfma_f32_16x16x32_bf16 v[240:243], a[228:231], v[156:159], v[240:243]
s_waitcnt lgkmcnt(0)
v_mfma_f32_16x16x32_bf16 a[52:55], a[232:235], v[144:147], a[52:55]
v_mfma_f32_16x16x32_bf16 a[116:119], a[232:235], v[148:151], a[116:119]
v_mfma_f32_16x16x32_bf16 a[180:183], a[232:235], v[152:155], a[180:183]
v_mfma_f32_16x16x32_bf16 v[244:247], a[232:235], v[156:159], v[244:247]
v_mfma_f32_16x16x32_bf16 a[56:59], a[236:239], v[144:147], a[56:59]
v_mfma_f32_16x16x32_bf16 a[120:123], a[236:239], v[148:151], a[120:123]
v_mfma_f32_16x16x32_bf16 a[184:187], a[236:239], v[152:155], a[184:187]
v_mfma_f32_16x16x32_bf16 v[248:251], a[236:239], v[156:159], v[248:251]
v_mfma_f32_16x16x32_bf16 a[60:63], a[240:243], v[144:147], a[60:63]
v_mfma_f32_16x16x32_bf16 a[124:127], a[240:243], v[148:151], a[124:127]
v_mfma_f32_16x16x32_bf16 a[188:191], a[240:243], v[152:155], a[188:191]
v_mfma_f32_16x16x32_bf16 v[252:255], a[240:243], v[156:159], v[252:255]
s_branch L_att_done
L_att1:
ds_read_b128 a[224:227], v185 offset:8448
ds_read_b128 a[248:251], v187 offset:0
ds_read_b128 a[252:255], v187 offset:1024
ds_read_b128 a[228:231], v185 offset:8512
ds_read_b128 a[232:235], v188 offset:8576
ds_read_b128 a[236:239], v188 offset:8640
ds_read_b128 a[240:243], v185 offset:8704
s_waitcnt lgkmcnt(6)
v_mfma_f32_16x16x32_bf16 v[128:131], a[224:227], v[32:35], 0
ds_read_b128 a[244:247], v185 offset:8768
v_mfma_f32_16x16x32_bf16 v[132:135], a[224:227], v[36:39], 0
s_add_u32 m0, s45, 16896
v_mfma_f32_16x16x32_bf16 v[136:139], a[224:227], v[96:99], 0
buffer_load_dwordx4 v189, s[16:19], s50 offen offset:0 nt lds
v_mfma_f32_16x16x32_bf16 v[140:143], a[224:227], v[100:103], 0
s_waitcnt lgkmcnt(6)
v_mfma_f32_16x16x32_bf16 v[176:179], a[224:227], a[248:251], 0
s_waitcnt lgkmcnt(4)
ds_read_b128 a[248:251], v187 offset:2048
v_mfma_f32_16x16x32_bf16 v[128:131], a[228:231], v[40:43], v[128:131]
ds_read_b128 a[224:227], v188 offset:8832
v_mfma_f32_16x16x32_bf16 v[132:135], a[228:231], v[44:47], v[132:135]
v_mfma_f32_16x16x32_bf16 v[136:139], a[228:231], v[104:107], v[136:139]
v_mfma_f32_16x16x32_bf16 v[140:143], a[228:231], v[108:111], v[140:143]
s_add_u32 m0, s45, 16928
v_mfma_f32_16x16x32_bf16 v[176:179], a[228:231], a[252:255], v[176:179]
s_waitcnt lgkmcnt(2)
ds_read_b128 a[252:255], v187 offset:3072
buffer_load_dwordx4 v189, s[16:19], s50 offen offset:1024 nt lds
v_mfma_f32_16x16x32_bf16 v[128:131], a[232:235], v[48:51], v[128:131]
ds_read_b128 a[228:231], v188 offset:8896
v_mfma_f32_16x16x32_bf16 v[132:135], a[232:235], v[52:55], v[132:135]
v_mfma_f32_16x16x32_bf16 v[136:139], a[232:235], v[112:115], v[136:139]
v_mfma_f32_16x16x32_bf16 v[140:143], a[232:235], v[116:119], v[140:143]
s_waitcnt lgkmcnt(2)
v_mfma_f32_16x16x32_bf16 v[176:179], a[232:235], a[248:251], v[176:179]
ds_read_b128 a[248:251], v187 offset:4096
v_mfma_f32_16x16x32_bf16 v[128:131], a[236:239], v[56:59], v[128:131]
s_add_u32 m0, s45, 16960
ds_read_b128 a[232:235], v185 offset:0
v_mfma_f32_16x16x32_bf16 v[132:135], a[236:239], v[60:63], v[132:135]
buffer_load_dwordx4 v189, s[16:19], s50 offen offset:2048 nt lds
v_mfma_f32_16x16x32_bf16 v[136:139], a[236:239], v[120:123], v[136:139]
v_mfma_f32_16x16x32_bf16 v[140:143], a[236:239], v[124:127], v[140:143]
s_waitcnt lgkmcnt(2)
v_mfma_f32_16x16x32_bf16 v[176:179], a[236:239], a[252:255], v[176:179]
ds_read_b128 a[252:255], v187 offset:5120
v_mfma_f32_16x16x32_bf16 v[128:131], a[240:243], v[0:3], v[128:131]
ds_read_b128 a[236:239], v185 offset:64
v_mfma_f32_16x16x32_bf16 v[132:135], a[240:243], v[4:7], v[132:135]
v_mfma_f32_16x16x32_bf16 v[136:139], a[240:243], v[64:67], v[136:139]
s_add_u32 m0, s45, 16992
v_mfma_f32_16x16x32_bf16 v[140:143], a[240:243], v[68:71], v[140:143]
s_waitcnt lgkmcnt(2)
buffer_load_dwordx4 v189, s[16:19], s50 offen offset:3072 nt lds
v_mfma_f32_16x16x32_bf16 v[176:179], a[240:243], a[248:251], v[176:179]
ds_read_b128 a[248:251], v187 offset:6144
v_mfma_f32_16x16x32_bf16 v[128:131], a[244:247], v[8:11], v[128:131]
ds_read_b128 a[240:243], v188 offset:128
v_mfma_f32_16x16x32_bf16 v[132:135], a[244:247], v[12:15], v[132:135]
v_mfma_f32_16x16x32_bf16 v[136:139], a[244:247], v[72:75], v[136:139]
v_mfma_f32_16x16x32_bf16 v[140:143], a[244:247], v[76:79], v[140:143]
s_waitcnt lgkmcnt(2)
v_mfma_f32_16x16x32_bf16 v[176:179], a[244:247], a[252:255], v[176:179]
s_add_u32 m0, s64, 0
ds_read_b128 a[252:255], v187 offset:7168
v_mfma_f32_16x16x32_bf16 v[128:131], a[224:227], v[16:19], v[128:131]
buffer_load_dwordx4 v189, s[16:19], s51 offen offset:0 nt lds
v_mfma_f32_16x16x32_bf16 v[132:135], a[224:227], v[20:23], v[132:135]
v_mfma_f32_16x16x32_bf16 v[136:139], a[224:227], v[80:83], v[136:139]
v_mfma_f32_16x16x32_bf16 v[140:143], a[224:227], v[84:87], v[140:143]
s_waitcnt lgkmcnt(1)
v_mfma_f32_16x16x32_bf16 v[176:179], a[224:227], a[248:251], v[176:179]
ds_read_b128 a[224:227], v188 offset:192
v_mfma_f32_16x16x32_bf16 v[128:131], a[228:231], v[24:27], v[128:131]
v_mfma_f32_16x16x32_bf16 v[132:135], a[228:231], v[28:31], v[132:135]
s_add_u32 m0, s64, 32
v_mfma_f32_16x16x32_bf16 v[136:139], a[228:231], v[88:91], v[136:139]
buffer_load_dwordx4 v189, s[16:19], s51 offen offset:1024 nt lds
v_mfma_f32_16x16x32_bf16 v[140:143], a[228:231], v[92:95], v[140:143]
s_waitcnt lgkmcnt(1)
v_mfma_f32_16x16x32_bf16 v[176:179], a[228:231], a[252:255], v[176:179]
ds_read_b128 a[228:231], v185 offset:256
v_mfma_f32_16x16x32_bf16 v[160:163], a[232:235], v[32:35], 0
v_exp_f32 v128, v128
v_mfma_f32_16x16x32_bf16 v[164:167], a[232:235], v[36:39], 0
v_exp_f32 v132, v132
v_mfma_f32_16x16x32_bf16 v[168:171], a[232:235], v[96:99], 0
v_exp_f32 v136, v136
v_mfma_f32_16x16x32_bf16 v[172:175], a[232:235], v[100:103], 0
s_add_u32 m0, s64, 64
v_exp_f32 v140, v140
v_mfma_f32_16x16x32_bf16 v[160:163], a[236:239], v[40:43], v[160:163]
v_exp_f32 v176, v176
v_mfma_f32_16x16x32_bf16 v[164:167], a[236:239], v[44:47], v[164:167]
v_exp_f32 v177, v177
v_mfma_f32_16x16x32_bf16 v[168:171], a[236:239], v[104:107], v[168:171]
buffer_load_dwordx4 v189, s[16:19], s51 offen offset:2048 nt lds
ds_read_b128 a[232:235], v185 offset:320
v_mfma_f32_16x16x32_bf16 v[172:175], a[236:239], v[108:111], v[172:175]
v_exp_f32 v178, v178
v_mfma_f32_16x16x32_bf16 v[160:163], a[240:243], v[48:51], v[160:163]
v_exp_f32 v179, v179
v_mfma_f32_16x16x32_bf16 v[164:167], a[240:243], v[52:55], v[164:167]
v_exp_f32 v129, v129
v_mfma_f32_16x16x32_bf16 v[168:171], a[240:243], v[112:115], v[168:171]
s_add_u32 m0, s64, 96
v_exp_f32 v133, v133
v_mfma_f32_16x16x32_bf16 v[172:175], a[240:243], v[116:119], v[172:175]
s_waitcnt lgkmcnt(1)
ds_read_b128 a[236:239], v188 offset:384
buffer_load_dwordx4 v189, s[16:19], s51 offen offset:3072 nt lds
v_mfma_f32_16x16x32_bf16 v[160:163], a[224:227], v[56:59], v[160:163]
v_exp_f32 v137, v137
v_mfma_f32_16x16x32_bf16 v[164:167], a[224:227], v[60:63], v[164:167]
v_exp_f32 v141, v141
v_mfma_f32_16x16x32_bf16 v[168:171], a[224:227], v[120:123], v[168:171]
v_exp_f32 v130, v130
v_mfma_f32_16x16x32_bf16 v[172:175], a[224:227], v[124:127], v[172:175]
ds_read_b128 a[240:243], v188 offset:448
v_add_f32 v184, v184, v176
v_mfma_f32_16x16x32_bf16 v[160:163], a[228:231], v[0:3], v[160:163]
v_exp_f32 v134, v134
v_mfma_f32_16x16x32_bf16 v[164:167], a[228:231], v[4:7], v[164:167]
v_exp_f32 v138, v138
v_mfma_f32_16x16x32_bf16 v[168:171], a[228:231], v[64:67], v[168:171]
v_exp_f32 v142, v142
v_mfma_f32_16x16x32_bf16 v[172:175], a[228:231], v[68:71], v[172:175]
s_waitcnt lgkmcnt(1)
v_exp_f32 v131, v131
v_mfma_f32_16x16x32_bf16 v[160:163], a[232:235], v[8:11], v[160:163]
v_exp_f32 v135, v135
v_mfma_f32_16x16x32_bf16 v[164:167], a[232:235], v[12:15], v[164:167]
v_add_f32 v184, v184, v177
v_add_f32 v184, v184, v178
v_mfma_f32_16x16x32_bf16 v[168:171], a[232:235], v[72:75], v[168:171]
v_add_f32 v184, v184, v179
v_cvt_pk_bf16_f32 v176, v176, v177
v_mfma_f32_16x16x32_bf16 v[172:175], a[232:235], v[76:79], v[172:175]
v_exp_f32 v139, v139
v_mfma_f32_16x16x32_bf16 v[160:163], a[236:239], v[16:19], v[160:163]
v_exp_f32 v143, v143
v_mfma_f32_16x16x32_bf16 v[164:167], a[236:239], v[20:23], v[164:167]
v_cvt_pk_bf16_f32 v177, v178, v179
v_add_f32 v180, v180, v128
v_mfma_f32_16x16x32_bf16 v[168:171], a[236:239], v[80:83], v[168:171]
ds_write_b64 v187, v[176:177] offset:16392
v_add_f32 v180, v180, v129
v_mfma_f32_16x16x32_bf16 v[172:175], a[236:239], v[84:87], v[172:175]
s_waitcnt lgkmcnt(1)
v_add_f32 v180, v180, v130
v_add_f32 v180, v180, v131
v_mfma_f32_16x16x32_bf16 v[160:163], a[240:243], v[24:27], v[160:163]
v_cvt_pk_bf16_f32 v131, v130, v131
v_cvt_pk_bf16_f32 v130, v128, v129
v_mfma_f32_16x16x32_bf16 v[164:167], a[240:243], v[28:31], v[164:167]
v_add_f32 v181, v181, v132
v_add_f32 v181, v181, v133
v_mfma_f32_16x16x32_bf16 v[168:171], a[240:243], v[88:91], v[168:171]
v_add_f32 v181, v181, v134
v_add_f32 v181, v181, v135
v_mfma_f32_16x16x32_bf16 v[172:175], a[240:243], v[92:95], v[172:175]
s_waitcnt lgkmcnt(0)
s_waitcnt vmcnt(8)
s_barrier
ds_read_b128 a[224:227], v185 offset:25344
ds_read_b128 a[248:251], v187 offset:0
ds_read_b128 a[252:255], v187 offset:1024
ds_read_b128 a[228:231], v185 offset:25408
ds_read_b128 a[232:235], v188 offset:25472
ds_read_b128 a[236:239], v188 offset:25536
v_cvt_pk_bf16_f32 v135, v134, v135
v_cvt_pk_bf16_f32 v134, v132, v133
v_add_f32 v182, v182, v136
v_add_f32 v182, v182, v137
v_add_f32 v182, v182, v138
v_add_f32 v182, v182, v139
v_cvt_pk_bf16_f32 v139, v138, v139
v_cvt_pk_bf16_f32 v138, v136, v137
v_add_f32 v183, v183, v140
v_add_f32 v183, v183, v141
v_add_f32 v183, v183, v142
v_add_f32 v183, v183, v143
v_cvt_pk_bf16_f32 v143, v142, v143
v_cvt_pk_bf16_f32 v142, v140, v141
v_exp_f32 v160, v160
s_nop 0
v_add_f32 v180, v180, v160
v_exp_f32 v161, v161
s_nop 0
v_add_f32 v180, v180, v161
v_exp_f32 v162, v162
s_nop 0
v_add_f32 v180, v180, v162
v_exp_f32 v163, v163
s_nop 0
v_add_f32 v180, v180, v163
v_cvt_pk_bf16_f32 v128, v160, v161
v_cvt_pk_bf16_f32 v129, v162, v163
v_exp_f32 v164, v164
s_nop 0
v_add_f32 v181, v181, v164
v_exp_f32 v165, v165
s_nop 0
v_add_f32 v181, v181, v165
v_exp_f32 v166, v166
s_nop 0
v_add_f32 v181, v181, v166
v_exp_f32 v167, v167
s_nop 0
v_add_f32 v181, v181, v167
v_cvt_pk_bf16_f32 v132, v164, v165
v_cvt_pk_bf16_f32 v133, v166, v167
v_exp_f32 v168, v168
s_nop 0
v_add_f32 v182, v182, v168
v_exp_f32 v169, v169
s_nop 0
v_add_f32 v182, v182, v169
v_exp_f32 v170, v170
s_nop 0
v_add_f32 v182, v182, v170
v_exp_f32 v171, v171
s_nop 0
v_add_f32 v182, v182, v171
v_cvt_pk_bf16_f32 v136, v168, v169
v_cvt_pk_bf16_f32 v137, v170, v171
v_exp_f32 v172, v172
s_nop 0
v_add_f32 v183, v183, v172
v_exp_f32 v173, v173
s_nop 0
v_add_f32 v183, v183, v173
v_exp_f32 v174, v174
s_nop 0
v_add_f32 v183, v183, v174
v_exp_f32 v175, v175
s_nop 0
v_add_f32 v183, v183, v175
v_cvt_pk_bf16_f32 v140, v172, v173
v_cvt_pk_bf16_f32 v141, v174, v175
s_sub_u32 s63, s63, 4294837248
ds_read_b128 a[240:243], v185 offset:25600
s_waitcnt lgkmcnt(6)
v_mfma_f32_16x16x32_bf16 v[144:147], a[224:227], v[32:35], 0
ds_read_b128 a[244:247], v185 offset:25664
v_mfma_f32_16x16x32_bf16 v[148:151], a[224:227], v[36:39], 0
v_mfma_f32_16x16x32_bf16 v[152:155], a[224:227], v[96:99], 0
v_mfma_f32_16x16x32_bf16 v[156:159], a[224:227], v[100:103], 0
s_waitcnt lgkmcnt(6)
v_mfma_f32_16x16x32_bf16 v[176:179], a[224:227], a[248:251], 0
s_waitcnt lgkmcnt(4)
ds_read_b128 a[248:251], v187 offset:2048
v_mfma_f32_16x16x32_bf16 v[144:147], a[228:231], v[40:43], v[144:147]
ds_read_b128 a[224:227], v188 offset:25728
v_mfma_f32_16x16x32_bf16 v[148:151], a[228:231], v[44:47], v[148:151]
v_mfma_f32_16x16x32_bf16 v[152:155], a[228:231], v[104:107], v[152:155]
v_mfma_f32_16x16x32_bf16 v[156:159], a[228:231], v[108:111], v[156:159]
v_mfma_f32_16x16x32_bf16 v[176:179], a[228:231], a[252:255], v[176:179]
s_waitcnt lgkmcnt(2)
ds_read_b128 a[252:255], v187 offset:3072
v_mfma_f32_16x16x32_bf16 v[144:147], a[232:235], v[48:51], v[144:147]
ds_read_b128 a[228:231], v188 offset:25792
v_mfma_f32_16x16x32_bf16 v[148:151], a[232:235], v[52:55], v[148:151]
v_mfma_f32_16x16x32_bf16 v[152:155], a[232:235], v[112:115], v[152:155]
v_mfma_f32_16x16x32_bf16 v[156:159], a[232:235], v[116:119], v[156:159]
s_waitcnt lgkmcnt(2)
v_mfma_f32_16x16x32_bf16 v[176:179], a[232:235], a[248:251], v[176:179]
ds_read_b128 a[248:251], v187 offset:4096
v_mfma_f32_16x16x32_bf16 v[144:147], a[236:239], v[56:59], v[144:147]
ds_read_b128 a[232:235], v185 offset:16896
v_mfma_f32_16x16x32_bf16 v[148:151], a[236:239], v[60:63], v[148:151]
v_mfma_f32_16x16x32_bf16 v[152:155], a[236:239], v[120:123], v[152:155]
v_mfma_f32_16x16x32_bf16 v[156:159], a[236:239], v[124:127], v[156:159]
s_waitcnt lgkmcnt(2)
v_mfma_f32_16x16x32_bf16 v[176:179], a[236:239], a[252:255], v[176:179]
ds_read_b128 a[252:255], v187 offset:5120
v_mfma_f32_16x16x32_bf16 v[144:147], a[240:243], v[0:3], v[144:147]
ds_read_b128 a[236:239], v185 offset:16960
v_mfma_f32_16x16x32_bf16 v[148:151], a[240:243], v[4:7], v[148:151]
v_mfma_f32_16x16x32_bf16 v[152:155], a[240:243], v[64:67], v[152:155]
v_mfma_f32_16x16x32_bf16 v[156:159], a[240:243], v[68:71], v[156:159]
s_waitcnt lgkmcnt(2)
v_mfma_f32_16x16x32_bf16 v[176:179], a[240:243], a[248:251], v[176:179]
ds_read_b128 a[248:251], v187 offset:6144
v_mfma_f32_16x16x32_bf16 v[144:147], a[244:247], v[8:11], v[144:147]
ds_read_b128 a[240:243], v188 offset:17024
v_mfma_f32_16x16x32_bf16 v[148:151], a[244:247], v[12:15], v[148:151]
v_mfma_f32_16x16x32_bf16 v[152:155], a[244:247], v[72:75], v[152:155]
v_mfma_f32_16x16x32_bf16 v[156:159], a[244:247], v[76:79], v[156:159]
s_waitcnt lgkmcnt(2)
v_mfma_f32_16x16x32_bf16 v[176:179], a[244:247], a[252:255], v[176:179]
ds_read_b128 a[252:255], v187 offset:7168
v_mfma_f32_16x16x32_bf16 v[144:147], a[224:227], v[16:19], v[144:147]
ds_read_b64_tr_b16 a[244:245], v190 offset:160
v_mfma_f32_16x16x32_bf16 v[148:151], a[224:227], v[20:23], v[148:151]
ds_read_b64_tr_b16 a[246:247], v190 offset:8608
v_mfma_f32_16x16x32_bf16 v[152:155], a[224:227], v[80:83], v[152:155]
v_mfma_f32_16x16x32_bf16 v[156:159], a[224:227], v[84:87], v[156:159]
s_waitcnt lgkmcnt(3)
v_mfma_f32_16x16x32_bf16 v[176:179], a[224:227], a[248:251], v[176:179]
ds_read_b128 a[224:227], v188 offset:17088
v_mfma_f32_16x16x32_bf16 v[144:147], a[228:231], v[24:27], v[144:147]
ds_read_b128 a[248:251], v187 offset:16384
v_mfma_f32_16x16x32_bf16 v[148:151], a[228:231], v[28:31], v[148:151]
v_mfma_f32_16x16x32_bf16 v[152:155], a[228:231], v[88:91], v[152:155]
v_mfma_f32_16x16x32_bf16 v[156:159], a[228:231], v[92:95], v[156:159]
s_waitcnt lgkmcnt(2)
v_mfma_f32_16x16x32_bf16 v[176:179], a[228:231], a[252:255], v[176:179]
ds_read_b128 a[228:231], v185 offset:17152
v_mfma_f32_16x16x32_bf16 v[160:163], a[232:235], v[32:35], 0
v_exp_f32 v144, v144
v_mfma_f32_16x16x32_bf16 v[164:167], a[232:235], v[36:39], 0
v_exp_f32 v145, v145
v_mfma_f32_16x16x32_bf16 v[168:171], a[232:235], v[96:99], 0
v_exp_f32 v146, v146
v_mfma_f32_16x16x32_bf16 v[172:175], a[232:235], v[100:103], 0
v_exp_f32 v147, v147
v_mfma_f32_16x16x32_bf16 v[160:163], a[236:239], v[40:43], v[160:163]
v_exp_f32 v176, v176
v_mfma_f32_16x16x32_bf16 v[164:167], a[236:239], v[44:47], v[164:167]
v_exp_f32 v177, v177
v_mfma_f32_16x16x32_bf16 v[168:171], a[236:239], v[104:107], v[168:171]
v_exp_f32 v178, v178
v_mfma_f32_16x16x32_bf16 v[172:175], a[236:239], v[108:111], v[172:175]
ds_read_b128 a[232:235], v185 offset:17216
v_add_f32 v184, v184, v176
v_mfma_f32_16x16x32_bf16 v[160:163], a[240:243], v[48:51], v[160:163]
v_exp_f32 v179, v179
v_mfma_f32_16x16x32_bf16 v[164:167], a[240:243], v[52:55], v[164:167]
v_exp_f32 v148, v148
v_mfma_f32_16x16x32_bf16 v[168:171], a[240:243], v[112:115], v[168:171]
v_exp_f32 v149, v149
v_mfma_f32_16x16x32_bf16 v[172:175], a[240:243], v[116:119], v[172:175]
s_waitcnt lgkmcnt(1)
ds_read_b128 a[236:239], v188 offset:17280
v_add_f32 v184, v184, v177
v_mfma_f32_16x16x32_bf16 v[160:163], a[224:227], v[56:59], v[160:163]
v_exp_f32 v150, v150
v_mfma_f32_16x16x32_bf16 v[164:167], a[224:227], v[60:63], v[164:167]
v_exp_f32 v151, v151
v_mfma_f32_16x16x32_bf16 v[168:171], a[224:227], v[120:123], v[168:171]
v_exp_f32 v152, v152
v_mfma_f32_16x16x32_bf16 v[172:175], a[224:227], v[124:127], v[172:175]
ds_read_b128 a[240:243], v188 offset:17344
v_add_f32 v184, v184, v178
v_mfma_f32_16x16x32_bf16 v[160:163], a[228:231], v[0:3], v[160:163]
v_exp_f32 v153, v153
v_mfma_f32_16x16x32_bf16 v[164:167], a[228:231], v[4:7], v[164:167]
v_exp_f32 v154, v154
v_mfma_f32_16x16x32_bf16 v[168:171], a[228:231], v[64:67], v[168:171]
v_exp_f32 v155, v155
v_mfma_f32_16x16x32_bf16 v[172:175], a[228:231], v[68:71], v[172:175]
s_waitcnt lgkmcnt(1)
ds_read_b64_tr_b16 a[224:225], v186 offset:0
v_add_f32 v184, v184, v179
v_mfma_f32_16x16x32_bf16 v[160:163], a[232:235], v[8:11], v[160:163]
ds_read_b64_tr_b16 a[226:227], v186 offset:8448
v_cvt_pk_bf16_f32 v176, v176, v177
v_mfma_f32_16x16x32_bf16 v[164:167], a[232:235], v[12:15], v[164:167]
v_exp_f32 v156, v156
v_mfma_f32_16x16x32_bf16 v[168:171], a[232:235], v[72:75], v[168:171]
v_exp_f32 v157, v157
v_mfma_f32_16x16x32_bf16 v[172:175], a[232:235], v[76:79], v[172:175]
ds_read_b64_tr_b16 a[228:229], v186 offset:32
v_cvt_pk_bf16_f32 v177, v178, v179
v_mfma_f32_16x16x32_bf16 v[160:163], a[236:239], v[16:19], v[160:163]
ds_read_b64_tr_b16 a[230:231], v186 offset:8480
v_add_f32 v180, v180, v144
v_mfma_f32_16x16x32_bf16 v[164:167], a[236:239], v[20:23], v[164:167]
v_exp_f32 v158, v158
v_mfma_f32_16x16x32_bf16 v[168:171], a[236:239], v[80:83], v[168:171]
v_exp_f32 v159, v159
v_mfma_f32_16x16x32_bf16 v[172:175], a[236:239], v[84:87], v[172:175]
s_waitcnt lgkmcnt(2)
ds_read_b64_tr_b16 a[232:233], v186 offset:64
v_add_f32 v180, v180, v145
v_mfma_f32_16x16x32_bf16 v[160:163], a[240:243], v[24:27], v[160:163]
ds_read_b64_tr_b16 a[234:235], v186 offset:8512
v_add_f32 v180, v180, v146
v_mfma_f32_16x16x32_bf16 v[164:167], a[240:243], v[28:31], v[164:167]
ds_write_b64 v187, v[176:177] offset:18440
v_add_f32 v180, v180, v147
v_mfma_f32_16x16x32_bf16 v[168:171], a[240:243], v[88:91], v[168:171]
ds_read_b64_tr_b16 a[236:237], v186 offset:96
v_cvt_pk_bf16_f32 v147, v146, v147
v_mfma_f32_16x16x32_bf16 v[172:175], a[240:243], v[92:95], v[172:175]
ds_read_b64_tr_b16 a[238:239], v186 offset:8544
v_cvt_pk_bf16_f32 v146, v144, v145
v_mfma_f32_16x16x32_bf16 a[0:3], a[224:227], v[128:131], 0
ds_read_b128 a[252:255], v187 offset:17408
v_add_f32 v181, v181, v148
v_mfma_f32_16x16x32_bf16 a[64:67], a[224:227], v[132:135], 0
v_exp_f32 v160, v160
v_mfma_f32_16x16x32_bf16 a[128:131], a[224:227], v[136:139], 0
v_exp_f32 v161, v161
v_mfma_f32_16x16x32_bf16 v[192:195], a[224:227], v[140:143], 0
s_waitcnt lgkmcnt(3)
ds_read_b64_tr_b16 a[240:241], v190 offset:128
v_add_f32 v181, v181, v149
v_mfma_f32_16x16x32_bf16 a[4:7], a[228:231], v[128:131], 0
ds_read_b64_tr_b16 a[242:243], v190 offset:8576
v_add_f32 v181, v181, v150
v_mfma_f32_16x16x32_bf16 a[68:71], a[228:231], v[132:135], 0
v_exp_f32 v162, v162
v_mfma_f32_16x16x32_bf16 a[132:135], a[228:231], v[136:139], 0
v_exp_f32 v163, v163
v_mfma_f32_16x16x32_bf16 v[196:199], a[228:231], v[140:143], 0
v_exp_f32 v164, v164
v_mfma_f32_16x16x32_bf16 a[8:11], a[232:235], v[128:131], 0
ds_read_b64_tr_b16 a[224:225], v190 offset:192
v_add_f32 v181, v181, v151
v_mfma_f32_16x16x32_bf16 a[72:75], a[232:235], v[132:135], 0
v_exp_f32 v165, v165
v_mfma_f32_16x16x32_bf16 a[136:139], a[232:235], v[136:139], 0
v_exp_f32 v166, v166
v_mfma_f32_16x16x32_bf16 v[200:203], a[232:235], v[140:143], 0
s_waitcnt lgkmcnt(1)
v_exp_f32 v167, v167
v_mfma_f32_16x16x32_bf16 a[12:15], a[236:239], v[128:131], 0
v_cvt_pk_bf16_f32 v151, v150, v151
v_cvt_pk_bf16_f32 v150, v148, v149
v_mfma_f32_16x16x32_bf16 a[76:79], a[236:239], v[132:135], 0
s_add_u32 m0, s63, 0
v_exp_f32 v168, v168
v_mfma_f32_16x16x32_bf16 a[140:143], a[236:239], v[136:139], 0
v_exp_f32 v169, v169
v_mfma_f32_16x16x32_bf16 v[204:207], a[236:239], v[140:143], 0
ds_read_b64_tr_b16 a[226:227], v190 offset:8640
buffer_load_dwordx4 v189, s[12:15], s61 offen offset:0 nt lds
v_mfma_f32_16x16x32_bf16 a[16:19], a[240:243], v[128:131], 0
v_exp_f32 v170, v170
v_mfma_f32_16x16x32_bf16 a[80:83], a[240:243], v[132:135], 0
s_add_u32 m0, s63, 32
v_add_f32 v182, v182, v152
v_add_f32 v182, v182, v153
v_mfma_f32_16x16x32_bf16 a[144:147], a[240:243], v[136:139], 0
v_add_f32 v182, v182, v154
v_add_f32 v182, v182, v155
v_mfma_f32_16x16x32_bf16 v[208:211], a[240:243], v[140:143], 0
v_exp_f32 v171, v171
v_mfma_f32_16x16x32_bf16 a[192:195], a[240:243], a[248:251], 0
buffer_load_dwordx4 v189, s[12:15], s61 offen offset:1024 nt lds
ds_read_b64_tr_b16 a[228:229], v190 offset:224
v_mfma_f32_16x16x32_bf16 a[196:199], a[240:243], a[252:255], 0
s_add_u32 m0, s63, 64
v_cvt_pk_bf16_f32 v155, v154, v155
v_cvt_pk_bf16_f32 v154, v152, v153
v_mfma_f32_16x16x32_bf16 a[20:23], a[244:247], v[128:131], 0
ds_read_b64_tr_b16 a[230:231], v190 offset:8672
buffer_load_dwordx4 v189, s[12:15], s61 offen offset:2048 nt lds
v_mfma_f32_16x16x32_bf16 a[84:87], a[244:247], v[132:135], 0
v_exp_f32 v172, v172
v_mfma_f32_16x16x32_bf16 a[148:151], a[244:247], v[136:139], 0
v_exp_f32 v173, v173
v_mfma_f32_16x16x32_bf16 v[212:215], a[244:247], v[140:143], 0
s_add_u32 m0, s63, 96
v_exp_f32 v174, v174
v_mfma_f32_16x16x32_bf16 a[200:203], a[244:247], a[248:251], 0
v_add_f32 v183, v183, v156
v_add_f32 v183, v183, v157
v_mfma_f32_16x16x32_bf16 a[204:207], a[244:247], a[252:255], 0
s_waitcnt lgkmcnt(1)
v_add_f32 v183, v183, v158
v_add_f32 v183, v183, v159
v_mfma_f32_16x16x32_bf16 a[24:27], a[224:227], v[128:131], 0
ds_read_b64_tr_b16 a[232:233], v186 offset:256
buffer_load_dwordx4 v189, s[12:15], s61 offen offset:3072 nt lds
v_mfma_f32_16x16x32_bf16 a[88:91], a[224:227], v[132:135], 0
s_add_u32 m0, s64, 16896
ds_read_b64_tr_b16 a[234:235], v186 offset:8704
v_cvt_pk_bf16_f32 v159, v158, v159
v_mfma_f32_16x16x32_bf16 a[152:155], a[224:227], v[136:139], 0
v_cvt_pk_bf16_f32 v158, v156, v157
v_add_f32 v180, v180, v160
v_mfma_f32_16x16x32_bf16 v[216:219], a[224:227], v[140:143], 0
v_add_f32 v180, v180, v161
v_add_f32 v180, v180, v162
v_mfma_f32_16x16x32_bf16 a[208:211], a[224:227], a[248:251], 0
ds_read_b64_tr_b16 a[236:237], v186 offset:288
v_add_f32 v180, v180, v163
v_mfma_f32_16x16x32_bf16 a[212:215], a[224:227], a[252:255], 0
s_waitcnt lgkmcnt(3)
ds_read_b64_tr_b16 a[238:239], v186 offset:8736
buffer_load_dwordx4 v189, s[16:19], s62 offen offset:0 nt lds
v_mfma_f32_16x16x32_bf16 a[28:31], a[228:231], v[128:131], 0
s_add_u32 m0, s64, 16928
v_exp_f32 v175, v175
v_mfma_f32_16x16x32_bf16 a[92:95], a[228:231], v[132:135], 0
ds_read_b64_tr_b16 a[240:241], v186 offset:320
buffer_load_dwordx4 v189, s[16:19], s62 offen offset:1024 nt lds
v_mfma_f32_16x16x32_bf16 a[156:159], a[228:231], v[136:139], 0
ds_read_b64_tr_b16 a[242:243], v186 offset:8768
v_add_f32 v181, v181, v164
v_mfma_f32_16x16x32_bf16 v[220:223], a[228:231], v[140:143], 0
s_add_u32 m0, s64, 16960
ds_read_b64_tr_b16 a[224:225], v186 offset:352
v_add_f32 v181, v181, v165
v_mfma_f32_16x16x32_bf16 a[216:219], a[228:231], a[248:251], 0
ds_read_b64_tr_b16 a[226:227], v186 offset:8800
buffer_load_dwordx4 v189, s[16:19], s62 offen offset:2048 nt lds
v_mfma_f32_16x16x32_bf16 a[220:223], a[228:231], a[252:255], 0
s_waitcnt lgkmcnt(4)
ds_read_b64_tr_b16 a[228:229], v190 offset:384
v_add_f32 v181, v181, v166
v_mfma_f32_16x16x32_bf16 a[32:35], a[232:235], v[128:131], 0
ds_read_b64_tr_b16 a[230:231], v190 offset:8832
v_add_f32 v181, v181, v167
v_mfma_f32_16x16x32_bf16 a[96:99], a[232:235], v[132:135], 0
s_add_u32 m0, s64, 16992
v_add_f32 v182, v182, v168
v_add_f32 v182, v182, v169
v_mfma_f32_16x16x32_bf16 a[160:163], a[232:235], v[136:139], 0
buffer_load_dwordx4 v189, s[16:19], s62 offen offset:3072 nt lds
v_add_f32 v182, v182, v170
v_mfma_f32_16x16x32_bf16 v[224:227], a[232:235], v[140:143], 0
s_add_u32 s61, s61, 16384
ds_read_b64_tr_b16 a[232:233], v190 offset:416
v_add_f32 v182, v182, v171
v_mfma_f32_16x16x32_bf16 a[36:39], a[236:239], v[128:131], 0
s_add_u32 s62, s62, 16384
ds_read_b64_tr_b16 a[234:235], v190 offset:8864
v_add_u32 v185, 4294837248, v185
v_mfma_f32_16x16x32_bf16 a[100:103], a[236:239], v[132:135], 0
v_add_u32 v188, 4294837248, v188
v_add_f32 v183, v183, v172
v_mfma_f32_16x16x32_bf16 a[164:167], a[236:239], v[136:139], 0
v_add_f32 v183, v183, v173
v_add_f32 v183, v183, v174
v_mfma_f32_16x16x32_bf16 v[228:231], a[236:239], v[140:143], 0
s_waitcnt lgkmcnt(2)
ds_read_b64_tr_b16 a[236:237], v190 offset:448
v_add_f32 v183, v183, v175
v_mfma_f32_16x16x32_bf16 a[40:43], a[240:243], v[128:131], 0
ds_read_b64_tr_b16 a[238:239], v190 offset:8896
v_cvt_pk_bf16_f32 v144, v160, v161
v_mfma_f32_16x16x32_bf16 a[104:107], a[240:243], v[132:135], 0
v_cvt_pk_bf16_f32 v145, v162, v163
v_cvt_pk_bf16_f32 v148, v164, v165
v_mfma_f32_16x16x32_bf16 a[168:171], a[240:243], v[136:139], 0
v_cvt_pk_bf16_f32 v149, v166, v167
v_cvt_pk_bf16_f32 v152, v168, v169
v_mfma_f32_16x16x32_bf16 v[232:235], a[240:243], v[140:143], 0
ds_read_b64_tr_b16 a[240:241], v190 offset:480
v_cvt_pk_bf16_f32 v153, v170, v171
v_mfma_f32_16x16x32_bf16 a[44:47], a[224:227], v[128:131], 0
ds_read_b64_tr_b16 a[242:243], v190 offset:8928
v_cvt_pk_bf16_f32 v156, v172, v173
v_mfma_f32_16x16x32_bf16 a[108:111], a[224:227], v[132:135], 0
v_cvt_pk_bf16_f32 v157, v174, v175
v_mfma_f32_16x16x32_bf16 a[172:175], a[224:227], v[136:139], 0
v_mfma_f32_16x16x32_bf16 v[236:239], a[224:227], v[140:143], 0
v_mfma_f32_16x16x32_bf16 a[48:51], a[228:231], v[128:131], 0
v_mfma_f32_16x16x32_bf16 a[112:115], a[228:231], v[132:135], 0
v_mfma_f32_16x16x32_bf16 a[176:179], a[228:231], v[136:139], 0
v_mfma_f32_16x16x32_bf16 v[240:243], a[228:231], v[140:143], 0
s_waitcnt lgkmcnt(0)
v_mfma_f32_16x16x32_bf16 a[52:55], a[232:235], v[128:131], 0
s_waitcnt lgkmcnt(0)
s_waitcnt vmcnt(12)
s_barrier
v_mfma_f32_16x16x32_bf16 a[116:119], a[232:235], v[132:135], 0
ds_read_b128 a[224:227], v185 offset:8448
v_mfma_f32_16x16x32_bf16 a[180:183], a[232:235], v[136:139], 0
ds_read_b128 a[248:251], v187 offset:0
v_mfma_f32_16x16x32_bf16 v[244:247], a[232:235], v[140:143], 0
ds_read_b128 a[252:255], v187 offset:1024
v_mfma_f32_16x16x32_bf16 a[56:59], a[236:239], v[128:131], 0
ds_read_b128 a[228:231], v185 offset:8512
v_mfma_f32_16x16x32_bf16 a[120:123], a[236:239], v[132:135], 0
ds_read_b128 a[232:235], v188 offset:8576
v_mfma_f32_16x16x32_bf16 a[184:187], a[236:239], v[136:139], 0
v_mfma_f32_16x16x32_bf16 v[248:251], a[236:239], v[140:143], 0
ds_read_b128 a[236:239], v188 offset:8640
v_mfma_f32_16x16x32_bf16 a[60:63], a[240:243], v[128:131], 0
v_mfma_f32_16x16x32_bf16 a[124:127], a[240:243], v[132:135], 0
v_mfma_f32_16x16x32_bf16 a[188:191], a[240:243], v[136:139], 0
v_mfma_f32_16x16x32_bf16 v[252:255], a[240:243], v[140:143], 0
L_attloop1:
s_sub_u32 s64, s64, s74
ds_read_b128 a[240:243], v185 offset:8704
s_waitcnt lgkmcnt(2)
v_mfma_f32_16x16x32_bf16 v[128:131], a[224:227], v[32:35], 0
ds_read_b128 a[244:247], v185 offset:8768
v_mfma_f32_16x16x32_bf16 v[132:135], a[224:227], v[36:39], 0
v_mfma_f32_16x16x32_bf16 v[136:139], a[224:227], v[96:99], 0
v_mfma_f32_16x16x32_bf16 v[140:143], a[224:227], v[100:103], 0
v_mfma_f32_16x16x32_bf16 v[176:179], a[224:227], a[248:251], 0
ds_read_b128 a[248:251], v187 offset:2048
v_mfma_f32_16x16x32_bf16 v[128:131], a[228:231], v[40:43], v[128:131]
ds_read_b128 a[224:227], v188 offset:8832
v_mfma_f32_16x16x32_bf16 v[132:135], a[228:231], v[44:47], v[132:135]
v_mfma_f32_16x16x32_bf16 v[136:139], a[228:231], v[104:107], v[136:139]
v_mfma_f32_16x16x32_bf16 v[140:143], a[228:231], v[108:111], v[140:143]
v_mfma_f32_16x16x32_bf16 v[176:179], a[228:231], a[252:255], v[176:179]
ds_read_b128 a[252:255], v187 offset:3072
v_mfma_f32_16x16x32_bf16 v[128:131], a[232:235], v[48:51], v[128:131]
ds_read_b128 a[228:231], v188 offset:8896
v_mfma_f32_16x16x32_bf16 v[132:135], a[232:235], v[52:55], v[132:135]
v_mfma_f32_16x16x32_bf16 v[136:139], a[232:235], v[112:115], v[136:139]
v_mfma_f32_16x16x32_bf16 v[140:143], a[232:235], v[116:119], v[140:143]
s_waitcnt lgkmcnt(2)
v_mfma_f32_16x16x32_bf16 v[176:179], a[232:235], a[248:251], v[176:179]
ds_read_b128 a[248:251], v187 offset:4096
v_mfma_f32_16x16x32_bf16 v[128:131], a[236:239], v[56:59], v[128:131]
ds_read_b128 a[232:235], v185 offset:0
v_mfma_f32_16x16x32_bf16 v[132:135], a[236:239], v[60:63], v[132:135]
v_mfma_f32_16x16x32_bf16 v[136:139], a[236:239], v[120:123], v[136:139]
v_mfma_f32_16x16x32_bf16 v[140:143], a[236:239], v[124:127], v[140:143]
s_waitcnt lgkmcnt(2)
v_mfma_f32_16x16x32_bf16 v[176:179], a[236:239], a[252:255], v[176:179]
ds_read_b128 a[252:255], v187 offset:5120
v_mfma_f32_16x16x32_bf16 v[128:131], a[240:243], v[0:3], v[128:131]
ds_read_b128 a[236:239], v185 offset:64
v_mfma_f32_16x16x32_bf16 v[132:135], a[240:243], v[4:7], v[132:135]
v_mfma_f32_16x16x32_bf16 v[136:139], a[240:243], v[64:67], v[136:139]
v_mfma_f32_16x16x32_bf16 v[140:143], a[240:243], v[68:71], v[140:143]
s_waitcnt lgkmcnt(2)
v_mfma_f32_16x16x32_bf16 v[176:179], a[240:243], a[248:251], v[176:179]
ds_read_b128 a[248:251], v187 offset:6144
v_mfma_f32_16x16x32_bf16 v[128:131], a[244:247], v[8:11], v[128:131]
ds_read_b128 a[240:243], v188 offset:128
v_mfma_f32_16x16x32_bf16 v[132:135], a[244:247], v[12:15], v[132:135]
v_mfma_f32_16x16x32_bf16 v[136:139], a[244:247], v[72:75], v[136:139]
v_mfma_f32_16x16x32_bf16 v[140:143], a[244:247], v[76:79], v[140:143]
s_waitcnt lgkmcnt(2)
v_mfma_f32_16x16x32_bf16 v[176:179], a[244:247], a[252:255], v[176:179]
ds_read_b128 a[252:255], v187 offset:7168
v_mfma_f32_16x16x32_bf16 v[128:131], a[224:227], v[16:19], v[128:131]
ds_read_b64_tr_b16 a[244:245], v190 offset:17056
v_mfma_f32_16x16x32_bf16 v[132:135], a[224:227], v[20:23], v[132:135]
ds_read_b64_tr_b16 a[246:247], v190 offset:25504
v_mfma_f32_16x16x32_bf16 v[136:139], a[224:227], v[80:83], v[136:139]
v_mfma_f32_16x16x32_bf16 v[140:143], a[224:227], v[84:87], v[140:143]
s_waitcnt lgkmcnt(3)
v_mfma_f32_16x16x32_bf16 v[176:179], a[224:227], a[248:251], v[176:179]
ds_read_b128 a[224:227], v188 offset:192
v_mfma_f32_16x16x32_bf16 v[128:131], a[228:231], v[24:27], v[128:131]
ds_read_b128 a[248:251], v187 offset:18432
v_mfma_f32_16x16x32_bf16 v[132:135], a[228:231], v[28:31], v[132:135]
v_mfma_f32_16x16x32_bf16 v[136:139], a[228:231], v[88:91], v[136:139]
v_mfma_f32_16x16x32_bf16 v[140:143], a[228:231], v[92:95], v[140:143]
s_waitcnt lgkmcnt(2)
v_mfma_f32_16x16x32_bf16 v[176:179], a[228:231], a[252:255], v[176:179]
ds_read_b128 a[228:231], v185 offset:256
v_mfma_f32_16x16x32_bf16 v[160:163], a[232:235], v[32:35], 0
v_exp_f32 v128, v128
v_mfma_f32_16x16x32_bf16 v[164:167], a[232:235], v[36:39], 0
v_exp_f32 v129, v129
v_mfma_f32_16x16x32_bf16 v[168:171], a[232:235], v[96:99], 0
v_exp_f32 v130, v130
v_mfma_f32_16x16x32_bf16 v[172:175], a[232:235], v[100:103], 0
v_exp_f32 v131, v131
v_mfma_f32_16x16x32_bf16 v[160:163], a[236:239], v[40:43], v[160:163]
v_exp_f32 v176, v176
v_mfma_f32_16x16x32_bf16 v[164:167], a[236:239], v[44:47], v[164:167]
v_exp_f32 v177, v177
v_mfma_f32_16x16x32_bf16 v[168:171], a[236:239], v[104:107], v[168:171]
v_exp_f32 v178, v178
v_mfma_f32_16x16x32_bf16 v[172:175], a[236:239], v[108:111], v[172:175]
ds_read_b128 a[232:235], v185 offset:320
v_add_f32 v184, v184, v176
v_mfma_f32_16x16x32_bf16 v[160:163], a[240:243], v[48:51], v[160:163]
v_exp_f32 v179, v179
v_mfma_f32_16x16x32_bf16 v[164:167], a[240:243], v[52:55], v[164:167]
v_exp_f32 v132, v132
v_mfma_f32_16x16x32_bf16 v[168:171], a[240:243], v[112:115], v[168:171]
v_exp_f32 v133, v133
v_mfma_f32_16x16x32_bf16 v[172:175], a[240:243], v[116:119], v[172:175]
s_waitcnt lgkmcnt(1)
ds_read_b128 a[236:239], v188 offset:384
v_add_f32 v184, v184, v177
v_mfma_f32_16x16x32_bf16 v[160:163], a[224:227], v[56:59], v[160:163]
v_exp_f32 v134, v134
v_mfma_f32_16x16x32_bf16 v[164:167], a[224:227], v[60:63], v[164:167]
v_exp_f32 v135, v135
v_mfma_f32_16x16x32_bf16 v[168:171], a[224:227], v[120:123], v[168:171]
v_exp_f32 v136, v136
v_mfma_f32_16x16x32_bf16 v[172:175], a[224:227], v[124:127], v[172:175]
ds_read_b128 a[240:243], v188 offset:448
v_add_f32 v184, v184, v178
v_mfma_f32_16x16x32_bf16 v[160:163], a[228:231], v[0:3], v[160:163]
v_exp_f32 v137, v137
v_mfma_f32_16x16x32_bf16 v[164:167], a[228:231], v[4:7], v[164:167]
v_exp_f32 v138, v138
v_mfma_f32_16x16x32_bf16 v[168:171], a[228:231], v[64:67], v[168:171]
v_exp_f32 v139, v139
v_mfma_f32_16x16x32_bf16 v[172:175], a[228:231], v[68:71], v[172:175]
s_waitcnt lgkmcnt(1)
ds_read_b64_tr_b16 a[224:225], v186 offset:16896
v_add_f32 v184, v184, v179
v_mfma_f32_16x16x32_bf16 v[160:163], a[232:235], v[8:11], v[160:163]
ds_read_b64_tr_b16 a[226:227], v186 offset:25344
v_cvt_pk_bf16_f32 v176, v176, v177
v_mfma_f32_16x16x32_bf16 v[164:167], a[232:235], v[12:15], v[164:167]
v_exp_f32 v140, v140
v_mfma_f32_16x16x32_bf16 v[168:171], a[232:235], v[72:75], v[168:171]
v_exp_f32 v141, v141
v_mfma_f32_16x16x32_bf16 v[172:175], a[232:235], v[76:79], v[172:175]
ds_read_b64_tr_b16 a[228:229], v186 offset:16928
v_cvt_pk_bf16_f32 v177, v178, v179
v_mfma_f32_16x16x32_bf16 v[160:163], a[236:239], v[16:19], v[160:163]
ds_read_b64_tr_b16 a[230:231], v186 offset:25376
v_add_f32 v180, v180, v128
v_mfma_f32_16x16x32_bf16 v[164:167], a[236:239], v[20:23], v[164:167]
v_exp_f32 v142, v142
v_mfma_f32_16x16x32_bf16 v[168:171], a[236:239], v[80:83], v[168:171]
v_exp_f32 v143, v143
v_mfma_f32_16x16x32_bf16 v[172:175], a[236:239], v[84:87], v[172:175]
s_waitcnt lgkmcnt(2)
ds_read_b64_tr_b16 a[232:233], v186 offset:16960
v_add_f32 v180, v180, v129
v_mfma_f32_16x16x32_bf16 v[160:163], a[240:243], v[24:27], v[160:163]
ds_read_b64_tr_b16 a[234:235], v186 offset:25408
v_add_f32 v180, v180, v130
v_mfma_f32_16x16x32_bf16 v[164:167], a[240:243], v[28:31], v[164:167]
ds_write_b64 v187, v[176:177] offset:16392
v_add_f32 v180, v180, v131
v_mfma_f32_16x16x32_bf16 v[168:171], a[240:243], v[88:91], v[168:171]
ds_read_b64_tr_b16 a[236:237], v186 offset:16992
v_cvt_pk_bf16_f32 v131, v130, v131
v_mfma_f32_16x16x32_bf16 v[172:175], a[240:243], v[92:95], v[172:175]
ds_read_b64_tr_b16 a[238:239], v186 offset:25440
v_cvt_pk_bf16_f32 v130, v128, v129
v_mfma_f32_16x16x32_bf16 a[0:3], a[224:227], v[144:147], a[0:3]
ds_read_b128 a[252:255], v187 offset:19456
v_add_f32 v181, v181, v132
v_mfma_f32_16x16x32_bf16 a[64:67], a[224:227], v[148:151], a[64:67]
v_exp_f32 v160, v160
v_mfma_f32_16x16x32_bf16 a[128:131], a[224:227], v[152:155], a[128:131]
v_exp_f32 v161, v161
v_mfma_f32_16x16x32_bf16 v[192:195], a[224:227], v[156:159], v[192:195]
s_waitcnt lgkmcnt(3)
ds_read_b64_tr_b16 a[240:241], v190 offset:17024
v_add_f32 v181, v181, v133
v_mfma_f32_16x16x32_bf16 a[4:7], a[228:231], v[144:147], a[4:7]
ds_read_b64_tr_b16 a[242:243], v190 offset:25472
v_add_f32 v181, v181, v134
v_mfma_f32_16x16x32_bf16 a[68:71], a[228:231], v[148:151], a[68:71]
v_exp_f32 v162, v162
v_mfma_f32_16x16x32_bf16 a[132:135], a[228:231], v[152:155], a[132:135]
v_exp_f32 v163, v163
v_mfma_f32_16x16x32_bf16 v[196:199], a[228:231], v[156:159], v[196:199]
v_exp_f32 v164, v164
v_mfma_f32_16x16x32_bf16 a[8:11], a[232:235], v[144:147], a[8:11]
ds_read_b64_tr_b16 a[224:225], v190 offset:17088
v_add_f32 v181, v181, v135
v_mfma_f32_16x16x32_bf16 a[72:75], a[232:235], v[148:151], a[72:75]
v_exp_f32 v165, v165
v_mfma_f32_16x16x32_bf16 a[136:139], a[232:235], v[152:155], a[136:139]
v_exp_f32 v166, v166
v_mfma_f32_16x16x32_bf16 v[200:203], a[232:235], v[156:159], v[200:203]
s_waitcnt lgkmcnt(1)
v_exp_f32 v167, v167
v_mfma_f32_16x16x32_bf16 a[12:15], a[236:239], v[144:147], a[12:15]
v_cvt_pk_bf16_f32 v135, v134, v135
v_cvt_pk_bf16_f32 v134, v132, v133
v_mfma_f32_16x16x32_bf16 a[76:79], a[236:239], v[148:151], a[76:79]
s_add_u32 m0, s63, 16896
v_exp_f32 v168, v168
v_mfma_f32_16x16x32_bf16 a[140:143], a[236:239], v[152:155], a[140:143]
v_exp_f32 v169, v169
v_mfma_f32_16x16x32_bf16 v[204:207], a[236:239], v[156:159], v[204:207]
ds_read_b64_tr_b16 a[226:227], v190 offset:25536
buffer_load_dwordx4 v189, s[12:15], s61 offen offset:0 nt lds
v_mfma_f32_16x16x32_bf16 a[16:19], a[240:243], v[144:147], a[16:19]
v_exp_f32 v170, v170
v_mfma_f32_16x16x32_bf16 a[80:83], a[240:243], v[148:151], a[80:83]
s_add_u32 m0, s63, 16928
v_add_f32 v182, v182, v136
v_add_f32 v182, v182, v137
v_mfma_f32_16x16x32_bf16 a[144:147], a[240:243], v[152:155], a[144:147]
v_add_f32 v182, v182, v138
v_add_f32 v182, v182, v139
v_mfma_f32_16x16x32_bf16 v[208:211], a[240:243], v[156:159], v[208:211]
v_exp_f32 v171, v171
v_mfma_f32_16x16x32_bf16 a[192:195], a[240:243], a[248:251], a[192:195]
buffer_load_dwordx4 v189, s[12:15], s61 offen offset:1024 nt lds
ds_read_b64_tr_b16 a[228:229], v190 offset:17120
v_mfma_f32_16x16x32_bf16 a[196:199], a[240:243], a[252:255], a[196:199]
s_add_u32 m0, s63, 16960
v_cvt_pk_bf16_f32 v139, v138, v139
v_cvt_pk_bf16_f32 v138, v136, v137
v_mfma_f32_16x16x32_bf16 a[20:23], a[244:247], v[144:147], a[20:23]
ds_read_b64_tr_b16 a[230:231], v190 offset:25568
buffer_load_dwordx4 v189, s[12:15], s61 offen offset:2048 nt lds
v_mfma_f32_16x16x32_bf16 a[84:87], a[244:247], v[148:151], a[84:87]
v_exp_f32 v172, v172
v_mfma_f32_16x16x32_bf16 a[148:151], a[244:247], v[152:155], a[148:151]
v_exp_f32 v173, v173
v_mfma_f32_16x16x32_bf16 v[212:215], a[244:247], v[156:159], v[212:215]
s_add_u32 m0, s63, 16992
v_exp_f32 v174, v174
v_mfma_f32_16x16x32_bf16 a[200:203], a[244:247], a[248:251], a[200:203]
v_add_f32 v183, v183, v140
v_add_f32 v183, v183, v141
v_mfma_f32_16x16x32_bf16 a[204:207], a[244:247], a[252:255], a[204:207]
s_waitcnt lgkmcnt(1)
v_add_f32 v183, v183, v142
v_add_f32 v183, v183, v143
v_mfma_f32_16x16x32_bf16 a[24:27], a[224:227], v[144:147], a[24:27]
ds_read_b64_tr_b16 a[232:233], v186 offset:17152
buffer_load_dwordx4 v189, s[12:15], s61 offen offset:3072 nt lds
v_mfma_f32_16x16x32_bf16 a[88:91], a[224:227], v[148:151], a[88:91]
s_add_u32 m0, s64, 0
ds_read_b64_tr_b16 a[234:235], v186 offset:25600
v_cvt_pk_bf16_f32 v143, v142, v143
v_mfma_f32_16x16x32_bf16 a[152:155], a[224:227], v[152:155], a[152:155]
v_cvt_pk_bf16_f32 v142, v140, v141
v_add_f32 v180, v180, v160
v_mfma_f32_16x16x32_bf16 v[216:219], a[224:227], v[156:159], v[216:219]
v_add_f32 v180, v180, v161
v_add_f32 v180, v180, v162
v_mfma_f32_16x16x32_bf16 a[208:211], a[224:227], a[248:251], a[208:211]
ds_read_b64_tr_b16 a[236:237], v186 offset:17184
v_add_f32 v180, v180, v163
v_mfma_f32_16x16x32_bf16 a[212:215], a[224:227], a[252:255], a[212:215]
s_waitcnt lgkmcnt(3)
ds_read_b64_tr_b16 a[238:239], v186 offset:25632
buffer_load_dwordx4 v189, s[16:19], s62 offen offset:0 nt lds
v_mfma_f32_16x16x32_bf16 a[28:31], a[228:231], v[144:147], a[28:31]
s_add_u32 m0, s64, 32
v_exp_f32 v175, v175
v_mfma_f32_16x16x32_bf16 a[92:95], a[228:231], v[148:151], a[92:95]
ds_read_b64_tr_b16 a[240:241], v186 offset:17216
buffer_load_dwordx4 v189, s[16:19], s62 offen offset:1024 nt lds
v_mfma_f32_16x16x32_bf16 a[156:159], a[228:231], v[152:155], a[156:159]
ds_read_b64_tr_b16 a[242:243], v186 offset:25664
v_add_f32 v181, v181, v164
v_mfma_f32_16x16x32_bf16 v[220:223], a[228:231], v[156:159], v[220:223]
s_add_u32 m0, s64, 64
ds_read_b64_tr_b16 a[224:225], v186 offset:17248
v_add_f32 v181, v181, v165
v_mfma_f32_16x16x32_bf16 a[216:219], a[228:231], a[248:251], a[216:219]
ds_read_b64_tr_b16 a[226:227], v186 offset:25696
buffer_load_dwordx4 v189, s[16:19], s62 offen offset:2048 nt lds
v_mfma_f32_16x16x32_bf16 a[220:223], a[228:231], a[252:255], a[220:223]
s_waitcnt lgkmcnt(4)
ds_read_b64_tr_b16 a[228:229], v190 offset:17280
v_add_f32 v181, v181, v166
v_mfma_f32_16x16x32_bf16 a[32:35], a[232:235], v[144:147], a[32:35]
ds_read_b64_tr_b16 a[230:231], v190 offset:25728
v_add_f32 v181, v181, v167
v_mfma_f32_16x16x32_bf16 a[96:99], a[232:235], v[148:151], a[96:99]
s_add_u32 m0, s64, 96
v_add_f32 v182, v182, v168
v_add_f32 v182, v182, v169
v_mfma_f32_16x16x32_bf16 a[160:163], a[232:235], v[152:155], a[160:163]
buffer_load_dwordx4 v189, s[16:19], s62 offen offset:3072 nt lds
v_add_f32 v182, v182, v170
v_mfma_f32_16x16x32_bf16 v[224:227], a[232:235], v[156:159], v[224:227]
s_add_u32 s61, s61, 16384
ds_read_b64_tr_b16 a[232:233], v190 offset:17312
v_add_f32 v182, v182, v171
v_mfma_f32_16x16x32_bf16 a[36:39], a[236:239], v[144:147], a[36:39]
s_add_u32 s62, s62, 16384
ds_read_b64_tr_b16 a[234:235], v190 offset:25760
v_add_f32 v183, v183, v172
v_mfma_f32_16x16x32_bf16 a[100:103], a[236:239], v[148:151], a[100:103]
v_add_f32 v183, v183, v173
v_add_f32 v183, v183, v174
v_mfma_f32_16x16x32_bf16 a[164:167], a[236:239], v[152:155], a[164:167]
v_add_f32 v183, v183, v175
v_add_u32 v186, s74, v186
v_mfma_f32_16x16x32_bf16 v[228:231], a[236:239], v[156:159], v[228:231]
s_waitcnt lgkmcnt(2)
ds_read_b64_tr_b16 a[236:237], v190 offset:17344
v_cvt_pk_bf16_f32 v128, v160, v161
v_mfma_f32_16x16x32_bf16 a[40:43], a[240:243], v[144:147], a[40:43]
ds_read_b64_tr_b16 a[238:239], v190 offset:25792
v_cvt_pk_bf16_f32 v129, v162, v163
v_mfma_f32_16x16x32_bf16 a[104:107], a[240:243], v[148:151], a[104:107]
v_cvt_pk_bf16_f32 v132, v164, v165
v_cvt_pk_bf16_f32 v133, v166, v167
v_mfma_f32_16x16x32_bf16 a[168:171], a[240:243], v[152:155], a[168:171]
v_cvt_pk_bf16_f32 v136, v168, v169
v_cvt_pk_bf16_f32 v137, v170, v171
v_mfma_f32_16x16x32_bf16 v[232:235], a[240:243], v[156:159], v[232:235]
ds_read_b64_tr_b16 a[240:241], v190 offset:17376
v_cvt_pk_bf16_f32 v140, v172, v173
v_mfma_f32_16x16x32_bf16 a[44:47], a[224:227], v[144:147], a[44:47]
ds_read_b64_tr_b16 a[242:243], v190 offset:25824
v_add_u32 v190, s74, v190
v_mfma_f32_16x16x32_bf16 a[108:111], a[224:227], v[148:151], a[108:111]
v_cvt_pk_bf16_f32 v141, v174, v175
v_mfma_f32_16x16x32_bf16 a[172:175], a[224:227], v[152:155], a[172:175]
v_mfma_f32_16x16x32_bf16 v[236:239], a[224:227], v[156:159], v[236:239]
v_mfma_f32_16x16x32_bf16 a[48:51], a[228:231], v[144:147], a[48:51]
v_mfma_f32_16x16x32_bf16 a[112:115], a[228:231], v[148:151], a[112:115]
v_mfma_f32_16x16x32_bf16 a[176:179], a[228:231], v[152:155], a[176:179]
v_mfma_f32_16x16x32_bf16 v[240:243], a[228:231], v[156:159], v[240:243]
s_waitcnt lgkmcnt(0)
v_mfma_f32_16x16x32_bf16 a[52:55], a[232:235], v[144:147], a[52:55]
s_waitcnt lgkmcnt(0)
s_waitcnt vmcnt(16)
s_barrier
v_mfma_f32_16x16x32_bf16 a[116:119], a[232:235], v[148:151], a[116:119]
ds_read_b128 a[224:227], v185 offset:25344
v_mfma_f32_16x16x32_bf16 a[180:183], a[232:235], v[152:155], a[180:183]
ds_read_b128 a[248:251], v187 offset:0
v_mfma_f32_16x16x32_bf16 v[244:247], a[232:235], v[156:159], v[244:247]
ds_read_b128 a[252:255], v187 offset:1024
v_mfma_f32_16x16x32_bf16 a[56:59], a[236:239], v[144:147], a[56:59]
ds_read_b128 a[228:231], v185 offset:25408
v_mfma_f32_16x16x32_bf16 a[120:123], a[236:239], v[148:151], a[120:123]
ds_read_b128 a[232:235], v188 offset:25472
v_mfma_f32_16x16x32_bf16 a[184:187], a[236:239], v[152:155], a[184:187]
v_mfma_f32_16x16x32_bf16 v[248:251], a[236:239], v[156:159], v[248:251]
ds_read_b128 a[236:239], v188 offset:25536
v_mfma_f32_16x16x32_bf16 a[60:63], a[240:243], v[144:147], a[60:63]
v_mfma_f32_16x16x32_bf16 a[124:127], a[240:243], v[148:151], a[124:127]
v_mfma_f32_16x16x32_bf16 a[188:191], a[240:243], v[152:155], a[188:191]
v_mfma_f32_16x16x32_bf16 v[252:255], a[240:243], v[156:159], v[252:255]
s_add_u32 s63, s63, s47
ds_read_b128 a[240:243], v185 offset:25600
s_waitcnt lgkmcnt(2)
v_mfma_f32_16x16x32_bf16 v[144:147], a[224:227], v[32:35], 0
ds_read_b128 a[244:247], v185 offset:25664
v_mfma_f32_16x16x32_bf16 v[148:151], a[224:227], v[36:39], 0
v_mfma_f32_16x16x32_bf16 v[152:155], a[224:227], v[96:99], 0
v_mfma_f32_16x16x32_bf16 v[156:159], a[224:227], v[100:103], 0
v_mfma_f32_16x16x32_bf16 v[176:179], a[224:227], a[248:251], 0
ds_read_b128 a[248:251], v187 offset:2048
v_mfma_f32_16x16x32_bf16 v[144:147], a[228:231], v[40:43], v[144:147]
ds_read_b128 a[224:227], v188 offset:25728
v_mfma_f32_16x16x32_bf16 v[148:151], a[228:231], v[44:47], v[148:151]
v_mfma_f32_16x16x32_bf16 v[152:155], a[228:231], v[104:107], v[152:155]
v_mfma_f32_16x16x32_bf16 v[156:159], a[228:231], v[108:111], v[156:159]
v_mfma_f32_16x16x32_bf16 v[176:179], a[228:231], a[252:255], v[176:179]
ds_read_b128 a[252:255], v187 offset:3072
v_mfma_f32_16x16x32_bf16 v[144:147], a[232:235], v[48:51], v[144:147]
ds_read_b128 a[228:231], v188 offset:25792
v_mfma_f32_16x16x32_bf16 v[148:151], a[232:235], v[52:55], v[148:151]
v_mfma_f32_16x16x32_bf16 v[152:155], a[232:235], v[112:115], v[152:155]
v_mfma_f32_16x16x32_bf16 v[156:159], a[232:235], v[116:119], v[156:159]
s_waitcnt lgkmcnt(2)
v_mfma_f32_16x16x32_bf16 v[176:179], a[232:235], a[248:251], v[176:179]
ds_read_b128 a[248:251], v187 offset:4096
v_mfma_f32_16x16x32_bf16 v[144:147], a[236:239], v[56:59], v[144:147]
ds_read_b128 a[232:235], v185 offset:16896
v_mfma_f32_16x16x32_bf16 v[148:151], a[236:239], v[60:63], v[148:151]
v_mfma_f32_16x16x32_bf16 v[152:155], a[236:239], v[120:123], v[152:155]
v_mfma_f32_16x16x32_bf16 v[156:159], a[236:239], v[124:127], v[156:159]
s_waitcnt lgkmcnt(2)
v_mfma_f32_16x16x32_bf16 v[176:179], a[236:239], a[252:255], v[176:179]
ds_read_b128 a[252:255], v187 offset:5120
v_mfma_f32_16x16x32_bf16 v[144:147], a[240:243], v[0:3], v[144:147]
ds_read_b128 a[236:239], v185 offset:16960
v_mfma_f32_16x16x32_bf16 v[148:151], a[240:243], v[4:7], v[148:151]
v_mfma_f32_16x16x32_bf16 v[152:155], a[240:243], v[64:67], v[152:155]
v_mfma_f32_16x16x32_bf16 v[156:159], a[240:243], v[68:71], v[156:159]
s_waitcnt lgkmcnt(2)
v_mfma_f32_16x16x32_bf16 v[176:179], a[240:243], a[248:251], v[176:179]
ds_read_b128 a[248:251], v187 offset:6144
v_mfma_f32_16x16x32_bf16 v[144:147], a[244:247], v[8:11], v[144:147]
ds_read_b128 a[240:243], v188 offset:17024
v_mfma_f32_16x16x32_bf16 v[148:151], a[244:247], v[12:15], v[148:151]
v_mfma_f32_16x16x32_bf16 v[152:155], a[244:247], v[72:75], v[152:155]
v_mfma_f32_16x16x32_bf16 v[156:159], a[244:247], v[76:79], v[156:159]
s_waitcnt lgkmcnt(2)
v_mfma_f32_16x16x32_bf16 v[176:179], a[244:247], a[252:255], v[176:179]
ds_read_b128 a[252:255], v187 offset:7168
v_mfma_f32_16x16x32_bf16 v[144:147], a[224:227], v[16:19], v[144:147]
ds_read_b64_tr_b16 a[244:245], v190 offset:160
v_mfma_f32_16x16x32_bf16 v[148:151], a[224:227], v[20:23], v[148:151]
ds_read_b64_tr_b16 a[246:247], v190 offset:8608
v_mfma_f32_16x16x32_bf16 v[152:155], a[224:227], v[80:83], v[152:155]
v_mfma_f32_16x16x32_bf16 v[156:159], a[224:227], v[84:87], v[156:159]
s_waitcnt lgkmcnt(3)
v_mfma_f32_16x16x32_bf16 v[176:179], a[224:227], a[248:251], v[176:179]
ds_read_b128 a[224:227], v188 offset:17088
v_mfma_f32_16x16x32_bf16 v[144:147], a[228:231], v[24:27], v[144:147]
ds_read_b128 a[248:251], v187 offset:16384
v_mfma_f32_16x16x32_bf16 v[148:151], a[228:231], v[28:31], v[148:151]
v_mfma_f32_16x16x32_bf16 v[152:155], a[228:231], v[88:91], v[152:155]
v_mfma_f32_16x16x32_bf16 v[156:159], a[228:231], v[92:95], v[156:159]
s_waitcnt lgkmcnt(2)
v_mfma_f32_16x16x32_bf16 v[176:179], a[228:231], a[252:255], v[176:179]
ds_read_b128 a[228:231], v185 offset:17152
v_mfma_f32_16x16x32_bf16 v[160:163], a[232:235], v[32:35], 0
v_exp_f32 v144, v144
v_mfma_f32_16x16x32_bf16 v[164:167], a[232:235], v[36:39], 0
v_exp_f32 v145, v145
v_mfma_f32_16x16x32_bf16 v[168:171], a[232:235], v[96:99], 0
v_exp_f32 v146, v146
v_mfma_f32_16x16x32_bf16 v[172:175], a[232:235], v[100:103], 0
v_exp_f32 v147, v147
v_mfma_f32_16x16x32_bf16 v[160:163], a[236:239], v[40:43], v[160:163]
v_exp_f32 v176, v176
v_mfma_f32_16x16x32_bf16 v[164:167], a[236:239], v[44:47], v[164:167]
v_exp_f32 v177, v177
v_mfma_f32_16x16x32_bf16 v[168:171], a[236:239], v[104:107], v[168:171]
v_exp_f32 v178, v178
v_mfma_f32_16x16x32_bf16 v[172:175], a[236:239], v[108:111], v[172:175]
ds_read_b128 a[232:235], v185 offset:17216
v_add_f32 v184, v184, v176
v_mfma_f32_16x16x32_bf16 v[160:163], a[240:243], v[48:51], v[160:163]
v_exp_f32 v179, v179
v_mfma_f32_16x16x32_bf16 v[164:167], a[240:243], v[52:55], v[164:167]
v_exp_f32 v148, v148
v_mfma_f32_16x16x32_bf16 v[168:171], a[240:243], v[112:115], v[168:171]
v_exp_f32 v149, v149
v_mfma_f32_16x16x32_bf16 v[172:175], a[240:243], v[116:119], v[172:175]
s_waitcnt lgkmcnt(1)
ds_read_b128 a[236:239], v188 offset:17280
v_add_f32 v184, v184, v177
v_mfma_f32_16x16x32_bf16 v[160:163], a[224:227], v[56:59], v[160:163]
v_exp_f32 v150, v150
v_mfma_f32_16x16x32_bf16 v[164:167], a[224:227], v[60:63], v[164:167]
v_exp_f32 v151, v151
v_mfma_f32_16x16x32_bf16 v[168:171], a[224:227], v[120:123], v[168:171]
v_exp_f32 v152, v152
v_mfma_f32_16x16x32_bf16 v[172:175], a[224:227], v[124:127], v[172:175]
ds_read_b128 a[240:243], v188 offset:17344
v_add_f32 v184, v184, v178
v_mfma_f32_16x16x32_bf16 v[160:163], a[228:231], v[0:3], v[160:163]
v_exp_f32 v153, v153
v_mfma_f32_16x16x32_bf16 v[164:167], a[228:231], v[4:7], v[164:167]
v_exp_f32 v154, v154
v_mfma_f32_16x16x32_bf16 v[168:171], a[228:231], v[64:67], v[168:171]
v_exp_f32 v155, v155
v_mfma_f32_16x16x32_bf16 v[172:175], a[228:231], v[68:71], v[172:175]
s_waitcnt lgkmcnt(1)
ds_read_b64_tr_b16 a[224:225], v186 offset:0
v_add_f32 v184, v184, v179
v_mfma_f32_16x16x32_bf16 v[160:163], a[232:235], v[8:11], v[160:163]
ds_read_b64_tr_b16 a[226:227], v186 offset:8448
v_cvt_pk_bf16_f32 v176, v176, v177
v_mfma_f32_16x16x32_bf16 v[164:167], a[232:235], v[12:15], v[164:167]
v_exp_f32 v156, v156
v_mfma_f32_16x16x32_bf16 v[168:171], a[232:235], v[72:75], v[168:171]
v_exp_f32 v157, v157
v_mfma_f32_16x16x32_bf16 v[172:175], a[232:235], v[76:79], v[172:175]
ds_read_b64_tr_b16 a[228:229], v186 offset:32
v_cvt_pk_bf16_f32 v177, v178, v179
v_mfma_f32_16x16x32_bf16 v[160:163], a[236:239], v[16:19], v[160:163]
ds_read_b64_tr_b16 a[230:231], v186 offset:8480
v_add_f32 v180, v180, v144
v_mfma_f32_16x16x32_bf16 v[164:167], a[236:239], v[20:23], v[164:167]
v_exp_f32 v158, v158
v_mfma_f32_16x16x32_bf16 v[168:171], a[236:239], v[80:83], v[168:171]
v_exp_f32 v159, v159
v_mfma_f32_16x16x32_bf16 v[172:175], a[236:239], v[84:87], v[172:175]
s_waitcnt lgkmcnt(2)
ds_read_b64_tr_b16 a[232:233], v186 offset:64
v_add_f32 v180, v180, v145
v_mfma_f32_16x16x32_bf16 v[160:163], a[240:243], v[24:27], v[160:163]
ds_read_b64_tr_b16 a[234:235], v186 offset:8512
v_add_f32 v180, v180, v146
v_mfma_f32_16x16x32_bf16 v[164:167], a[240:243], v[28:31], v[164:167]
ds_write_b64 v187, v[176:177] offset:18440
v_add_f32 v180, v180, v147
v_mfma_f32_16x16x32_bf16 v[168:171], a[240:243], v[88:91], v[168:171]
ds_read_b64_tr_b16 a[236:237], v186 offset:96
v_cvt_pk_bf16_f32 v147, v146, v147
v_mfma_f32_16x16x32_bf16 v[172:175], a[240:243], v[92:95], v[172:175]
ds_read_b64_tr_b16 a[238:239], v186 offset:8544
v_cvt_pk_bf16_f32 v146, v144, v145
v_mfma_f32_16x16x32_bf16 a[0:3], a[224:227], v[128:131], a[0:3]
ds_read_b128 a[252:255], v187 offset:17408
v_add_f32 v181, v181, v148
v_mfma_f32_16x16x32_bf16 a[64:67], a[224:227], v[132:135], a[64:67]
v_exp_f32 v160, v160
v_mfma_f32_16x16x32_bf16 a[128:131], a[224:227], v[136:139], a[128:131]
v_exp_f32 v161, v161
v_mfma_f32_16x16x32_bf16 v[192:195], a[224:227], v[140:143], v[192:195]
s_waitcnt lgkmcnt(3)
ds_read_b64_tr_b16 a[240:241], v190 offset:128
v_add_f32 v181, v181, v149
v_mfma_f32_16x16x32_bf16 a[4:7], a[228:231], v[128:131], a[4:7]
ds_read_b64_tr_b16 a[242:243], v190 offset:8576
v_add_f32 v181, v181, v150
v_mfma_f32_16x16x32_bf16 a[68:71], a[228:231], v[132:135], a[68:71]
v_exp_f32 v162, v162
v_mfma_f32_16x16x32_bf16 a[132:135], a[228:231], v[136:139], a[132:135]
v_exp_f32 v163, v163
v_mfma_f32_16x16x32_bf16 v[196:199], a[228:231], v[140:143], v[196:199]
v_exp_f32 v164, v164
v_mfma_f32_16x16x32_bf16 a[8:11], a[232:235], v[128:131], a[8:11]
ds_read_b64_tr_b16 a[224:225], v190 offset:192
v_add_f32 v181, v181, v151
v_mfma_f32_16x16x32_bf16 a[72:75], a[232:235], v[132:135], a[72:75]
v_exp_f32 v165, v165
v_mfma_f32_16x16x32_bf16 a[136:139], a[232:235], v[136:139], a[136:139]
v_exp_f32 v166, v166
v_mfma_f32_16x16x32_bf16 v[200:203], a[232:235], v[140:143], v[200:203]
s_waitcnt lgkmcnt(1)
v_exp_f32 v167, v167
v_mfma_f32_16x16x32_bf16 a[12:15], a[236:239], v[128:131], a[12:15]
v_cvt_pk_bf16_f32 v151, v150, v151
v_cvt_pk_bf16_f32 v150, v148, v149
v_mfma_f32_16x16x32_bf16 a[76:79], a[236:239], v[132:135], a[76:79]
s_add_u32 m0, s63, 0
v_exp_f32 v168, v168
v_mfma_f32_16x16x32_bf16 a[140:143], a[236:239], v[136:139], a[140:143]
v_exp_f32 v169, v169
v_mfma_f32_16x16x32_bf16 v[204:207], a[236:239], v[140:143], v[204:207]
ds_read_b64_tr_b16 a[226:227], v190 offset:8640
buffer_load_dwordx4 v189, s[12:15], s61 offen offset:0 nt lds
v_mfma_f32_16x16x32_bf16 a[16:19], a[240:243], v[128:131], a[16:19]
v_exp_f32 v170, v170
v_mfma_f32_16x16x32_bf16 a[80:83], a[240:243], v[132:135], a[80:83]
s_add_u32 m0, s63, 32
v_add_f32 v182, v182, v152
v_add_f32 v182, v182, v153
v_mfma_f32_16x16x32_bf16 a[144:147], a[240:243], v[136:139], a[144:147]
v_add_f32 v182, v182, v154
v_add_f32 v182, v182, v155
v_mfma_f32_16x16x32_bf16 v[208:211], a[240:243], v[140:143], v[208:211]
v_exp_f32 v171, v171
v_mfma_f32_16x16x32_bf16 a[192:195], a[240:243], a[248:251], a[192:195]
buffer_load_dwordx4 v189, s[12:15], s61 offen offset:1024 nt lds
ds_read_b64_tr_b16 a[228:229], v190 offset:224
v_mfma_f32_16x16x32_bf16 a[196:199], a[240:243], a[252:255], a[196:199]
s_add_u32 m0, s63, 64
v_cvt_pk_bf16_f32 v155, v154, v155
v_cvt_pk_bf16_f32 v154, v152, v153
v_mfma_f32_16x16x32_bf16 a[20:23], a[244:247], v[128:131], a[20:23]
ds_read_b64_tr_b16 a[230:231], v190 offset:8672
buffer_load_dwordx4 v189, s[12:15], s61 offen offset:2048 nt lds
v_mfma_f32_16x16x32_bf16 a[84:87], a[244:247], v[132:135], a[84:87]
v_exp_f32 v172, v172
v_mfma_f32_16x16x32_bf16 a[148:151], a[244:247], v[136:139], a[148:151]
v_exp_f32 v173, v173
v_mfma_f32_16x16x32_bf16 v[212:215], a[244:247], v[140:143], v[212:215]
s_add_u32 m0, s63, 96
v_exp_f32 v174, v174
v_mfma_f32_16x16x32_bf16 a[200:203], a[244:247], a[248:251], a[200:203]
v_add_f32 v183, v183, v156
v_add_f32 v183, v183, v157
v_mfma_f32_16x16x32_bf16 a[204:207], a[244:247], a[252:255], a[204:207]
s_waitcnt lgkmcnt(1)
v_add_f32 v183, v183, v158
v_add_f32 v183, v183, v159
v_mfma_f32_16x16x32_bf16 a[24:27], a[224:227], v[128:131], a[24:27]
ds_read_b64_tr_b16 a[232:233], v186 offset:256
buffer_load_dwordx4 v189, s[12:15], s61 offen offset:3072 nt lds
v_mfma_f32_16x16x32_bf16 a[88:91], a[224:227], v[132:135], a[88:91]
s_add_u32 m0, s64, 16896
ds_read_b64_tr_b16 a[234:235], v186 offset:8704
v_cvt_pk_bf16_f32 v159, v158, v159
v_mfma_f32_16x16x32_bf16 a[152:155], a[224:227], v[136:139], a[152:155]
v_cvt_pk_bf16_f32 v158, v156, v157
v_add_f32 v180, v180, v160
v_mfma_f32_16x16x32_bf16 v[216:219], a[224:227], v[140:143], v[216:219]
v_add_f32 v180, v180, v161
v_add_f32 v180, v180, v162
v_mfma_f32_16x16x32_bf16 a[208:211], a[224:227], a[248:251], a[208:211]
ds_read_b64_tr_b16 a[236:237], v186 offset:288
v_add_f32 v180, v180, v163
v_mfma_f32_16x16x32_bf16 a[212:215], a[224:227], a[252:255], a[212:215]
s_waitcnt lgkmcnt(3)
ds_read_b64_tr_b16 a[238:239], v186 offset:8736
buffer_load_dwordx4 v189, s[16:19], s62 offen offset:0 nt lds
v_mfma_f32_16x16x32_bf16 a[28:31], a[228:231], v[128:131], a[28:31]
s_add_u32 m0, s64, 16928
v_exp_f32 v175, v175
v_mfma_f32_16x16x32_bf16 a[92:95], a[228:231], v[132:135], a[92:95]
ds_read_b64_tr_b16 a[240:241], v186 offset:320
buffer_load_dwordx4 v189, s[16:19], s62 offen offset:1024 nt lds
v_mfma_f32_16x16x32_bf16 a[156:159], a[228:231], v[136:139], a[156:159]
ds_read_b64_tr_b16 a[242:243], v186 offset:8768
v_add_f32 v181, v181, v164
v_mfma_f32_16x16x32_bf16 v[220:223], a[228:231], v[140:143], v[220:223]
s_add_u32 m0, s64, 16960
ds_read_b64_tr_b16 a[224:225], v186 offset:352
v_add_f32 v181, v181, v165
v_mfma_f32_16x16x32_bf16 a[216:219], a[228:231], a[248:251], a[216:219]
ds_read_b64_tr_b16 a[226:227], v186 offset:8800
buffer_load_dwordx4 v189, s[16:19], s62 offen offset:2048 nt lds
v_mfma_f32_16x16x32_bf16 a[220:223], a[228:231], a[252:255], a[220:223]
s_waitcnt lgkmcnt(4)
ds_read_b64_tr_b16 a[228:229], v190 offset:384
v_add_f32 v181, v181, v166
v_mfma_f32_16x16x32_bf16 a[32:35], a[232:235], v[128:131], a[32:35]
ds_read_b64_tr_b16 a[230:231], v190 offset:8832
v_add_f32 v181, v181, v167
v_mfma_f32_16x16x32_bf16 a[96:99], a[232:235], v[132:135], a[96:99]
s_add_u32 m0, s64, 16992
v_add_f32 v182, v182, v168
v_add_f32 v182, v182, v169
v_mfma_f32_16x16x32_bf16 a[160:163], a[232:235], v[136:139], a[160:163]
buffer_load_dwordx4 v189, s[16:19], s62 offen offset:3072 nt lds
v_add_f32 v182, v182, v170
v_mfma_f32_16x16x32_bf16 v[224:227], a[232:235], v[140:143], v[224:227]
s_add_u32 s61, s61, 16384
ds_read_b64_tr_b16 a[232:233], v190 offset:416
v_add_f32 v182, v182, v171
v_mfma_f32_16x16x32_bf16 a[36:39], a[236:239], v[128:131], a[36:39]
s_add_u32 s62, s62, 16384
ds_read_b64_tr_b16 a[234:235], v190 offset:8864
v_subrev_u32 v185, s47, v185
v_mfma_f32_16x16x32_bf16 a[100:103], a[236:239], v[132:135], a[100:103]
v_subrev_u32 v188, s47, v188
v_add_f32 v183, v183, v172
v_mfma_f32_16x16x32_bf16 a[164:167], a[236:239], v[136:139], a[164:167]
v_add_f32 v183, v183, v173
v_add_f32 v183, v183, v174
v_mfma_f32_16x16x32_bf16 v[228:231], a[236:239], v[140:143], v[228:231]
s_waitcnt lgkmcnt(2)
ds_read_b64_tr_b16 a[236:237], v190 offset:448
v_add_f32 v183, v183, v175
v_mfma_f32_16x16x32_bf16 a[40:43], a[240:243], v[128:131], a[40:43]
ds_read_b64_tr_b16 a[238:239], v190 offset:8896
v_cvt_pk_bf16_f32 v144, v160, v161
v_mfma_f32_16x16x32_bf16 a[104:107], a[240:243], v[132:135], a[104:107]
v_cvt_pk_bf16_f32 v145, v162, v163
v_cvt_pk_bf16_f32 v148, v164, v165
v_mfma_f32_16x16x32_bf16 a[168:171], a[240:243], v[136:139], a[168:171]
v_cvt_pk_bf16_f32 v149, v166, v167
v_cvt_pk_bf16_f32 v152, v168, v169
v_mfma_f32_16x16x32_bf16 v[232:235], a[240:243], v[140:143], v[232:235]
ds_read_b64_tr_b16 a[240:241], v190 offset:480
v_cvt_pk_bf16_f32 v153, v170, v171
v_mfma_f32_16x16x32_bf16 a[44:47], a[224:227], v[128:131], a[44:47]
ds_read_b64_tr_b16 a[242:243], v190 offset:8928
v_cvt_pk_bf16_f32 v156, v172, v173
v_mfma_f32_16x16x32_bf16 a[108:111], a[224:227], v[132:135], a[108:111]
v_cvt_pk_bf16_f32 v157, v174, v175
v_mfma_f32_16x16x32_bf16 a[172:175], a[224:227], v[136:139], a[172:175]
v_mfma_f32_16x16x32_bf16 v[236:239], a[224:227], v[140:143], v[236:239]
v_mfma_f32_16x16x32_bf16 a[48:51], a[228:231], v[128:131], a[48:51]
v_mfma_f32_16x16x32_bf16 a[112:115], a[228:231], v[132:135], a[112:115]
v_mfma_f32_16x16x32_bf16 a[176:179], a[228:231], v[136:139], a[176:179]
v_mfma_f32_16x16x32_bf16 v[240:243], a[228:231], v[140:143], v[240:243]
s_waitcnt lgkmcnt(0)
v_mfma_f32_16x16x32_bf16 a[52:55], a[232:235], v[128:131], a[52:55]
s_waitcnt lgkmcnt(0)
s_waitcnt vmcnt(16)
s_barrier
v_mfma_f32_16x16x32_bf16 a[116:119], a[232:235], v[132:135], a[116:119]
ds_read_b128 a[224:227], v185 offset:8448
v_mfma_f32_16x16x32_bf16 a[180:183], a[232:235], v[136:139], a[180:183]
ds_read_b128 a[248:251], v187 offset:0
v_mfma_f32_16x16x32_bf16 v[244:247], a[232:235], v[140:143], v[244:247]
ds_read_b128 a[252:255], v187 offset:1024
v_mfma_f32_16x16x32_bf16 a[56:59], a[236:239], v[128:131], a[56:59]
ds_read_b128 a[228:231], v185 offset:8512
v_mfma_f32_16x16x32_bf16 a[120:123], a[236:239], v[132:135], a[120:123]
ds_read_b128 a[232:235], v188 offset:8576
v_mfma_f32_16x16x32_bf16 a[184:187], a[236:239], v[136:139], a[184:187]
v_mfma_f32_16x16x32_bf16 v[248:251], a[236:239], v[140:143], v[248:251]
ds_read_b128 a[236:239], v188 offset:8640
v_mfma_f32_16x16x32_bf16 a[60:63], a[240:243], v[128:131], a[60:63]
v_mfma_f32_16x16x32_bf16 a[124:127], a[240:243], v[132:135], a[124:127]
v_mfma_f32_16x16x32_bf16 a[188:191], a[240:243], v[136:139], a[188:191]
v_mfma_f32_16x16x32_bf16 v[252:255], a[240:243], v[140:143], v[252:255]
s_sub_u32 s47, 0, s47
s_sub_u32 s74, 0, s74
s_add_u32 s46, s46, 1
s_cmp_lt_u32 s46, 15
s_cbranch_scc1 L_attloop1
s_lshr_b32 s56, s2, 5
s_and_b32 s56, s56, 7
s_mul_i32 s56, s56, 57344
s_add_u32 s56, s56, 14336
s_waitcnt lgkmcnt(1)
ds_read_b64_tr_b16 a[224:225], v186 offset:16896
ds_read_b64_tr_b16 a[226:227], v186 offset:25344
s_waitcnt lgkmcnt(0)
v_mfma_f32_16x16x32_bf16 a[0:3], a[224:227], v[144:147], a[0:3]
ds_read_b64_tr_b16 a[228:229], v186 offset:16928
v_mfma_f32_16x16x32_bf16 a[64:67], a[224:227], v[148:151], a[64:67]
ds_read_b64_tr_b16 a[230:231], v186 offset:25376
ds_read_b64_tr_b16 a[232:233], v186 offset:16960
ds_read_b64_tr_b16 a[234:235], v186 offset:25408
v_mfma_f32_16x16x32_bf16 a[128:131], a[224:227], v[152:155], a[128:131]
ds_read_b64_tr_b16 a[236:237], v186 offset:16992
buffer_load_dwordx4 v[176:179], v189, s[20:23], s56 offen offset:0
v_mfma_f32_16x16x32_bf16 v[192:195], a[224:227], v[156:159], v[192:195]
s_waitcnt lgkmcnt(3)
ds_read_b64_tr_b16 a[238:239], v186 offset:25440
v_mfma_f32_16x16x32_bf16 a[4:7], a[228:231], v[144:147], a[4:7]
ds_read_b128 a[248:251], v187 offset:18432
v_mfma_f32_16x16x32_bf16 a[68:71], a[228:231], v[148:151], a[68:71]
ds_read_b128 a[252:255], v187 offset:19456
v_mfma_f32_16x16x32_bf16 a[132:135], a[228:231], v[152:155], a[132:135]
ds_read_b64_tr_b16 a[240:241], v190 offset:17024
buffer_load_dwordx4 v[176:179], v189, s[20:23], s56 offen offset:1024
v_mfma_f32_16x16x32_bf16 v[196:199], a[228:231], v[156:159], v[196:199]
s_waitcnt lgkmcnt(5)
ds_read_b64_tr_b16 a[242:243], v190 offset:25472
v_mfma_f32_16x16x32_bf16 a[8:11], a[232:235], v[144:147], a[8:11]
ds_read_b64_tr_b16 a[244:245], v190 offset:17056
v_mfma_f32_16x16x32_bf16 a[72:75], a[232:235], v[148:151], a[72:75]
ds_read_b64_tr_b16 a[246:247], v190 offset:25504
v_mfma_f32_16x16x32_bf16 a[136:139], a[232:235], v[152:155], a[136:139]
buffer_load_dwordx4 v[176:179], v189, s[20:23], s56 offen offset:2048
ds_read_b64_tr_b16 a[224:225], v190 offset:17088
v_mfma_f32_16x16x32_bf16 v[200:203], a[232:235], v[156:159], v[200:203]
s_waitcnt lgkmcnt(5)
ds_read_b64_tr_b16 a[226:227], v190 offset:25536
v_mfma_f32_16x16x32_bf16 a[12:15], a[236:239], v[144:147], a[12:15]
ds_read_b64_tr_b16 a[228:229], v190 offset:17120
v_mfma_f32_16x16x32_bf16 a[76:79], a[236:239], v[148:151], a[76:79]
ds_read_b64_tr_b16 a[230:231], v190 offset:25568
v_mfma_f32_16x16x32_bf16 a[140:143], a[236:239], v[152:155], a[140:143]
buffer_load_dwordx4 v[176:179], v189, s[20:23], s56 offen offset:3072
ds_read_b64_tr_b16 a[232:233], v186 offset:17152
v_mfma_f32_16x16x32_bf16 v[204:207], a[236:239], v[156:159], v[204:207]
s_waitcnt lgkmcnt(5)
s_add_u32 s56, s56, 4096
ds_read_b64_tr_b16 a[234:235], v186 offset:25600
v_mfma_f32_16x16x32_bf16 a[16:19], a[240:243], v[144:147], a[16:19]
ds_read_b64_tr_b16 a[236:237], v186 offset:17184
v_mfma_f32_16x16x32_bf16 a[80:83], a[240:243], v[148:151], a[80:83]
ds_read_b64_tr_b16 a[238:239], v186 offset:25632
v_mfma_f32_16x16x32_bf16 a[144:147], a[240:243], v[152:155], a[144:147]
buffer_load_dwordx4 v[176:179], v189, s[20:23], s56 offen offset:0
v_mfma_f32_16x16x32_bf16 v[208:211], a[240:243], v[156:159], v[208:211]
v_mfma_f32_16x16x32_bf16 a[192:195], a[240:243], a[248:251], a[192:195]
v_mfma_f32_16x16x32_bf16 a[196:199], a[240:243], a[252:255], a[196:199]
ds_read_b64_tr_b16 a[240:241], v186 offset:17216
v_mfma_f32_16x16x32_bf16 a[20:23], a[244:247], v[144:147], a[20:23]
buffer_load_dwordx4 v[176:179], v189, s[20:23], s56 offen offset:1024
ds_read_b64_tr_b16 a[242:243], v186 offset:25664
v_mfma_f32_16x16x32_bf16 a[84:87], a[244:247], v[148:151], a[84:87]
v_mfma_f32_16x16x32_bf16 a[148:151], a[244:247], v[152:155], a[148:151]
v_mfma_f32_16x16x32_bf16 v[212:215], a[244:247], v[156:159], v[212:215]
v_mfma_f32_16x16x32_bf16 a[200:203], a[244:247], a[248:251], a[200:203]
buffer_load_dwordx4 v[176:179], v189, s[20:23], s56 offen offset:2048
v_mfma_f32_16x16x32_bf16 a[204:207], a[244:247], a[252:255], a[204:207]
s_waitcnt lgkmcnt(1)
v_mfma_f32_16x16x32_bf16 a[24:27], a[224:227], v[144:147], a[24:27]
v_mfma_f32_16x16x32_bf16 a[88:91], a[224:227], v[148:151], a[88:91]
v_mfma_f32_16x16x32_bf16 a[152:155], a[224:227], v[152:155], a[152:155]
buffer_load_dwordx4 v[176:179], v189, s[20:23], s56 offen offset:3072
v_mfma_f32_16x16x32_bf16 v[216:219], a[224:227], v[156:159], v[216:219]
s_add_u32 s56, s56, 4096
v_mfma_f32_16x16x32_bf16 a[208:211], a[224:227], a[248:251], a[208:211]
v_mfma_f32_16x16x32_bf16 a[212:215], a[224:227], a[252:255], a[212:215]
ds_read_b64_tr_b16 a[224:225], v186 offset:17248
v_mfma_f32_16x16x32_bf16 a[28:31], a[228:231], v[144:147], a[28:31]
buffer_load_dwordx4 v[176:179], v189, s[20:23], s56 offen offset:0
ds_read_b64_tr_b16 a[226:227], v186 offset:25696
v_mfma_f32_16x16x32_bf16 a[92:95], a[228:231], v[148:151], a[92:95]
v_mfma_f32_16x16x32_bf16 a[156:159], a[228:231], v[152:155], a[156:159]
v_mfma_f32_16x16x32_bf16 v[220:223], a[228:231], v[156:159], v[220:223]
v_mfma_f32_16x16x32_bf16 a[216:219], a[228:231], a[248:251], a[216:219]
buffer_load_dwordx4 v[176:179], v189, s[20:23], s56 offen offset:1024
v_mfma_f32_16x16x32_bf16 a[220:223], a[228:231], a[252:255], a[220:223]
ds_read_b64_tr_b16 a[228:229], v190 offset:17280
v_mfma_f32_16x16x32_bf16 a[32:35], a[232:235], v[144:147], a[32:35]
ds_read_b64_tr_b16 a[230:231], v190 offset:25728
v_mfma_f32_16x16x32_bf16 a[96:99], a[232:235], v[148:151], a[96:99]
v_mfma_f32_16x16x32_bf16 a[160:163], a[232:235], v[152:155], a[160:163]
buffer_load_dwordx4 v[176:179], v189, s[20:23], s56 offen offset:2048
v_mfma_f32_16x16x32_bf16 v[224:227], a[232:235], v[156:159], v[224:227]
ds_read_b64_tr_b16 a[232:233], v190 offset:17312
v_mfma_f32_16x16x32_bf16 a[36:39], a[236:239], v[144:147], a[36:39]
ds_read_b64_tr_b16 a[234:235], v190 offset:25760
v_mfma_f32_16x16x32_bf16 a[100:103], a[236:239], v[148:151], a[100:103]
v_mfma_f32_16x16x32_bf16 a[164:167], a[236:239], v[152:155], a[164:167]
buffer_load_dwordx4 v[176:179], v189, s[20:23], s56 offen offset:3072
v_mfma_f32_16x16x32_bf16 v[228:231], a[236:239], v[156:159], v[228:231]
s_waitcnt lgkmcnt(2)
s_add_u32 s56, s56, 4096
ds_read_b64_tr_b16 a[236:237], v190 offset:17344
v_mfma_f32_16x16x32_bf16 a[40:43], a[240:243], v[144:147], a[40:43]
ds_read_b64_tr_b16 a[238:239], v190 offset:25792
v_mfma_f32_16x16x32_bf16 a[104:107], a[240:243], v[148:151], a[104:107]
v_mfma_f32_16x16x32_bf16 a[168:171], a[240:243], v[152:155], a[168:171]
buffer_load_dwordx4 v[176:179], v189, s[20:23], s56 offen offset:0
v_mfma_f32_16x16x32_bf16 v[232:235], a[240:243], v[156:159], v[232:235]
ds_read_b64_tr_b16 a[240:241], v190 offset:17376
v_mfma_f32_16x16x32_bf16 a[44:47], a[224:227], v[144:147], a[44:47]
ds_read_b64_tr_b16 a[242:243], v190 offset:25824
v_mfma_f32_16x16x32_bf16 a[108:111], a[224:227], v[148:151], a[108:111]
v_mfma_f32_16x16x32_bf16 a[172:175], a[224:227], v[152:155], a[172:175]
buffer_load_dwordx4 v[176:179], v189, s[20:23], s56 offen offset:1024
v_mfma_f32_16x16x32_bf16 v[236:239], a[224:227], v[156:159], v[236:239]
v_mfma_f32_16x16x32_bf16 a[48:51], a[228:231], v[144:147], a[48:51]
v_mfma_f32_16x16x32_bf16 a[112:115], a[228:231], v[148:151], a[112:115]
v_mfma_f32_16x16x32_bf16 a[176:179], a[228:231], v[152:155], a[176:179]
v_mfma_f32_16x16x32_bf16 v[240:243], a[228:231], v[156:159], v[240:243]
s_waitcnt lgkmcnt(0)
v_mfma_f32_16x16x32_bf16 a[52:55], a[232:235], v[144:147], a[52:55]
v_mfma_f32_16x16x32_bf16 a[116:119], a[232:235], v[148:151], a[116:119]
v_mfma_f32_16x16x32_bf16 a[180:183], a[232:235], v[152:155], a[180:183]
v_mfma_f32_16x16x32_bf16 v[244:247], a[232:235], v[156:159], v[244:247]
v_mfma_f32_16x16x32_bf16 a[56:59], a[236:239], v[144:147], a[56:59]
v_mfma_f32_16x16x32_bf16 a[120:123], a[236:239], v[148:151], a[120:123]
v_mfma_f32_16x16x32_bf16 a[184:187], a[236:239], v[152:155], a[184:187]
v_mfma_f32_16x16x32_bf16 v[248:251], a[236:239], v[156:159], v[248:251]
v_mfma_f32_16x16x32_bf16 a[60:63], a[240:243], v[144:147], a[60:63]
v_mfma_f32_16x16x32_bf16 a[124:127], a[240:243], v[148:151], a[124:127]
v_mfma_f32_16x16x32_bf16 a[188:191], a[240:243], v[152:155], a[188:191]
v_mfma_f32_16x16x32_bf16 v[252:255], a[240:243], v[156:159], v[252:255]
s_branch L_att_done
L_att2:
ds_read_b128 a[224:227], v185 offset:0
ds_read_b128 a[248:251], v187 offset:8192
ds_read_b128 a[252:255], v187 offset:9216
ds_read_b128 a[228:231], v185 offset:64
ds_read_b128 a[232:235], v188 offset:128
ds_read_b128 a[236:239], v188 offset:192
ds_read_b128 a[240:243], v185 offset:256
s_waitcnt lgkmcnt(6)
v_mfma_f32_16x16x32_bf16 v[128:131], a[224:227], v[64:67], 0
ds_read_b128 a[244:247], v185 offset:320
v_mfma_f32_16x16x32_bf16 v[132:135], a[224:227], v[68:71], 0
s_add_u32 m0, s45, 16896
v_mfma_f32_16x16x32_bf16 v[136:139], a[224:227], v[0:3], 0
buffer_load_dwordx4 v189, s[16:19], s50 offen offset:0 nt lds
v_mfma_f32_16x16x32_bf16 v[140:143], a[224:227], v[4:7], 0
s_waitcnt lgkmcnt(6)
v_mfma_f32_16x16x32_bf16 v[176:179], a[224:227], a[248:251], 0
s_waitcnt lgkmcnt(4)
ds_read_b128 a[248:251], v187 offset:10240
v_mfma_f32_16x16x32_bf16 v[128:131], a[228:231], v[72:75], v[128:131]
ds_read_b128 a[224:227], v188 offset:384
v_mfma_f32_16x16x32_bf16 v[132:135], a[228:231], v[76:79], v[132:135]
v_mfma_f32_16x16x32_bf16 v[136:139], a[228:231], v[8:11], v[136:139]
v_mfma_f32_16x16x32_bf16 v[140:143], a[228:231], v[12:15], v[140:143]
s_add_u32 m0, s45, 16928
v_mfma_f32_16x16x32_bf16 v[176:179], a[228:231], a[252:255], v[176:179]
s_waitcnt lgkmcnt(2)
ds_read_b128 a[252:255], v187 offset:11264
buffer_load_dwordx4 v189, s[16:19], s50 offen offset:1024 nt lds
v_mfma_f32_16x16x32_bf16 v[128:131], a[232:235], v[80:83], v[128:131]
ds_read_b128 a[228:231], v188 offset:448
v_mfma_f32_16x16x32_bf16 v[132:135], a[232:235], v[84:87], v[132:135]
v_mfma_f32_16x16x32_bf16 v[136:139], a[232:235], v[16:19], v[136:139]
v_mfma_f32_16x16x32_bf16 v[140:143], a[232:235], v[20:23], v[140:143]
s_waitcnt lgkmcnt(2)
v_mfma_f32_16x16x32_bf16 v[176:179], a[232:235], a[248:251], v[176:179]
ds_read_b128 a[248:251], v187 offset:12288
v_mfma_f32_16x16x32_bf16 v[128:131], a[236:239], v[88:91], v[128:131]
s_add_u32 m0, s45, 16960
ds_read_b128 a[232:235], v185 offset:8448
v_mfma_f32_16x16x32_bf16 v[132:135], a[236:239], v[92:95], v[132:135]
buffer_load_dwordx4 v189, s[16:19], s50 offen offset:2048 nt lds
v_mfma_f32_16x16x32_bf16 v[136:139], a[236:239], v[24:27], v[136:139]
v_mfma_f32_16x16x32_bf16 v[140:143], a[236:239], v[28:31], v[140:143]
s_waitcnt lgkmcnt(2)
v_mfma_f32_16x16x32_bf16 v[176:179], a[236:239], a[252:255], v[176:179]
ds_read_b128 a[252:255], v187 offset:13312
v_mfma_f32_16x16x32_bf16 v[128:131], a[240:243], v[96:99], v[128:131]
ds_read_b128 a[236:239], v185 offset:8512
v_mfma_f32_16x16x32_bf16 v[132:135], a[240:243], v[100:103], v[132:135]
v_mfma_f32_16x16x32_bf16 v[136:139], a[240:243], v[32:35], v[136:139]
s_add_u32 m0, s45, 16992
v_mfma_f32_16x16x32_bf16 v[140:143], a[240:243], v[36:39], v[140:143]
s_waitcnt lgkmcnt(2)
buffer_load_dwordx4 v189, s[16:19], s50 offen offset:3072 nt lds
v_mfma_f32_16x16x32_bf16 v[176:179], a[240:243], a[248:251], v[176:179]
ds_read_b128 a[248:251], v187 offset:14336
v_mfma_f32_16x16x32_bf16 v[128:131], a[244:247], v[104:107], v[128:131]
ds_read_b128 a[240:243], v188 offset:8576
v_mfma_f32_16x16x32_bf16 v[132:135], a[244:247], v[108:111], v[132:135]
v_mfma_f32_16x16x32_bf16 v[136:139], a[244:247], v[40:43], v[136:139]
v_mfma_f32_16x16x32_bf16 v[140:143], a[244:247], v[44:47], v[140:143]
s_waitcnt lgkmcnt(2)
v_mfma_f32_16x16x32_bf16 v[176:179], a[244:247], a[252:255], v[176:179]
s_add_u32 m0, s64, 0
ds_read_b128 a[252:255], v187 offset:15360
v_mfma_f32_16x16x32_bf16 v[128:131], a[224:227], v[112:115], v[128:131]
buffer_load_dwordx4 v189, s[16:19], s51 offen offset:0 nt lds
v_mfma_f32_16x16x32_bf16 v[132:135], a[224:227], v[116:119], v[132:135]
v_mfma_f32_16x16x32_bf16 v[136:139], a[224:227], v[48:51], v[136:139]
v_mfma_f32_16x16x32_bf16 v[140:143], a[224:227], v[52:55], v[140:143]
s_waitcnt lgkmcnt(1)
v_mfma_f32_16x16x32_bf16 v[176:179], a[224:227], a[248:251], v[176:179]
ds_read_b128 a[224:227], v188 offset:8640
v_mfma_f32_16x16x32_bf16 v[128:131], a[228:231], v[120:123], v[128:131]
v_mfma_f32_16x16x32_bf16 v[132:135], a[228:231], v[124:127], v[132:135]
s_add_u32 m0, s64, 32
v_mfma_f32_16x16x32_bf16 v[136:139], a[228:231], v[56:59], v[136:139]
buffer_load_dwordx4 v189, s[16:19], s51 offen offset:1024 nt lds
v_mfma_f32_16x16x32_bf16 v[140:143], a[228:231], v[60:63], v[140:143]
s_waitcnt lgkmcnt(1)
v_mfma_f32_16x16x32_bf16 v[176:179], a[228:231], a[252:255], v[176:179]
ds_read_b128 a[228:231], v185 offset:8704
v_mfma_f32_16x16x32_bf16 v[160:163], a[232:235], v[64:67], 0
v_exp_f32 v128, v128
v_mfma_f32_16x16x32_bf16 v[164:167], a[232:235], v[68:71], 0
v_exp_f32 v132, v132
v_mfma_f32_16x16x32_bf16 v[168:171], a[232:235], v[0:3], 0
v_exp_f32 v136, v136
v_mfma_f32_16x16x32_bf16 v[172:175], a[232:235], v[4:7], 0
s_add_u32 m0, s64, 64
v_exp_f32 v140, v140
v_mfma_f32_16x16x32_bf16 v[160:163], a[236:239], v[72:75], v[160:163]
v_exp_f32 v176, v176
v_mfma_f32_16x16x32_bf16 v[164:167], a[236:239], v[76:79], v[164:167]
v_exp_f32 v177, v177
v_mfma_f32_16x16x32_bf16 v[168:171], a[236:239], v[8:11], v[168:171]
buffer_load_dwordx4 v189, s[16:19], s51 offen offset:2048 nt lds
ds_read_b128 a[232:235], v185 offset:8768
v_mfma_f32_16x16x32_bf16 v[172:175], a[236:239], v[12:15], v[172:175]
v_exp_f32 v178, v178
v_mfma_f32_16x16x32_bf16 v[160:163], a[240:243], v[80:83], v[160:163]
v_exp_f32 v179, v179
v_mfma_f32_16x16x32_bf16 v[164:167], a[240:243], v[84:87], v[164:167]
v_exp_f32 v129, v129
v_mfma_f32_16x16x32_bf16 v[168:171], a[240:243], v[16:19], v[168:171]
s_add_u32 m0, s64, 96
v_exp_f32 v133, v133
v_mfma_f32_16x16x32_bf16 v[172:175], a[240:243], v[20:23], v[172:175]
s_waitcnt lgkmcnt(1)
ds_read_b128 a[236:239], v188 offset:8832
buffer_load_dwordx4 v189, s[16:19], s51 offen offset:3072 nt lds
v_mfma_f32_16x16x32_bf16 v[160:163], a[224:227], v[88:91], v[160:163]
v_exp_f32 v137, v137
v_mfma_f32_16x16x32_bf16 v[164:167], a[224:227], v[92:95], v[164:167]
v_exp_f32 v141, v141
v_mfma_f32_16x16x32_bf16 v[168:171], a[224:227], v[24:27], v[168:171]
v_exp_f32 v130, v130
v_mfma_f32_16x16x32_bf16 v[172:175], a[224:227], v[28:31], v[172:175]
ds_read_b128 a[240:243], v188 offset:8896
v_add_f32 v184, v184, v176
v_mfma_f32_16x16x32_bf16 v[160:163], a[228:231], v[96:99], v[160:163]
v_exp_f32 v134, v134
v_mfma_f32_16x16x32_bf16 v[164:167], a[228:231], v[100:103], v[164:167]
v_exp_f32 v138, v138
v_mfma_f32_16x16x32_bf16 v[168:171], a[228:231], v[32:35], v[168:171]
v_exp_f32 v142, v142
v_mfma_f32_16x16x32_bf16 v[172:175], a[228:231], v[36:39], v[172:175]
s_waitcnt lgkmcnt(1)
v_exp_f32 v131, v131
v_mfma_f32_16x16x32_bf16 v[160:163], a[232:235], v[104:107], v[160:163]
v_exp_f32 v135, v135
v_mfma_f32_16x16x32_bf16 v[164:167], a[232:235], v[108:111], v[164:167]
v_add_f32 v184, v184, v177
v_add_f32 v184, v184, v178
v_mfma_f32_16x16x32_bf16 v[168:171], a[232:235], v[40:43], v[168:171]
v_add_f32 v184, v184, v179
v_cvt_pk_bf16_f32 v176, v176, v177
v_mfma_f32_16x16x32_bf16 v[172:175], a[232:235], v[44:47], v[172:175]
v_exp_f32 v139, v139
v_mfma_f32_16x16x32_bf16 v[160:163], a[236:239], v[112:115], v[160:163]
v_exp_f32 v143, v143
v_mfma_f32_16x16x32_bf16 v[164:167], a[236:239], v[116:119], v[164:167]
v_cvt_pk_bf16_f32 v177, v178, v179
v_add_f32 v180, v180, v128
v_mfma_f32_16x16x32_bf16 v[168:171], a[236:239], v[48:51], v[168:171]
ds_write_b64 v187, v[176:177] offset:17408
v_add_f32 v180, v180, v129
v_mfma_f32_16x16x32_bf16 v[172:175], a[236:239], v[52:55], v[172:175]
s_waitcnt lgkmcnt(1)
v_cvt_pk_bf16_f32 v128, v128, v129
v_add_f32 v180, v180, v130
v_mfma_f32_16x16x32_bf16 v[160:163], a[240:243], v[120:123], v[160:163]
v_add_f32 v180, v180, v131
v_cvt_pk_bf16_f32 v129, v130, v131
v_mfma_f32_16x16x32_bf16 v[164:167], a[240:243], v[124:127], v[164:167]
v_add_f32 v181, v181, v132
v_add_f32 v181, v181, v133
v_mfma_f32_16x16x32_bf16 v[168:171], a[240:243], v[56:59], v[168:171]
v_cvt_pk_bf16_f32 v132, v132, v133
v_add_f32 v181, v181, v134
v_mfma_f32_16x16x32_bf16 v[172:175], a[240:243], v[60:63], v[172:175]
s_waitcnt lgkmcnt(0)
s_waitcnt vmcnt(8)
s_barrier
ds_read_b128 a[224:227], v185 offset:16896
ds_read_b128 a[248:251], v187 offset:8192
ds_read_b128 a[252:255], v187 offset:9216
ds_read_b128 a[228:231], v185 offset:16960
ds_read_b128 a[232:235], v188 offset:17024
ds_read_b128 a[236:239], v188 offset:17088
v_add_f32 v181, v181, v135
v_cvt_pk_bf16_f32 v133, v134, v135
v_add_f32 v182, v182, v136
v_add_f32 v182, v182, v137
v_add_f32 v182, v182, v138
v_add_f32 v182, v182, v139
v_cvt_pk_bf16_f32 v136, v136, v137
v_cvt_pk_bf16_f32 v137, v138, v139
v_add_f32 v183, v183, v140
v_add_f32 v183, v183, v141
v_add_f32 v183, v183, v142
v_add_f32 v183, v183, v143
v_cvt_pk_bf16_f32 v140, v140, v141
v_cvt_pk_bf16_f32 v141, v142, v143
v_exp_f32 v160, v160
s_nop 0
v_add_f32 v180, v180, v160
v_exp_f32 v161, v161
s_nop 0
v_add_f32 v180, v180, v161
v_exp_f32 v162, v162
s_nop 0
v_add_f32 v180, v180, v162
v_exp_f32 v163, v163
s_nop 0
v_add_f32 v180, v180, v163
v_cvt_pk_bf16_f32 v130, v160, v161
v_cvt_pk_bf16_f32 v131, v162, v163
v_exp_f32 v164, v164
s_nop 0
v_add_f32 v181, v181, v164
v_exp_f32 v165, v165
s_nop 0
v_add_f32 v181, v181, v165
v_exp_f32 v166, v166
s_nop 0
v_add_f32 v181, v181, v166
v_exp_f32 v167, v167
s_nop 0
v_add_f32 v181, v181, v167
v_cvt_pk_bf16_f32 v134, v164, v165
v_cvt_pk_bf16_f32 v135, v166, v167
v_exp_f32 v168, v168
s_nop 0
v_add_f32 v182, v182, v168
v_exp_f32 v169, v169
s_nop 0
v_add_f32 v182, v182, v169
v_exp_f32 v170, v170
s_nop 0
v_add_f32 v182, v182, v170
v_exp_f32 v171, v171
s_nop 0
v_add_f32 v182, v182, v171
v_cvt_pk_bf16_f32 v138, v168, v169
v_cvt_pk_bf16_f32 v139, v170, v171
v_exp_f32 v172, v172
s_nop 0
v_add_f32 v183, v183, v172
v_exp_f32 v173, v173
s_nop 0
v_add_f32 v183, v183, v173
v_exp_f32 v174, v174
s_nop 0
v_add_f32 v183, v183, v174
v_exp_f32 v175, v175
s_nop 0
v_add_f32 v183, v183, v175
v_cvt_pk_bf16_f32 v142, v172, v173
v_cvt_pk_bf16_f32 v143, v174, v175
s_sub_u32 s63, s63, 4294837248
ds_read_b128 a[240:243], v185 offset:17152
s_waitcnt lgkmcnt(6)
v_mfma_f32_16x16x32_bf16 v[144:147], a[224:227], v[64:67], 0
ds_read_b128 a[244:247], v185 offset:17216
v_mfma_f32_16x16x32_bf16 v[148:151], a[224:227], v[68:71], 0
v_mfma_f32_16x16x32_bf16 v[152:155], a[224:227], v[0:3], 0
v_mfma_f32_16x16x32_bf16 v[156:159], a[224:227], v[4:7], 0
s_waitcnt lgkmcnt(6)
v_mfma_f32_16x16x32_bf16 v[176:179], a[224:227], a[248:251], 0
s_waitcnt lgkmcnt(4)
ds_read_b128 a[248:251], v187 offset:10240
v_mfma_f32_16x16x32_bf16 v[144:147], a[228:231], v[72:75], v[144:147]
ds_read_b128 a[224:227], v188 offset:17280
v_mfma_f32_16x16x32_bf16 v[148:151], a[228:231], v[76:79], v[148:151]
v_mfma_f32_16x16x32_bf16 v[152:155], a[228:231], v[8:11], v[152:155]
v_mfma_f32_16x16x32_bf16 v[156:159], a[228:231], v[12:15], v[156:159]
v_mfma_f32_16x16x32_bf16 v[176:179], a[228:231], a[252:255], v[176:179]
s_waitcnt lgkmcnt(2)
ds_read_b128 a[252:255], v187 offset:11264
v_mfma_f32_16x16x32_bf16 v[144:147], a[232:235], v[80:83], v[144:147]
ds_read_b128 a[228:231], v188 offset:17344
v_mfma_f32_16x16x32_bf16 v[148:151], a[232:235], v[84:87], v[148:151]
v_mfma_f32_16x16x32_bf16 v[152:155], a[232:235], v[16:19], v[152:155]
v_mfma_f32_16x16x32_bf16 v[156:159], a[232:235], v[20:23], v[156:159]
s_waitcnt lgkmcnt(2)
v_mfma_f32_16x16x32_bf16 v[176:179], a[232:235], a[248:251], v[176:179]
ds_read_b128 a[248:251], v187 offset:12288
v_mfma_f32_16x16x32_bf16 v[144:147], a[236:239], v[88:91], v[144:147]
ds_read_b128 a[232:235], v185 offset:25344
v_mfma_f32_16x16x32_bf16 v[148:151], a[236:239], v[92:95], v[148:151]
v_mfma_f32_16x16x32_bf16 v[152:155], a[236:239], v[24:27], v[152:155]
v_mfma_f32_16x16x32_bf16 v[156:159], a[236:239], v[28:31], v[156:159]
s_waitcnt lgkmcnt(2)
v_mfma_f32_16x16x32_bf16 v[176:179], a[236:239], a[252:255], v[176:179]
ds_read_b128 a[252:255], v187 offset:13312
v_mfma_f32_16x16x32_bf16 v[144:147], a[240:243], v[96:99], v[144:147]
ds_read_b128 a[236:239], v185 offset:25408
v_mfma_f32_16x16x32_bf16 v[148:151], a[240:243], v[100:103], v[148:151]
v_mfma_f32_16x16x32_bf16 v[152:155], a[240:243], v[32:35], v[152:155]
v_mfma_f32_16x16x32_bf16 v[156:159], a[240:243], v[36:39], v[156:159]
s_waitcnt lgkmcnt(2)
v_mfma_f32_16x16x32_bf16 v[176:179], a[240:243], a[248:251], v[176:179]
ds_read_b128 a[248:251], v187 offset:14336
v_mfma_f32_16x16x32_bf16 v[144:147], a[244:247], v[104:107], v[144:147]
ds_read_b128 a[240:243], v188 offset:25472
v_mfma_f32_16x16x32_bf16 v[148:151], a[244:247], v[108:111], v[148:151]
v_mfma_f32_16x16x32_bf16 v[152:155], a[244:247], v[40:43], v[152:155]
v_mfma_f32_16x16x32_bf16 v[156:159], a[244:247], v[44:47], v[156:159]
s_waitcnt lgkmcnt(2)
v_mfma_f32_16x16x32_bf16 v[176:179], a[244:247], a[252:255], v[176:179]
ds_read_b128 a[252:255], v187 offset:15360
v_mfma_f32_16x16x32_bf16 v[144:147], a[224:227], v[112:115], v[144:147]
ds_read_b64_tr_b16 a[244:245], v186 offset:288
v_mfma_f32_16x16x32_bf16 v[148:151], a[224:227], v[116:119], v[148:151]
ds_read_b64_tr_b16 a[246:247], v186 offset:8736
v_mfma_f32_16x16x32_bf16 v[152:155], a[224:227], v[48:51], v[152:155]
v_mfma_f32_16x16x32_bf16 v[156:159], a[224:227], v[52:55], v[156:159]
s_waitcnt lgkmcnt(3)
v_mfma_f32_16x16x32_bf16 v[176:179], a[224:227], a[248:251], v[176:179]
ds_read_b128 a[224:227], v188 offset:25536
v_mfma_f32_16x16x32_bf16 v[144:147], a[228:231], v[120:123], v[144:147]
ds_read_b128 a[248:251], v187 offset:16384
v_mfma_f32_16x16x32_bf16 v[148:151], a[228:231], v[124:127], v[148:151]
v_mfma_f32_16x16x32_bf16 v[152:155], a[228:231], v[56:59], v[152:155]
v_mfma_f32_16x16x32_bf16 v[156:159], a[228:231], v[60:63], v[156:159]
s_waitcnt lgkmcnt(2)
v_mfma_f32_16x16x32_bf16 v[176:179], a[228:231], a[252:255], v[176:179]
ds_read_b128 a[228:231], v185 offset:25600
v_mfma_f32_16x16x32_bf16 v[160:163], a[232:235], v[64:67], 0
v_exp_f32 v144, v144
v_mfma_f32_16x16x32_bf16 v[164:167], a[232:235], v[68:71], 0
v_exp_f32 v145, v145
v_mfma_f32_16x16x32_bf16 v[168:171], a[232:235], v[0:3], 0
v_exp_f32 v146, v146
v_mfma_f32_16x16x32_bf16 v[172:175], a[232:235], v[4:7], 0
v_exp_f32 v147, v147
v_mfma_f32_16x16x32_bf16 v[160:163], a[236:239], v[72:75], v[160:163]
v_exp_f32 v176, v176
v_mfma_f32_16x16x32_bf16 v[164:167], a[236:239], v[76:79], v[164:167]
v_exp_f32 v177, v177
v_mfma_f32_16x16x32_bf16 v[168:171], a[236:239], v[8:11], v[168:171]
v_exp_f32 v178, v178
v_mfma_f32_16x16x32_bf16 v[172:175], a[236:239], v[12:15], v[172:175]
ds_read_b128 a[232:235], v185 offset:25664
v_add_f32 v184, v184, v176
v_mfma_f32_16x16x32_bf16 v[160:163], a[240:243], v[80:83], v[160:163]
v_exp_f32 v179, v179
v_mfma_f32_16x16x32_bf16 v[164:167], a[240:243], v[84:87], v[164:167]
v_exp_f32 v148, v148
v_mfma_f32_16x16x32_bf16 v[168:171], a[240:243], v[16:19], v[168:171]
v_exp_f32 v149, v149
v_mfma_f32_16x16x32_bf16 v[172:175], a[240:243], v[20:23], v[172:175]
s_waitcnt lgkmcnt(1)
ds_read_b128 a[236:239], v188 offset:25728
v_add_f32 v184, v184, v177
v_mfma_f32_16x16x32_bf16 v[160:163], a[224:227], v[88:91], v[160:163]
v_exp_f32 v150, v150
v_mfma_f32_16x16x32_bf16 v[164:167], a[224:227], v[92:95], v[164:167]
v_exp_f32 v151, v151
v_mfma_f32_16x16x32_bf16 v[168:171], a[224:227], v[24:27], v[168:171]
v_exp_f32 v152, v152
v_mfma_f32_16x16x32_bf16 v[172:175], a[224:227], v[28:31], v[172:175]
ds_read_b128 a[240:243], v188 offset:25792
v_add_f32 v184, v184, v178
v_mfma_f32_16x16x32_bf16 v[160:163], a[228:231], v[96:99], v[160:163]
v_exp_f32 v153, v153
v_mfma_f32_16x16x32_bf16 v[164:167], a[228:231], v[100:103], v[164:167]
v_exp_f32 v154, v154
v_mfma_f32_16x16x32_bf16 v[168:171], a[228:231], v[32:35], v[168:171]
v_exp_f32 v155, v155
v_mfma_f32_16x16x32_bf16 v[172:175], a[228:231], v[36:39], v[172:175]
s_waitcnt lgkmcnt(1)
ds_read_b64_tr_b16 a[224:225], v186 offset:0
v_add_f32 v184, v184, v179
v_mfma_f32_16x16x32_bf16 v[160:163], a[232:235], v[104:107], v[160:163]
ds_read_b64_tr_b16 a[226:227], v186 offset:8448
v_cvt_pk_bf16_f32 v176, v176, v177
v_mfma_f32_16x16x32_bf16 v[164:167], a[232:235], v[108:111], v[164:167]
v_exp_f32 v156, v156
v_mfma_f32_16x16x32_bf16 v[168:171], a[232:235], v[40:43], v[168:171]
v_exp_f32 v157, v157
v_mfma_f32_16x16x32_bf16 v[172:175], a[232:235], v[44:47], v[172:175]
ds_read_b64_tr_b16 a[228:229], v186 offset:32
v_cvt_pk_bf16_f32 v177, v178, v179
v_mfma_f32_16x16x32_bf16 v[160:163], a[236:239], v[112:115], v[160:163]
ds_read_b64_tr_b16 a[230:231], v186 offset:8480
v_add_f32 v180, v180, v144
v_mfma_f32_16x16x32_bf16 v[164:167], a[236:239], v[116:119], v[164:167]
v_exp_f32 v158, v158
v_mfma_f32_16x16x32_bf16 v[168:171], a[236:239], v[48:51], v[168:171]
v_exp_f32 v159, v159
v_mfma_f32_16x16x32_bf16 v[172:175], a[236:239], v[52:55], v[172:175]
s_waitcnt lgkmcnt(2)
ds_read_b64_tr_b16 a[232:233], v186 offset:64
v_add_f32 v180, v180, v145
v_mfma_f32_16x16x32_bf16 v[160:163], a[240:243], v[120:123], v[160:163]
ds_read_b64_tr_b16 a[234:235], v186 offset:8512
v_add_f32 v180, v180, v146
v_mfma_f32_16x16x32_bf16 v[164:167], a[240:243], v[124:127], v[164:167]
ds_write_b64 v187, v[176:177] offset:19456
v_add_f32 v180, v180, v147
v_mfma_f32_16x16x32_bf16 v[168:171], a[240:243], v[56:59], v[168:171]
ds_read_b64_tr_b16 a[236:237], v186 offset:96
v_cvt_pk_bf16_f32 v144, v144, v145
v_mfma_f32_16x16x32_bf16 v[172:175], a[240:243], v[60:63], v[172:175]
ds_read_b64_tr_b16 a[238:239], v186 offset:8544
v_cvt_pk_bf16_f32 v145, v146, v147
v_mfma_f32_16x16x32_bf16 a[0:3], a[224:227], v[128:131], 0
ds_read_b128 a[252:255], v187 offset:17408
v_add_f32 v181, v181, v148
v_mfma_f32_16x16x32_bf16 a[64:67], a[224:227], v[132:135], 0
v_exp_f32 v160, v160
v_mfma_f32_16x16x32_bf16 a[128:131], a[224:227], v[136:139], 0
v_exp_f32 v161, v161
v_mfma_f32_16x16x32_bf16 v[192:195], a[224:227], v[140:143], 0
s_waitcnt lgkmcnt(3)
ds_read_b64_tr_b16 a[240:241], v186 offset:256
v_add_f32 v181, v181, v149
v_mfma_f32_16x16x32_bf16 a[4:7], a[228:231], v[128:131], 0
ds_read_b64_tr_b16 a[242:243], v186 offset:8704
v_add_f32 v181, v181, v150
v_mfma_f32_16x16x32_bf16 a[68:71], a[228:231], v[132:135], 0
v_exp_f32 v162, v162
v_mfma_f32_16x16x32_bf16 a[132:135], a[228:231], v[136:139], 0
v_exp_f32 v163, v163
v_mfma_f32_16x16x32_bf16 v[196:199], a[228:231], v[140:143], 0
v_exp_f32 v164, v164
v_mfma_f32_16x16x32_bf16 a[8:11], a[232:235], v[128:131], 0
ds_read_b64_tr_b16 a[224:225], v186 offset:320
v_add_f32 v181, v181, v151
v_mfma_f32_16x16x32_bf16 a[72:75], a[232:235], v[132:135], 0
v_exp_f32 v165, v165
v_mfma_f32_16x16x32_bf16 a[136:139], a[232:235], v[136:139], 0
v_exp_f32 v166, v166
v_mfma_f32_16x16x32_bf16 v[200:203], a[232:235], v[140:143], 0
s_waitcnt lgkmcnt(1)
v_exp_f32 v167, v167
v_mfma_f32_16x16x32_bf16 a[12:15], a[236:239], v[128:131], 0
v_cvt_pk_bf16_f32 v148, v148, v149
v_cvt_pk_bf16_f32 v149, v150, v151
v_mfma_f32_16x16x32_bf16 a[76:79], a[236:239], v[132:135], 0
v_exp_f32 v168, v168
v_mfma_f32_16x16x32_bf16 a[140:143], a[236:239], v[136:139], 0
s_add_u32 m0, s63, 0
v_exp_f32 v169, v169
v_mfma_f32_16x16x32_bf16 v[204:207], a[236:239], v[140:143], 0
ds_read_b64_tr_b16 a[226:227], v186 offset:8768
buffer_load_dwordx4 v189, s[12:15], s61 offen offset:0 nt lds
v_mfma_f32_16x16x32_bf16 a[32:35], a[240:243], v[128:131], 0
v_exp_f32 v170, v170
v_mfma_f32_16x16x32_bf16 a[96:99], a[240:243], v[132:135], 0
v_add_f32 v182, v182, v152
v_add_f32 v182, v182, v153
v_mfma_f32_16x16x32_bf16 a[160:163], a[240:243], v[136:139], 0
s_add_u32 m0, s63, 32
v_add_f32 v182, v182, v154
v_add_f32 v182, v182, v155
v_mfma_f32_16x16x32_bf16 v[224:227], a[240:243], v[140:143], 0
v_exp_f32 v171, v171
v_mfma_f32_16x16x32_bf16 a[192:195], a[240:243], a[248:251], 0
v_exp_f32 v172, v172
v_mfma_f32_16x16x32_bf16 a[196:199], a[240:243], a[252:255], 0
v_cvt_pk_bf16_f32 v152, v152, v153
v_cvt_pk_bf16_f32 v153, v154, v155
v_mfma_f32_16x16x32_bf16 a[36:39], a[244:247], v[128:131], 0
ds_read_b64_tr_b16 a[228:229], v186 offset:352
buffer_load_dwordx4 v189, s[12:15], s61 offen offset:1024 nt lds
v_mfma_f32_16x16x32_bf16 a[100:103], a[244:247], v[132:135], 0
s_add_u32 m0, s63, 64
ds_read_b64_tr_b16 a[230:231], v186 offset:8800
v_add_f32 v183, v183, v156
v_mfma_f32_16x16x32_bf16 a[164:167], a[244:247], v[136:139], 0
v_exp_f32 v173, v173
v_mfma_f32_16x16x32_bf16 v[228:231], a[244:247], v[140:143], 0
buffer_load_dwordx4 v189, s[12:15], s61 offen offset:2048 nt lds
ds_read_b64_tr_b16 a[232:233], v190 offset:128
v_mfma_f32_16x16x32_bf16 a[200:203], a[244:247], a[248:251], 0
s_add_u32 m0, s63, 96
v_add_f32 v183, v183, v157
v_add_f32 v183, v183, v158
v_mfma_f32_16x16x32_bf16 a[204:207], a[244:247], a[252:255], 0
s_waitcnt lgkmcnt(3)
ds_read_b64_tr_b16 a[234:235], v190 offset:8576
v_add_f32 v183, v183, v159
v_mfma_f32_16x16x32_bf16 a[40:43], a[224:227], v[128:131], 0
v_exp_f32 v174, v174
v_mfma_f32_16x16x32_bf16 a[104:107], a[224:227], v[132:135], 0
buffer_load_dwordx4 v189, s[12:15], s61 offen offset:3072 nt lds
ds_read_b64_tr_b16 a[236:237], v190 offset:160
v_mfma_f32_16x16x32_bf16 a[168:171], a[224:227], v[136:139], 0
s_add_u32 m0, s64, 16896
v_cvt_pk_bf16_f32 v156, v156, v157
v_cvt_pk_bf16_f32 v157, v158, v159
v_mfma_f32_16x16x32_bf16 v[232:235], a[224:227], v[140:143], 0
v_add_f32 v180, v180, v160
v_add_f32 v180, v180, v161
v_mfma_f32_16x16x32_bf16 a[208:211], a[224:227], a[248:251], 0
v_add_f32 v180, v180, v162
v_add_f32 v180, v180, v163
v_mfma_f32_16x16x32_bf16 a[212:215], a[224:227], a[252:255], 0
s_waitcnt lgkmcnt(1)
ds_read_b64_tr_b16 a[238:239], v190 offset:8608
buffer_load_dwordx4 v189, s[16:19], s62 offen offset:0 nt lds
v_mfma_f32_16x16x32_bf16 a[44:47], a[228:231], v[128:131], 0
s_add_u32 m0, s64, 16928
v_exp_f32 v175, v175
v_mfma_f32_16x16x32_bf16 a[108:111], a[228:231], v[132:135], 0
ds_read_b64_tr_b16 a[240:241], v190 offset:192
buffer_load_dwordx4 v189, s[16:19], s62 offen offset:1024 nt lds
v_mfma_f32_16x16x32_bf16 a[172:175], a[228:231], v[136:139], 0
ds_read_b64_tr_b16 a[242:243], v190 offset:8640
v_add_f32 v181, v181, v164
v_mfma_f32_16x16x32_bf16 v[236:239], a[228:231], v[140:143], 0
ds_read_b64_tr_b16 a[224:225], v190 offset:224
v_add_f32 v181, v181, v165
v_mfma_f32_16x16x32_bf16 a[216:219], a[228:231], a[248:251], 0
s_add_u32 m0, s64, 16960
ds_read_b64_tr_b16 a[226:227], v190 offset:8672
v_add_f32 v181, v181, v166
v_mfma_f32_16x16x32_bf16 a[220:223], a[228:231], a[252:255], 0
buffer_load_dwordx4 v189, s[16:19], s62 offen offset:2048 nt lds
ds_read_b64_tr_b16 a[228:229], v190 offset:384
v_mfma_f32_16x16x32_bf16 a[16:19], a[232:235], v[128:131], 0
ds_read_b64_tr_b16 a[230:231], v190 offset:8832
v_add_f32 v181, v181, v167
v_mfma_f32_16x16x32_bf16 a[80:83], a[232:235], v[132:135], 0
v_add_f32 v182, v182, v168
v_add_f32 v182, v182, v169
v_mfma_f32_16x16x32_bf16 a[144:147], a[232:235], v[136:139], 0
s_add_u32 m0, s64, 16992
v_add_f32 v182, v182, v170
v_add_f32 v182, v182, v171
v_mfma_f32_16x16x32_bf16 v[208:211], a[232:235], v[140:143], 0
s_waitcnt lgkmcnt(3)
buffer_load_dwordx4 v189, s[16:19], s62 offen offset:3072 nt lds
ds_read_b64_tr_b16 a[232:233], v190 offset:416
v_mfma_f32_16x16x32_bf16 a[20:23], a[236:239], v[128:131], 0
s_add_u32 s61, s61, 16384
ds_read_b64_tr_b16 a[234:235], v190 offset:8864
v_add_u32 v185, 4294837248, v185
v_mfma_f32_16x16x32_bf16 a[84:87], a[236:239], v[132:135], 0
s_add_u32 s62, s62, 16384
v_add_u32 v188, 4294837248, v188
v_add_f32 v183, v183, v172
v_mfma_f32_16x16x32_bf16 a[148:151], a[236:239], v[136:139], 0
v_add_f32 v183, v183, v173
v_add_f32 v183, v183, v174
v_mfma_f32_16x16x32_bf16 v[212:215], a[236:239], v[140:143], 0
ds_read_b64_tr_b16 a[236:237], v190 offset:448
v_add_f32 v183, v183, v175
v_mfma_f32_16x16x32_bf16 a[24:27], a[240:243], v[128:131], 0
ds_read_b64_tr_b16 a[238:239], v190 offset:8896
v_cvt_pk_bf16_f32 v146, v160, v161
v_mfma_f32_16x16x32_bf16 a[88:91], a[240:243], v[132:135], 0
v_cvt_pk_bf16_f32 v147, v162, v163
v_cvt_pk_bf16_f32 v150, v164, v165
v_mfma_f32_16x16x32_bf16 a[152:155], a[240:243], v[136:139], 0
v_cvt_pk_bf16_f32 v151, v166, v167
v_cvt_pk_bf16_f32 v154, v168, v169
v_mfma_f32_16x16x32_bf16 v[216:219], a[240:243], v[140:143], 0
s_waitcnt lgkmcnt(2)
ds_read_b64_tr_b16 a[240:241], v190 offset:480
v_cvt_pk_bf16_f32 v155, v170, v171
v_mfma_f32_16x16x32_bf16 a[28:31], a[224:227], v[128:131], 0
ds_read_b64_tr_b16 a[242:243], v190 offset:8928
v_cvt_pk_bf16_f32 v158, v172, v173
v_mfma_f32_16x16x32_bf16 a[92:95], a[224:227], v[132:135], 0
v_cvt_pk_bf16_f32 v159, v174, v175
v_mfma_f32_16x16x32_bf16 a[156:159], a[224:227], v[136:139], 0
v_mfma_f32_16x16x32_bf16 v[220:223], a[224:227], v[140:143], 0
v_mfma_f32_16x16x32_bf16 a[48:51], a[228:231], v[128:131], 0
v_mfma_f32_16x16x32_bf16 a[112:115], a[228:231], v[132:135], 0
v_mfma_f32_16x16x32_bf16 a[176:179], a[228:231], v[136:139], 0
v_mfma_f32_16x16x32_bf16 v[240:243], a[228:231], v[140:143], 0
v_mfma_f32_16x16x32_bf16 a[52:55], a[232:235], v[128:131], 0
s_waitcnt lgkmcnt(0)
s_waitcnt vmcnt(12)
s_barrier
v_mfma_f32_16x16x32_bf16 a[116:119], a[232:235], v[132:135], 0
ds_read_b128 a[224:227], v185 offset:0
v_mfma_f32_16x16x32_bf16 a[180:183], a[232:235], v[136:139], 0
ds_read_b128 a[248:251], v187 offset:8192
v_mfma_f32_16x16x32_bf16 v[244:247], a[232:235], v[140:143], 0
ds_read_b128 a[252:255], v187 offset:9216
v_mfma_f32_16x16x32_bf16 a[56:59], a[236:239], v[128:131], 0
ds_read_b128 a[228:231], v185 offset:64
v_mfma_f32_16x16x32_bf16 a[120:123], a[236:239], v[132:135], 0
ds_read_b128 a[232:235], v188 offset:128
v_mfma_f32_16x16x32_bf16 a[184:187], a[236:239], v[136:139], 0
v_mfma_f32_16x16x32_bf16 v[248:251], a[236:239], v[140:143], 0
ds_read_b128 a[236:239], v188 offset:192
v_mfma_f32_16x16x32_bf16 a[60:63], a[240:243], v[128:131], 0
v_mfma_f32_16x16x32_bf16 a[124:127], a[240:243], v[132:135], 0
v_mfma_f32_16x16x32_bf16 a[188:191], a[240:243], v[136:139], 0
v_mfma_f32_16x16x32_bf16 v[252:255], a[240:243], v[140:143], 0
L_attloop2:
s_sub_u32 s64, s64, s74
ds_read_b128 a[240:243], v185 offset:256
s_waitcnt lgkmcnt(2)
v_mfma_f32_16x16x32_bf16 v[128:131], a[224:227], v[64:67], 0
ds_read_b128 a[244:247], v185 offset:320
v_mfma_f32_16x16x32_bf16 v[132:135], a[224:227], v[68:71], 0
v_mfma_f32_16x16x32_bf16 v[136:139], a[224:227], v[0:3], 0
v_mfma_f32_16x16x32_bf16 v[140:143], a[224:227], v[4:7], 0
v_mfma_f32_16x16x32_bf16 v[176:179], a[224:227], a[248:251], 0
ds_read_b128 a[248:251], v187 offset:10240
v_mfma_f32_16x16x32_bf16 v[128:131], a[228:231], v[72:75], v[128:131]
ds_read_b128 a[224:227], v188 offset:384
v_mfma_f32_16x16x32_bf16 v[132:135], a[228:231], v[76:79], v[132:135]
v_mfma_f32_16x16x32_bf16 v[136:139], a[228:231], v[8:11], v[136:139]
v_mfma_f32_16x16x32_bf16 v[140:143], a[228:231], v[12:15], v[140:143]
v_mfma_f32_16x16x32_bf16 v[176:179], a[228:231], a[252:255], v[176:179]
ds_read_b128 a[252:255], v187 offset:11264
v_mfma_f32_16x16x32_bf16 v[128:131], a[232:235], v[80:83], v[128:131]
ds_read_b128 a[228:231], v188 offset:448
v_mfma_f32_16x16x32_bf16 v[132:135], a[232:235], v[84:87], v[132:135]
v_mfma_f32_16x16x32_bf16 v[136:139], a[232:235], v[16:19], v[136:139]
v_mfma_f32_16x16x32_bf16 v[140:143], a[232:235], v[20:23], v[140:143]
s_waitcnt lgkmcnt(2)
v_mfma_f32_16x16x32_bf16 v[176:179], a[232:235], a[248:251], v[176:179]
ds_read_b128 a[248:251], v187 offset:12288
v_mfma_f32_16x16x32_bf16 v[128:131], a[236:239], v[88:91], v[128:131]
ds_read_b128 a[232:235], v185 offset:8448
v_mfma_f32_16x16x32_bf16 v[132:135], a[236:239], v[92:95], v[132:135]
v_mfma_f32_16x16x32_bf16 v[136:139], a[236:239], v[24:27], v[136:139]
v_mfma_f32_16x16x32_bf16 v[140:143], a[236:239], v[28:31], v[140:143]
s_waitcnt lgkmcnt(2)
v_mfma_f32_16x16x32_bf16 v[176:179], a[236:239], a[252:255], v[176:179]
ds_read_b128 a[252:255], v187 offset:13312
v_mfma_f32_16x16x32_bf16 v[128:131], a[240:243], v[96:99], v[128:131]
ds_read_b128 a[236:239], v185 offset:8512
v_mfma_f32_16x16x32_bf16 v[132:135], a[240:243], v[100:103], v[132:135]
v_mfma_f32_16x16x32_bf16 v[136:139], a[240:243], v[32:35], v[136:139]
v_mfma_f32_16x16x32_bf16 v[140:143], a[240:243], v[36:39], v[140:143]
s_waitcnt lgkmcnt(2)
v_mfma_f32_16x16x32_bf16 v[176:179], a[240:243], a[248:251], v[176:179]
ds_read_b128 a[248:251], v187 offset:14336
v_mfma_f32_16x16x32_bf16 v[128:131], a[244:247], v[104:107], v[128:131]
ds_read_b128 a[240:243], v188 offset:8576
v_mfma_f32_16x16x32_bf16 v[132:135], a[244:247], v[108:111], v[132:135]
v_mfma_f32_16x16x32_bf16 v[136:139], a[244:247], v[40:43], v[136:139]
v_mfma_f32_16x16x32_bf16 v[140:143], a[244:247], v[44:47], v[140:143]
s_waitcnt lgkmcnt(2)
v_mfma_f32_16x16x32_bf16 v[176:179], a[244:247], a[252:255], v[176:179]
ds_read_b128 a[252:255], v187 offset:15360
v_mfma_f32_16x16x32_bf16 v[128:131], a[224:227], v[112:115], v[128:131]
ds_read_b64_tr_b16 a[244:245], v186 offset:17184
v_mfma_f32_16x16x32_bf16 v[132:135], a[224:227], v[116:119], v[132:135]
ds_read_b64_tr_b16 a[246:247], v186 offset:25632
v_mfma_f32_16x16x32_bf16 v[136:139], a[224:227], v[48:51], v[136:139]
v_mfma_f32_16x16x32_bf16 v[140:143], a[224:227], v[52:55], v[140:143]
s_waitcnt lgkmcnt(3)
v_mfma_f32_16x16x32_bf16 v[176:179], a[224:227], a[248:251], v[176:179]
ds_read_b128 a[224:227], v188 offset:8640
v_mfma_f32_16x16x32_bf16 v[128:131], a[228:231], v[120:123], v[128:131]
ds_read_b128 a[248:251], v187 offset:18432
v_mfma_f32_16x16x32_bf16 v[132:135], a[228:231], v[124:127], v[132:135]
v_mfma_f32_16x16x32_bf16 v[136:139], a[228:231], v[56:59], v[136:139]
v_mfma_f32_16x16x32_bf16 v[140:143], a[228:231], v[60:63], v[140:143]
s_waitcnt lgkmcnt(2)
v_mfma_f32_16x16x32_bf16 v[176:179], a[228:231], a[252:255], v[176:179]
ds_read_b128 a[228:231], v185 offset:8704
v_mfma_f32_16x16x32_bf16 v[160:163], a[232:235], v[64:67], 0
v_exp_f32 v128, v128
v_mfma_f32_16x16x32_bf16 v[164:167], a[232:235], v[68:71], 0
v_exp_f32 v129, v129
v_mfma_f32_16x16x32_bf16 v[168:171], a[232:235], v[0:3], 0
v_exp_f32 v130, v130
v_mfma_f32_16x16x32_bf16 v[172:175], a[232:235], v[4:7], 0
v_exp_f32 v131, v131
v_mfma_f32_16x16x32_bf16 v[160:163], a[236:239], v[72:75], v[160:163]
v_exp_f32 v176, v176
v_mfma_f32_16x16x32_bf16 v[164:167], a[236:239], v[76:79], v[164:167]
v_exp_f32 v177, v177
v_mfma_f32_16x16x32_bf16 v[168:171], a[236:239], v[8:11], v[168:171]
v_exp_f32 v178, v178
v_mfma_f32_16x16x32_bf16 v[172:175], a[236:239], v[12:15], v[172:175]
ds_read_b128 a[232:235], v185 offset:8768
v_add_f32 v184, v184, v176
v_mfma_f32_16x16x32_bf16 v[160:163], a[240:243], v[80:83], v[160:163]
v_exp_f32 v179, v179
v_mfma_f32_16x16x32_bf16 v[164:167], a[240:243], v[84:87], v[164:167]
v_exp_f32 v132, v132
v_mfma_f32_16x16x32_bf16 v[168:171], a[240:243], v[16:19], v[168:171]
v_exp_f32 v133, v133
v_mfma_f32_16x16x32_bf16 v[172:175], a[240:243], v[20:23], v[172:175]
s_waitcnt lgkmcnt(1)
ds_read_b128 a[236:239], v188 offset:8832
v_add_f32 v184, v184, v177
v_mfma_f32_16x16x32_bf16 v[160:163], a[224:227], v[88:91], v[160:163]
v_exp_f32 v134, v134
v_mfma_f32_16x16x32_bf16 v[164:167], a[224:227], v[92:95], v[164:167]
v_exp_f32 v135, v135
v_mfma_f32_16x16x32_bf16 v[168:171], a[224:227], v[24:27], v[168:171]
v_exp_f32 v136, v136
v_mfma_f32_16x16x32_bf16 v[172:175], a[224:227], v[28:31], v[172:175]
ds_read_b128 a[240:243], v188 offset:8896
v_add_f32 v184, v184, v178
v_mfma_f32_16x16x32_bf16 v[160:163], a[228:231], v[96:99], v[160:163]
v_exp_f32 v137, v137
v_mfma_f32_16x16x32_bf16 v[164:167], a[228:231], v[100:103], v[164:167]
v_exp_f32 v138, v138
v_mfma_f32_16x16x32_bf16 v[168:171], a[228:231], v[32:35], v[168:171]
v_exp_f32 v139, v139
v_mfma_f32_16x16x32_bf16 v[172:175], a[228:231], v[36:39], v[172:175]
s_waitcnt lgkmcnt(1)
ds_read_b64_tr_b16 a[224:225], v186 offset:16896
v_add_f32 v184, v184, v179
v_mfma_f32_16x16x32_bf16 v[160:163], a[232:235], v[104:107], v[160:163]
ds_read_b64_tr_b16 a[226:227], v186 offset:25344
v_cvt_pk_bf16_f32 v176, v176, v177
v_mfma_f32_16x16x32_bf16 v[164:167], a[232:235], v[108:111], v[164:167]
v_exp_f32 v140, v140
v_mfma_f32_16x16x32_bf16 v[168:171], a[232:235], v[40:43], v[168:171]
v_exp_f32 v141, v141
v_mfma_f32_16x16x32_bf16 v[172:175], a[232:235], v[44:47], v[172:175]
ds_read_b64_tr_b16 a[228:229], v186 offset:16928
v_cvt_pk_bf16_f32 v177, v178, v179
v_mfma_f32_16x16x32_bf16 v[160:163], a[236:239], v[112:115], v[160:163]
ds_read_b64_tr_b16 a[230:231], v186 offset:25376
v_add_f32 v180, v180, v128
v_mfma_f32_16x16x32_bf16 v[164:167], a[236:239], v[116:119], v[164:167]
v_exp_f32 v142, v142
v_mfma_f32_16x16x32_bf16 v[168:171], a[236:239], v[48:51], v[168:171]
v_exp_f32 v143, v143
v_mfma_f32_16x16x32_bf16 v[172:175], a[236:239], v[52:55], v[172:175]
s_waitcnt lgkmcnt(2)
ds_read_b64_tr_b16 a[232:233], v186 offset:16960
v_add_f32 v180, v180, v129
v_mfma_f32_16x16x32_bf16 v[160:163], a[240:243], v[120:123], v[160:163]
ds_read_b64_tr_b16 a[234:235], v186 offset:25408
v_add_f32 v180, v180, v130
v_mfma_f32_16x16x32_bf16 v[164:167], a[240:243], v[124:127], v[164:167]
ds_write_b64 v187, v[176:177] offset:17408
v_add_f32 v180, v180, v131
v_mfma_f32_16x16x32_bf16 v[168:171], a[240:243], v[56:59], v[168:171]
ds_read_b64_tr_b16 a[236:237], v186 offset:16992
v_cvt_pk_bf16_f32 v128, v128, v129
v_mfma_f32_16x16x32_bf16 v[172:175], a[240:243], v[60:63], v[172:175]
ds_read_b64_tr_b16 a[238:239], v186 offset:25440
v_cvt_pk_bf16_f32 v129, v130, v131
v_mfma_f32_16x16x32_bf16 a[0:3], a[224:227], v[144:147], a[0:3]
ds_read_b128 a[252:255], v187 offset:19456
v_add_f32 v181, v181, v132
v_mfma_f32_16x16x32_bf16 a[64:67], a[224:227], v[148:151], a[64:67]
v_exp_f32 v160, v160
v_mfma_f32_16x16x32_bf16 a[128:131], a[224:227], v[152:155], a[128:131]
v_exp_f32 v161, v161
v_mfma_f32_16x16x32_bf16 v[192:195], a[224:227], v[156:159], v[192:195]
s_waitcnt lgkmcnt(3)
ds_read_b64_tr_b16 a[240:241], v186 offset:17152
v_add_f32 v181, v181, v133
v_mfma_f32_16x16x32_bf16 a[4:7], a[228:231], v[144:147], a[4:7]
ds_read_b64_tr_b16 a[242:243], v186 offset:25600
v_add_f32 v181, v181, v134
v_mfma_f32_16x16x32_bf16 a[68:71], a[228:231], v[148:151], a[68:71]
v_exp_f32 v162, v162
v_mfma_f32_16x16x32_bf16 a[132:135], a[228:231], v[152:155], a[132:135]
v_exp_f32 v163, v163
v_mfma_f32_16x16x32_bf16 v[196:199], a[228:231], v[156:159], v[196:199]
v_exp_f32 v164, v164
v_mfma_f32_16x16x32_bf16 a[8:11], a[232:235], v[144:147], a[8:11]
ds_read_b64_tr_b16 a[224:225], v186 offset:17216
v_add_f32 v181, v181, v135
v_mfma_f32_16x16x32_bf16 a[72:75], a[232:235], v[148:151], a[72:75]
v_exp_f32 v165, v165
v_mfma_f32_16x16x32_bf16 a[136:139], a[232:235], v[152:155], a[136:139]
v_exp_f32 v166, v166
v_mfma_f32_16x16x32_bf16 v[200:203], a[232:235], v[156:159], v[200:203]
s_waitcnt lgkmcnt(1)
v_exp_f32 v167, v167
v_mfma_f32_16x16x32_bf16 a[12:15], a[236:239], v[144:147], a[12:15]
v_cvt_pk_bf16_f32 v132, v132, v133
v_cvt_pk_bf16_f32 v133, v134, v135
v_mfma_f32_16x16x32_bf16 a[76:79], a[236:239], v[148:151], a[76:79]
v_exp_f32 v168, v168
v_mfma_f32_16x16x32_bf16 a[140:143], a[236:239], v[152:155], a[140:143]
s_add_u32 m0, s63, 16896
v_exp_f32 v169, v169
v_mfma_f32_16x16x32_bf16 v[204:207], a[236:239], v[156:159], v[204:207]
ds_read_b64_tr_b16 a[226:227], v186 offset:25664
buffer_load_dwordx4 v189, s[12:15], s61 offen offset:0 nt lds
v_mfma_f32_16x16x32_bf16 a[32:35], a[240:243], v[144:147], a[32:35]
v_exp_f32 v170, v170
v_mfma_f32_16x16x32_bf16 a[96:99], a[240:243], v[148:151], a[96:99]
v_add_f32 v182, v182, v136
v_add_f32 v182, v182, v137
v_mfma_f32_16x16x32_bf16 a[160:163], a[240:243], v[152:155], a[160:163]
s_add_u32 m0, s63, 16928
v_add_f32 v182, v182, v138
v_add_f32 v182, v182, v139
v_mfma_f32_16x16x32_bf16 v[224:227], a[240:243], v[156:159], v[224:227]
v_exp_f32 v171, v171
v_mfma_f32_16x16x32_bf16 a[192:195], a[240:243], a[248:251], a[192:195]
v_exp_f32 v172, v172
v_mfma_f32_16x16x32_bf16 a[196:199], a[240:243], a[252:255], a[196:199]
v_cvt_pk_bf16_f32 v136, v136, v137
v_cvt_pk_bf16_f32 v137, v138, v139
v_mfma_f32_16x16x32_bf16 a[36:39], a[244:247], v[144:147], a[36:39]
ds_read_b64_tr_b16 a[228:229], v186 offset:17248
buffer_load_dwordx4 v189, s[12:15], s61 offen offset:1024 nt lds
v_mfma_f32_16x16x32_bf16 a[100:103], a[244:247], v[148:151], a[100:103]
s_add_u32 m0, s63, 16960
ds_read_b64_tr_b16 a[230:231], v186 offset:25696
v_add_f32 v183, v183, v140
v_mfma_f32_16x16x32_bf16 a[164:167], a[244:247], v[152:155], a[164:167]
v_exp_f32 v173, v173
v_mfma_f32_16x16x32_bf16 v[228:231], a[244:247], v[156:159], v[228:231]
buffer_load_dwordx4 v189, s[12:15], s61 offen offset:2048 nt lds
ds_read_b64_tr_b16 a[232:233], v190 offset:17024
v_mfma_f32_16x16x32_bf16 a[200:203], a[244:247], a[248:251], a[200:203]
s_add_u32 m0, s63, 16992
v_add_f32 v183, v183, v141
v_add_f32 v183, v183, v142
v_mfma_f32_16x16x32_bf16 a[204:207], a[244:247], a[252:255], a[204:207]
s_waitcnt lgkmcnt(3)
ds_read_b64_tr_b16 a[234:235], v190 offset:25472
v_add_f32 v183, v183, v143
v_mfma_f32_16x16x32_bf16 a[40:43], a[224:227], v[144:147], a[40:43]
v_exp_f32 v174, v174
v_mfma_f32_16x16x32_bf16 a[104:107], a[224:227], v[148:151], a[104:107]
buffer_load_dwordx4 v189, s[12:15], s61 offen offset:3072 nt lds
ds_read_b64_tr_b16 a[236:237], v190 offset:17056
v_mfma_f32_16x16x32_bf16 a[168:171], a[224:227], v[152:155], a[168:171]
s_add_u32 m0, s64, 0
v_cvt_pk_bf16_f32 v140, v140, v141
v_cvt_pk_bf16_f32 v141, v142, v143
v_mfma_f32_16x16x32_bf16 v[232:235], a[224:227], v[156:159], v[232:235]
v_add_f32 v180, v180, v160
v_add_f32 v180, v180, v161
v_mfma_f32_16x16x32_bf16 a[208:211], a[224:227], a[248:251], a[208:211]
v_add_f32 v180, v180, v162
v_add_f32 v180, v180, v163
v_mfma_f32_16x16x32_bf16 a[212:215], a[224:227], a[252:255], a[212:215]
s_waitcnt lgkmcnt(1)
ds_read_b64_tr_b16 a[238:239], v190 offset:25504
buffer_load_dwordx4 v189, s[16:19], s62 offen offset:0 nt lds
v_mfma_f32_16x16x32_bf16 a[44:47], a[228:231], v[144:147], a[44:47]
s_add_u32 m0, s64, 32
v_exp_f32 v175, v175
v_mfma_f32_16x16x32_bf16 a[108:111], a[228:231], v[148:151], a[108:111]
ds_read_b64_tr_b16 a[240:241], v190 offset:17088
buffer_load_dwordx4 v189, s[16:19], s62 offen offset:1024 nt lds
v_mfma_f32_16x16x32_bf16 a[172:175], a[228:231], v[152:155], a[172:175]
ds_read_b64_tr_b16 a[242:243], v190 offset:25536
v_add_f32 v181, v181, v164
v_mfma_f32_16x16x32_bf16 v[236:239], a[228:231], v[156:159], v[236:239]
ds_read_b64_tr_b16 a[224:225], v190 offset:17120
v_add_f32 v181, v181, v165
v_mfma_f32_16x16x32_bf16 a[216:219], a[228:231], a[248:251], a[216:219]
s_add_u32 m0, s64, 64
ds_read_b64_tr_b16 a[226:227], v190 offset:25568
v_add_f32 v181, v181, v166
v_mfma_f32_16x16x32_bf16 a[220:223], a[228:231], a[252:255], a[220:223]
buffer_load_dwordx4 v189, s[16:19], s62 offen offset:2048 nt lds
ds_read_b64_tr_b16 a[228:229], v190 offset:17280
v_mfma_f32_16x16x32_bf16 a[16:19], a[232:235], v[144:147], a[16:19]
ds_read_b64_tr_b16 a[230:231], v190 offset:25728
v_add_f32 v181, v181, v167
v_mfma_f32_16x16x32_bf16 a[80:83], a[232:235], v[148:151], a[80:83]
v_add_f32 v182, v182, v168
v_add_f32 v182, v182, v169
v_mfma_f32_16x16x32_bf16 a[144:147], a[232:235], v[152:155], a[144:147]
s_add_u32 m0, s64, 96
v_add_f32 v182, v182, v170
v_add_f32 v182, v182, v171
v_mfma_f32_16x16x32_bf16 v[208:211], a[232:235], v[156:159], v[208:211]
s_waitcnt lgkmcnt(3)
buffer_load_dwordx4 v189, s[16:19], s62 offen offset:3072 nt lds
ds_read_b64_tr_b16 a[232:233], v190 offset:17312
v_mfma_f32_16x16x32_bf16 a[20:23], a[236:239], v[144:147], a[20:23]
s_add_u32 s61, s61, 16384
ds_read_b64_tr_b16 a[234:235], v190 offset:25760
v_add_f32 v183, v183, v172
v_mfma_f32_16x16x32_bf16 a[84:87], a[236:239], v[148:151], a[84:87]
s_add_u32 s62, s62, 16384
v_add_f32 v183, v183, v173
v_add_f32 v183, v183, v174
v_mfma_f32_16x16x32_bf16 a[148:151], a[236:239], v[152:155], a[148:151]
v_add_f32 v183, v183, v175
v_add_u32 v186, s74, v186
v_mfma_f32_16x16x32_bf16 v[212:215], a[236:239], v[156:159], v[212:215]
ds_read_b64_tr_b16 a[236:237], v190 offset:17344
v_cvt_pk_bf16_f32 v130, v160, v161
v_mfma_f32_16x16x32_bf16 a[24:27], a[240:243], v[144:147], a[24:27]
ds_read_b64_tr_b16 a[238:239], v190 offset:25792
v_cvt_pk_bf16_f32 v131, v162, v163
v_mfma_f32_16x16x32_bf16 a[88:91], a[240:243], v[148:151], a[88:91]
v_cvt_pk_bf16_f32 v134, v164, v165
v_cvt_pk_bf16_f32 v135, v166, v167
v_mfma_f32_16x16x32_bf16 a[152:155], a[240:243], v[152:155], a[152:155]
v_cvt_pk_bf16_f32 v138, v168, v169
v_cvt_pk_bf16_f32 v139, v170, v171
v_mfma_f32_16x16x32_bf16 v[216:219], a[240:243], v[156:159], v[216:219]
s_waitcnt lgkmcnt(2)
ds_read_b64_tr_b16 a[240:241], v190 offset:17376
v_cvt_pk_bf16_f32 v142, v172, v173
v_mfma_f32_16x16x32_bf16 a[28:31], a[224:227], v[144:147], a[28:31]
ds_read_b64_tr_b16 a[242:243], v190 offset:25824
v_add_u32 v190, s74, v190
v_mfma_f32_16x16x32_bf16 a[92:95], a[224:227], v[148:151], a[92:95]
v_cvt_pk_bf16_f32 v143, v174, v175
v_mfma_f32_16x16x32_bf16 a[156:159], a[224:227], v[152:155], a[156:159]
v_mfma_f32_16x16x32_bf16 v[220:223], a[224:227], v[156:159], v[220:223]
v_mfma_f32_16x16x32_bf16 a[48:51], a[228:231], v[144:147], a[48:51]
v_mfma_f32_16x16x32_bf16 a[112:115], a[228:231], v[148:151], a[112:115]
v_mfma_f32_16x16x32_bf16 a[176:179], a[228:231], v[152:155], a[176:179]
v_mfma_f32_16x16x32_bf16 v[240:243], a[228:231], v[156:159], v[240:243]
v_mfma_f32_16x16x32_bf16 a[52:55], a[232:235], v[144:147], a[52:55]
s_waitcnt lgkmcnt(0)
s_waitcnt vmcnt(16)
s_barrier
v_mfma_f32_16x16x32_bf16 a[116:119], a[232:235], v[148:151], a[116:119]
ds_read_b128 a[224:227], v185 offset:16896
v_mfma_f32_16x16x32_bf16 a[180:183], a[232:235], v[152:155], a[180:183]
ds_read_b128 a[248:251], v187 offset:8192
v_mfma_f32_16x16x32_bf16 v[244:247], a[232:235], v[156:159], v[244:247]
ds_read_b128 a[252:255], v187 offset:9216
v_mfma_f32_16x16x32_bf16 a[56:59], a[236:239], v[144:147], a[56:59]
ds_read_b128 a[228:231], v185 offset:16960
v_mfma_f32_16x16x32_bf16 a[120:123], a[236:239], v[148:151], a[120:123]
ds_read_b128 a[232:235], v188 offset:17024
v_mfma_f32_16x16x32_bf16 a[184:187], a[236:239], v[152:155], a[184:187]
v_mfma_f32_16x16x32_bf16 v[248:251], a[236:239], v[156:159], v[248:251]
ds_read_b128 a[236:239], v188 offset:17088
v_mfma_f32_16x16x32_bf16 a[60:63], a[240:243], v[144:147], a[60:63]
v_mfma_f32_16x16x32_bf16 a[124:127], a[240:243], v[148:151], a[124:127]
v_mfma_f32_16x16x32_bf16 a[188:191], a[240:243], v[152:155], a[188:191]
v_mfma_f32_16x16x32_bf16 v[252:255], a[240:243], v[156:159], v[252:255]
s_add_u32 s63, s63, s47
ds_read_b128 a[240:243], v185 offset:17152
s_waitcnt lgkmcnt(2)
v_mfma_f32_16x16x32_bf16 v[144:147], a[224:227], v[64:67], 0
ds_read_b128 a[244:247], v185 offset:17216
v_mfma_f32_16x16x32_bf16 v[148:151], a[224:227], v[68:71], 0
v_mfma_f32_16x16x32_bf16 v[152:155], a[224:227], v[0:3], 0
v_mfma_f32_16x16x32_bf16 v[156:159], a[224:227], v[4:7], 0
v_mfma_f32_16x16x32_bf16 v[176:179], a[224:227], a[248:251], 0
ds_read_b128 a[248:251], v187 offset:10240
v_mfma_f32_16x16x32_bf16 v[144:147], a[228:231], v[72:75], v[144:147]
ds_read_b128 a[224:227], v188 offset:17280
v_mfma_f32_16x16x32_bf16 v[148:151], a[228:231], v[76:79], v[148:151]
v_mfma_f32_16x16x32_bf16 v[152:155], a[228:231], v[8:11], v[152:155]
v_mfma_f32_16x16x32_bf16 v[156:159], a[228:231], v[12:15], v[156:159]
v_mfma_f32_16x16x32_bf16 v[176:179], a[228:231], a[252:255], v[176:179]
ds_read_b128 a[252:255], v187 offset:11264
v_mfma_f32_16x16x32_bf16 v[144:147], a[232:235], v[80:83], v[144:147]
ds_read_b128 a[228:231], v188 offset:17344
v_mfma_f32_16x16x32_bf16 v[148:151], a[232:235], v[84:87], v[148:151]
v_mfma_f32_16x16x32_bf16 v[152:155], a[232:235], v[16:19], v[152:155]
v_mfma_f32_16x16x32_bf16 v[156:159], a[232:235], v[20:23], v[156:159]
s_waitcnt lgkmcnt(2)
v_mfma_f32_16x16x32_bf16 v[176:179], a[232:235], a[248:251], v[176:179]
ds_read_b128 a[248:251], v187 offset:12288
v_mfma_f32_16x16x32_bf16 v[144:147], a[236:239], v[88:91], v[144:147]
ds_read_b128 a[232:235], v185 offset:25344
v_mfma_f32_16x16x32_bf16 v[148:151], a[236:239], v[92:95], v[148:151]
v_mfma_f32_16x16x32_bf16 v[152:155], a[236:239], v[24:27], v[152:155]
v_mfma_f32_16x16x32_bf16 v[156:159], a[236:239], v[28:31], v[156:159]
s_waitcnt lgkmcnt(2)
v_mfma_f32_16x16x32_bf16 v[176:179], a[236:239], a[252:255], v[176:179]
ds_read_b128 a[252:255], v187 offset:13312
v_mfma_f32_16x16x32_bf16 v[144:147], a[240:243], v[96:99], v[144:147]
ds_read_b128 a[236:239], v185 offset:25408
v_mfma_f32_16x16x32_bf16 v[148:151], a[240:243], v[100:103], v[148:151]
v_mfma_f32_16x16x32_bf16 v[152:155], a[240:243], v[32:35], v[152:155]
v_mfma_f32_16x16x32_bf16 v[156:159], a[240:243], v[36:39], v[156:159]
s_waitcnt lgkmcnt(2)
v_mfma_f32_16x16x32_bf16 v[176:179], a[240:243], a[248:251], v[176:179]
ds_read_b128 a[248:251], v187 offset:14336
v_mfma_f32_16x16x32_bf16 v[144:147], a[244:247], v[104:107], v[144:147]
ds_read_b128 a[240:243], v188 offset:25472
v_mfma_f32_16x16x32_bf16 v[148:151], a[244:247], v[108:111], v[148:151]
v_mfma_f32_16x16x32_bf16 v[152:155], a[244:247], v[40:43], v[152:155]
v_mfma_f32_16x16x32_bf16 v[156:159], a[244:247], v[44:47], v[156:159]
s_waitcnt lgkmcnt(2)
v_mfma_f32_16x16x32_bf16 v[176:179], a[244:247], a[252:255], v[176:179]
ds_read_b128 a[252:255], v187 offset:15360
v_mfma_f32_16x16x32_bf16 v[144:147], a[224:227], v[112:115], v[144:147]
ds_read_b64_tr_b16 a[244:245], v186 offset:288
v_mfma_f32_16x16x32_bf16 v[148:151], a[224:227], v[116:119], v[148:151]
ds_read_b64_tr_b16 a[246:247], v186 offset:8736
v_mfma_f32_16x16x32_bf16 v[152:155], a[224:227], v[48:51], v[152:155]
v_mfma_f32_16x16x32_bf16 v[156:159], a[224:227], v[52:55], v[156:159]
s_waitcnt lgkmcnt(3)
v_mfma_f32_16x16x32_bf16 v[176:179], a[224:227], a[248:251], v[176:179]
ds_read_b128 a[224:227], v188 offset:25536
v_mfma_f32_16x16x32_bf16 v[144:147], a[228:231], v[120:123], v[144:147]
ds_read_b128 a[248:251], v187 offset:16384
v_mfma_f32_16x16x32_bf16 v[148:151], a[228:231], v[124:127], v[148:151]
v_mfma_f32_16x16x32_bf16 v[152:155], a[228:231], v[56:59], v[152:155]
v_mfma_f32_16x16x32_bf16 v[156:159], a[228:231], v[60:63], v[156:159]
s_waitcnt lgkmcnt(2)
v_mfma_f32_16x16x32_bf16 v[176:179], a[228:231], a[252:255], v[176:179]
ds_read_b128 a[228:231], v185 offset:25600
v_mfma_f32_16x16x32_bf16 v[160:163], a[232:235], v[64:67], 0
v_exp_f32 v144, v144
v_mfma_f32_16x16x32_bf16 v[164:167], a[232:235], v[68:71], 0
v_exp_f32 v145, v145
v_mfma_f32_16x16x32_bf16 v[168:171], a[232:235], v[0:3], 0
v_exp_f32 v146, v146
v_mfma_f32_16x16x32_bf16 v[172:175], a[232:235], v[4:7], 0
v_exp_f32 v147, v147
v_mfma_f32_16x16x32_bf16 v[160:163], a[236:239], v[72:75], v[160:163]
v_exp_f32 v176, v176
v_mfma_f32_16x16x32_bf16 v[164:167], a[236:239], v[76:79], v[164:167]
v_exp_f32 v177, v177
v_mfma_f32_16x16x32_bf16 v[168:171], a[236:239], v[8:11], v[168:171]
v_exp_f32 v178, v178
v_mfma_f32_16x16x32_bf16 v[172:175], a[236:239], v[12:15], v[172:175]
ds_read_b128 a[232:235], v185 offset:25664
v_add_f32 v184, v184, v176
v_mfma_f32_16x16x32_bf16 v[160:163], a[240:243], v[80:83], v[160:163]
v_exp_f32 v179, v179
v_mfma_f32_16x16x32_bf16 v[164:167], a[240:243], v[84:87], v[164:167]
v_exp_f32 v148, v148
v_mfma_f32_16x16x32_bf16 v[168:171], a[240:243], v[16:19], v[168:171]
v_exp_f32 v149, v149
v_mfma_f32_16x16x32_bf16 v[172:175], a[240:243], v[20:23], v[172:175]
s_waitcnt lgkmcnt(1)
ds_read_b128 a[236:239], v188 offset:25728
v_add_f32 v184, v184, v177
v_mfma_f32_16x16x32_bf16 v[160:163], a[224:227], v[88:91], v[160:163]
v_exp_f32 v150, v150
v_mfma_f32_16x16x32_bf16 v[164:167], a[224:227], v[92:95], v[164:167]
v_exp_f32 v151, v151
v_mfma_f32_16x16x32_bf16 v[168:171], a[224:227], v[24:27], v[168:171]
v_exp_f32 v152, v152
v_mfma_f32_16x16x32_bf16 v[172:175], a[224:227], v[28:31], v[172:175]
ds_read_b128 a[240:243], v188 offset:25792
v_add_f32 v184, v184, v178
v_mfma_f32_16x16x32_bf16 v[160:163], a[228:231], v[96:99], v[160:163]
v_exp_f32 v153, v153
v_mfma_f32_16x16x32_bf16 v[164:167], a[228:231], v[100:103], v[164:167]
v_exp_f32 v154, v154
v_mfma_f32_16x16x32_bf16 v[168:171], a[228:231], v[32:35], v[168:171]
v_exp_f32 v155, v155
v_mfma_f32_16x16x32_bf16 v[172:175], a[228:231], v[36:39], v[172:175]
s_waitcnt lgkmcnt(1)
ds_read_b64_tr_b16 a[224:225], v186 offset:0
v_add_f32 v184, v184, v179
v_mfma_f32_16x16x32_bf16 v[160:163], a[232:235], v[104:107], v[160:163]
ds_read_b64_tr_b16 a[226:227], v186 offset:8448
v_cvt_pk_bf16_f32 v176, v176, v177
v_mfma_f32_16x16x32_bf16 v[164:167], a[232:235], v[108:111], v[164:167]
v_exp_f32 v156, v156
v_mfma_f32_16x16x32_bf16 v[168:171], a[232:235], v[40:43], v[168:171]
v_exp_f32 v157, v157
v_mfma_f32_16x16x32_bf16 v[172:175], a[232:235], v[44:47], v[172:175]
ds_read_b64_tr_b16 a[228:229], v186 offset:32
v_cvt_pk_bf16_f32 v177, v178, v179
v_mfma_f32_16x16x32_bf16 v[160:163], a[236:239], v[112:115], v[160:163]
ds_read_b64_tr_b16 a[230:231], v186 offset:8480
v_add_f32 v180, v180, v144
v_mfma_f32_16x16x32_bf16 v[164:167], a[236:239], v[116:119], v[164:167]
v_exp_f32 v158, v158
v_mfma_f32_16x16x32_bf16 v[168:171], a[236:239], v[48:51], v[168:171]
v_exp_f32 v159, v159
v_mfma_f32_16x16x32_bf16 v[172:175], a[236:239], v[52:55], v[172:175]
s_waitcnt lgkmcnt(2)
ds_read_b64_tr_b16 a[232:233], v186 offset:64
v_add_f32 v180, v180, v145
v_mfma_f32_16x16x32_bf16 v[160:163], a[240:243], v[120:123], v[160:163]
ds_read_b64_tr_b16 a[234:235], v186 offset:8512
v_add_f32 v180, v180, v146
v_mfma_f32_16x16x32_bf16 v[164:167], a[240:243], v[124:127], v[164:167]
ds_write_b64 v187, v[176:177] offset:19456
v_add_f32 v180, v180, v147
v_mfma_f32_16x16x32_bf16 v[168:171], a[240:243], v[56:59], v[168:171]
ds_read_b64_tr_b16 a[236:237], v186 offset:96
v_cvt_pk_bf16_f32 v144, v144, v145
v_mfma_f32_16x16x32_bf16 v[172:175], a[240:243], v[60:63], v[172:175]
ds_read_b64_tr_b16 a[238:239], v186 offset:8544
v_cvt_pk_bf16_f32 v145, v146, v147
v_mfma_f32_16x16x32_bf16 a[0:3], a[224:227], v[128:131], a[0:3]
ds_read_b128 a[252:255], v187 offset:17408
v_add_f32 v181, v181, v148
v_mfma_f32_16x16x32_bf16 a[64:67], a[224:227], v[132:135], a[64:67]
v_exp_f32 v160, v160
v_mfma_f32_16x16x32_bf16 a[128:131], a[224:227], v[136:139], a[128:131]
v_exp_f32 v161, v161
v_mfma_f32_16x16x32_bf16 v[192:195], a[224:227], v[140:143], v[192:195]
s_waitcnt lgkmcnt(3)
ds_read_b64_tr_b16 a[240:241], v186 offset:256
v_add_f32 v181, v181, v149
v_mfma_f32_16x16x32_bf16 a[4:7], a[228:231], v[128:131], a[4:7]
ds_read_b64_tr_b16 a[242:243], v186 offset:8704
v_add_f32 v181, v181, v150
v_mfma_f32_16x16x32_bf16 a[68:71], a[228:231], v[132:135], a[68:71]
v_exp_f32 v162, v162
v_mfma_f32_16x16x32_bf16 a[132:135], a[228:231], v[136:139], a[132:135]
v_exp_f32 v163, v163
v_mfma_f32_16x16x32_bf16 v[196:199], a[228:231], v[140:143], v[196:199]
v_exp_f32 v164, v164
v_mfma_f32_16x16x32_bf16 a[8:11], a[232:235], v[128:131], a[8:11]
ds_read_b64_tr_b16 a[224:225], v186 offset:320
v_add_f32 v181, v181, v151
v_mfma_f32_16x16x32_bf16 a[72:75], a[232:235], v[132:135], a[72:75]
v_exp_f32 v165, v165
v_mfma_f32_16x16x32_bf16 a[136:139], a[232:235], v[136:139], a[136:139]
v_exp_f32 v166, v166
v_mfma_f32_16x16x32_bf16 v[200:203], a[232:235], v[140:143], v[200:203]
s_waitcnt lgkmcnt(1)
v_exp_f32 v167, v167
v_mfma_f32_16x16x32_bf16 a[12:15], a[236:239], v[128:131], a[12:15]
v_cvt_pk_bf16_f32 v148, v148, v149
v_cvt_pk_bf16_f32 v149, v150, v151
v_mfma_f32_16x16x32_bf16 a[76:79], a[236:239], v[132:135], a[76:79]
v_exp_f32 v168, v168
v_mfma_f32_16x16x32_bf16 a[140:143], a[236:239], v[136:139], a[140:143]
s_add_u32 m0, s63, 0
v_exp_f32 v169, v169
v_mfma_f32_16x16x32_bf16 v[204:207], a[236:239], v[140:143], v[204:207]
ds_read_b64_tr_b16 a[226:227], v186 offset:8768
buffer_load_dwordx4 v189, s[12:15], s61 offen offset:0 nt lds
v_mfma_f32_16x16x32_bf16 a[32:35], a[240:243], v[128:131], a[32:35]
v_exp_f32 v170, v170
v_mfma_f32_16x16x32_bf16 a[96:99], a[240:243], v[132:135], a[96:99]
v_add_f32 v182, v182, v152
v_add_f32 v182, v182, v153
v_mfma_f32_16x16x32_bf16 a[160:163], a[240:243], v[136:139], a[160:163]
s_add_u32 m0, s63, 32
v_add_f32 v182, v182, v154
v_add_f32 v182, v182, v155
v_mfma_f32_16x16x32_bf16 v[224:227], a[240:243], v[140:143], v[224:227]
v_exp_f32 v171, v171
v_mfma_f32_16x16x32_bf16 a[192:195], a[240:243], a[248:251], a[192:195]
v_exp_f32 v172, v172
v_mfma_f32_16x16x32_bf16 a[196:199], a[240:243], a[252:255], a[196:199]
v_cvt_pk_bf16_f32 v152, v152, v153
v_cvt_pk_bf16_f32 v153, v154, v155
v_mfma_f32_16x16x32_bf16 a[36:39], a[244:247], v[128:131], a[36:39]
ds_read_b64_tr_b16 a[228:229], v186 offset:352
buffer_load_dwordx4 v189, s[12:15], s61 offen offset:1024 nt lds
v_mfma_f32_16x16x32_bf16 a[100:103], a[244:247], v[132:135], a[100:103]
s_add_u32 m0, s63, 64
ds_read_b64_tr_b16 a[230:231], v186 offset:8800
v_add_f32 v183, v183, v156
v_mfma_f32_16x16x32_bf16 a[164:167], a[244:247], v[136:139], a[164:167]
v_exp_f32 v173, v173
v_mfma_f32_16x16x32_bf16 v[228:231], a[244:247], v[140:143], v[228:231]
buffer_load_dwordx4 v189, s[12:15], s61 offen offset:2048 nt lds
ds_read_b64_tr_b16 a[232:233], v190 offset:128
v_mfma_f32_16x16x32_bf16 a[200:203], a[244:247], a[248:251], a[200:203]
s_add_u32 m0, s63, 96
v_add_f32 v183, v183, v157
v_add_f32 v183, v183, v158
v_mfma_f32_16x16x32_bf16 a[204:207], a[244:247], a[252:255], a[204:207]
s_waitcnt lgkmcnt(3)
ds_read_b64_tr_b16 a[234:235], v190 offset:8576
v_add_f32 v183, v183, v159
v_mfma_f32_16x16x32_bf16 a[40:43], a[224:227], v[128:131], a[40:43]
v_exp_f32 v174, v174
v_mfma_f32_16x16x32_bf16 a[104:107], a[224:227], v[132:135], a[104:107]
buffer_load_dwordx4 v189, s[12:15], s61 offen offset:3072 nt lds
ds_read_b64_tr_b16 a[236:237], v190 offset:160
v_mfma_f32_16x16x32_bf16 a[168:171], a[224:227], v[136:139], a[168:171]
s_add_u32 m0, s64, 16896
v_cvt_pk_bf16_f32 v156, v156, v157
v_cvt_pk_bf16_f32 v157, v158, v159
v_mfma_f32_16x16x32_bf16 v[232:235], a[224:227], v[140:143], v[232:235]
v_add_f32 v180, v180, v160
v_add_f32 v180, v180, v161
v_mfma_f32_16x16x32_bf16 a[208:211], a[224:227], a[248:251], a[208:211]
v_add_f32 v180, v180, v162
v_add_f32 v180, v180, v163
v_mfma_f32_16x16x32_bf16 a[212:215], a[224:227], a[252:255], a[212:215]
s_waitcnt lgkmcnt(1)
ds_read_b64_tr_b16 a[238:239], v190 offset:8608
buffer_load_dwordx4 v189, s[16:19], s62 offen offset:0 nt lds
v_mfma_f32_16x16x32_bf16 a[44:47], a[228:231], v[128:131], a[44:47]
s_add_u32 m0, s64, 16928
v_exp_f32 v175, v175
v_mfma_f32_16x16x32_bf16 a[108:111], a[228:231], v[132:135], a[108:111]
ds_read_b64_tr_b16 a[240:241], v190 offset:192
buffer_load_dwordx4 v189, s[16:19], s62 offen offset:1024 nt lds
v_mfma_f32_16x16x32_bf16 a[172:175], a[228:231], v[136:139], a[172:175]
ds_read_b64_tr_b16 a[242:243], v190 offset:8640
v_add_f32 v181, v181, v164
v_mfma_f32_16x16x32_bf16 v[236:239], a[228:231], v[140:143], v[236:239]
ds_read_b64_tr_b16 a[224:225], v190 offset:224
v_add_f32 v181, v181, v165
v_mfma_f32_16x16x32_bf16 a[216:219], a[228:231], a[248:251], a[216:219]
s_add_u32 m0, s64, 16960
ds_read_b64_tr_b16 a[226:227], v190 offset:8672
v_add_f32 v181, v181, v166
v_mfma_f32_16x16x32_bf16 a[220:223], a[228:231], a[252:255], a[220:223]
buffer_load_dwordx4 v189, s[16:19], s62 offen offset:2048 nt lds
ds_read_b64_tr_b16 a[228:229], v190 offset:384
v_mfma_f32_16x16x32_bf16 a[16:19], a[232:235], v[128:131], a[16:19]
ds_read_b64_tr_b16 a[230:231], v190 offset:8832
v_add_f32 v181, v181, v167
v_mfma_f32_16x16x32_bf16 a[80:83], a[232:235], v[132:135], a[80:83]
v_add_f32 v182, v182, v168
v_add_f32 v182, v182, v169
v_mfma_f32_16x16x32_bf16 a[144:147], a[232:235], v[136:139], a[144:147]
s_add_u32 m0, s64, 16992
v_add_f32 v182, v182, v170
v_add_f32 v182, v182, v171
v_mfma_f32_16x16x32_bf16 v[208:211], a[232:235], v[140:143], v[208:211]
s_waitcnt lgkmcnt(3)
buffer_load_dwordx4 v189, s[16:19], s62 offen offset:3072 nt lds
ds_read_b64_tr_b16 a[232:233], v190 offset:416
v_mfma_f32_16x16x32_bf16 a[20:23], a[236:239], v[128:131], a[20:23]
s_add_u32 s61, s61, 16384
ds_read_b64_tr_b16 a[234:235], v190 offset:8864
v_subrev_u32 v185, s47, v185
v_mfma_f32_16x16x32_bf16 a[84:87], a[236:239], v[132:135], a[84:87]
s_add_u32 s62, s62, 16384
v_subrev_u32 v188, s47, v188
v_add_f32 v183, v183, v172
v_mfma_f32_16x16x32_bf16 a[148:151], a[236:239], v[136:139], a[148:151]
v_add_f32 v183, v183, v173
v_add_f32 v183, v183, v174
v_mfma_f32_16x16x32_bf16 v[212:215], a[236:239], v[140:143], v[212:215]
ds_read_b64_tr_b16 a[236:237], v190 offset:448
v_add_f32 v183, v183, v175
v_mfma_f32_16x16x32_bf16 a[24:27], a[240:243], v[128:131], a[24:27]
ds_read_b64_tr_b16 a[238:239], v190 offset:8896
v_cvt_pk_bf16_f32 v146, v160, v161
v_mfma_f32_16x16x32_bf16 a[88:91], a[240:243], v[132:135], a[88:91]
v_cvt_pk_bf16_f32 v147, v162, v163
v_cvt_pk_bf16_f32 v150, v164, v165
v_mfma_f32_16x16x32_bf16 a[152:155], a[240:243], v[136:139], a[152:155]
v_cvt_pk_bf16_f32 v151, v166, v167
v_cvt_pk_bf16_f32 v154, v168, v169
v_mfma_f32_16x16x32_bf16 v[216:219], a[240:243], v[140:143], v[216:219]
s_waitcnt lgkmcnt(2)
ds_read_b64_tr_b16 a[240:241], v190 offset:480
v_cvt_pk_bf16_f32 v155, v170, v171
v_mfma_f32_16x16x32_bf16 a[28:31], a[224:227], v[128:131], a[28:31]
ds_read_b64_tr_b16 a[242:243], v190 offset:8928
v_cvt_pk_bf16_f32 v158, v172, v173
v_mfma_f32_16x16x32_bf16 a[92:95], a[224:227], v[132:135], a[92:95]
v_cvt_pk_bf16_f32 v159, v174, v175
v_mfma_f32_16x16x32_bf16 a[156:159], a[224:227], v[136:139], a[156:159]
v_mfma_f32_16x16x32_bf16 v[220:223], a[224:227], v[140:143], v[220:223]
v_mfma_f32_16x16x32_bf16 a[48:51], a[228:231], v[128:131], a[48:51]
v_mfma_f32_16x16x32_bf16 a[112:115], a[228:231], v[132:135], a[112:115]
v_mfma_f32_16x16x32_bf16 a[176:179], a[228:231], v[136:139], a[176:179]
v_mfma_f32_16x16x32_bf16 v[240:243], a[228:231], v[140:143], v[240:243]
v_mfma_f32_16x16x32_bf16 a[52:55], a[232:235], v[128:131], a[52:55]
s_waitcnt lgkmcnt(0)
s_waitcnt vmcnt(16)
s_barrier
v_mfma_f32_16x16x32_bf16 a[116:119], a[232:235], v[132:135], a[116:119]
ds_read_b128 a[224:227], v185 offset:0
v_mfma_f32_16x16x32_bf16 a[180:183], a[232:235], v[136:139], a[180:183]
ds_read_b128 a[248:251], v187 offset:8192
v_mfma_f32_16x16x32_bf16 v[244:247], a[232:235], v[140:143], v[244:247]
ds_read_b128 a[252:255], v187 offset:9216
v_mfma_f32_16x16x32_bf16 a[56:59], a[236:239], v[128:131], a[56:59]
ds_read_b128 a[228:231], v185 offset:64
v_mfma_f32_16x16x32_bf16 a[120:123], a[236:239], v[132:135], a[120:123]
ds_read_b128 a[232:235], v188 offset:128
v_mfma_f32_16x16x32_bf16 a[184:187], a[236:239], v[136:139], a[184:187]
v_mfma_f32_16x16x32_bf16 v[248:251], a[236:239], v[140:143], v[248:251]
ds_read_b128 a[236:239], v188 offset:192
v_mfma_f32_16x16x32_bf16 a[60:63], a[240:243], v[128:131], a[60:63]
v_mfma_f32_16x16x32_bf16 a[124:127], a[240:243], v[132:135], a[124:127]
v_mfma_f32_16x16x32_bf16 a[188:191], a[240:243], v[136:139], a[188:191]
v_mfma_f32_16x16x32_bf16 v[252:255], a[240:243], v[140:143], v[252:255]
s_sub_u32 s47, 0, s47
s_sub_u32 s74, 0, s74
s_add_u32 s46, s46, 1
s_cmp_lt_u32 s46, 15
s_cbranch_scc1 L_attloop2
s_lshr_b32 s56, s2, 5
s_and_b32 s56, s56, 7
s_mul_i32 s56, s56, 57344
s_add_u32 s56, s56, 28672
s_waitcnt lgkmcnt(1)
ds_read_b64_tr_b16 a[224:225], v186 offset:16896
ds_read_b64_tr_b16 a[226:227], v186 offset:25344
s_waitcnt lgkmcnt(0)
v_mfma_f32_16x16x32_bf16 a[0:3], a[224:227], v[144:147], a[0:3]
ds_read_b64_tr_b16 a[228:229], v186 offset:16928
v_mfma_f32_16x16x32_bf16 a[64:67], a[224:227], v[148:151], a[64:67]
ds_read_b64_tr_b16 a[230:231], v186 offset:25376
ds_read_b64_tr_b16 a[232:233], v186 offset:16960
ds_read_b64_tr_b16 a[234:235], v186 offset:25408
v_mfma_f32_16x16x32_bf16 a[128:131], a[224:227], v[152:155], a[128:131]
ds_read_b64_tr_b16 a[236:237], v186 offset:16992
buffer_load_dwordx4 v[176:179], v189, s[20:23], s56 offen offset:0
v_mfma_f32_16x16x32_bf16 v[192:195], a[224:227], v[156:159], v[192:195]
s_waitcnt lgkmcnt(3)
ds_read_b64_tr_b16 a[238:239], v186 offset:25440
v_mfma_f32_16x16x32_bf16 a[4:7], a[228:231], v[144:147], a[4:7]
ds_read_b128 a[248:251], v187 offset:18432
v_mfma_f32_16x16x32_bf16 a[68:71], a[228:231], v[148:151], a[68:71]
ds_read_b128 a[252:255], v187 offset:19456
v_mfma_f32_16x16x32_bf16 a[132:135], a[228:231], v[152:155], a[132:135]
ds_read_b64_tr_b16 a[240:241], v186 offset:17152
buffer_load_dwordx4 v[176:179], v189, s[20:23], s56 offen offset:1024
v_mfma_f32_16x16x32_bf16 v[196:199], a[228:231], v[156:159], v[196:199]
s_waitcnt lgkmcnt(5)
ds_read_b64_tr_b16 a[242:243], v186 offset:25600
v_mfma_f32_16x16x32_bf16 a[8:11], a[232:235], v[144:147], a[8:11]
ds_read_b64_tr_b16 a[244:245], v186 offset:17184
v_mfma_f32_16x16x32_bf16 a[72:75], a[232:235], v[148:151], a[72:75]
ds_read_b64_tr_b16 a[246:247], v186 offset:25632
v_mfma_f32_16x16x32_bf16 a[136:139], a[232:235], v[152:155], a[136:139]
buffer_load_dwordx4 v[176:179], v189, s[20:23], s56 offen offset:2048
ds_read_b64_tr_b16 a[224:225], v186 offset:17216
v_mfma_f32_16x16x32_bf16 v[200:203], a[232:235], v[156:159], v[200:203]
s_waitcnt lgkmcnt(5)
ds_read_b64_tr_b16 a[226:227], v186 offset:25664
v_mfma_f32_16x16x32_bf16 a[12:15], a[236:239], v[144:147], a[12:15]
ds_read_b64_tr_b16 a[228:229], v186 offset:17248
v_mfma_f32_16x16x32_bf16 a[76:79], a[236:239], v[148:151], a[76:79]
ds_read_b64_tr_b16 a[230:231], v186 offset:25696
v_mfma_f32_16x16x32_bf16 a[140:143], a[236:239], v[152:155], a[140:143]
buffer_load_dwordx4 v[176:179], v189, s[20:23], s56 offen offset:3072
ds_read_b64_tr_b16 a[232:233], v190 offset:17024
v_mfma_f32_16x16x32_bf16 v[204:207], a[236:239], v[156:159], v[204:207]
s_waitcnt lgkmcnt(5)
s_add_u32 s56, s56, 4096
ds_read_b64_tr_b16 a[234:235], v190 offset:25472
v_mfma_f32_16x16x32_bf16 a[32:35], a[240:243], v[144:147], a[32:35]
ds_read_b64_tr_b16 a[236:237], v190 offset:17056
v_mfma_f32_16x16x32_bf16 a[96:99], a[240:243], v[148:151], a[96:99]
ds_read_b64_tr_b16 a[238:239], v190 offset:25504
v_mfma_f32_16x16x32_bf16 a[160:163], a[240:243], v[152:155], a[160:163]
buffer_load_dwordx4 v[176:179], v189, s[20:23], s56 offen offset:0
v_mfma_f32_16x16x32_bf16 v[224:227], a[240:243], v[156:159], v[224:227]
v_mfma_f32_16x16x32_bf16 a[192:195], a[240:243], a[248:251], a[192:195]
v_mfma_f32_16x16x32_bf16 a[196:199], a[240:243], a[252:255], a[196:199]
ds_read_b64_tr_b16 a[240:241], v190 offset:17088
v_mfma_f32_16x16x32_bf16 a[36:39], a[244:247], v[144:147], a[36:39]
buffer_load_dwordx4 v[176:179], v189, s[20:23], s56 offen offset:1024
ds_read_b64_tr_b16 a[242:243], v190 offset:25536
v_mfma_f32_16x16x32_bf16 a[100:103], a[244:247], v[148:151], a[100:103]
v_mfma_f32_16x16x32_bf16 a[164:167], a[244:247], v[152:155], a[164:167]
v_mfma_f32_16x16x32_bf16 v[228:231], a[244:247], v[156:159], v[228:231]
v_mfma_f32_16x16x32_bf16 a[200:203], a[244:247], a[248:251], a[200:203]
buffer_load_dwordx4 v[176:179], v189, s[20:23], s56 offen offset:2048
v_mfma_f32_16x16x32_bf16 a[204:207], a[244:247], a[252:255], a[204:207]
s_waitcnt lgkmcnt(1)
v_mfma_f32_16x16x32_bf16 a[40:43], a[224:227], v[144:147], a[40:43]
v_mfma_f32_16x16x32_bf16 a[104:107], a[224:227], v[148:151], a[104:107]
v_mfma_f32_16x16x32_bf16 a[168:171], a[224:227], v[152:155], a[168:171]
buffer_load_dwordx4 v[176:179], v189, s[20:23], s56 offen offset:3072
v_mfma_f32_16x16x32_bf16 v[232:235], a[224:227], v[156:159], v[232:235]
s_add_u32 s56, s56, 4096
v_mfma_f32_16x16x32_bf16 a[208:211], a[224:227], a[248:251], a[208:211]
v_mfma_f32_16x16x32_bf16 a[212:215], a[224:227], a[252:255], a[212:215]
ds_read_b64_tr_b16 a[224:225], v190 offset:17120
v_mfma_f32_16x16x32_bf16 a[44:47], a[228:231], v[144:147], a[44:47]
buffer_load_dwordx4 v[176:179], v189, s[20:23], s56 offen offset:0
ds_read_b64_tr_b16 a[226:227], v190 offset:25568
v_mfma_f32_16x16x32_bf16 a[108:111], a[228:231], v[148:151], a[108:111]
v_mfma_f32_16x16x32_bf16 a[172:175], a[228:231], v[152:155], a[172:175]
v_mfma_f32_16x16x32_bf16 v[236:239], a[228:231], v[156:159], v[236:239]
v_mfma_f32_16x16x32_bf16 a[216:219], a[228:231], a[248:251], a[216:219]
buffer_load_dwordx4 v[176:179], v189, s[20:23], s56 offen offset:1024
v_mfma_f32_16x16x32_bf16 a[220:223], a[228:231], a[252:255], a[220:223]
ds_read_b64_tr_b16 a[228:229], v190 offset:17280
v_mfma_f32_16x16x32_bf16 a[16:19], a[232:235], v[144:147], a[16:19]
ds_read_b64_tr_b16 a[230:231], v190 offset:25728
v_mfma_f32_16x16x32_bf16 a[80:83], a[232:235], v[148:151], a[80:83]
v_mfma_f32_16x16x32_bf16 a[144:147], a[232:235], v[152:155], a[144:147]
buffer_load_dwordx4 v[176:179], v189, s[20:23], s56 offen offset:2048
v_mfma_f32_16x16x32_bf16 v[208:211], a[232:235], v[156:159], v[208:211]
ds_read_b64_tr_b16 a[232:233], v190 offset:17312
v_mfma_f32_16x16x32_bf16 a[20:23], a[236:239], v[144:147], a[20:23]
ds_read_b64_tr_b16 a[234:235], v190 offset:25760
v_mfma_f32_16x16x32_bf16 a[84:87], a[236:239], v[148:151], a[84:87]
v_mfma_f32_16x16x32_bf16 a[148:151], a[236:239], v[152:155], a[148:151]
buffer_load_dwordx4 v[176:179], v189, s[20:23], s56 offen offset:3072
v_mfma_f32_16x16x32_bf16 v[212:215], a[236:239], v[156:159], v[212:215]
s_waitcnt lgkmcnt(2)
s_add_u32 s56, s56, 4096
ds_read_b64_tr_b16 a[236:237], v190 offset:17344
v_mfma_f32_16x16x32_bf16 a[24:27], a[240:243], v[144:147], a[24:27]
ds_read_b64_tr_b16 a[238:239], v190 offset:25792
v_mfma_f32_16x16x32_bf16 a[88:91], a[240:243], v[148:151], a[88:91]
v_mfma_f32_16x16x32_bf16 a[152:155], a[240:243], v[152:155], a[152:155]
buffer_load_dwordx4 v[176:179], v189, s[20:23], s56 offen offset:0
v_mfma_f32_16x16x32_bf16 v[216:219], a[240:243], v[156:159], v[216:219]
ds_read_b64_tr_b16 a[240:241], v190 offset:17376
v_mfma_f32_16x16x32_bf16 a[28:31], a[224:227], v[144:147], a[28:31]
ds_read_b64_tr_b16 a[242:243], v190 offset:25824
v_mfma_f32_16x16x32_bf16 a[92:95], a[224:227], v[148:151], a[92:95]
v_mfma_f32_16x16x32_bf16 a[156:159], a[224:227], v[152:155], a[156:159]
buffer_load_dwordx4 v[176:179], v189, s[20:23], s56 offen offset:1024
v_mfma_f32_16x16x32_bf16 v[220:223], a[224:227], v[156:159], v[220:223]
v_mfma_f32_16x16x32_bf16 a[48:51], a[228:231], v[144:147], a[48:51]
v_mfma_f32_16x16x32_bf16 a[112:115], a[228:231], v[148:151], a[112:115]
v_mfma_f32_16x16x32_bf16 a[176:179], a[228:231], v[152:155], a[176:179]
v_mfma_f32_16x16x32_bf16 v[240:243], a[228:231], v[156:159], v[240:243]
s_waitcnt lgkmcnt(0)
v_mfma_f32_16x16x32_bf16 a[52:55], a[232:235], v[144:147], a[52:55]
v_mfma_f32_16x16x32_bf16 a[116:119], a[232:235], v[148:151], a[116:119]
v_mfma_f32_16x16x32_bf16 a[180:183], a[232:235], v[152:155], a[180:183]
v_mfma_f32_16x16x32_bf16 v[244:247], a[232:235], v[156:159], v[244:247]
v_mfma_f32_16x16x32_bf16 a[56:59], a[236:239], v[144:147], a[56:59]
v_mfma_f32_16x16x32_bf16 a[120:123], a[236:239], v[148:151], a[120:123]
v_mfma_f32_16x16x32_bf16 a[184:187], a[236:239], v[152:155], a[184:187]
v_mfma_f32_16x16x32_bf16 v[248:251], a[236:239], v[156:159], v[248:251]
v_mfma_f32_16x16x32_bf16 a[60:63], a[240:243], v[144:147], a[60:63]
v_mfma_f32_16x16x32_bf16 a[124:127], a[240:243], v[148:151], a[124:127]
v_mfma_f32_16x16x32_bf16 a[188:191], a[240:243], v[152:155], a[188:191]
v_mfma_f32_16x16x32_bf16 v[252:255], a[240:243], v[156:159], v[252:255]
s_branch L_att_done
L_att3:
ds_read_b128 a[224:227], v185 offset:8448
ds_read_b128 a[248:251], v187 offset:8192
ds_read_b128 a[252:255], v187 offset:9216
ds_read_b128 a[228:231], v185 offset:8512
ds_read_b128 a[232:235], v188 offset:8576
ds_read_b128 a[236:239], v188 offset:8640
ds_read_b128 a[240:243], v185 offset:8704
s_waitcnt lgkmcnt(6)
v_mfma_f32_16x16x32_bf16 v[128:131], a[224:227], v[96:99], 0
ds_read_b128 a[244:247], v185 offset:8768
v_mfma_f32_16x16x32_bf16 v[132:135], a[224:227], v[100:103], 0
s_add_u32 m0, s45, 16896
v_mfma_f32_16x16x32_bf16 v[136:139], a[224:227], v[32:35], 0
buffer_load_dwordx4 v189, s[16:19], s50 offen offset:0 nt lds
v_mfma_f32_16x16x32_bf16 v[140:143], a[224:227], v[36:39], 0
s_waitcnt lgkmcnt(6)
v_mfma_f32_16x16x32_bf16 v[176:179], a[224:227], a[248:251], 0
s_waitcnt lgkmcnt(4)
ds_read_b128 a[248:251], v187 offset:10240
v_mfma_f32_16x16x32_bf16 v[128:131], a[228:231], v[104:107], v[128:131]
ds_read_b128 a[224:227], v188 offset:8832
v_mfma_f32_16x16x32_bf16 v[132:135], a[228:231], v[108:111], v[132:135]
v_mfma_f32_16x16x32_bf16 v[136:139], a[228:231], v[40:43], v[136:139]
v_mfma_f32_16x16x32_bf16 v[140:143], a[228:231], v[44:47], v[140:143]
s_add_u32 m0, s45, 16928
v_mfma_f32_16x16x32_bf16 v[176:179], a[228:231], a[252:255], v[176:179]
s_waitcnt lgkmcnt(2)
ds_read_b128 a[252:255], v187 offset:11264
buffer_load_dwordx4 v189, s[16:19], s50 offen offset:1024 nt lds
v_mfma_f32_16x16x32_bf16 v[128:131], a[232:235], v[112:115], v[128:131]
ds_read_b128 a[228:231], v188 offset:8896
v_mfma_f32_16x16x32_bf16 v[132:135], a[232:235], v[116:119], v[132:135]
v_mfma_f32_16x16x32_bf16 v[136:139], a[232:235], v[48:51], v[136:139]
v_mfma_f32_16x16x32_bf16 v[140:143], a[232:235], v[52:55], v[140:143]
s_waitcnt lgkmcnt(2)
v_mfma_f32_16x16x32_bf16 v[176:179], a[232:235], a[248:251], v[176:179]
ds_read_b128 a[248:251], v187 offset:12288
v_mfma_f32_16x16x32_bf16 v[128:131], a[236:239], v[120:123], v[128:131]
s_add_u32 m0, s45, 16960
ds_read_b128 a[232:235], v185 offset:0
v_mfma_f32_16x16x32_bf16 v[132:135], a[236:239], v[124:127], v[132:135]
buffer_load_dwordx4 v189, s[16:19], s50 offen offset:2048 nt lds
v_mfma_f32_16x16x32_bf16 v[136:139], a[236:239], v[56:59], v[136:139]
v_mfma_f32_16x16x32_bf16 v[140:143], a[236:239], v[60:63], v[140:143]
s_waitcnt lgkmcnt(2)
v_mfma_f32_16x16x32_bf16 v[176:179], a[236:239], a[252:255], v[176:179]
ds_read_b128 a[252:255], v187 offset:13312
v_mfma_f32_16x16x32_bf16 v[128:131], a[240:243], v[64:67], v[128:131]
ds_read_b128 a[236:239], v185 offset:64
v_mfma_f32_16x16x32_bf16 v[132:135], a[240:243], v[68:71], v[132:135]
v_mfma_f32_16x16x32_bf16 v[136:139], a[240:243], v[0:3], v[136:139]
s_add_u32 m0, s45, 16992
v_mfma_f32_16x16x32_bf16 v[140:143], a[240:243], v[4:7], v[140:143]
s_waitcnt lgkmcnt(2)
buffer_load_dwordx4 v189, s[16:19], s50 offen offset:3072 nt lds
v_mfma_f32_16x16x32_bf16 v[176:179], a[240:243], a[248:251], v[176:179]
ds_read_b128 a[248:251], v187 offset:14336
v_mfma_f32_16x16x32_bf16 v[128:131], a[244:247], v[72:75], v[128:131]
ds_read_b128 a[240:243], v188 offset:128
v_mfma_f32_16x16x32_bf16 v[132:135], a[244:247], v[76:79], v[132:135]
v_mfma_f32_16x16x32_bf16 v[136:139], a[244:247], v[8:11], v[136:139]
v_mfma_f32_16x16x32_bf16 v[140:143], a[244:247], v[12:15], v[140:143]
s_waitcnt lgkmcnt(2)
v_mfma_f32_16x16x32_bf16 v[176:179], a[244:247], a[252:255], v[176:179]
s_add_u32 m0, s64, 0
ds_read_b128 a[252:255], v187 offset:15360
v_mfma_f32_16x16x32_bf16 v[128:131], a[224:227], v[80:83], v[128:131]
buffer_load_dwordx4 v189, s[16:19], s51 offen offset:0 nt lds
v_mfma_f32_16x16x32_bf16 v[132:135], a[224:227], v[84:87], v[132:135]
v_mfma_f32_16x16x32_bf16 v[136:139], a[224:227], v[16:19], v[136:139]
v_mfma_f32_16x16x32_bf16 v[140:143], a[224:227], v[20:23], v[140:143]
s_waitcnt lgkmcnt(1)
v_mfma_f32_16x16x32_bf16 v[176:179], a[224:227], a[248:251], v[176:179]
ds_read_b128 a[224:227], v188 offset:192
v_mfma_f32_16x16x32_bf16 v[128:131], a[228:231], v[88:91], v[128:131]
v_mfma_f32_16x16x32_bf16 v[132:135], a[228:231], v[92:95], v[132:135]
s_add_u32 m0, s64, 32
v_mfma_f32_16x16x32_bf16 v[136:139], a[228:231], v[24:27], v[136:139]
buffer_load_dwordx4 v189, s[16:19], s51 offen offset:1024 nt lds
v_mfma_f32_16x16x32_bf16 v[140:143], a[228:231], v[28:31], v[140:143]
s_waitcnt lgkmcnt(1)
v_mfma_f32_16x16x32_bf16 v[176:179], a[228:231], a[252:255], v[176:179]
ds_read_b128 a[228:231], v185 offset:256
v_mfma_f32_16x16x32_bf16 v[160:163], a[232:235], v[96:99], 0
v_exp_f32 v128, v128
v_mfma_f32_16x16x32_bf16 v[164:167], a[232:235], v[100:103], 0
v_exp_f32 v132, v132
v_mfma_f32_16x16x32_bf16 v[168:171], a[232:235], v[32:35], 0
v_exp_f32 v136, v136
v_mfma_f32_16x16x32_bf16 v[172:175], a[232:235], v[36:39], 0
s_add_u32 m0, s64, 64
v_exp_f32 v140, v140
v_mfma_f32_16x16x32_bf16 v[160:163], a[236:239], v[104:107], v[160:163]
v_exp_f32 v176, v176
v_mfma_f32_16x16x32_bf16 v[164:167], a[236:239], v[108:111], v[164:167]
v_exp_f32 v177, v177
v_mfma_f32_16x16x32_bf16 v[168:171], a[236:239], v[40:43], v[168:171]
buffer_load_dwordx4 v189, s[16:19], s51 offen offset:2048 nt lds
ds_read_b128 a[232:235], v185 offset:320
v_mfma_f32_16x16x32_bf16 v[172:175], a[236:239], v[44:47], v[172:175]
v_exp_f32 v178, v178
v_mfma_f32_16x16x32_bf16 v[160:163], a[240:243], v[112:115], v[160:163]
v_exp_f32 v179, v179
v_mfma_f32_16x16x32_bf16 v[164:167], a[240:243], v[116:119], v[164:167]
v_exp_f32 v129, v129
v_mfma_f32_16x16x32_bf16 v[168:171], a[240:243], v[48:51], v[168:171]
s_add_u32 m0, s64, 96
v_exp_f32 v133, v133
v_mfma_f32_16x16x32_bf16 v[172:175], a[240:243], v[52:55], v[172:175]
s_waitcnt lgkmcnt(1)
ds_read_b128 a[236:239], v188 offset:384
buffer_load_dwordx4 v189, s[16:19], s51 offen offset:3072 nt lds
v_mfma_f32_16x16x32_bf16 v[160:163], a[224:227], v[120:123], v[160:163]
v_exp_f32 v137, v137
v_mfma_f32_16x16x32_bf16 v[164:167], a[224:227], v[124:127], v[164:167]
v_exp_f32 v141, v141
v_mfma_f32_16x16x32_bf16 v[168:171], a[224:227], v[56:59], v[168:171]
v_exp_f32 v130, v130
v_mfma_f32_16x16x32_bf16 v[172:175], a[224:227], v[60:63], v[172:175]
ds_read_b128 a[240:243], v188 offset:448
v_add_f32 v184, v184, v176
v_mfma_f32_16x16x32_bf16 v[160:163], a[228:231], v[64:67], v[160:163]
v_exp_f32 v134, v134
v_mfma_f32_16x16x32_bf16 v[164:167], a[228:231], v[68:71], v[164:167]
v_exp_f32 v138, v138
v_mfma_f32_16x16x32_bf16 v[168:171], a[228:231], v[0:3], v[168:171]
v_exp_f32 v142, v142
v_mfma_f32_16x16x32_bf16 v[172:175], a[228:231], v[4:7], v[172:175]
s_waitcnt lgkmcnt(1)
v_exp_f32 v131, v131
v_mfma_f32_16x16x32_bf16 v[160:163], a[232:235], v[72:75], v[160:163]
v_exp_f32 v135, v135
v_mfma_f32_16x16x32_bf16 v[164:167], a[232:235], v[76:79], v[164:167]
v_add_f32 v184, v184, v177
v_add_f32 v184, v184, v178
v_mfma_f32_16x16x32_bf16 v[168:171], a[232:235], v[8:11], v[168:171]
v_add_f32 v184, v184, v179
v_cvt_pk_bf16_f32 v176, v176, v177
v_mfma_f32_16x16x32_bf16 v[172:175], a[232:235], v[12:15], v[172:175]
v_exp_f32 v139, v139
v_mfma_f32_16x16x32_bf16 v[160:163], a[236:239], v[80:83], v[160:163]
v_exp_f32 v143, v143
v_mfma_f32_16x16x32_bf16 v[164:167], a[236:239], v[84:87], v[164:167]
v_cvt_pk_bf16_f32 v177, v178, v179
v_add_f32 v180, v180, v128
v_mfma_f32_16x16x32_bf16 v[168:171], a[236:239], v[16:19], v[168:171]
ds_write_b64 v187, v[176:177] offset:17416
v_add_f32 v180, v180, v129
v_mfma_f32_16x16x32_bf16 v[172:175], a[236:239], v[20:23], v[172:175]
s_waitcnt lgkmcnt(1)
v_add_f32 v180, v180, v130
v_add_f32 v180, v180, v131
v_mfma_f32_16x16x32_bf16 v[160:163], a[240:243], v[88:91], v[160:163]
v_cvt_pk_bf16_f32 v131, v130, v131
v_cvt_pk_bf16_f32 v130, v128, v129
v_mfma_f32_16x16x32_bf16 v[164:167], a[240:243], v[92:95], v[164:167]
v_add_f32 v181, v181, v132
v_add_f32 v181, v181, v133
v_mfma_f32_16x16x32_bf16 v[168:171], a[240:243], v[24:27], v[168:171]
v_add_f32 v181, v181, v134
v_add_f32 v181, v181, v135
v_mfma_f32_16x16x32_bf16 v[172:175], a[240:243], v[28:31], v[172:175]
s_waitcnt lgkmcnt(0)
s_waitcnt vmcnt(8)
s_barrier
ds_read_b128 a[224:227], v185 offset:25344
ds_read_b128 a[248:251], v187 offset:8192
ds_read_b128 a[252:255], v187 offset:9216
ds_read_b128 a[228:231], v185 offset:25408
ds_read_b128 a[232:235], v188 offset:25472
ds_read_b128 a[236:239], v188 offset:25536
v_cvt_pk_bf16_f32 v135, v134, v135
v_cvt_pk_bf16_f32 v134, v132, v133
v_add_f32 v182, v182, v136
v_add_f32 v182, v182, v137
v_add_f32 v182, v182, v138
v_add_f32 v182, v182, v139
v_cvt_pk_bf16_f32 v139, v138, v139
v_cvt_pk_bf16_f32 v138, v136, v137
v_add_f32 v183, v183, v140
v_add_f32 v183, v183, v141
v_add_f32 v183, v183, v142
v_add_f32 v183, v183, v143
v_cvt_pk_bf16_f32 v143, v142, v143
v_cvt_pk_bf16_f32 v142, v140, v141
v_exp_f32 v160, v160
s_nop 0
v_add_f32 v180, v180, v160
v_exp_f32 v161, v161
s_nop 0
v_add_f32 v180, v180, v161
v_exp_f32 v162, v162
s_nop 0
v_add_f32 v180, v180, v162
v_exp_f32 v163, v163
s_nop 0
v_add_f32 v180, v180, v163
v_cvt_pk_bf16_f32 v128, v160, v161
v_cvt_pk_bf16_f32 v129, v162, v163
v_exp_f32 v164, v164
s_nop 0
v_add_f32 v181, v181, v164
v_exp_f32 v165, v165
s_nop 0
v_add_f32 v181, v181, v165
v_exp_f32 v166, v166
s_nop 0
v_add_f32 v181, v181, v166
v_exp_f32 v167, v167
s_nop 0
v_add_f32 v181, v181, v167
v_cvt_pk_bf16_f32 v132, v164, v165
v_cvt_pk_bf16_f32 v133, v166, v167
v_exp_f32 v168, v168
s_nop 0
v_add_f32 v182, v182, v168
v_exp_f32 v169, v169
s_nop 0
v_add_f32 v182, v182, v169
v_exp_f32 v170, v170
s_nop 0
v_add_f32 v182, v182, v170
v_exp_f32 v171, v171
s_nop 0
v_add_f32 v182, v182, v171
v_cvt_pk_bf16_f32 v136, v168, v169
v_cvt_pk_bf16_f32 v137, v170, v171
v_exp_f32 v172, v172
s_nop 0
v_add_f32 v183, v183, v172
v_exp_f32 v173, v173
s_nop 0
v_add_f32 v183, v183, v173
v_exp_f32 v174, v174
s_nop 0
v_add_f32 v183, v183, v174
v_exp_f32 v175, v175
s_nop 0
v_add_f32 v183, v183, v175
v_cvt_pk_bf16_f32 v140, v172, v173
v_cvt_pk_bf16_f32 v141, v174, v175
s_sub_u32 s63, s63, 4294837248
ds_read_b128 a[240:243], v185 offset:25600
s_waitcnt lgkmcnt(6)
v_mfma_f32_16x16x32_bf16 v[144:147], a[224:227], v[96:99], 0
ds_read_b128 a[244:247], v185 offset:25664
v_mfma_f32_16x16x32_bf16 v[148:151], a[224:227], v[100:103], 0
v_mfma_f32_16x16x32_bf16 v[152:155], a[224:227], v[32:35], 0
v_mfma_f32_16x16x32_bf16 v[156:159], a[224:227], v[36:39], 0
s_waitcnt lgkmcnt(6)
v_mfma_f32_16x16x32_bf16 v[176:179], a[224:227], a[248:251], 0
s_waitcnt lgkmcnt(4)
ds_read_b128 a[248:251], v187 offset:10240
v_mfma_f32_16x16x32_bf16 v[144:147], a[228:231], v[104:107], v[144:147]
ds_read_b128 a[224:227], v188 offset:25728
v_mfma_f32_16x16x32_bf16 v[148:151], a[228:231], v[108:111], v[148:151]
v_mfma_f32_16x16x32_bf16 v[152:155], a[228:231], v[40:43], v[152:155]
v_mfma_f32_16x16x32_bf16 v[156:159], a[228:231], v[44:47], v[156:159]
v_mfma_f32_16x16x32_bf16 v[176:179], a[228:231], a[252:255], v[176:179]
s_waitcnt lgkmcnt(2)
ds_read_b128 a[252:255], v187 offset:11264
v_mfma_f32_16x16x32_bf16 v[144:147], a[232:235], v[112:115], v[144:147]
ds_read_b128 a[228:231], v188 offset:25792
v_mfma_f32_16x16x32_bf16 v[148:151], a[232:235], v[116:119], v[148:151]
v_mfma_f32_16x16x32_bf16 v[152:155], a[232:235], v[48:51], v[152:155]
v_mfma_f32_16x16x32_bf16 v[156:159], a[232:235], v[52:55], v[156:159]
s_waitcnt lgkmcnt(2)
v_mfma_f32_16x16x32_bf16 v[176:179], a[232:235], a[248:251], v[176:179]
ds_read_b128 a[248:251], v187 offset:12288
v_mfma_f32_16x16x32_bf16 v[144:147], a[236:239], v[120:123], v[144:147]
ds_read_b128 a[232:235], v185 offset:16896
v_mfma_f32_16x16x32_bf16 v[148:151], a[236:239], v[124:127], v[148:151]
v_mfma_f32_16x16x32_bf16 v[152:155], a[236:239], v[56:59], v[152:155]
v_mfma_f32_16x16x32_bf16 v[156:159], a[236:239], v[60:63], v[156:159]
s_waitcnt lgkmcnt(2)
v_mfma_f32_16x16x32_bf16 v[176:179], a[236:239], a[252:255], v[176:179]
ds_read_b128 a[252:255], v187 offset:13312
v_mfma_f32_16x16x32_bf16 v[144:147], a[240:243], v[64:67], v[144:147]
ds_read_b128 a[236:239], v185 offset:16960
v_mfma_f32_16x16x32_bf16 v[148:151], a[240:243], v[68:71], v[148:151]
v_mfma_f32_16x16x32_bf16 v[152:155], a[240:243], v[0:3], v[152:155]
v_mfma_f32_16x16x32_bf16 v[156:159], a[240:243], v[4:7], v[156:159]
s_waitcnt lgkmcnt(2)
v_mfma_f32_16x16x32_bf16 v[176:179], a[240:243], a[248:251], v[176:179]
ds_read_b128 a[248:251], v187 offset:14336
v_mfma_f32_16x16x32_bf16 v[144:147], a[244:247], v[72:75], v[144:147]
ds_read_b128 a[240:243], v188 offset:17024
v_mfma_f32_16x16x32_bf16 v[148:151], a[244:247], v[76:79], v[148:151]
v_mfma_f32_16x16x32_bf16 v[152:155], a[244:247], v[8:11], v[152:155]
v_mfma_f32_16x16x32_bf16 v[156:159], a[244:247], v[12:15], v[156:159]
s_waitcnt lgkmcnt(2)
v_mfma_f32_16x16x32_bf16 v[176:179], a[244:247], a[252:255], v[176:179]
ds_read_b128 a[252:255], v187 offset:15360
v_mfma_f32_16x16x32_bf16 v[144:147], a[224:227], v[80:83], v[144:147]
ds_read_b64_tr_b16 a[244:245], v190 offset:416
v_mfma_f32_16x16x32_bf16 v[148:151], a[224:227], v[84:87], v[148:151]
ds_read_b64_tr_b16 a[246:247], v190 offset:8864
v_mfma_f32_16x16x32_bf16 v[152:155], a[224:227], v[16:19], v[152:155]
v_mfma_f32_16x16x32_bf16 v[156:159], a[224:227], v[20:23], v[156:159]
s_waitcnt lgkmcnt(3)
v_mfma_f32_16x16x32_bf16 v[176:179], a[224:227], a[248:251], v[176:179]
ds_read_b128 a[224:227], v188 offset:17088
v_mfma_f32_16x16x32_bf16 v[144:147], a[228:231], v[88:91], v[144:147]
ds_read_b128 a[248:251], v187 offset:16384
v_mfma_f32_16x16x32_bf16 v[148:151], a[228:231], v[92:95], v[148:151]
v_mfma_f32_16x16x32_bf16 v[152:155], a[228:231], v[24:27], v[152:155]
v_mfma_f32_16x16x32_bf16 v[156:159], a[228:231], v[28:31], v[156:159]
s_waitcnt lgkmcnt(2)
v_mfma_f32_16x16x32_bf16 v[176:179], a[228:231], a[252:255], v[176:179]
ds_read_b128 a[228:231], v185 offset:17152
v_mfma_f32_16x16x32_bf16 v[160:163], a[232:235], v[96:99], 0
v_exp_f32 v144, v144
v_mfma_f32_16x16x32_bf16 v[164:167], a[232:235], v[100:103], 0
v_exp_f32 v145, v145
v_mfma_f32_16x16x32_bf16 v[168:171], a[232:235], v[32:35], 0
v_exp_f32 v146, v146
v_mfma_f32_16x16x32_bf16 v[172:175], a[232:235], v[36:39], 0
v_exp_f32 v147, v147
v_mfma_f32_16x16x32_bf16 v[160:163], a[236:239], v[104:107], v[160:163]
v_exp_f32 v176, v176
v_mfma_f32_16x16x32_bf16 v[164:167], a[236:239], v[108:111], v[164:167]
v_exp_f32 v177, v177
v_mfma_f32_16x16x32_bf16 v[168:171], a[236:239], v[40:43], v[168:171]
v_exp_f32 v178, v178
v_mfma_f32_16x16x32_bf16 v[172:175], a[236:239], v[44:47], v[172:175]
ds_read_b128 a[232:235], v185 offset:17216
v_add_f32 v184, v184, v176
v_mfma_f32_16x16x32_bf16 v[160:163], a[240:243], v[112:115], v[160:163]
v_exp_f32 v179, v179
v_mfma_f32_16x16x32_bf16 v[164:167], a[240:243], v[116:119], v[164:167]
v_exp_f32 v148, v148
v_mfma_f32_16x16x32_bf16 v[168:171], a[240:243], v[48:51], v[168:171]
v_exp_f32 v149, v149
v_mfma_f32_16x16x32_bf16 v[172:175], a[240:243], v[52:55], v[172:175]
s_waitcnt lgkmcnt(1)
ds_read_b128 a[236:239], v188 offset:17280
v_add_f32 v184, v184, v177
v_mfma_f32_16x16x32_bf16 v[160:163], a[224:227], v[120:123], v[160:163]
v_exp_f32 v150, v150
v_mfma_f32_16x16x32_bf16 v[164:167], a[224:227], v[124:127], v[164:167]
v_exp_f32 v151, v151
v_mfma_f32_16x16x32_bf16 v[168:171], a[224:227], v[56:59], v[168:171]
v_exp_f32 v152, v152
v_mfma_f32_16x16x32_bf16 v[172:175], a[224:227], v[60:63], v[172:175]
ds_read_b128 a[240:243], v188 offset:17344
v_add_f32 v184, v184, v178
v_mfma_f32_16x16x32_bf16 v[160:163], a[228:231], v[64:67], v[160:163]
v_exp_f32 v153, v153
v_mfma_f32_16x16x32_bf16 v[164:167], a[228:231], v[68:71], v[164:167]
v_exp_f32 v154, v154
v_mfma_f32_16x16x32_bf16 v[168:171], a[228:231], v[0:3], v[168:171]
v_exp_f32 v155, v155
v_mfma_f32_16x16x32_bf16 v[172:175], a[228:231], v[4:7], v[172:175]
s_waitcnt lgkmcnt(1)
ds_read_b64_tr_b16 a[224:225], v186 offset:0
v_add_f32 v184, v184, v179
v_mfma_f32_16x16x32_bf16 v[160:163], a[232:235], v[72:75], v[160:163]
ds_read_b64_tr_b16 a[226:227], v186 offset:8448
v_cvt_pk_bf16_f32 v176, v176, v177
v_mfma_f32_16x16x32_bf16 v[164:167], a[232:235], v[76:79], v[164:167]
v_exp_f32 v156, v156
v_mfma_f32_16x16x32_bf16 v[168:171], a[232:235], v[8:11], v[168:171]
v_exp_f32 v157, v157
v_mfma_f32_16x16x32_bf16 v[172:175], a[232:235], v[12:15], v[172:175]
ds_read_b64_tr_b16 a[228:229], v186 offset:32
v_cvt_pk_bf16_f32 v177, v178, v179
v_mfma_f32_16x16x32_bf16 v[160:163], a[236:239], v[80:83], v[160:163]
ds_read_b64_tr_b16 a[230:231], v186 offset:8480
v_add_f32 v180, v180, v144
v_mfma_f32_16x16x32_bf16 v[164:167], a[236:239], v[84:87], v[164:167]
v_exp_f32 v158, v158
v_mfma_f32_16x16x32_bf16 v[168:171], a[236:239], v[16:19], v[168:171]
v_exp_f32 v159, v159
v_mfma_f32_16x16x32_bf16 v[172:175], a[236:239], v[20:23], v[172:175]
s_waitcnt lgkmcnt(2)
ds_read_b64_tr_b16 a[232:233], v186 offset:64
v_add_f32 v180, v180, v145
v_mfma_f32_16x16x32_bf16 v[160:163], a[240:243], v[88:91], v[160:163]
ds_read_b64_tr_b16 a[234:235], v186 offset:8512
v_add_f32 v180, v180, v146
v_mfma_f32_16x16x32_bf16 v[164:167], a[240:243], v[92:95], v[164:167]
ds_write_b64 v187, v[176:177] offset:19464
v_add_f32 v180, v180, v147
v_mfma_f32_16x16x32_bf16 v[168:171], a[240:243], v[24:27], v[168:171]
ds_read_b64_tr_b16 a[236:237], v186 offset:96
v_cvt_pk_bf16_f32 v147, v146, v147
v_mfma_f32_16x16x32_bf16 v[172:175], a[240:243], v[28:31], v[172:175]
ds_read_b64_tr_b16 a[238:239], v186 offset:8544
v_cvt_pk_bf16_f32 v146, v144, v145
v_mfma_f32_16x16x32_bf16 a[0:3], a[224:227], v[128:131], 0
ds_read_b128 a[252:255], v187 offset:17408
v_add_f32 v181, v181, v148
v_mfma_f32_16x16x32_bf16 a[64:67], a[224:227], v[132:135], 0
v_exp_f32 v160, v160
v_mfma_f32_16x16x32_bf16 a[128:131], a[224:227], v[136:139], 0
v_exp_f32 v161, v161
v_mfma_f32_16x16x32_bf16 v[192:195], a[224:227], v[140:143], 0
s_waitcnt lgkmcnt(3)
ds_read_b64_tr_b16 a[240:241], v190 offset:384
v_add_f32 v181, v181, v149
v_mfma_f32_16x16x32_bf16 a[4:7], a[228:231], v[128:131], 0
ds_read_b64_tr_b16 a[242:243], v190 offset:8832
v_add_f32 v181, v181, v150
v_mfma_f32_16x16x32_bf16 a[68:71], a[228:231], v[132:135], 0
v_exp_f32 v162, v162
v_mfma_f32_16x16x32_bf16 a[132:135], a[228:231], v[136:139], 0
v_exp_f32 v163, v163
v_mfma_f32_16x16x32_bf16 v[196:199], a[228:231], v[140:143], 0
v_exp_f32 v164, v164
v_mfma_f32_16x16x32_bf16 a[8:11], a[232:235], v[128:131], 0
ds_read_b64_tr_b16 a[224:225], v190 offset:448
v_add_f32 v181, v181, v151
v_mfma_f32_16x16x32_bf16 a[72:75], a[232:235], v[132:135], 0
v_exp_f32 v165, v165
v_mfma_f32_16x16x32_bf16 a[136:139], a[232:235], v[136:139], 0
v_exp_f32 v166, v166
v_mfma_f32_16x16x32_bf16 v[200:203], a[232:235], v[140:143], 0
s_waitcnt lgkmcnt(1)
v_exp_f32 v167, v167
v_mfma_f32_16x16x32_bf16 a[12:15], a[236:239], v[128:131], 0
v_cvt_pk_bf16_f32 v151, v150, v151
v_cvt_pk_bf16_f32 v150, v148, v149
v_mfma_f32_16x16x32_bf16 a[76:79], a[236:239], v[132:135], 0
v_exp_f32 v168, v168
v_mfma_f32_16x16x32_bf16 a[140:143], a[236:239], v[136:139], 0
v_exp_f32 v169, v169
v_mfma_f32_16x16x32_bf16 v[204:207], a[236:239], v[140:143], 0
s_add_u32 m0, s63, 0
ds_read_b64_tr_b16 a[226:227], v190 offset:8896
v_add_f32 v182, v182, v152
v_mfma_f32_16x16x32_bf16 a[48:51], a[240:243], v[128:131], 0
v_exp_f32 v170, v170
v_mfma_f32_16x16x32_bf16 a[112:115], a[240:243], v[132:135], 0
v_add_f32 v182, v182, v153
v_add_f32 v182, v182, v154
v_mfma_f32_16x16x32_bf16 a[176:179], a[240:243], v[136:139], 0
buffer_load_dwordx4 v189, s[12:15], s61 offen offset:0 nt lds
v_add_f32 v182, v182, v155
v_mfma_f32_16x16x32_bf16 v[240:243], a[240:243], v[140:143], 0
s_add_u32 m0, s63, 32
v_exp_f32 v171, v171
v_mfma_f32_16x16x32_bf16 a[192:195], a[240:243], a[248:251], 0
v_exp_f32 v172, v172
v_mfma_f32_16x16x32_bf16 a[196:199], a[240:243], a[252:255], 0
v_cvt_pk_bf16_f32 v155, v154, v155
v_cvt_pk_bf16_f32 v154, v152, v153
v_mfma_f32_16x16x32_bf16 a[52:55], a[244:247], v[128:131], 0
ds_read_b64_tr_b16 a[228:229], v190 offset:480
buffer_load_dwordx4 v189, s[12:15], s61 offen offset:1024 nt lds
v_mfma_f32_16x16x32_bf16 a[116:119], a[244:247], v[132:135], 0
s_add_u32 m0, s63, 64
ds_read_b64_tr_b16 a[230:231], v190 offset:8928
v_add_f32 v183, v183, v156
v_mfma_f32_16x16x32_bf16 a[180:183], a[244:247], v[136:139], 0
v_exp_f32 v173, v173
v_mfma_f32_16x16x32_bf16 v[244:247], a[244:247], v[140:143], 0
v_exp_f32 v174, v174
v_mfma_f32_16x16x32_bf16 a[200:203], a[244:247], a[248:251], 0
v_add_f32 v183, v183, v157
v_add_f32 v183, v183, v158
v_mfma_f32_16x16x32_bf16 a[204:207], a[244:247], a[252:255], 0
s_waitcnt lgkmcnt(2)
buffer_load_dwordx4 v189, s[12:15], s61 offen offset:2048 nt lds
v_add_f32 v183, v183, v159
v_mfma_f32_16x16x32_bf16 a[56:59], a[224:227], v[128:131], 0
s_add_u32 m0, s63, 96
ds_read_b64_tr_b16 a[232:233], v190 offset:128
v_cvt_pk_bf16_f32 v159, v158, v159
v_mfma_f32_16x16x32_bf16 a[120:123], a[224:227], v[132:135], 0
ds_read_b64_tr_b16 a[234:235], v190 offset:8576
buffer_load_dwordx4 v189, s[12:15], s61 offen offset:3072 nt lds
v_mfma_f32_16x16x32_bf16 a[184:187], a[224:227], v[136:139], 0
v_cvt_pk_bf16_f32 v158, v156, v157
v_add_f32 v180, v180, v160
v_mfma_f32_16x16x32_bf16 v[248:251], a[224:227], v[140:143], 0
s_add_u32 m0, s64, 16896
v_add_f32 v180, v180, v161
v_add_f32 v180, v180, v162
v_mfma_f32_16x16x32_bf16 a[208:211], a[224:227], a[248:251], 0
ds_read_b64_tr_b16 a[236:237], v190 offset:160
v_add_f32 v180, v180, v163
v_mfma_f32_16x16x32_bf16 a[212:215], a[224:227], a[252:255], 0
s_waitcnt lgkmcnt(3)
ds_read_b64_tr_b16 a[238:239], v190 offset:8608
buffer_load_dwordx4 v189, s[16:19], s62 offen offset:0 nt lds
v_mfma_f32_16x16x32_bf16 a[60:63], a[228:231], v[128:131], 0
v_exp_f32 v175, v175
v_mfma_f32_16x16x32_bf16 a[124:127], a[228:231], v[132:135], 0
s_add_u32 m0, s64, 16928
ds_read_b64_tr_b16 a[240:241], v190 offset:192
v_add_f32 v181, v181, v164
v_mfma_f32_16x16x32_bf16 a[188:191], a[228:231], v[136:139], 0
ds_read_b64_tr_b16 a[242:243], v190 offset:8640
buffer_load_dwordx4 v189, s[16:19], s62 offen offset:1024 nt lds
v_mfma_f32_16x16x32_bf16 v[252:255], a[228:231], v[140:143], 0
ds_read_b64_tr_b16 a[224:225], v190 offset:224
v_add_f32 v181, v181, v165
v_mfma_f32_16x16x32_bf16 a[216:219], a[228:231], a[248:251], 0
ds_read_b64_tr_b16 a[226:227], v190 offset:8672
v_add_f32 v181, v181, v166
v_mfma_f32_16x16x32_bf16 a[220:223], a[228:231], a[252:255], 0
s_waitcnt lgkmcnt(4)
s_add_u32 m0, s64, 16960
ds_read_b64_tr_b16 a[228:229], v186 offset:256
v_add_f32 v181, v181, v167
v_mfma_f32_16x16x32_bf16 a[16:19], a[232:235], v[128:131], 0
buffer_load_dwordx4 v189, s[16:19], s62 offen offset:2048 nt lds
ds_read_b64_tr_b16 a[230:231], v186 offset:8704
v_mfma_f32_16x16x32_bf16 a[80:83], a[232:235], v[132:135], 0
v_add_f32 v182, v182, v168
v_add_f32 v182, v182, v169
v_mfma_f32_16x16x32_bf16 a[144:147], a[232:235], v[136:139], 0
v_add_f32 v182, v182, v170
v_add_f32 v182, v182, v171
v_mfma_f32_16x16x32_bf16 v[208:211], a[232:235], v[140:143], 0
s_add_u32 m0, s64, 16992
ds_read_b64_tr_b16 a[232:233], v186 offset:288
v_add_u32 v185, 4294837248, v185
v_mfma_f32_16x16x32_bf16 a[20:23], a[236:239], v[128:131], 0
buffer_load_dwordx4 v189, s[16:19], s62 offen offset:3072 nt lds
ds_read_b64_tr_b16 a[234:235], v186 offset:8736
v_mfma_f32_16x16x32_bf16 a[84:87], a[236:239], v[132:135], 0
s_add_u32 s61, s61, 16384
v_add_u32 v188, 4294837248, v188
v_add_f32 v183, v183, v172
v_mfma_f32_16x16x32_bf16 a[148:151], a[236:239], v[136:139], 0
s_add_u32 s62, s62, 16384
v_add_f32 v183, v183, v173
v_add_f32 v183, v183, v174
v_mfma_f32_16x16x32_bf16 v[212:215], a[236:239], v[140:143], 0
s_waitcnt lgkmcnt(2)
ds_read_b64_tr_b16 a[236:237], v186 offset:320
v_add_f32 v183, v183, v175
v_mfma_f32_16x16x32_bf16 a[24:27], a[240:243], v[128:131], 0
ds_read_b64_tr_b16 a[238:239], v186 offset:8768
v_cvt_pk_bf16_f32 v144, v160, v161
v_mfma_f32_16x16x32_bf16 a[88:91], a[240:243], v[132:135], 0
v_cvt_pk_bf16_f32 v145, v162, v163
v_cvt_pk_bf16_f32 v148, v164, v165
v_mfma_f32_16x16x32_bf16 a[152:155], a[240:243], v[136:139], 0
v_cvt_pk_bf16_f32 v149, v166, v167
v_cvt_pk_bf16_f32 v152, v168, v169
v_mfma_f32_16x16x32_bf16 v[216:219], a[240:243], v[140:143], 0
ds_read_b64_tr_b16 a[240:241], v186 offset:352
v_cvt_pk_bf16_f32 v153, v170, v171
v_mfma_f32_16x16x32_bf16 a[28:31], a[224:227], v[128:131], 0
ds_read_b64_tr_b16 a[242:243], v186 offset:8800
v_cvt_pk_bf16_f32 v156, v172, v173
v_mfma_f32_16x16x32_bf16 a[92:95], a[224:227], v[132:135], 0
v_cvt_pk_bf16_f32 v157, v174, v175
v_mfma_f32_16x16x32_bf16 a[156:159], a[224:227], v[136:139], 0
v_mfma_f32_16x16x32_bf16 v[220:223], a[224:227], v[140:143], 0
v_mfma_f32_16x16x32_bf16 a[32:35], a[228:231], v[128:131], 0
v_mfma_f32_16x16x32_bf16 a[96:99], a[228:231], v[132:135], 0
v_mfma_f32_16x16x32_bf16 a[160:163], a[228:231], v[136:139], 0
v_mfma_f32_16x16x32_bf16 v[224:227], a[228:231], v[140:143], 0
s_waitcnt lgkmcnt(0)
v_mfma_f32_16x16x32_bf16 a[36:39], a[232:235], v[128:131], 0
s_waitcnt lgkmcnt(0)
s_waitcnt vmcnt(12)
s_barrier
v_mfma_f32_16x16x32_bf16 a[100:103], a[232:235], v[132:135], 0
ds_read_b128 a[224:227], v185 offset:8448
v_mfma_f32_16x16x32_bf16 a[164:167], a[232:235], v[136:139], 0
ds_read_b128 a[248:251], v187 offset:8192
v_mfma_f32_16x16x32_bf16 v[228:231], a[232:235], v[140:143], 0
ds_read_b128 a[252:255], v187 offset:9216
v_mfma_f32_16x16x32_bf16 a[40:43], a[236:239], v[128:131], 0
ds_read_b128 a[228:231], v185 offset:8512
v_mfma_f32_16x16x32_bf16 a[104:107], a[236:239], v[132:135], 0
ds_read_b128 a[232:235], v188 offset:8576
v_mfma_f32_16x16x32_bf16 a[168:171], a[236:239], v[136:139], 0
v_mfma_f32_16x16x32_bf16 v[232:235], a[236:239], v[140:143], 0
ds_read_b128 a[236:239], v188 offset:8640
v_mfma_f32_16x16x32_bf16 a[44:47], a[240:243], v[128:131], 0
v_mfma_f32_16x16x32_bf16 a[108:111], a[240:243], v[132:135], 0
v_mfma_f32_16x16x32_bf16 a[172:175], a[240:243], v[136:139], 0
v_mfma_f32_16x16x32_bf16 v[236:239], a[240:243], v[140:143], 0
L_attloop3:
s_sub_u32 s64, s64, s74
ds_read_b128 a[240:243], v185 offset:8704
s_waitcnt lgkmcnt(2)
v_mfma_f32_16x16x32_bf16 v[128:131], a[224:227], v[96:99], 0
ds_read_b128 a[244:247], v185 offset:8768
v_mfma_f32_16x16x32_bf16 v[132:135], a[224:227], v[100:103], 0
v_mfma_f32_16x16x32_bf16 v[136:139], a[224:227], v[32:35], 0
v_mfma_f32_16x16x32_bf16 v[140:143], a[224:227], v[36:39], 0
v_mfma_f32_16x16x32_bf16 v[176:179], a[224:227], a[248:251], 0
ds_read_b128 a[248:251], v187 offset:10240
v_mfma_f32_16x16x32_bf16 v[128:131], a[228:231], v[104:107], v[128:131]
ds_read_b128 a[224:227], v188 offset:8832
v_mfma_f32_16x16x32_bf16 v[132:135], a[228:231], v[108:111], v[132:135]
v_mfma_f32_16x16x32_bf16 v[136:139], a[228:231], v[40:43], v[136:139]
v_mfma_f32_16x16x32_bf16 v[140:143], a[228:231], v[44:47], v[140:143]
v_mfma_f32_16x16x32_bf16 v[176:179], a[228:231], a[252:255], v[176:179]
ds_read_b128 a[252:255], v187 offset:11264
v_mfma_f32_16x16x32_bf16 v[128:131], a[232:235], v[112:115], v[128:131]
ds_read_b128 a[228:231], v188 offset:8896
v_mfma_f32_16x16x32_bf16 v[132:135], a[232:235], v[116:119], v[132:135]
v_mfma_f32_16x16x32_bf16 v[136:139], a[232:235], v[48:51], v[136:139]
v_mfma_f32_16x16x32_bf16 v[140:143], a[232:235], v[52:55], v[140:143]
s_waitcnt lgkmcnt(2)
v_mfma_f32_16x16x32_bf16 v[176:179], a[232:235], a[248:251], v[176:179]
ds_read_b128 a[248:251], v187 offset:12288
v_mfma_f32_16x16x32_bf16 v[128:131], a[236:239], v[120:123], v[128:131]
ds_read_b128 a[232:235], v185 offset:0
v_mfma_f32_16x16x32_bf16 v[132:135], a[236:239], v[124:127], v[132:135]
v_mfma_f32_16x16x32_bf16 v[136:139], a[236:239], v[56:59], v[136:139]
v_mfma_f32_16x16x32_bf16 v[140:143], a[236:239], v[60:63], v[140:143]
s_waitcnt lgkmcnt(2)
v_mfma_f32_16x16x32_bf16 v[176:179], a[236:239], a[252:255], v[176:179]
ds_read_b128 a[252:255], v187 offset:13312
v_mfma_f32_16x16x32_bf16 v[128:131], a[240:243], v[64:67], v[128:131]
ds_read_b128 a[236:239], v185 offset:64
v_mfma_f32_16x16x32_bf16 v[132:135], a[240:243], v[68:71], v[132:135]
v_mfma_f32_16x16x32_bf16 v[136:139], a[240:243], v[0:3], v[136:139]
v_mfma_f32_16x16x32_bf16 v[140:143], a[240:243], v[4:7], v[140:143]
s_waitcnt lgkmcnt(2)
v_mfma_f32_16x16x32_bf16 v[176:179], a[240:243], a[248:251], v[176:179]
ds_read_b128 a[248:251], v187 offset:14336
v_mfma_f32_16x16x32_bf16 v[128:131], a[244:247], v[72:75], v[128:131]
ds_read_b128 a[240:243], v188 offset:128
v_mfma_f32_16x16x32_bf16 v[132:135], a[244:247], v[76:79], v[132:135]
v_mfma_f32_16x16x32_bf16 v[136:139], a[244:247], v[8:11], v[136:139]
v_mfma_f32_16x16x32_bf16 v[140:143], a[244:247], v[12:15], v[140:143]
s_waitcnt lgkmcnt(2)
v_mfma_f32_16x16x32_bf16 v[176:179], a[244:247], a[252:255], v[176:179]
ds_read_b128 a[252:255], v187 offset:15360
v_mfma_f32_16x16x32_bf16 v[128:131], a[224:227], v[80:83], v[128:131]
ds_read_b64_tr_b16 a[244:245], v190 offset:17312
v_mfma_f32_16x16x32_bf16 v[132:135], a[224:227], v[84:87], v[132:135]
ds_read_b64_tr_b16 a[246:247], v190 offset:25760
v_mfma_f32_16x16x32_bf16 v[136:139], a[224:227], v[16:19], v[136:139]
v_mfma_f32_16x16x32_bf16 v[140:143], a[224:227], v[20:23], v[140:143]
s_waitcnt lgkmcnt(3)
v_mfma_f32_16x16x32_bf16 v[176:179], a[224:227], a[248:251], v[176:179]
ds_read_b128 a[224:227], v188 offset:192
v_mfma_f32_16x16x32_bf16 v[128:131], a[228:231], v[88:91], v[128:131]
ds_read_b128 a[248:251], v187 offset:18432
v_mfma_f32_16x16x32_bf16 v[132:135], a[228:231], v[92:95], v[132:135]
v_mfma_f32_16x16x32_bf16 v[136:139], a[228:231], v[24:27], v[136:139]
v_mfma_f32_16x16x32_bf16 v[140:143], a[228:231], v[28:31], v[140:143]
s_waitcnt lgkmcnt(2)
v_mfma_f32_16x16x32_bf16 v[176:179], a[228:231], a[252:255], v[176:179]
ds_read_b128 a[228:231], v185 offset:256
v_mfma_f32_16x16x32_bf16 v[160:163], a[232:235], v[96:99], 0
v_exp_f32 v128, v128
v_mfma_f32_16x16x32_bf16 v[164:167], a[232:235], v[100:103], 0
v_exp_f32 v129, v129
v_mfma_f32_16x16x32_bf16 v[168:171], a[232:235], v[32:35], 0
v_exp_f32 v130, v130
v_mfma_f32_16x16x32_bf16 v[172:175], a[232:235], v[36:39], 0
v_exp_f32 v131, v131
v_mfma_f32_16x16x32_bf16 v[160:163], a[236:239], v[104:107], v[160:163]
v_exp_f32 v176, v176
v_mfma_f32_16x16x32_bf16 v[164:167], a[236:239], v[108:111], v[164:167]
v_exp_f32 v177, v177
v_mfma_f32_16x16x32_bf16 v[168:171], a[236:239], v[40:43], v[168:171]
v_exp_f32 v178, v178
v_mfma_f32_16x16x32_bf16 v[172:175], a[236:239], v[44:47], v[172:175]
ds_read_b128 a[232:235], v185 offset:320
v_add_f32 v184, v184, v176
v_mfma_f32_16x16x32_bf16 v[160:163], a[240:243], v[112:115], v[160:163]
v_exp_f32 v179, v179
v_mfma_f32_16x16x32_bf16 v[164:167], a[240:243], v[116:119], v[164:167]
v_exp_f32 v132, v132
v_mfma_f32_16x16x32_bf16 v[168:171], a[240:243], v[48:51], v[168:171]
v_exp_f32 v133, v133
v_mfma_f32_16x16x32_bf16 v[172:175], a[240:243], v[52:55], v[172:175]
s_waitcnt lgkmcnt(1)
ds_read_b128 a[236:239], v188 offset:384
v_add_f32 v184, v184, v177
v_mfma_f32_16x16x32_bf16 v[160:163], a[224:227], v[120:123], v[160:163]
v_exp_f32 v134, v134
v_mfma_f32_16x16x32_bf16 v[164:167], a[224:227], v[124:127], v[164:167]
v_exp_f32 v135, v135
v_mfma_f32_16x16x32_bf16 v[168:171], a[224:227], v[56:59], v[168:171]
v_exp_f32 v136, v136
v_mfma_f32_16x16x32_bf16 v[172:175], a[224:227], v[60:63], v[172:175]
ds_read_b128 a[240:243], v188 offset:448
v_add_f32 v184, v184, v178
v_mfma_f32_16x16x32_bf16 v[160:163], a[228:231], v[64:67], v[160:163]
v_exp_f32 v137, v137
v_mfma_f32_16x16x32_bf16 v[164:167], a[228:231], v[68:71], v[164:167]
v_exp_f32 v138, v138
v_mfma_f32_16x16x32_bf16 v[168:171], a[228:231], v[0:3], v[168:171]
v_exp_f32 v139, v139
v_mfma_f32_16x16x32_bf16 v[172:175], a[228:231], v[4:7], v[172:175]
s_waitcnt lgkmcnt(1)
ds_read_b64_tr_b16 a[224:225], v186 offset:16896
v_add_f32 v184, v184, v179
v_mfma_f32_16x16x32_bf16 v[160:163], a[232:235], v[72:75], v[160:163]
ds_read_b64_tr_b16 a[226:227], v186 offset:25344
v_cvt_pk_bf16_f32 v176, v176, v177
v_mfma_f32_16x16x32_bf16 v[164:167], a[232:235], v[76:79], v[164:167]
v_exp_f32 v140, v140
v_mfma_f32_16x16x32_bf16 v[168:171], a[232:235], v[8:11], v[168:171]
v_exp_f32 v141, v141
v_mfma_f32_16x16x32_bf16 v[172:175], a[232:235], v[12:15], v[172:175]
ds_read_b64_tr_b16 a[228:229], v186 offset:16928
v_cvt_pk_bf16_f32 v177, v178, v179
v_mfma_f32_16x16x32_bf16 v[160:163], a[236:239], v[80:83], v[160:163]
ds_read_b64_tr_b16 a[230:231], v186 offset:25376
v_add_f32 v180, v180, v128
v_mfma_f32_16x16x32_bf16 v[164:167], a[236:239], v[84:87], v[164:167]
v_exp_f32 v142, v142
v_mfma_f32_16x16x32_bf16 v[168:171], a[236:239], v[16:19], v[168:171]
v_exp_f32 v143, v143
v_mfma_f32_16x16x32_bf16 v[172:175], a[236:239], v[20:23], v[172:175]
s_waitcnt lgkmcnt(2)
ds_read_b64_tr_b16 a[232:233], v186 offset:16960
v_add_f32 v180, v180, v129
v_mfma_f32_16x16x32_bf16 v[160:163], a[240:243], v[88:91], v[160:163]
ds_read_b64_tr_b16 a[234:235], v186 offset:25408
v_add_f32 v180, v180, v130
v_mfma_f32_16x16x32_bf16 v[164:167], a[240:243], v[92:95], v[164:167]
ds_write_b64 v187, v[176:177] offset:17416
v_add_f32 v180, v180, v131
v_mfma_f32_16x16x32_bf16 v[168:171], a[240:243], v[24:27], v[168:171]
ds_read_b64_tr_b16 a[236:237], v186 offset:16992
v_cvt_pk_bf16_f32 v131, v130, v131
v_mfma_f32_16x16x32_bf16 v[172:175], a[240:243], v[28:31], v[172:175]
ds_read_b64_tr_b16 a[238:239], v186 offset:25440
v_cvt_pk_bf16_f32 v130, v128, v129
v_mfma_f32_16x16x32_bf16 a[0:3], a[224:227], v[144:147], a[0:3]
ds_read_b128 a[252:255], v187 offset:19456
v_add_f32 v181, v181, v132
v_mfma_f32_16x16x32_bf16 a[64:67], a[224:227], v[148:151], a[64:67]
v_exp_f32 v160, v160
v_mfma_f32_16x16x32_bf16 a[128:131], a[224:227], v[152:155], a[128:131]
v_exp_f32 v161, v161
v_mfma_f32_16x16x32_bf16 v[192:195], a[224:227], v[156:159], v[192:195]
s_waitcnt lgkmcnt(3)
ds_read_b64_tr_b16 a[240:241], v190 offset:17280
v_add_f32 v181, v181, v133
v_mfma_f32_16x16x32_bf16 a[4:7], a[228:231], v[144:147], a[4:7]
ds_read_b64_tr_b16 a[242:243], v190 offset:25728
v_add_f32 v181, v181, v134
v_mfma_f32_16x16x32_bf16 a[68:71], a[228:231], v[148:151], a[68:71]
v_exp_f32 v162, v162
v_mfma_f32_16x16x32_bf16 a[132:135], a[228:231], v[152:155], a[132:135]
v_exp_f32 v163, v163
v_mfma_f32_16x16x32_bf16 v[196:199], a[228:231], v[156:159], v[196:199]
v_exp_f32 v164, v164
v_mfma_f32_16x16x32_bf16 a[8:11], a[232:235], v[144:147], a[8:11]
ds_read_b64_tr_b16 a[224:225], v190 offset:17344
v_add_f32 v181, v181, v135
v_mfma_f32_16x16x32_bf16 a[72:75], a[232:235], v[148:151], a[72:75]
v_exp_f32 v165, v165
v_mfma_f32_16x16x32_bf16 a[136:139], a[232:235], v[152:155], a[136:139]
v_exp_f32 v166, v166
v_mfma_f32_16x16x32_bf16 v[200:203], a[232:235], v[156:159], v[200:203]
s_waitcnt lgkmcnt(1)
v_exp_f32 v167, v167
v_mfma_f32_16x16x32_bf16 a[12:15], a[236:239], v[144:147], a[12:15]
v_cvt_pk_bf16_f32 v135, v134, v135
v_cvt_pk_bf16_f32 v134, v132, v133
v_mfma_f32_16x16x32_bf16 a[76:79], a[236:239], v[148:151], a[76:79]
v_exp_f32 v168, v168
v_mfma_f32_16x16x32_bf16 a[140:143], a[236:239], v[152:155], a[140:143]
v_exp_f32 v169, v169
v_mfma_f32_16x16x32_bf16 v[204:207], a[236:239], v[156:159], v[204:207]
s_add_u32 m0, s63, 16896
ds_read_b64_tr_b16 a[226:227], v190 offset:25792
v_add_f32 v182, v182, v136
v_mfma_f32_16x16x32_bf16 a[48:51], a[240:243], v[144:147], a[48:51]
v_exp_f32 v170, v170
v_mfma_f32_16x16x32_bf16 a[112:115], a[240:243], v[148:151], a[112:115]
v_add_f32 v182, v182, v137
v_add_f32 v182, v182, v138
v_mfma_f32_16x16x32_bf16 a[176:179], a[240:243], v[152:155], a[176:179]
buffer_load_dwordx4 v189, s[12:15], s61 offen offset:0 nt lds
v_add_f32 v182, v182, v139
v_mfma_f32_16x16x32_bf16 v[240:243], a[240:243], v[156:159], v[240:243]
s_add_u32 m0, s63, 16928
v_exp_f32 v171, v171
v_mfma_f32_16x16x32_bf16 a[192:195], a[240:243], a[248:251], a[192:195]
v_exp_f32 v172, v172
v_mfma_f32_16x16x32_bf16 a[196:199], a[240:243], a[252:255], a[196:199]
v_cvt_pk_bf16_f32 v139, v138, v139
v_cvt_pk_bf16_f32 v138, v136, v137
v_mfma_f32_16x16x32_bf16 a[52:55], a[244:247], v[144:147], a[52:55]
ds_read_b64_tr_b16 a[228:229], v190 offset:17376
buffer_load_dwordx4 v189, s[12:15], s61 offen offset:1024 nt lds
v_mfma_f32_16x16x32_bf16 a[116:119], a[244:247], v[148:151], a[116:119]
s_add_u32 m0, s63, 16960
ds_read_b64_tr_b16 a[230:231], v190 offset:25824
v_add_f32 v183, v183, v140
v_mfma_f32_16x16x32_bf16 a[180:183], a[244:247], v[152:155], a[180:183]
v_exp_f32 v173, v173
v_mfma_f32_16x16x32_bf16 v[244:247], a[244:247], v[156:159], v[244:247]
v_exp_f32 v174, v174
v_mfma_f32_16x16x32_bf16 a[200:203], a[244:247], a[248:251], a[200:203]
v_add_f32 v183, v183, v141
v_add_f32 v183, v183, v142
v_mfma_f32_16x16x32_bf16 a[204:207], a[244:247], a[252:255], a[204:207]
s_waitcnt lgkmcnt(2)
buffer_load_dwordx4 v189, s[12:15], s61 offen offset:2048 nt lds
v_add_f32 v183, v183, v143
v_mfma_f32_16x16x32_bf16 a[56:59], a[224:227], v[144:147], a[56:59]
s_add_u32 m0, s63, 16992
ds_read_b64_tr_b16 a[232:233], v190 offset:17024
v_cvt_pk_bf16_f32 v143, v142, v143
v_mfma_f32_16x16x32_bf16 a[120:123], a[224:227], v[148:151], a[120:123]
ds_read_b64_tr_b16 a[234:235], v190 offset:25472
buffer_load_dwordx4 v189, s[12:15], s61 offen offset:3072 nt lds
v_mfma_f32_16x16x32_bf16 a[184:187], a[224:227], v[152:155], a[184:187]
v_cvt_pk_bf16_f32 v142, v140, v141
v_add_f32 v180, v180, v160
v_mfma_f32_16x16x32_bf16 v[248:251], a[224:227], v[156:159], v[248:251]
s_add_u32 m0, s64, 0
v_add_f32 v180, v180, v161
v_add_f32 v180, v180, v162
v_mfma_f32_16x16x32_bf16 a[208:211], a[224:227], a[248:251], a[208:211]
ds_read_b64_tr_b16 a[236:237], v190 offset:17056
v_add_f32 v180, v180, v163
v_mfma_f32_16x16x32_bf16 a[212:215], a[224:227], a[252:255], a[212:215]
s_waitcnt lgkmcnt(3)
ds_read_b64_tr_b16 a[238:239], v190 offset:25504
buffer_load_dwordx4 v189, s[16:19], s62 offen offset:0 nt lds
v_mfma_f32_16x16x32_bf16 a[60:63], a[228:231], v[144:147], a[60:63]
v_exp_f32 v175, v175
v_mfma_f32_16x16x32_bf16 a[124:127], a[228:231], v[148:151], a[124:127]
s_add_u32 m0, s64, 32
ds_read_b64_tr_b16 a[240:241], v190 offset:17088
v_add_f32 v181, v181, v164
v_mfma_f32_16x16x32_bf16 a[188:191], a[228:231], v[152:155], a[188:191]
ds_read_b64_tr_b16 a[242:243], v190 offset:25536
buffer_load_dwordx4 v189, s[16:19], s62 offen offset:1024 nt lds
v_mfma_f32_16x16x32_bf16 v[252:255], a[228:231], v[156:159], v[252:255]
ds_read_b64_tr_b16 a[224:225], v190 offset:17120
v_add_f32 v181, v181, v165
v_mfma_f32_16x16x32_bf16 a[216:219], a[228:231], a[248:251], a[216:219]
ds_read_b64_tr_b16 a[226:227], v190 offset:25568
v_add_f32 v181, v181, v166
v_mfma_f32_16x16x32_bf16 a[220:223], a[228:231], a[252:255], a[220:223]
s_waitcnt lgkmcnt(4)
s_add_u32 m0, s64, 64
ds_read_b64_tr_b16 a[228:229], v186 offset:17152
v_add_f32 v181, v181, v167
v_mfma_f32_16x16x32_bf16 a[16:19], a[232:235], v[144:147], a[16:19]
buffer_load_dwordx4 v189, s[16:19], s62 offen offset:2048 nt lds
ds_read_b64_tr_b16 a[230:231], v186 offset:25600
v_mfma_f32_16x16x32_bf16 a[80:83], a[232:235], v[148:151], a[80:83]
v_add_f32 v182, v182, v168
v_add_f32 v182, v182, v169
v_mfma_f32_16x16x32_bf16 a[144:147], a[232:235], v[152:155], a[144:147]
v_add_f32 v182, v182, v170
v_add_f32 v182, v182, v171
v_mfma_f32_16x16x32_bf16 v[208:211], a[232:235], v[156:159], v[208:211]
s_add_u32 m0, s64, 96
ds_read_b64_tr_b16 a[232:233], v186 offset:17184
v_add_f32 v183, v183, v172
v_mfma_f32_16x16x32_bf16 a[20:23], a[236:239], v[144:147], a[20:23]
buffer_load_dwordx4 v189, s[16:19], s62 offen offset:3072 nt lds
ds_read_b64_tr_b16 a[234:235], v186 offset:25632
v_mfma_f32_16x16x32_bf16 a[84:87], a[236:239], v[148:151], a[84:87]
s_add_u32 s61, s61, 16384
v_add_f32 v183, v183, v173
v_add_f32 v183, v183, v174
v_mfma_f32_16x16x32_bf16 a[148:151], a[236:239], v[152:155], a[148:151]
s_add_u32 s62, s62, 16384
v_add_f32 v183, v183, v175
v_add_u32 v190, s74, v190
v_mfma_f32_16x16x32_bf16 v[212:215], a[236:239], v[156:159], v[212:215]
s_waitcnt lgkmcnt(2)
ds_read_b64_tr_b16 a[236:237], v186 offset:17216
v_cvt_pk_bf16_f32 v128, v160, v161
v_mfma_f32_16x16x32_bf16 a[24:27], a[240:243], v[144:147], a[24:27]
ds_read_b64_tr_b16 a[238:239], v186 offset:25664
v_cvt_pk_bf16_f32 v129, v162, v163
v_mfma_f32_16x16x32_bf16 a[88:91], a[240:243], v[148:151], a[88:91]
v_cvt_pk_bf16_f32 v132, v164, v165
v_cvt_pk_bf16_f32 v133, v166, v167
v_mfma_f32_16x16x32_bf16 a[152:155], a[240:243], v[152:155], a[152:155]
v_cvt_pk_bf16_f32 v136, v168, v169
v_cvt_pk_bf16_f32 v137, v170, v171
v_mfma_f32_16x16x32_bf16 v[216:219], a[240:243], v[156:159], v[216:219]
ds_read_b64_tr_b16 a[240:241], v186 offset:17248
v_cvt_pk_bf16_f32 v140, v172, v173
v_mfma_f32_16x16x32_bf16 a[28:31], a[224:227], v[144:147], a[28:31]
ds_read_b64_tr_b16 a[242:243], v186 offset:25696
v_add_u32 v186, s74, v186
v_mfma_f32_16x16x32_bf16 a[92:95], a[224:227], v[148:151], a[92:95]
v_cvt_pk_bf16_f32 v141, v174, v175
v_mfma_f32_16x16x32_bf16 a[156:159], a[224:227], v[152:155], a[156:159]
v_mfma_f32_16x16x32_bf16 v[220:223], a[224:227], v[156:159], v[220:223]
v_mfma_f32_16x16x32_bf16 a[32:35], a[228:231], v[144:147], a[32:35]
v_mfma_f32_16x16x32_bf16 a[96:99], a[228:231], v[148:151], a[96:99]
v_mfma_f32_16x16x32_bf16 a[160:163], a[228:231], v[152:155], a[160:163]
v_mfma_f32_16x16x32_bf16 v[224:227], a[228:231], v[156:159], v[224:227]
s_waitcnt lgkmcnt(0)
v_mfma_f32_16x16x32_bf16 a[36:39], a[232:235], v[144:147], a[36:39]
s_waitcnt lgkmcnt(0)
s_waitcnt vmcnt(16)
s_barrier
v_mfma_f32_16x16x32_bf16 a[100:103], a[232:235], v[148:151], a[100:103]
ds_read_b128 a[224:227], v185 offset:25344
v_mfma_f32_16x16x32_bf16 a[164:167], a[232:235], v[152:155], a[164:167]
ds_read_b128 a[248:251], v187 offset:8192
v_mfma_f32_16x16x32_bf16 v[228:231], a[232:235], v[156:159], v[228:231]
ds_read_b128 a[252:255], v187 offset:9216
v_mfma_f32_16x16x32_bf16 a[40:43], a[236:239], v[144:147], a[40:43]
ds_read_b128 a[228:231], v185 offset:25408
v_mfma_f32_16x16x32_bf16 a[104:107], a[236:239], v[148:151], a[104:107]
ds_read_b128 a[232:235], v188 offset:25472
v_mfma_f32_16x16x32_bf16 a[168:171], a[236:239], v[152:155], a[168:171]
v_mfma_f32_16x16x32_bf16 v[232:235], a[236:239], v[156:159], v[232:235]
ds_read_b128 a[236:239], v188 offset:25536
v_mfma_f32_16x16x32_bf16 a[44:47], a[240:243], v[144:147], a[44:47]
v_mfma_f32_16x16x32_bf16 a[108:111], a[240:243], v[148:151], a[108:111]
v_mfma_f32_16x16x32_bf16 a[172:175], a[240:243], v[152:155], a[172:175]
v_mfma_f32_16x16x32_bf16 v[236:239], a[240:243], v[156:159], v[236:239]
s_add_u32 s63, s63, s47
ds_read_b128 a[240:243], v185 offset:25600
s_waitcnt lgkmcnt(2)
v_mfma_f32_16x16x32_bf16 v[144:147], a[224:227], v[96:99], 0
ds_read_b128 a[244:247], v185 offset:25664
v_mfma_f32_16x16x32_bf16 v[148:151], a[224:227], v[100:103], 0
v_mfma_f32_16x16x32_bf16 v[152:155], a[224:227], v[32:35], 0
v_mfma_f32_16x16x32_bf16 v[156:159], a[224:227], v[36:39], 0
v_mfma_f32_16x16x32_bf16 v[176:179], a[224:227], a[248:251], 0
ds_read_b128 a[248:251], v187 offset:10240
v_mfma_f32_16x16x32_bf16 v[144:147], a[228:231], v[104:107], v[144:147]
ds_read_b128 a[224:227], v188 offset:25728
v_mfma_f32_16x16x32_bf16 v[148:151], a[228:231], v[108:111], v[148:151]
v_mfma_f32_16x16x32_bf16 v[152:155], a[228:231], v[40:43], v[152:155]
v_mfma_f32_16x16x32_bf16 v[156:159], a[228:231], v[44:47], v[156:159]
v_mfma_f32_16x16x32_bf16 v[176:179], a[228:231], a[252:255], v[176:179]
ds_read_b128 a[252:255], v187 offset:11264
v_mfma_f32_16x16x32_bf16 v[144:147], a[232:235], v[112:115], v[144:147]
ds_read_b128 a[228:231], v188 offset:25792
v_mfma_f32_16x16x32_bf16 v[148:151], a[232:235], v[116:119], v[148:151]
v_mfma_f32_16x16x32_bf16 v[152:155], a[232:235], v[48:51], v[152:155]
v_mfma_f32_16x16x32_bf16 v[156:159], a[232:235], v[52:55], v[156:159]
s_waitcnt lgkmcnt(2)
v_mfma_f32_16x16x32_bf16 v[176:179], a[232:235], a[248:251], v[176:179]
ds_read_b128 a[248:251], v187 offset:12288
v_mfma_f32_16x16x32_bf16 v[144:147], a[236:239], v[120:123], v[144:147]
ds_read_b128 a[232:235], v185 offset:16896
v_mfma_f32_16x16x32_bf16 v[148:151], a[236:239], v[124:127], v[148:151]
v_mfma_f32_16x16x32_bf16 v[152:155], a[236:239], v[56:59], v[152:155]
v_mfma_f32_16x16x32_bf16 v[156:159], a[236:239], v[60:63], v[156:159]
s_waitcnt lgkmcnt(2)
v_mfma_f32_16x16x32_bf16 v[176:179], a[236:239], a[252:255], v[176:179]
ds_read_b128 a[252:255], v187 offset:13312
v_mfma_f32_16x16x32_bf16 v[144:147], a[240:243], v[64:67], v[144:147]
ds_read_b128 a[236:239], v185 offset:16960
v_mfma_f32_16x16x32_bf16 v[148:151], a[240:243], v[68:71], v[148:151]
v_mfma_f32_16x16x32_bf16 v[152:155], a[240:243], v[0:3], v[152:155]
v_mfma_f32_16x16x32_bf16 v[156:159], a[240:243], v[4:7], v[156:159]
s_waitcnt lgkmcnt(2)
v_mfma_f32_16x16x32_bf16 v[176:179], a[240:243], a[248:251], v[176:179]
ds_read_b128 a[248:251], v187 offset:14336
v_mfma_f32_16x16x32_bf16 v[144:147], a[244:247], v[72:75], v[144:147]
ds_read_b128 a[240:243], v188 offset:17024
v_mfma_f32_16x16x32_bf16 v[148:151], a[244:247], v[76:79], v[148:151]
v_mfma_f32_16x16x32_bf16 v[152:155], a[244:247], v[8:11], v[152:155]
v_mfma_f32_16x16x32_bf16 v[156:159], a[244:247], v[12:15], v[156:159]
s_waitcnt lgkmcnt(2)
v_mfma_f32_16x16x32_bf16 v[176:179], a[244:247], a[252:255], v[176:179]
ds_read_b128 a[252:255], v187 offset:15360
v_mfma_f32_16x16x32_bf16 v[144:147], a[224:227], v[80:83], v[144:147]
ds_read_b64_tr_b16 a[244:245], v190 offset:416
v_mfma_f32_16x16x32_bf16 v[148:151], a[224:227], v[84:87], v[148:151]
ds_read_b64_tr_b16 a[246:247], v190 offset:8864
v_mfma_f32_16x16x32_bf16 v[152:155], a[224:227], v[16:19], v[152:155]
v_mfma_f32_16x16x32_bf16 v[156:159], a[224:227], v[20:23], v[156:159]
s_waitcnt lgkmcnt(3)
v_mfma_f32_16x16x32_bf16 v[176:179], a[224:227], a[248:251], v[176:179]
ds_read_b128 a[224:227], v188 offset:17088
v_mfma_f32_16x16x32_bf16 v[144:147], a[228:231], v[88:91], v[144:147]
ds_read_b128 a[248:251], v187 offset:16384
v_mfma_f32_16x16x32_bf16 v[148:151], a[228:231], v[92:95], v[148:151]
v_mfma_f32_16x16x32_bf16 v[152:155], a[228:231], v[24:27], v[152:155]
v_mfma_f32_16x16x32_bf16 v[156:159], a[228:231], v[28:31], v[156:159]
s_waitcnt lgkmcnt(2)
v_mfma_f32_16x16x32_bf16 v[176:179], a[228:231], a[252:255], v[176:179]
ds_read_b128 a[228:231], v185 offset:17152
v_mfma_f32_16x16x32_bf16 v[160:163], a[232:235], v[96:99], 0
v_exp_f32 v144, v144
v_mfma_f32_16x16x32_bf16 v[164:167], a[232:235], v[100:103], 0
v_exp_f32 v145, v145
v_mfma_f32_16x16x32_bf16 v[168:171], a[232:235], v[32:35], 0
v_exp_f32 v146, v146
v_mfma_f32_16x16x32_bf16 v[172:175], a[232:235], v[36:39], 0
v_exp_f32 v147, v147
v_mfma_f32_16x16x32_bf16 v[160:163], a[236:239], v[104:107], v[160:163]
v_exp_f32 v176, v176
v_mfma_f32_16x16x32_bf16 v[164:167], a[236:239], v[108:111], v[164:167]
v_exp_f32 v177, v177
v_mfma_f32_16x16x32_bf16 v[168:171], a[236:239], v[40:43], v[168:171]
v_exp_f32 v178, v178
v_mfma_f32_16x16x32_bf16 v[172:175], a[236:239], v[44:47], v[172:175]
ds_read_b128 a[232:235], v185 offset:17216
v_add_f32 v184, v184, v176
v_mfma_f32_16x16x32_bf16 v[160:163], a[240:243], v[112:115], v[160:163]
v_exp_f32 v179, v179
v_mfma_f32_16x16x32_bf16 v[164:167], a[240:243], v[116:119], v[164:167]
v_exp_f32 v148, v148
v_mfma_f32_16x16x32_bf16 v[168:171], a[240:243], v[48:51], v[168:171]
v_exp_f32 v149, v149
v_mfma_f32_16x16x32_bf16 v[172:175], a[240:243], v[52:55], v[172:175]
s_waitcnt lgkmcnt(1)
ds_read_b128 a[236:239], v188 offset:17280
v_add_f32 v184, v184, v177
v_mfma_f32_16x16x32_bf16 v[160:163], a[224:227], v[120:123], v[160:163]
v_exp_f32 v150, v150
v_mfma_f32_16x16x32_bf16 v[164:167], a[224:227], v[124:127], v[164:167]
v_exp_f32 v151, v151
v_mfma_f32_16x16x32_bf16 v[168:171], a[224:227], v[56:59], v[168:171]
v_exp_f32 v152, v152
v_mfma_f32_16x16x32_bf16 v[172:175], a[224:227], v[60:63], v[172:175]
ds_read_b128 a[240:243], v188 offset:17344
v_add_f32 v184, v184, v178
v_mfma_f32_16x16x32_bf16 v[160:163], a[228:231], v[64:67], v[160:163]
v_exp_f32 v153, v153
v_mfma_f32_16x16x32_bf16 v[164:167], a[228:231], v[68:71], v[164:167]
v_exp_f32 v154, v154
v_mfma_f32_16x16x32_bf16 v[168:171], a[228:231], v[0:3], v[168:171]
v_exp_f32 v155, v155
v_mfma_f32_16x16x32_bf16 v[172:175], a[228:231], v[4:7], v[172:175]
s_waitcnt lgkmcnt(1)
ds_read_b64_tr_b16 a[224:225], v186 offset:0
v_add_f32 v184, v184, v179
v_mfma_f32_16x16x32_bf16 v[160:163], a[232:235], v[72:75], v[160:163]
ds_read_b64_tr_b16 a[226:227], v186 offset:8448
v_cvt_pk_bf16_f32 v176, v176, v177
v_mfma_f32_16x16x32_bf16 v[164:167], a[232:235], v[76:79], v[164:167]
v_exp_f32 v156, v156
v_mfma_f32_16x16x32_bf16 v[168:171], a[232:235], v[8:11], v[168:171]
v_exp_f32 v157, v157
v_mfma_f32_16x16x32_bf16 v[172:175], a[232:235], v[12:15], v[172:175]
ds_read_b64_tr_b16 a[228:229], v186 offset:32
v_cvt_pk_bf16_f32 v177, v178, v179
v_mfma_f32_16x16x32_bf16 v[160:163], a[236:239], v[80:83], v[160:163]
ds_read_b64_tr_b16 a[230:231], v186 offset:8480
v_add_f32 v180, v180, v144
v_mfma_f32_16x16x32_bf16 v[164:167], a[236:239], v[84:87], v[164:167]
v_exp_f32 v158, v158
v_mfma_f32_16x16x32_bf16 v[168:171], a[236:239], v[16:19], v[168:171]
v_exp_f32 v159, v159
v_mfma_f32_16x16x32_bf16 v[172:175], a[236:239], v[20:23], v[172:175]
s_waitcnt lgkmcnt(2)
ds_read_b64_tr_b16 a[232:233], v186 offset:64
v_add_f32 v180, v180, v145
v_mfma_f32_16x16x32_bf16 v[160:163], a[240:243], v[88:91], v[160:163]
ds_read_b64_tr_b16 a[234:235], v186 offset:8512
v_add_f32 v180, v180, v146
v_mfma_f32_16x16x32_bf16 v[164:167], a[240:243], v[92:95], v[164:167]
ds_write_b64 v187, v[176:177] offset:19464
v_add_f32 v180, v180, v147
v_mfma_f32_16x16x32_bf16 v[168:171], a[240:243], v[24:27], v[168:171]
ds_read_b64_tr_b16 a[236:237], v186 offset:96
v_cvt_pk_bf16_f32 v147, v146, v147
v_mfma_f32_16x16x32_bf16 v[172:175], a[240:243], v[28:31], v[172:175]
ds_read_b64_tr_b16 a[238:239], v186 offset:8544
v_cvt_pk_bf16_f32 v146, v144, v145
v_mfma_f32_16x16x32_bf16 a[0:3], a[224:227], v[128:131], a[0:3]
ds_read_b128 a[252:255], v187 offset:17408
v_add_f32 v181, v181, v148
v_mfma_f32_16x16x32_bf16 a[64:67], a[224:227], v[132:135], a[64:67]
v_exp_f32 v160, v160
v_mfma_f32_16x16x32_bf16 a[128:131], a[224:227], v[136:139], a[128:131]
v_exp_f32 v161, v161
v_mfma_f32_16x16x32_bf16 v[192:195], a[224:227], v[140:143], v[192:195]
s_waitcnt lgkmcnt(3)
ds_read_b64_tr_b16 a[240:241], v190 offset:384
v_add_f32 v181, v181, v149
v_mfma_f32_16x16x32_bf16 a[4:7], a[228:231], v[128:131], a[4:7]
ds_read_b64_tr_b16 a[242:243], v190 offset:8832
v_add_f32 v181, v181, v150
v_mfma_f32_16x16x32_bf16 a[68:71], a[228:231], v[132:135], a[68:71]
v_exp_f32 v162, v162
v_mfma_f32_16x16x32_bf16 a[132:135], a[228:231], v[136:139], a[132:135]
v_exp_f32 v163, v163
v_mfma_f32_16x16x32_bf16 v[196:199], a[228:231], v[140:143], v[196:199]
v_exp_f32 v164, v164
v_mfma_f32_16x16x32_bf16 a[8:11], a[232:235], v[128:131], a[8:11]
ds_read_b64_tr_b16 a[224:225], v190 offset:448
v_add_f32 v181, v181, v151
v_mfma_f32_16x16x32_bf16 a[72:75], a[232:235], v[132:135], a[72:75]
v_exp_f32 v165, v165
v_mfma_f32_16x16x32_bf16 a[136:139], a[232:235], v[136:139], a[136:139]
v_exp_f32 v166, v166
v_mfma_f32_16x16x32_bf16 v[200:203], a[232:235], v[140:143], v[200:203]
s_waitcnt lgkmcnt(1)
v_exp_f32 v167, v167
v_mfma_f32_16x16x32_bf16 a[12:15], a[236:239], v[128:131], a[12:15]
v_cvt_pk_bf16_f32 v151, v150, v151
v_cvt_pk_bf16_f32 v150, v148, v149
v_mfma_f32_16x16x32_bf16 a[76:79], a[236:239], v[132:135], a[76:79]
v_exp_f32 v168, v168
v_mfma_f32_16x16x32_bf16 a[140:143], a[236:239], v[136:139], a[140:143]
v_exp_f32 v169, v169
v_mfma_f32_16x16x32_bf16 v[204:207], a[236:239], v[140:143], v[204:207]
s_add_u32 m0, s63, 0
ds_read_b64_tr_b16 a[226:227], v190 offset:8896
v_add_f32 v182, v182, v152
v_mfma_f32_16x16x32_bf16 a[48:51], a[240:243], v[128:131], a[48:51]
v_exp_f32 v170, v170
v_mfma_f32_16x16x32_bf16 a[112:115], a[240:243], v[132:135], a[112:115]
v_add_f32 v182, v182, v153
v_add_f32 v182, v182, v154
v_mfma_f32_16x16x32_bf16 a[176:179], a[240:243], v[136:139], a[176:179]
buffer_load_dwordx4 v189, s[12:15], s61 offen offset:0 nt lds
v_add_f32 v182, v182, v155
v_mfma_f32_16x16x32_bf16 v[240:243], a[240:243], v[140:143], v[240:243]
s_add_u32 m0, s63, 32
v_exp_f32 v171, v171
v_mfma_f32_16x16x32_bf16 a[192:195], a[240:243], a[248:251], a[192:195]
v_exp_f32 v172, v172
v_mfma_f32_16x16x32_bf16 a[196:199], a[240:243], a[252:255], a[196:199]
v_cvt_pk_bf16_f32 v155, v154, v155
v_cvt_pk_bf16_f32 v154, v152, v153
v_mfma_f32_16x16x32_bf16 a[52:55], a[244:247], v[128:131], a[52:55]
ds_read_b64_tr_b16 a[228:229], v190 offset:480
buffer_load_dwordx4 v189, s[12:15], s61 offen offset:1024 nt lds
v_mfma_f32_16x16x32_bf16 a[116:119], a[244:247], v[132:135], a[116:119]
s_add_u32 m0, s63, 64
ds_read_b64_tr_b16 a[230:231], v190 offset:8928
v_add_f32 v183, v183, v156
v_mfma_f32_16x16x32_bf16 a[180:183], a[244:247], v[136:139], a[180:183]
v_exp_f32 v173, v173
v_mfma_f32_16x16x32_bf16 v[244:247], a[244:247], v[140:143], v[244:247]
v_exp_f32 v174, v174
v_mfma_f32_16x16x32_bf16 a[200:203], a[244:247], a[248:251], a[200:203]
v_add_f32 v183, v183, v157
v_add_f32 v183, v183, v158
v_mfma_f32_16x16x32_bf16 a[204:207], a[244:247], a[252:255], a[204:207]
s_waitcnt lgkmcnt(2)
buffer_load_dwordx4 v189, s[12:15], s61 offen offset:2048 nt lds
v_add_f32 v183, v183, v159
v_mfma_f32_16x16x32_bf16 a[56:59], a[224:227], v[128:131], a[56:59]
s_add_u32 m0, s63, 96
ds_read_b64_tr_b16 a[232:233], v190 offset:128
v_cvt_pk_bf16_f32 v159, v158, v159
v_mfma_f32_16x16x32_bf16 a[120:123], a[224:227], v[132:135], a[120:123]
ds_read_b64_tr_b16 a[234:235], v190 offset:8576
buffer_load_dwordx4 v189, s[12:15], s61 offen offset:3072 nt lds
v_mfma_f32_16x16x32_bf16 a[184:187], a[224:227], v[136:139], a[184:187]
v_cvt_pk_bf16_f32 v158, v156, v157
v_add_f32 v180, v180, v160
v_mfma_f32_16x16x32_bf16 v[248:251], a[224:227], v[140:143], v[248:251]
s_add_u32 m0, s64, 16896
v_add_f32 v180, v180, v161
v_add_f32 v180, v180, v162
v_mfma_f32_16x16x32_bf16 a[208:211], a[224:227], a[248:251], a[208:211]
ds_read_b64_tr_b16 a[236:237], v190 offset:160
v_add_f32 v180, v180, v163
v_mfma_f32_16x16x32_bf16 a[212:215], a[224:227], a[252:255], a[212:215]
s_waitcnt lgkmcnt(3)
ds_read_b64_tr_b16 a[238:239], v190 offset:8608
buffer_load_dwordx4 v189, s[16:19], s62 offen offset:0 nt lds
v_mfma_f32_16x16x32_bf16 a[60:63], a[228:231], v[128:131], a[60:63]
v_exp_f32 v175, v175
v_mfma_f32_16x16x32_bf16 a[124:127], a[228:231], v[132:135], a[124:127]
s_add_u32 m0, s64, 16928
ds_read_b64_tr_b16 a[240:241], v190 offset:192
v_add_f32 v181, v181, v164
v_mfma_f32_16x16x32_bf16 a[188:191], a[228:231], v[136:139], a[188:191]
ds_read_b64_tr_b16 a[242:243], v190 offset:8640
buffer_load_dwordx4 v189, s[16:19], s62 offen offset:1024 nt lds
v_mfma_f32_16x16x32_bf16 v[252:255], a[228:231], v[140:143], v[252:255]
ds_read_b64_tr_b16 a[224:225], v190 offset:224
v_add_f32 v181, v181, v165
v_mfma_f32_16x16x32_bf16 a[216:219], a[228:231], a[248:251], a[216:219]
ds_read_b64_tr_b16 a[226:227], v190 offset:8672
v_add_f32 v181, v181, v166
v_mfma_f32_16x16x32_bf16 a[220:223], a[228:231], a[252:255], a[220:223]
s_waitcnt lgkmcnt(4)
s_add_u32 m0, s64, 16960
ds_read_b64_tr_b16 a[228:229], v186 offset:256
v_add_f32 v181, v181, v167
v_mfma_f32_16x16x32_bf16 a[16:19], a[232:235], v[128:131], a[16:19]
buffer_load_dwordx4 v189, s[16:19], s62 offen offset:2048 nt lds
ds_read_b64_tr_b16 a[230:231], v186 offset:8704
v_mfma_f32_16x16x32_bf16 a[80:83], a[232:235], v[132:135], a[80:83]
v_add_f32 v182, v182, v168
v_add_f32 v182, v182, v169
v_mfma_f32_16x16x32_bf16 a[144:147], a[232:235], v[136:139], a[144:147]
v_add_f32 v182, v182, v170
v_add_f32 v182, v182, v171
v_mfma_f32_16x16x32_bf16 v[208:211], a[232:235], v[140:143], v[208:211]
s_add_u32 m0, s64, 16992
ds_read_b64_tr_b16 a[232:233], v186 offset:288
v_subrev_u32 v185, s47, v185
v_mfma_f32_16x16x32_bf16 a[20:23], a[236:239], v[128:131], a[20:23]
buffer_load_dwordx4 v189, s[16:19], s62 offen offset:3072 nt lds
ds_read_b64_tr_b16 a[234:235], v186 offset:8736
v_mfma_f32_16x16x32_bf16 a[84:87], a[236:239], v[132:135], a[84:87]
s_add_u32 s61, s61, 16384
v_subrev_u32 v188, s47, v188
v_add_f32 v183, v183, v172
v_mfma_f32_16x16x32_bf16 a[148:151], a[236:239], v[136:139], a[148:151]
s_add_u32 s62, s62, 16384
v_add_f32 v183, v183, v173
v_add_f32 v183, v183, v174
v_mfma_f32_16x16x32_bf16 v[212:215], a[236:239], v[140:143], v[212:215]
s_waitcnt lgkmcnt(2)
ds_read_b64_tr_b16 a[236:237], v186 offset:320
v_add_f32 v183, v183, v175
v_mfma_f32_16x16x32_bf16 a[24:27], a[240:243], v[128:131], a[24:27]
ds_read_b64_tr_b16 a[238:239], v186 offset:8768
v_cvt_pk_bf16_f32 v144, v160, v161
v_mfma_f32_16x16x32_bf16 a[88:91], a[240:243], v[132:135], a[88:91]
v_cvt_pk_bf16_f32 v145, v162, v163
v_cvt_pk_bf16_f32 v148, v164, v165
v_mfma_f32_16x16x32_bf16 a[152:155], a[240:243], v[136:139], a[152:155]
v_cvt_pk_bf16_f32 v149, v166, v167
v_cvt_pk_bf16_f32 v152, v168, v169
v_mfma_f32_16x16x32_bf16 v[216:219], a[240:243], v[140:143], v[216:219]
ds_read_b64_tr_b16 a[240:241], v186 offset:352
v_cvt_pk_bf16_f32 v153, v170, v171
v_mfma_f32_16x16x32_bf16 a[28:31], a[224:227], v[128:131], a[28:31]
ds_read_b64_tr_b16 a[242:243], v186 offset:8800
v_cvt_pk_bf16_f32 v156, v172, v173
v_mfma_f32_16x16x32_bf16 a[92:95], a[224:227], v[132:135], a[92:95]
v_cvt_pk_bf16_f32 v157, v174, v175
v_mfma_f32_16x16x32_bf16 a[156:159], a[224:227], v[136:139], a[156:159]
v_mfma_f32_16x16x32_bf16 v[220:223], a[224:227], v[140:143], v[220:223]
v_mfma_f32_16x16x32_bf16 a[32:35], a[228:231], v[128:131], a[32:35]
v_mfma_f32_16x16x32_bf16 a[96:99], a[228:231], v[132:135], a[96:99]
v_mfma_f32_16x16x32_bf16 a[160:163], a[228:231], v[136:139], a[160:163]
v_mfma_f32_16x16x32_bf16 v[224:227], a[228:231], v[140:143], v[224:227]
s_waitcnt lgkmcnt(0)
v_mfma_f32_16x16x32_bf16 a[36:39], a[232:235], v[128:131], a[36:39]
s_waitcnt lgkmcnt(0)
s_waitcnt vmcnt(16)
s_barrier
v_mfma_f32_16x16x32_bf16 a[100:103], a[232:235], v[132:135], a[100:103]
ds_read_b128 a[224:227], v185 offset:8448
v_mfma_f32_16x16x32_bf16 a[164:167], a[232:235], v[136:139], a[164:167]
ds_read_b128 a[248:251], v187 offset:8192
v_mfma_f32_16x16x32_bf16 v[228:231], a[232:235], v[140:143], v[228:231]
ds_read_b128 a[252:255], v187 offset:9216
v_mfma_f32_16x16x32_bf16 a[40:43], a[236:239], v[128:131], a[40:43]
ds_read_b128 a[228:231], v185 offset:8512
v_mfma_f32_16x16x32_bf16 a[104:107], a[236:239], v[132:135], a[104:107]
ds_read_b128 a[232:235], v188 offset:8576
v_mfma_f32_16x16x32_bf16 a[168:171], a[236:239], v[136:139], a[168:171]
v_mfma_f32_16x16x32_bf16 v[232:235], a[236:239], v[140:143], v[232:235]
ds_read_b128 a[236:239], v188 offset:8640
v_mfma_f32_16x16x32_bf16 a[44:47], a[240:243], v[128:131], a[44:47]
v_mfma_f32_16x16x32_bf16 a[108:111], a[240:243], v[132:135], a[108:111]
v_mfma_f32_16x16x32_bf16 a[172:175], a[240:243], v[136:139], a[172:175]
v_mfma_f32_16x16x32_bf16 v[236:239], a[240:243], v[140:143], v[236:239]
s_sub_u32 s47, 0, s47
s_sub_u32 s74, 0, s74
s_add_u32 s46, s46, 1
s_cmp_lt_u32 s46, 15
s_cbranch_scc1 L_attloop3
s_lshr_b32 s56, s2, 5
s_and_b32 s56, s56, 7
s_mul_i32 s56, s56, 57344
s_add_u32 s56, s56, 43008
s_waitcnt lgkmcnt(1)
ds_read_b64_tr_b16 a[224:225], v186 offset:16896
ds_read_b64_tr_b16 a[226:227], v186 offset:25344
s_waitcnt lgkmcnt(0)
v_mfma_f32_16x16x32_bf16 a[0:3], a[224:227], v[144:147], a[0:3]
ds_read_b64_tr_b16 a[228:229], v186 offset:16928
v_mfma_f32_16x16x32_bf16 a[64:67], a[224:227], v[148:151], a[64:67]
ds_read_b64_tr_b16 a[230:231], v186 offset:25376
ds_read_b64_tr_b16 a[232:233], v186 offset:16960
ds_read_b64_tr_b16 a[234:235], v186 offset:25408
v_mfma_f32_16x16x32_bf16 a[128:131], a[224:227], v[152:155], a[128:131]
ds_read_b64_tr_b16 a[236:237], v186 offset:16992
buffer_load_dwordx4 v[176:179], v189, s[20:23], s56 offen offset:0
v_mfma_f32_16x16x32_bf16 v[192:195], a[224:227], v[156:159], v[192:195]
s_waitcnt lgkmcnt(3)
ds_read_b64_tr_b16 a[238:239], v186 offset:25440
v_mfma_f32_16x16x32_bf16 a[4:7], a[228:231], v[144:147], a[4:7]
ds_read_b128 a[248:251], v187 offset:18432
v_mfma_f32_16x16x32_bf16 a[68:71], a[228:231], v[148:151], a[68:71]
ds_read_b128 a[252:255], v187 offset:19456
v_mfma_f32_16x16x32_bf16 a[132:135], a[228:231], v[152:155], a[132:135]
ds_read_b64_tr_b16 a[240:241], v190 offset:17280
buffer_load_dwordx4 v[176:179], v189, s[20:23], s56 offen offset:1024
v_mfma_f32_16x16x32_bf16 v[196:199], a[228:231], v[156:159], v[196:199]
s_waitcnt lgkmcnt(5)
ds_read_b64_tr_b16 a[242:243], v190 offset:25728
v_mfma_f32_16x16x32_bf16 a[8:11], a[232:235], v[144:147], a[8:11]
ds_read_b64_tr_b16 a[244:245], v190 offset:17312
v_mfma_f32_16x16x32_bf16 a[72:75], a[232:235], v[148:151], a[72:75]
ds_read_b64_tr_b16 a[246:247], v190 offset:25760
v_mfma_f32_16x16x32_bf16 a[136:139], a[232:235], v[152:155], a[136:139]
buffer_load_dwordx4 v[176:179], v189, s[20:23], s56 offen offset:2048
ds_read_b64_tr_b16 a[224:225], v190 offset:17344
v_mfma_f32_16x16x32_bf16 v[200:203], a[232:235], v[156:159], v[200:203]
s_waitcnt lgkmcnt(5)
ds_read_b64_tr_b16 a[226:227], v190 offset:25792
v_mfma_f32_16x16x32_bf16 a[12:15], a[236:239], v[144:147], a[12:15]
ds_read_b64_tr_b16 a[228:229], v190 offset:17376
v_mfma_f32_16x16x32_bf16 a[76:79], a[236:239], v[148:151], a[76:79]
ds_read_b64_tr_b16 a[230:231], v190 offset:25824
v_mfma_f32_16x16x32_bf16 a[140:143], a[236:239], v[152:155], a[140:143]
buffer_load_dwordx4 v[176:179], v189, s[20:23], s56 offen offset:3072
ds_read_b64_tr_b16 a[232:233], v190 offset:17024
v_mfma_f32_16x16x32_bf16 v[204:207], a[236:239], v[156:159], v[204:207]
s_waitcnt lgkmcnt(5)
s_add_u32 s56, s56, 4096
ds_read_b64_tr_b16 a[234:235], v190 offset:25472
v_mfma_f32_16x16x32_bf16 a[48:51], a[240:243], v[144:147], a[48:51]
ds_read_b64_tr_b16 a[236:237], v190 offset:17056
v_mfma_f32_16x16x32_bf16 a[112:115], a[240:243], v[148:151], a[112:115]
ds_read_b64_tr_b16 a[238:239], v190 offset:25504
v_mfma_f32_16x16x32_bf16 a[176:179], a[240:243], v[152:155], a[176:179]
buffer_load_dwordx4 v[176:179], v189, s[20:23], s56 offen offset:0
v_mfma_f32_16x16x32_bf16 v[240:243], a[240:243], v[156:159], v[240:243]
v_mfma_f32_16x16x32_bf16 a[192:195], a[240:243], a[248:251], a[192:195]
v_mfma_f32_16x16x32_bf16 a[196:199], a[240:243], a[252:255], a[196:199]
ds_read_b64_tr_b16 a[240:241], v190 offset:17088
v_mfma_f32_16x16x32_bf16 a[52:55], a[244:247], v[144:147], a[52:55]
buffer_load_dwordx4 v[176:179], v189, s[20:23], s56 offen offset:1024
ds_read_b64_tr_b16 a[242:243], v190 offset:25536
v_mfma_f32_16x16x32_bf16 a[116:119], a[244:247], v[148:151], a[116:119]
v_mfma_f32_16x16x32_bf16 a[180:183], a[244:247], v[152:155], a[180:183]
v_mfma_f32_16x16x32_bf16 v[244:247], a[244:247], v[156:159], v[244:247]
v_mfma_f32_16x16x32_bf16 a[200:203], a[244:247], a[248:251], a[200:203]
buffer_load_dwordx4 v[176:179], v189, s[20:23], s56 offen offset:2048
v_mfma_f32_16x16x32_bf16 a[204:207], a[244:247], a[252:255], a[204:207]
s_waitcnt lgkmcnt(1)
v_mfma_f32_16x16x32_bf16 a[56:59], a[224:227], v[144:147], a[56:59]
v_mfma_f32_16x16x32_bf16 a[120:123], a[224:227], v[148:151], a[120:123]
v_mfma_f32_16x16x32_bf16 a[184:187], a[224:227], v[152:155], a[184:187]
buffer_load_dwordx4 v[176:179], v189, s[20:23], s56 offen offset:3072
v_mfma_f32_16x16x32_bf16 v[248:251], a[224:227], v[156:159], v[248:251]
s_add_u32 s56, s56, 4096
v_mfma_f32_16x16x32_bf16 a[208:211], a[224:227], a[248:251], a[208:211]
v_mfma_f32_16x16x32_bf16 a[212:215], a[224:227], a[252:255], a[212:215]
ds_read_b64_tr_b16 a[224:225], v190 offset:17120
v_mfma_f32_16x16x32_bf16 a[60:63], a[228:231], v[144:147], a[60:63]
buffer_load_dwordx4 v[176:179], v189, s[20:23], s56 offen offset:0
ds_read_b64_tr_b16 a[226:227], v190 offset:25568
v_mfma_f32_16x16x32_bf16 a[124:127], a[228:231], v[148:151], a[124:127]
v_mfma_f32_16x16x32_bf16 a[188:191], a[228:231], v[152:155], a[188:191]
v_mfma_f32_16x16x32_bf16 v[252:255], a[228:231], v[156:159], v[252:255]
v_mfma_f32_16x16x32_bf16 a[216:219], a[228:231], a[248:251], a[216:219]
buffer_load_dwordx4 v[176:179], v189, s[20:23], s56 offen offset:1024
v_mfma_f32_16x16x32_bf16 a[220:223], a[228:231], a[252:255], a[220:223]
ds_read_b64_tr_b16 a[228:229], v186 offset:17152
v_mfma_f32_16x16x32_bf16 a[16:19], a[232:235], v[144:147], a[16:19]
ds_read_b64_tr_b16 a[230:231], v186 offset:25600
v_mfma_f32_16x16x32_bf16 a[80:83], a[232:235], v[148:151], a[80:83]
v_mfma_f32_16x16x32_bf16 a[144:147], a[232:235], v[152:155], a[144:147]
buffer_load_dwordx4 v[176:179], v189, s[20:23], s56 offen offset:2048
v_mfma_f32_16x16x32_bf16 v[208:211], a[232:235], v[156:159], v[208:211]
ds_read_b64_tr_b16 a[232:233], v186 offset:17184
v_mfma_f32_16x16x32_bf16 a[20:23], a[236:239], v[144:147], a[20:23]
ds_read_b64_tr_b16 a[234:235], v186 offset:25632
v_mfma_f32_16x16x32_bf16 a[84:87], a[236:239], v[148:151], a[84:87]
v_mfma_f32_16x16x32_bf16 a[148:151], a[236:239], v[152:155], a[148:151]
buffer_load_dwordx4 v[176:179], v189, s[20:23], s56 offen offset:3072
v_mfma_f32_16x16x32_bf16 v[212:215], a[236:239], v[156:159], v[212:215]
s_waitcnt lgkmcnt(2)
s_add_u32 s56, s56, 4096
ds_read_b64_tr_b16 a[236:237], v186 offset:17216
v_mfma_f32_16x16x32_bf16 a[24:27], a[240:243], v[144:147], a[24:27]
ds_read_b64_tr_b16 a[238:239], v186 offset:25664
v_mfma_f32_16x16x32_bf16 a[88:91], a[240:243], v[148:151], a[88:91]
v_mfma_f32_16x16x32_bf16 a[152:155], a[240:243], v[152:155], a[152:155]
buffer_load_dwordx4 v[176:179], v189, s[20:23], s56 offen offset:0
v_mfma_f32_16x16x32_bf16 v[216:219], a[240:243], v[156:159], v[216:219]
ds_read_b64_tr_b16 a[240:241], v186 offset:17248
v_mfma_f32_16x16x32_bf16 a[28:31], a[224:227], v[144:147], a[28:31]
ds_read_b64_tr_b16 a[242:243], v186 offset:25696
v_mfma_f32_16x16x32_bf16 a[92:95], a[224:227], v[148:151], a[92:95]
v_mfma_f32_16x16x32_bf16 a[156:159], a[224:227], v[152:155], a[156:159]
buffer_load_dwordx4 v[176:179], v189, s[20:23], s56 offen offset:1024
v_mfma_f32_16x16x32_bf16 v[220:223], a[224:227], v[156:159], v[220:223]
v_mfma_f32_16x16x32_bf16 a[32:35], a[228:231], v[144:147], a[32:35]
v_mfma_f32_16x16x32_bf16 a[96:99], a[228:231], v[148:151], a[96:99]
v_mfma_f32_16x16x32_bf16 a[160:163], a[228:231], v[152:155], a[160:163]
v_mfma_f32_16x16x32_bf16 v[224:227], a[228:231], v[156:159], v[224:227]
s_waitcnt lgkmcnt(0)
v_mfma_f32_16x16x32_bf16 a[36:39], a[232:235], v[144:147], a[36:39]
v_mfma_f32_16x16x32_bf16 a[100:103], a[232:235], v[148:151], a[100:103]
v_mfma_f32_16x16x32_bf16 a[164:167], a[232:235], v[152:155], a[164:167]
v_mfma_f32_16x16x32_bf16 v[228:231], a[232:235], v[156:159], v[228:231]
v_mfma_f32_16x16x32_bf16 a[40:43], a[236:239], v[144:147], a[40:43]
v_mfma_f32_16x16x32_bf16 a[104:107], a[236:239], v[148:151], a[104:107]
v_mfma_f32_16x16x32_bf16 a[168:171], a[236:239], v[152:155], a[168:171]
v_mfma_f32_16x16x32_bf16 v[232:235], a[236:239], v[156:159], v[232:235]
v_mfma_f32_16x16x32_bf16 a[44:47], a[240:243], v[144:147], a[44:47]
v_mfma_f32_16x16x32_bf16 a[108:111], a[240:243], v[148:151], a[108:111]
v_mfma_f32_16x16x32_bf16 a[172:175], a[240:243], v[152:155], a[172:175]
v_mfma_f32_16x16x32_bf16 v[236:239], a[240:243], v[156:159], v[236:239]
s_branch L_att_done
L_far_safe:
s_getpc_b64 s[32:33]
L_fs_pc:
s_add_u32 s32, s32, L_safe-L_fs_pc
s_addc_u32 s33, s33, 0
s_setpc_b64 s[32:33]
L_att_done:
s_waitcnt vmcnt(14) lgkmcnt(0)
s_barrier
v_mbcnt_lo_u32_b32 v190, -1, 0
v_mbcnt_hi_u32_b32 v190, -1, v190
v_lshrrev_b32 v132, 3, v190
v_mul_u32_u24 v128, 896, v132
v_and_b32 v132, 6, v132
v_and_b32 v133, 7, v190
v_xor_b32 v133, v133, v132
v_lshl_add_u32 v128, v133, 4, v128
v_add_u32 v129, 6144, v128
v_add_u32 v130, 12288, v128
v_add_u32 v131, 18432, v128
s_lshl_b32 s67, s28, 13
s_mul_i32 s62, s28, 57344
s_add_u32 s32, s62, 229376
s_add_u32 s33, s32, 28672
s_add_u32 s34, s62, 128
s_add_u32 s35, s34, 28672
s_add_u32 s36, s62, 28672
s_mov_b32 s37, 0x40000000
s_add_u32 m0, s67, 0
s_nop 0
buffer_load_dwordx4 v128, s[20:23], s62 offen offset:0 lds
buffer_load_dwordx4 v129, s[20:23], s62 offen offset:1024 lds
buffer_load_dwordx4 v130, s[20:23], s62 offen offset:2048 lds
buffer_load_dwordx4 v131, s[20:23], s62 offen offset:3072 lds
s_add_u32 m0, s67, 4096
s_nop 0
buffer_load_dwordx4 v128, s[20:23], s36 offen offset:0 lds
buffer_load_dwordx4 v129, s[20:23], s36 offen offset:1024 lds
buffer_load_dwordx4 v130, s[20:23], s36 offen offset:2048 lds
buffer_load_dwordx4 v131, s[20:23], s36 offen offset:3072 lds
v_mov_b32 v136, v180
s_nop 1
v_permlane32_swap_b32 v180, v136
v_add_f32 v180, v180, v136
v_mov_b32 v136, v180
s_nop 1
v_permlane16_swap_b32 v180, v136
v_add_f32 v180, v180, v136
v_mov_b32 v137, v181
s_nop 1
v_permlane32_swap_b32 v181, v137
v_add_f32 v181, v181, v137
v_mov_b32 v137, v181
s_nop 1
v_permlane16_swap_b32 v181, v137
v_add_f32 v181, v181, v137
v_mov_b32 v138, v182
s_nop 1
v_permlane32_swap_b32 v182, v138
v_add_f32 v182, v182, v138
v_mov_b32 v138, v182
s_nop 1
v_permlane16_swap_b32 v182, v138
v_add_f32 v182, v182, v138
v_mov_b32 v139, v183
s_nop 1
v_permlane32_swap_b32 v183, v139
v_add_f32 v183, v183, v139
v_mov_b32 v139, v183
s_nop 1
v_permlane16_swap_b32 v183, v139
v_add_f32 v183, v183, v139
v_mov_b32 v140, v184
s_nop 1
v_permlane32_swap_b32 v184, v140
v_add_f32 v184, v184, v140
v_mov_b32 v140, v184
s_nop 1
v_permlane16_swap_b32 v184, v140
v_add_f32 v184, v184, v140
v_and_b32 v136, 15, v190
v_lshlrev_b32 v136, 2, v136
s_lshl_b32 s58, s28, 6
v_add_u32 v136, 147456, v136
v_add_u32 v137, s58, v136
ds_write_b32 v137, v184
s_mov_b32 s58, 0x33800000
s_mov_b32 s59, 0x4f800000
v_min_f32 v138, v180, v181
v_min3_f32 v138, v138, v182, v183
v_max_f32 v139, v180, v181
v_max3_f32 v139, v139, v182, v183
v_add_f32 v140, v180, v181
v_add_f32 v141, v182, v183
v_add_f32 v140, v140, v141
v_cmp_nle_f32 vcc, s58, v138
v_cmp_nge_f32 s[38:39], s59, v139
v_cmp_u_f32 s[40:41], v140, v140
s_nop 1
s_or_b64 s[38:39], s[38:39], vcc
s_or_b64 s[38:39], s[38:39], s[40:41]
s_cmp_lg_u64 s[38:39], 0
s_cselect_b32 s56, 1, 0
v_mov_b32 v138, s56
s_lshl_b32 s56, s28, 2
s_add_u32 s56, s56, 147712
v_mov_b32 v139, s56
ds_write_b32 v139, v138
s_waitcnt lgkmcnt(0)
s_barrier
v_mov_b32 v139, 147712
ds_read_b128 v[140:143], v139
ds_read_b32 v144, v136 offset:0
ds_read_b32 v145, v136 offset:64
ds_read_b32 v146, v136 offset:128
ds_read_b32 v147, v136 offset:192
s_waitcnt lgkmcnt(0)
v_add_f32 v144, v144, v145
v_add_f32 v146, v146, v147
v_or_b32 v140, v140, v141
v_or_b32 v142, v142, v143
v_or_b32 v140, v140, v142
v_min_f32 v138, v144, v146
v_max_f32 v139, v144, v146
v_add_f32 v141, v144, v146
v_cmp_nle_f32 vcc, s58, v138
v_cmp_nge_f32 s[38:39], s59, v139
v_cmp_u_f32 s[40:41], v141, v141
v_cmp_ne_u32 s[44:45], 0, v140
s_nop 1
s_or_b64 s[38:39], s[38:39], vcc
s_or_b64 s[38:39], s[38:39], s[40:41]
s_or_b64 s[38:39], s[38:39], s[44:45]
s_cmp_lg_u64 s[38:39], 0
s_cbranch_scc0 L_att_ok
s_cmp_eq_u32 s65, 0
s_cbranch_scc1 L_fallback
L_att_ok:
v_rcp_f32 v180, v180
v_rcp_f32 v181, v181
v_rcp_f32 v182, v182
v_rcp_f32 v183, v183
v_rcp_f32 v184, v144
v_rcp_f32 v185, v146
v_lshlrev_b32 v144, 4, v190
s_lshl_b32 s58, s28, 11
s_add_u32 s58, s58, 131072
v_add_u32 v144, s58, v144
v_accvgpr_read_b32 v136, a192
v_accvgpr_read_b32 v137, a193
v_accvgpr_read_b32 v138, a194
v_accvgpr_read_b32 v139, a195
v_pk_mul_f32 v[136:137], v[136:137], v[184:185] op_sel_hi:[1,0]
v_pk_mul_f32 v[138:139], v[138:139], v[184:185] op_sel_hi:[1,0]
v_cvt_pk_bf16_f32 v136, v136, v137
v_cvt_pk_bf16_f32 v137, v138, v139
ds_write_b64 v144, v[136:137] offset:0
v_accvgpr_read_b32 v140, a196
v_accvgpr_read_b32 v141, a197
v_accvgpr_read_b32 v142, a198
v_accvgpr_read_b32 v143, a199
v_pk_mul_f32 v[140:141], v[140:141], v[184:185] op_sel:[0,1] op_sel_hi:[1,1]
v_pk_mul_f32 v[142:143], v[142:143], v[184:185] op_sel:[0,1] op_sel_hi:[1,1]
v_cvt_pk_bf16_f32 v140, v140, v141
v_cvt_pk_bf16_f32 v141, v142, v143
ds_write_b64 v144, v[140:141] offset:8192
v_accvgpr_read_b32 v136, a200
s_add_u32 m0, s67, 32768
v_accvgpr_read_b32 v137, a201
buffer_load_dwordx4 v128, s[20:23], s32 offen offset:0 lds
v_accvgpr_read_b32 v138, a202
v_accvgpr_read_b32 v139, a203
v_pk_mul_f32 v[136:137], v[136:137], v[184:185] op_sel_hi:[1,0]
v_pk_mul_f32 v[138:139], v[138:139], v[184:185] op_sel_hi:[1,0]
v_cvt_pk_bf16_f32 v136, v136, v137
v_cvt_pk_bf16_f32 v137, v138, v139
ds_write_b64 v144, v[136:137] offset:8
v_accvgpr_read_b32 v140, a204
v_accvgpr_read_b32 v141, a205
v_accvgpr_read_b32 v142, a206
v_accvgpr_read_b32 v143, a207
v_pk_mul_f32 v[140:141], v[140:141], v[184:185] op_sel:[0,1] op_sel_hi:[1,1]
v_pk_mul_f32 v[142:143], v[142:143], v[184:185] op_sel:[0,1] op_sel_hi:[1,1]
v_cvt_pk_bf16_f32 v140, v140, v141
v_cvt_pk_bf16_f32 v141, v142, v143
ds_write_b64 v144, v[140:141] offset:8200
v_accvgpr_read_b32 v136, a208
v_accvgpr_read_b32 v137, a209
v_accvgpr_read_b32 v138, a210
v_accvgpr_read_b32 v139, a211
v_pk_mul_f32 v[136:137], v[136:137], v[184:185] op_sel_hi:[1,0]
v_pk_mul_f32 v[138:139], v[138:139], v[184:185] op_sel_hi:[1,0]
buffer_load_dwordx4 v129, s[20:23], s32 offen offset:1024 lds
v_cvt_pk_bf16_f32 v136, v136, v137
v_cvt_pk_bf16_f32 v137, v138, v139
ds_write_b64 v144, v[136:137] offset:1024
v_accvgpr_read_b32 v140, a212
v_accvgpr_read_b32 v141, a213
v_accvgpr_read_b32 v142, a214
v_accvgpr_read_b32 v143, a215
v_pk_mul_f32 v[140:141], v[140:141], v[184:185] op_sel:[0,1] op_sel_hi:[1,1]
v_pk_mul_f32 v[142:143], v[142:143], v[184:185] op_sel:[0,1] op_sel_hi:[1,1]
v_cvt_pk_bf16_f32 v140, v140, v141
v_cvt_pk_bf16_f32 v141, v142, v143
ds_write_b64 v144, v[140:141] offset:9216
v_accvgpr_read_b32 v136, a216
v_accvgpr_read_b32 v137, a217
v_accvgpr_read_b32 v138, a218
v_accvgpr_read_b32 v139, a219
v_pk_mul_f32 v[136:137], v[136:137], v[184:185] op_sel_hi:[1,0]
v_pk_mul_f32 v[138:139], v[138:139], v[184:185] op_sel_hi:[1,0]
v_cvt_pk_bf16_f32 v136, v136, v137
v_cvt_pk_bf16_f32 v137, v138, v139
ds_write_b64 v144, v[136:137] offset:1032
v_accvgpr_read_b32 v140, a220
v_accvgpr_read_b32 v141, a221
buffer_load_dwordx4 v130, s[20:23], s32 offen offset:2048 lds
v_accvgpr_read_b32 v142, a222
v_accvgpr_read_b32 v143, a223
v_pk_mul_f32 v[140:141], v[140:141], v[184:185] op_sel:[0,1] op_sel_hi:[1,1]
v_pk_mul_f32 v[142:143], v[142:143], v[184:185] op_sel:[0,1] op_sel_hi:[1,1]
v_cvt_pk_bf16_f32 v140, v140, v141
v_cvt_pk_bf16_f32 v141, v142, v143
ds_write_b64 v144, v[140:141] offset:9224
v_accvgpr_read_b32 v148, a0
v_accvgpr_read_b32 v149, a1
v_accvgpr_read_b32 v150, a2
v_accvgpr_read_b32 v151, a3
v_accvgpr_read_b32 v152, a4
v_accvgpr_read_b32 v153, a5
v_accvgpr_read_b32 v154, a6
v_accvgpr_read_b32 v155, a7
v_pk_mul_f32 v[148:149], v[148:149], v[180:181] op_sel_hi:[1,0]
v_pk_mul_f32 v[150:151], v[150:151], v[180:181] op_sel_hi:[1,0]
v_pk_mul_f32 v[152:153], v[152:153], v[180:181] op_sel_hi:[1,0]
v_pk_mul_f32 v[154:155], v[154:155], v[180:181] op_sel_hi:[1,0]
v_cvt_pk_bf16_f32 v0, v148, v149
v_cvt_pk_bf16_f32 v1, v150, v151
v_cvt_pk_bf16_f32 v2, v152, v153
v_cvt_pk_bf16_f32 v3, v154, v155
buffer_load_dwordx4 v131, s[20:23], s32 offen offset:3072 lds
v_accvgpr_read_b32 v156, a8
v_accvgpr_read_b32 v157, a9
v_accvgpr_read_b32 v158, a10
v_accvgpr_read_b32 v159, a11
v_accvgpr_read_b32 v160, a12
v_accvgpr_read_b32 v161, a13
v_accvgpr_read_b32 v162, a14
v_accvgpr_read_b32 v163, a15
v_pk_mul_f32 v[156:157], v[156:157], v[180:181] op_sel_hi:[1,0]
v_pk_mul_f32 v[158:159], v[158:159], v[180:181] op_sel_hi:[1,0]
v_pk_mul_f32 v[160:161], v[160:161], v[180:181] op_sel_hi:[1,0]
v_pk_mul_f32 v[162:163], v[162:163], v[180:181] op_sel_hi:[1,0]
v_cvt_pk_bf16_f32 v4, v156, v157
v_cvt_pk_bf16_f32 v5, v158, v159
v_cvt_pk_bf16_f32 v6, v160, v161
v_cvt_pk_bf16_f32 v7, v162, v163
v_accvgpr_read_b32 v148, a16
v_accvgpr_read_b32 v149, a17
v_accvgpr_read_b32 v150, a18
v_accvgpr_read_b32 v151, a19
v_accvgpr_read_b32 v152, a20
v_accvgpr_read_b32 v153, a21
v_accvgpr_read_b32 v154, a22
s_add_u32 m0, s67, 36864
v_accvgpr_read_b32 v155, a23
buffer_load_dwordx4 v128, s[20:23], s33 offen offset:0 lds
v_pk_mul_f32 v[148:149], v[148:149], v[180:181] op_sel_hi:[1,0]
v_pk_mul_f32 v[150:151], v[150:151], v[180:181] op_sel_hi:[1,0]
v_pk_mul_f32 v[152:153], v[152:153], v[180:181] op_sel_hi:[1,0]
v_pk_mul_f32 v[154:155], v[154:155], v[180:181] op_sel_hi:[1,0]
v_cvt_pk_bf16_f32 v8, v148, v149
v_cvt_pk_bf16_f32 v9, v150, v151
v_cvt_pk_bf16_f32 v10, v152, v153
v_cvt_pk_bf16_f32 v11, v154, v155
v_accvgpr_read_b32 v156, a24
v_accvgpr_read_b32 v157, a25
v_accvgpr_read_b32 v158, a26
v_accvgpr_read_b32 v159, a27
v_accvgpr_read_b32 v160, a28
v_accvgpr_read_b32 v161, a29
v_accvgpr_read_b32 v162, a30
v_accvgpr_read_b32 v163, a31
v_pk_mul_f32 v[156:157], v[156:157], v[180:181] op_sel_hi:[1,0]
v_pk_mul_f32 v[158:159], v[158:159], v[180:181] op_sel_hi:[1,0]
v_pk_mul_f32 v[160:161], v[160:161], v[180:181] op_sel_hi:[1,0]
v_pk_mul_f32 v[162:163], v[162:163], v[180:181] op_sel_hi:[1,0]
v_cvt_pk_bf16_f32 v12, v156, v157
v_cvt_pk_bf16_f32 v13, v158, v159
buffer_load_dwordx4 v129, s[20:23], s33 offen offset:1024 lds
v_cvt_pk_bf16_f32 v14, v160, v161
v_cvt_pk_bf16_f32 v15, v162, v163
v_accvgpr_read_b32 v148, a32
v_accvgpr_read_b32 v149, a33
v_accvgpr_read_b32 v150, a34
v_accvgpr_read_b32 v151, a35
v_accvgpr_read_b32 v152, a36
v_accvgpr_read_b32 v153, a37
v_accvgpr_read_b32 v154, a38
v_accvgpr_read_b32 v155, a39
v_pk_mul_f32 v[148:149], v[148:149], v[180:181] op_sel_hi:[1,0]
v_pk_mul_f32 v[150:151], v[150:151], v[180:181] op_sel_hi:[1,0]
v_pk_mul_f32 v[152:153], v[152:153], v[180:181] op_sel_hi:[1,0]
v_pk_mul_f32 v[154:155], v[154:155], v[180:181] op_sel_hi:[1,0]
v_cvt_pk_bf16_f32 v16, v148, v149
v_cvt_pk_bf16_f32 v17, v150, v151
v_cvt_pk_bf16_f32 v18, v152, v153
v_cvt_pk_bf16_f32 v19, v154, v155
v_accvgpr_read_b32 v156, a40
v_accvgpr_read_b32 v157, a41
v_accvgpr_read_b32 v158, a42
v_accvgpr_read_b32 v159, a43
v_accvgpr_read_b32 v160, a44
buffer_load_dwordx4 v130, s[20:23], s33 offen offset:2048 lds
v_accvgpr_read_b32 v161, a45
v_accvgpr_read_b32 v162, a46
v_accvgpr_read_b32 v163, a47
v_pk_mul_f32 v[156:157], v[156:157], v[180:181] op_sel_hi:[1,0]
v_pk_mul_f32 v[158:159], v[158:159], v[180:181] op_sel_hi:[1,0]
v_pk_mul_f32 v[160:161], v[160:161], v[180:181] op_sel_hi:[1,0]
v_pk_mul_f32 v[162:163], v[162:163], v[180:181] op_sel_hi:[1,0]
v_cvt_pk_bf16_f32 v20, v156, v157
v_cvt_pk_bf16_f32 v21, v158, v159
v_cvt_pk_bf16_f32 v22, v160, v161
v_cvt_pk_bf16_f32 v23, v162, v163
v_accvgpr_read_b32 v148, a48
v_accvgpr_read_b32 v149, a49
v_accvgpr_read_b32 v150, a50
v_accvgpr_read_b32 v151, a51
v_accvgpr_read_b32 v152, a52
v_accvgpr_read_b32 v153, a53
v_accvgpr_read_b32 v154, a54
v_accvgpr_read_b32 v155, a55
v_pk_mul_f32 v[148:149], v[148:149], v[180:181] op_sel_hi:[1,0]
v_pk_mul_f32 v[150:151], v[150:151], v[180:181] op_sel_hi:[1,0]
v_pk_mul_f32 v[152:153], v[152:153], v[180:181] op_sel_hi:[1,0]
v_pk_mul_f32 v[154:155], v[154:155], v[180:181] op_sel_hi:[1,0]
buffer_load_dwordx4 v131, s[20:23], s33 offen offset:3072 lds
v_cvt_pk_bf16_f32 v24, v148, v149
v_cvt_pk_bf16_f32 v25, v150, v151
v_cvt_pk_bf16_f32 v26, v152, v153
v_cvt_pk_bf16_f32 v27, v154, v155
v_accvgpr_read_b32 v156, a56
v_accvgpr_read_b32 v157, a57
v_accvgpr_read_b32 v158, a58
v_accvgpr_read_b32 v159, a59
v_accvgpr_read_b32 v160, a60
v_accvgpr_read_b32 v161, a61
v_accvgpr_read_b32 v162, a62
v_accvgpr_read_b32 v163, a63
v_pk_mul_f32 v[156:157], v[156:157], v[180:181] op_sel_hi:[1,0]
v_pk_mul_f32 v[158:159], v[158:159], v[180:181] op_sel_hi:[1,0]
v_pk_mul_f32 v[160:161], v[160:161], v[180:181] op_sel_hi:[1,0]
v_pk_mul_f32 v[162:163], v[162:163], v[180:181] op_sel_hi:[1,0]
v_cvt_pk_bf16_f32 v28, v156, v157
v_cvt_pk_bf16_f32 v29, v158, v159
v_cvt_pk_bf16_f32 v30, v160, v161
v_cvt_pk_bf16_f32 v31, v162, v163
v_accvgpr_read_b32 v148, a64
v_accvgpr_read_b32 v149, a65
v_accvgpr_read_b32 v150, a66
s_add_u32 m0, s67, 65536
v_accvgpr_read_b32 v151, a67
buffer_load_dwordx4 v128, s[20:23], s34 offen offset:0 lds
v_accvgpr_read_b32 v152, a68
v_accvgpr_read_b32 v153, a69
v_accvgpr_read_b32 v154, a70
v_accvgpr_read_b32 v155, a71
v_pk_mul_f32 v[148:149], v[148:149], v[180:181] op_sel:[0,1] op_sel_hi:[1,1]
v_pk_mul_f32 v[150:151], v[150:151], v[180:181] op_sel:[0,1] op_sel_hi:[1,1]
v_pk_mul_f32 v[152:153], v[152:153], v[180:181] op_sel:[0,1] op_sel_hi:[1,1]
v_pk_mul_f32 v[154:155], v[154:155], v[180:181] op_sel:[0,1] op_sel_hi:[1,1]
v_cvt_pk_bf16_f32 v32, v148, v149
v_cvt_pk_bf16_f32 v33, v150, v151
v_cvt_pk_bf16_f32 v34, v152, v153
v_cvt_pk_bf16_f32 v35, v154, v155
v_accvgpr_read_b32 v156, a72
v_accvgpr_read_b32 v157, a73
v_accvgpr_read_b32 v158, a74
v_accvgpr_read_b32 v159, a75
v_accvgpr_read_b32 v160, a76
v_accvgpr_read_b32 v161, a77
v_accvgpr_read_b32 v162, a78
v_accvgpr_read_b32 v163, a79
v_pk_mul_f32 v[156:157], v[156:157], v[180:181] op_sel:[0,1] op_sel_hi:[1,1]
v_pk_mul_f32 v[158:159], v[158:159], v[180:181] op_sel:[0,1] op_sel_hi:[1,1]
buffer_load_dwordx4 v129, s[20:23], s34 offen offset:1024 lds
v_pk_mul_f32 v[160:161], v[160:161], v[180:181] op_sel:[0,1] op_sel_hi:[1,1]
v_pk_mul_f32 v[162:163], v[162:163], v[180:181] op_sel:[0,1] op_sel_hi:[1,1]
v_cvt_pk_bf16_f32 v36, v156, v157
v_cvt_pk_bf16_f32 v37, v158, v159
v_cvt_pk_bf16_f32 v38, v160, v161
v_cvt_pk_bf16_f32 v39, v162, v163
v_accvgpr_read_b32 v148, a80
v_accvgpr_read_b32 v149, a81
v_accvgpr_read_b32 v150, a82
v_accvgpr_read_b32 v151, a83
v_accvgpr_read_b32 v152, a84
v_accvgpr_read_b32 v153, a85
v_accvgpr_read_b32 v154, a86
v_accvgpr_read_b32 v155, a87
v_pk_mul_f32 v[148:149], v[148:149], v[180:181] op_sel:[0,1] op_sel_hi:[1,1]
v_pk_mul_f32 v[150:151], v[150:151], v[180:181] op_sel:[0,1] op_sel_hi:[1,1]
v_pk_mul_f32 v[152:153], v[152:153], v[180:181] op_sel:[0,1] op_sel_hi:[1,1]
v_pk_mul_f32 v[154:155], v[154:155], v[180:181] op_sel:[0,1] op_sel_hi:[1,1]
v_cvt_pk_bf16_f32 v40, v148, v149
v_cvt_pk_bf16_f32 v41, v150, v151
v_cvt_pk_bf16_f32 v42, v152, v153
v_cvt_pk_bf16_f32 v43, v154, v155
v_accvgpr_read_b32 v156, a88
buffer_load_dwordx4 v130, s[20:23], s34 offen offset:2048 lds
v_accvgpr_read_b32 v157, a89
v_accvgpr_read_b32 v158, a90
v_accvgpr_read_b32 v159, a91
v_accvgpr_read_b32 v160, a92
v_accvgpr_read_b32 v161, a93
v_accvgpr_read_b32 v162, a94
v_accvgpr_read_b32 v163, a95
v_pk_mul_f32 v[156:157], v[156:157], v[180:181] op_sel:[0,1] op_sel_hi:[1,1]
v_pk_mul_f32 v[158:159], v[158:159], v[180:181] op_sel:[0,1] op_sel_hi:[1,1]
v_pk_mul_f32 v[160:161], v[160:161], v[180:181] op_sel:[0,1] op_sel_hi:[1,1]
v_pk_mul_f32 v[162:163], v[162:163], v[180:181] op_sel:[0,1] op_sel_hi:[1,1]
v_cvt_pk_bf16_f32 v44, v156, v157
v_cvt_pk_bf16_f32 v45, v158, v159
v_cvt_pk_bf16_f32 v46, v160, v161
v_cvt_pk_bf16_f32 v47, v162, v163
v_accvgpr_read_b32 v148, a96
v_accvgpr_read_b32 v149, a97
v_accvgpr_read_b32 v150, a98
v_accvgpr_read_b32 v151, a99
v_accvgpr_read_b32 v152, a100
v_accvgpr_read_b32 v153, a101
v_accvgpr_read_b32 v154, a102
v_accvgpr_read_b32 v155, a103
buffer_load_dwordx4 v131, s[20:23], s34 offen offset:3072 lds
v_pk_mul_f32 v[148:149], v[148:149], v[180:181] op_sel:[0,1] op_sel_hi:[1,1]
v_pk_mul_f32 v[150:151], v[150:151], v[180:181] op_sel:[0,1] op_sel_hi:[1,1]
v_pk_mul_f32 v[152:153], v[152:153], v[180:181] op_sel:[0,1] op_sel_hi:[1,1]
v_pk_mul_f32 v[154:155], v[154:155], v[180:181] op_sel:[0,1] op_sel_hi:[1,1]
v_cvt_pk_bf16_f32 v48, v148, v149
v_cvt_pk_bf16_f32 v49, v150, v151
v_cvt_pk_bf16_f32 v50, v152, v153
v_cvt_pk_bf16_f32 v51, v154, v155
v_accvgpr_read_b32 v156, a104
v_accvgpr_read_b32 v157, a105
v_accvgpr_read_b32 v158, a106
v_accvgpr_read_b32 v159, a107
v_accvgpr_read_b32 v160, a108
v_accvgpr_read_b32 v161, a109
v_accvgpr_read_b32 v162, a110
v_accvgpr_read_b32 v163, a111
v_pk_mul_f32 v[156:157], v[156:157], v[180:181] op_sel:[0,1] op_sel_hi:[1,1]
v_pk_mul_f32 v[158:159], v[158:159], v[180:181] op_sel:[0,1] op_sel_hi:[1,1]
v_pk_mul_f32 v[160:161], v[160:161], v[180:181] op_sel:[0,1] op_sel_hi:[1,1]
v_pk_mul_f32 v[162:163], v[162:163], v[180:181] op_sel:[0,1] op_sel_hi:[1,1]
v_cvt_pk_bf16_f32 v52, v156, v157
v_cvt_pk_bf16_f32 v53, v158, v159
v_cvt_pk_bf16_f32 v54, v160, v161
s_add_u32 m0, s67, 69632
v_cvt_pk_bf16_f32 v55, v162, v163
buffer_load_dwordx4 v128, s[20:23], s35 offen offset:0 lds
v_accvgpr_read_b32 v148, a112
v_accvgpr_read_b32 v149, a113
v_accvgpr_read_b32 v150, a114
v_accvgpr_read_b32 v151, a115
v_accvgpr_read_b32 v152, a116
v_accvgpr_read_b32 v153, a117
v_accvgpr_read_b32 v154, a118
v_accvgpr_read_b32 v155, a119
v_pk_mul_f32 v[148:149], v[148:149], v[180:181] op_sel:[0,1] op_sel_hi:[1,1]
v_pk_mul_f32 v[150:151], v[150:151], v[180:181] op_sel:[0,1] op_sel_hi:[1,1]
v_pk_mul_f32 v[152:153], v[152:153], v[180:181] op_sel:[0,1] op_sel_hi:[1,1]
v_pk_mul_f32 v[154:155], v[154:155], v[180:181] op_sel:[0,1] op_sel_hi:[1,1]
v_cvt_pk_bf16_f32 v56, v148, v149
v_cvt_pk_bf16_f32 v57, v150, v151
v_cvt_pk_bf16_f32 v58, v152, v153
v_cvt_pk_bf16_f32 v59, v154, v155
v_accvgpr_read_b32 v156, a120
v_accvgpr_read_b32 v157, a121
v_accvgpr_read_b32 v158, a122
v_accvgpr_read_b32 v159, a123
v_accvgpr_read_b32 v160, a124
v_accvgpr_read_b32 v161, a125
buffer_load_dwordx4 v129, s[20:23], s35 offen offset:1024 lds
v_accvgpr_read_b32 v162, a126
v_accvgpr_read_b32 v163, a127
v_pk_mul_f32 v[156:157], v[156:157], v[180:181] op_sel:[0,1] op_sel_hi:[1,1]
v_pk_mul_f32 v[158:159], v[158:159], v[180:181] op_sel:[0,1] op_sel_hi:[1,1]
v_pk_mul_f32 v[160:161], v[160:161], v[180:181] op_sel:[0,1] op_sel_hi:[1,1]
v_pk_mul_f32 v[162:163], v[162:163], v[180:181] op_sel:[0,1] op_sel_hi:[1,1]
v_cvt_pk_bf16_f32 v60, v156, v157
v_cvt_pk_bf16_f32 v61, v158, v159
v_cvt_pk_bf16_f32 v62, v160, v161
v_cvt_pk_bf16_f32 v63, v162, v163
v_accvgpr_read_b32 v148, a128
v_accvgpr_read_b32 v149, a129
v_accvgpr_read_b32 v150, a130
v_accvgpr_read_b32 v151, a131
v_accvgpr_read_b32 v152, a132
v_accvgpr_read_b32 v153, a133
v_accvgpr_read_b32 v154, a134
v_accvgpr_read_b32 v155, a135
v_pk_mul_f32 v[148:149], v[148:149], v[182:183] op_sel_hi:[1,0]
v_pk_mul_f32 v[150:151], v[150:151], v[182:183] op_sel_hi:[1,0]
v_pk_mul_f32 v[152:153], v[152:153], v[182:183] op_sel_hi:[1,0]
v_pk_mul_f32 v[154:155], v[154:155], v[182:183] op_sel_hi:[1,0]
v_cvt_pk_bf16_f32 v64, v148, v149
buffer_load_dwordx4 v130, s[20:23], s35 offen offset:2048 lds
v_cvt_pk_bf16_f32 v65, v150, v151
v_cvt_pk_bf16_f32 v66, v152, v153
v_cvt_pk_bf16_f32 v67, v154, v155
v_accvgpr_read_b32 v156, a136
v_accvgpr_read_b32 v157, a137
v_accvgpr_read_b32 v158, a138
v_accvgpr_read_b32 v159, a139
v_accvgpr_read_b32 v160, a140
v_accvgpr_read_b32 v161, a141
v_accvgpr_read_b32 v162, a142
v_accvgpr_read_b32 v163, a143
v_pk_mul_f32 v[156:157], v[156:157], v[182:183] op_sel_hi:[1,0]
v_pk_mul_f32 v[158:159], v[158:159], v[182:183] op_sel_hi:[1,0]
v_pk_mul_f32 v[160:161], v[160:161], v[182:183] op_sel_hi:[1,0]
v_pk_mul_f32 v[162:163], v[162:163], v[182:183] op_sel_hi:[1,0]
v_cvt_pk_bf16_f32 v68, v156, v157
v_cvt_pk_bf16_f32 v69, v158, v159
v_cvt_pk_bf16_f32 v70, v160, v161
v_cvt_pk_bf16_f32 v71, v162, v163
v_accvgpr_read_b32 v148, a144
v_accvgpr_read_b32 v149, a145
v_accvgpr_read_b32 v150, a146
v_accvgpr_read_b32 v151, a147
buffer_load_dwordx4 v131, s[20:23], s35 offen offset:3072 lds
v_accvgpr_read_b32 v152, a148
v_accvgpr_read_b32 v153, a149
v_accvgpr_read_b32 v154, a150
v_accvgpr_read_b32 v155, a151
v_pk_mul_f32 v[148:149], v[148:149], v[182:183] op_sel_hi:[1,0]
v_pk_mul_f32 v[150:151], v[150:151], v[182:183] op_sel_hi:[1,0]
v_pk_mul_f32 v[152:153], v[152:153], v[182:183] op_sel_hi:[1,0]
v_pk_mul_f32 v[154:155], v[154:155], v[182:183] op_sel_hi:[1,0]
v_cvt_pk_bf16_f32 v72, v148, v149
v_cvt_pk_bf16_f32 v73, v150, v151
v_cvt_pk_bf16_f32 v74, v152, v153
v_cvt_pk_bf16_f32 v75, v154, v155
v_accvgpr_read_b32 v156, a152
v_accvgpr_read_b32 v157, a153
v_accvgpr_read_b32 v158, a154
v_accvgpr_read_b32 v159, a155
v_accvgpr_read_b32 v160, a156
v_accvgpr_read_b32 v161, a157
v_accvgpr_read_b32 v162, a158
v_accvgpr_read_b32 v163, a159
v_pk_mul_f32 v[156:157], v[156:157], v[182:183] op_sel_hi:[1,0]
v_pk_mul_f32 v[158:159], v[158:159], v[182:183] op_sel_hi:[1,0]
v_pk_mul_f32 v[160:161], v[160:161], v[182:183] op_sel_hi:[1,0]
buffer_store_dword v128, v128, s[24:27], s37 offen
v_pk_mul_f32 v[162:163], v[162:163], v[182:183] op_sel_hi:[1,0]
v_cvt_pk_bf16_f32 v76, v156, v157
v_cvt_pk_bf16_f32 v77, v158, v159
v_cvt_pk_bf16_f32 v78, v160, v161
v_cvt_pk_bf16_f32 v79, v162, v163
v_accvgpr_read_b32 v148, a160
v_accvgpr_read_b32 v149, a161
v_accvgpr_read_b32 v150, a162
v_accvgpr_read_b32 v151, a163
v_accvgpr_read_b32 v152, a164
v_accvgpr_read_b32 v153, a165
v_accvgpr_read_b32 v154, a166
v_accvgpr_read_b32 v155, a167
v_pk_mul_f32 v[148:149], v[148:149], v[182:183] op_sel_hi:[1,0]
v_pk_mul_f32 v[150:151], v[150:151], v[182:183] op_sel_hi:[1,0]
v_pk_mul_f32 v[152:153], v[152:153], v[182:183] op_sel_hi:[1,0]
v_pk_mul_f32 v[154:155], v[154:155], v[182:183] op_sel_hi:[1,0]
v_cvt_pk_bf16_f32 v80, v148, v149
v_cvt_pk_bf16_f32 v81, v150, v151
v_cvt_pk_bf16_f32 v82, v152, v153
v_cvt_pk_bf16_f32 v83, v154, v155
v_accvgpr_read_b32 v156, a168
v_accvgpr_read_b32 v157, a169
buffer_store_dword v128, v128, s[24:27], s37 offen
v_accvgpr_read_b32 v158, a170
v_accvgpr_read_b32 v159, a171
v_accvgpr_read_b32 v160, a172
v_accvgpr_read_b32 v161, a173
v_accvgpr_read_b32 v162, a174
v_accvgpr_read_b32 v163, a175
v_pk_mul_f32 v[156:157], v[156:157], v[182:183] op_sel_hi:[1,0]
v_pk_mul_f32 v[158:159], v[158:159], v[182:183] op_sel_hi:[1,0]
v_pk_mul_f32 v[160:161], v[160:161], v[182:183] op_sel_hi:[1,0]
v_pk_mul_f32 v[162:163], v[162:163], v[182:183] op_sel_hi:[1,0]
v_cvt_pk_bf16_f32 v84, v156, v157
v_cvt_pk_bf16_f32 v85, v158, v159
v_cvt_pk_bf16_f32 v86, v160, v161
v_cvt_pk_bf16_f32 v87, v162, v163
v_accvgpr_read_b32 v148, a176
v_accvgpr_read_b32 v149, a177
v_accvgpr_read_b32 v150, a178
v_accvgpr_read_b32 v151, a179
v_accvgpr_read_b32 v152, a180
v_accvgpr_read_b32 v153, a181
v_accvgpr_read_b32 v154, a182
v_accvgpr_read_b32 v155, a183
v_pk_mul_f32 v[148:149], v[148:149], v[182:183] op_sel_hi:[1,0]
buffer_store_dword v128, v128, s[24:27], s37 offen
v_pk_mul_f32 v[150:151], v[150:151], v[182:183] op_sel_hi:[1,0]
v_pk_mul_f32 v[152:153], v[152:153], v[182:183] op_sel_hi:[1,0]
v_pk_mul_f32 v[154:155], v[154:155], v[182:183] op_sel_hi:[1,0]
v_cvt_pk_bf16_f32 v88, v148, v149
v_cvt_pk_bf16_f32 v89, v150, v151
v_cvt_pk_bf16_f32 v90, v152, v153
v_cvt_pk_bf16_f32 v91, v154, v155
v_accvgpr_read_b32 v156, a184
v_accvgpr_read_b32 v157, a185
v_accvgpr_read_b32 v158, a186
v_accvgpr_read_b32 v159, a187
v_accvgpr_read_b32 v160, a188
v_accvgpr_read_b32 v161, a189
v_accvgpr_read_b32 v162, a190
v_accvgpr_read_b32 v163, a191
v_pk_mul_f32 v[156:157], v[156:157], v[182:183] op_sel_hi:[1,0]
v_pk_mul_f32 v[158:159], v[158:159], v[182:183] op_sel_hi:[1,0]
v_pk_mul_f32 v[160:161], v[160:161], v[182:183] op_sel_hi:[1,0]
v_pk_mul_f32 v[162:163], v[162:163], v[182:183] op_sel_hi:[1,0]
v_cvt_pk_bf16_f32 v92, v156, v157
v_cvt_pk_bf16_f32 v93, v158, v159
v_cvt_pk_bf16_f32 v94, v160, v161
v_cvt_pk_bf16_f32 v95, v162, v163
buffer_store_dword v128, v128, s[24:27], s37 offen
v_pk_mul_f32 v[192:193], v[192:193], v[182:183] op_sel:[0,1] op_sel_hi:[1,1]
v_pk_mul_f32 v[194:195], v[194:195], v[182:183] op_sel:[0,1] op_sel_hi:[1,1]
v_pk_mul_f32 v[196:197], v[196:197], v[182:183] op_sel:[0,1] op_sel_hi:[1,1]
v_pk_mul_f32 v[198:199], v[198:199], v[182:183] op_sel:[0,1] op_sel_hi:[1,1]
v_cvt_pk_bf16_f32 v96, v192, v193
v_cvt_pk_bf16_f32 v97, v194, v195
v_cvt_pk_bf16_f32 v98, v196, v197
v_cvt_pk_bf16_f32 v99, v198, v199
v_pk_mul_f32 v[200:201], v[200:201], v[182:183] op_sel:[0,1] op_sel_hi:[1,1]
v_pk_mul_f32 v[202:203], v[202:203], v[182:183] op_sel:[0,1] op_sel_hi:[1,1]
v_pk_mul_f32 v[204:205], v[204:205], v[182:183] op_sel:[0,1] op_sel_hi:[1,1]
v_pk_mul_f32 v[206:207], v[206:207], v[182:183] op_sel:[0,1] op_sel_hi:[1,1]
v_cvt_pk_bf16_f32 v100, v200, v201
v_cvt_pk_bf16_f32 v101, v202, v203
v_cvt_pk_bf16_f32 v102, v204, v205
v_cvt_pk_bf16_f32 v103, v206, v207
v_pk_mul_f32 v[208:209], v[208:209], v[182:183] op_sel:[0,1] op_sel_hi:[1,1]
v_pk_mul_f32 v[210:211], v[210:211], v[182:183] op_sel:[0,1] op_sel_hi:[1,1]
v_pk_mul_f32 v[212:213], v[212:213], v[182:183] op_sel:[0,1] op_sel_hi:[1,1]
v_pk_mul_f32 v[214:215], v[214:215], v[182:183] op_sel:[0,1] op_sel_hi:[1,1]
v_cvt_pk_bf16_f32 v104, v208, v209
v_cvt_pk_bf16_f32 v105, v210, v211
v_cvt_pk_bf16_f32 v106, v212, v213
buffer_store_dword v128, v128, s[24:27], s37 offen
v_cvt_pk_bf16_f32 v107, v214, v215
v_pk_mul_f32 v[216:217], v[216:217], v[182:183] op_sel:[0,1] op_sel_hi:[1,1]
v_pk_mul_f32 v[218:219], v[218:219], v[182:183] op_sel:[0,1] op_sel_hi:[1,1]
v_pk_mul_f32 v[220:221], v[220:221], v[182:183] op_sel:[0,1] op_sel_hi:[1,1]
v_pk_mul_f32 v[222:223], v[222:223], v[182:183] op_sel:[0,1] op_sel_hi:[1,1]
v_cvt_pk_bf16_f32 v108, v216, v217
v_cvt_pk_bf16_f32 v109, v218, v219
v_cvt_pk_bf16_f32 v110, v220, v221
v_cvt_pk_bf16_f32 v111, v222, v223
v_pk_mul_f32 v[224:225], v[224:225], v[182:183] op_sel:[0,1] op_sel_hi:[1,1]
v_pk_mul_f32 v[226:227], v[226:227], v[182:183] op_sel:[0,1] op_sel_hi:[1,1]
v_pk_mul_f32 v[228:229], v[228:229], v[182:183] op_sel:[0,1] op_sel_hi:[1,1]
v_pk_mul_f32 v[230:231], v[230:231], v[182:183] op_sel:[0,1] op_sel_hi:[1,1]
v_cvt_pk_bf16_f32 v112, v224, v225
v_cvt_pk_bf16_f32 v113, v226, v227
v_cvt_pk_bf16_f32 v114, v228, v229
v_cvt_pk_bf16_f32 v115, v230, v231
v_pk_mul_f32 v[232:233], v[232:233], v[182:183] op_sel:[0,1] op_sel_hi:[1,1]
v_pk_mul_f32 v[234:235], v[234:235], v[182:183] op_sel:[0,1] op_sel_hi:[1,1]
v_pk_mul_f32 v[236:237], v[236:237], v[182:183] op_sel:[0,1] op_sel_hi:[1,1]
v_pk_mul_f32 v[238:239], v[238:239], v[182:183] op_sel:[0,1] op_sel_hi:[1,1]
v_cvt_pk_bf16_f32 v116, v232, v233
v_cvt_pk_bf16_f32 v117, v234, v235
v_cvt_pk_bf16_f32 v118, v236, v237
v_cvt_pk_bf16_f32 v119, v238, v239
v_pk_mul_f32 v[240:241], v[240:241], v[182:183] op_sel:[0,1] op_sel_hi:[1,1]
v_pk_mul_f32 v[242:243], v[242:243], v[182:183] op_sel:[0,1] op_sel_hi:[1,1]
v_pk_mul_f32 v[244:245], v[244:245], v[182:183] op_sel:[0,1] op_sel_hi:[1,1]
v_pk_mul_f32 v[246:247], v[246:247], v[182:183] op_sel:[0,1] op_sel_hi:[1,1]
v_cvt_pk_bf16_f32 v120, v240, v241
v_cvt_pk_bf16_f32 v121, v242, v243
v_cvt_pk_bf16_f32 v122, v244, v245
v_cvt_pk_bf16_f32 v123, v246, v247
v_pk_mul_f32 v[248:249], v[248:249], v[182:183] op_sel:[0,1] op_sel_hi:[1,1]
v_pk_mul_f32 v[250:251], v[250:251], v[182:183] op_sel:[0,1] op_sel_hi:[1,1]
v_pk_mul_f32 v[252:253], v[252:253], v[182:183] op_sel:[0,1] op_sel_hi:[1,1]
v_pk_mul_f32 v[254:255], v[254:255], v[182:183] op_sel:[0,1] op_sel_hi:[1,1]
v_cvt_pk_bf16_f32 v124, v248, v249
v_cvt_pk_bf16_f32 v125, v250, v251
v_cvt_pk_bf16_f32 v126, v252, v253
v_cvt_pk_bf16_f32 v127, v254, v255
v_mov_b32 v170, v190
v_mov_b32 v188, v128
v_mov_b32 v189, v129
v_mov_b32 v190, v130
v_mov_b32 v191, v131
v_lshrrev_b32 v136, 5, v170
v_lshlrev_b32 v136, 10, v136
v_bfe_u32 v137, v170, 2, 3
v_lshl_add_u32 v136, v137, 7, v136
v_and_b32 v138, 3, v170
v_lshl_add_u32 v136, v138, 3, v136
v_lshrrev_b32 v137, 1, v137
s_and_b32 s74, s31, 3
s_xor_b32 s74, s74, s28
s_lshr_b32 s66, s31, 2
s_mov_b32 s44, 0x40000000
s_mov_b64 s[38:39], 0
s_xor_b32 s58, s74, 0
v_xor_b32 v138, s58, v137
v_lshl_add_u32 v184, v138, 5, v136
s_xor_b32 s58, s74, 1
v_xor_b32 v138, s58, v137
v_lshl_add_u32 v185, v138, 5, v136
s_xor_b32 s58, s74, 2
v_xor_b32 v138, s58, v137
v_lshl_add_u32 v186, v138, 5, v136
s_xor_b32 s58, s74, 3
v_xor_b32 v138, s58, v137
v_lshl_add_u32 v187, v138, 5, v136
v_lshlrev_b32 v138, 4, v170
s_lshl_b32 s58, s74, 10
v_add_u32 v138, s58, v138
v_xor_b32 v192, 0, v138
v_xor_b32 v193, 1024, v138
v_xor_b32 v194, 2048, v138
v_xor_b32 v195, 3072, v138
v_lshlrev_b32 v138, 3, v170
s_lshl_b32 s58, s74, 9
s_add_u32 s58, s58, 16384
s_lshl_b32 s59, s28, 12
s_sub_u32 s58, s58, s59
v_add_u32 v196, s58, v138
s_lshl_b32 s72, s28, 12
s_mov_b32 s63, 0x40000000
s_load_dwordx2 s[40:41], s[0:1], 96
s_lshl_b32 s58, s29, 4
s_add_u32 s58, s58, s30
s_lshl_b32 s58, s58, 3
s_add_u32 s58, s58, s31
s_lshl_b32 s58, s58, 7
s_cmp_eq_u32 s28, 0
s_cselect_b32 s58, s58, 0x100000
v_mov_b32 v199, 0x100000
v_mov_b32 v138, s58
v_cmp_eq_u32 vcc, 0, v170
s_nop 1
v_cndmask_b32 v199, v199, v138, vcc
s_waitcnt lgkmcnt(0)
s_add_u32 s40, s40, 67108864
s_addc_u32 s41, s41, 0
s_mov_b32 s42, 32768
s_mov_b32 s43, 0x20000
s_add_u32 s61, s62, 229504
s_add_u32 s62, s62, 256
s_xor_b32 s57, s67, 0x10000
s_mov_b32 s46, 0
s_waitcnt vmcnt(21) lgkmcnt(0)
s_barrier
v_lshlrev_b32 v138, 4, v170
v_add_u32 v138, 131072, v138
ds_read_b128 a[0:3], v138 offset:0
ds_read_b128 a[4:7], v138 offset:1024
ds_read_b128 a[8:11], v138 offset:2048
ds_read_b128 a[12:15], v138 offset:3072
ds_read_b128 a[16:19], v138 offset:4096
ds_read_b128 a[20:23], v138 offset:5120
ds_read_b128 a[24:27], v138 offset:6144
ds_read_b128 a[28:31], v138 offset:7168
ds_read_b128 a[32:35], v138 offset:8192
ds_read_b128 a[36:39], v138 offset:9216
ds_read_b128 a[40:43], v138 offset:10240
ds_read_b128 a[44:47], v138 offset:11264
ds_read_b128 a[48:51], v138 offset:12288
ds_read_b128 a[52:55], v138 offset:13312
ds_read_b128 a[56:59], v138 offset:14336
ds_read_b128 a[60:63], v138 offset:15360
s_waitcnt lgkmcnt(0)
ds_read_b64_tr_b16 a[64:65], v184 offset:0
ds_read_b64_tr_b16 a[66:67], v184 offset:2048
ds_read_b64_tr_b16 a[68:69], v185 offset:0
ds_read_b64_tr_b16 a[70:71], v185 offset:2048
ds_read_b64_tr_b16 a[72:73], v186 offset:0
ds_read_b64_tr_b16 a[74:75], v186 offset:2048
ds_read_b64_tr_b16 a[76:77], v187 offset:0
ds_read_b64_tr_b16 a[78:79], v187 offset:2048
ds_read_b64_tr_b16 a[80:81], v184 offset:4096
ds_read_b64_tr_b16 a[82:83], v184 offset:6144
L_oloop:
v_cvt_pk_bf16_f32 v164, v128, v129
v_cvt_pk_bf16_f32 v165, v130, v131
s_waitcnt lgkmcnt(6)
v_mfma_f32_16x16x32_bf16 v[128:131], a[64:67], v[0:3], 0
s_add_u32 s56, s61, 28672
v_cvt_pk_bf16_f32 v166, v132, v133
v_cvt_pk_bf16_f32 v167, v134, v135
v_mfma_f32_16x16x32_bf16 v[132:135], a[64:67], v[32:35], 0
s_add_u32 m0, s57, 32768
v_cvt_pk_bf16_f32 v180, v160, v161
v_cvt_pk_bf16_f32 v181, v162, v163
v_mfma_f32_16x16x32_bf16 v[160:163], a[64:67], a[0:3], 0
v_cvt_pk_bf16_f32 v168, v136, v137
v_cvt_pk_bf16_f32 v169, v138, v139
v_mfma_f32_16x16x32_bf16 v[136:139], a[68:71], v[0:3], 0
v_cvt_pk_bf16_f32 v170, v140, v141
v_cvt_pk_bf16_f32 v171, v142, v143
v_mfma_f32_16x16x32_bf16 v[140:143], a[68:71], v[32:35], 0
s_waitcnt lgkmcnt(1)
ds_read_b64_tr_b16 a[84:85], v185 offset:4096
v_cvt_pk_bf16_f32 v172, v144, v145
v_cvt_pk_bf16_f32 v173, v146, v147
v_mfma_f32_16x16x32_bf16 v[144:147], a[72:75], v[0:3], 0
ds_read_b64_tr_b16 a[86:87], v185 offset:6144
v_cvt_pk_bf16_f32 v174, v148, v149
v_cvt_pk_bf16_f32 v175, v150, v151
v_mfma_f32_16x16x32_bf16 v[148:151], a[72:75], v[32:35], 0
ds_read_b64_tr_b16 a[88:89], v186 offset:4096
buffer_load_dwordx4 v188, s[20:23], s61 offen offset:0 lds
v_cvt_pk_bf16_f32 v176, v152, v153
v_cvt_pk_bf16_f32 v177, v154, v155
v_mfma_f32_16x16x32_bf16 v[152:155], a[76:79], v[0:3], 0
ds_read_b64_tr_b16 a[90:91], v186 offset:6144
v_cvt_pk_bf16_f32 v178, v156, v157
v_cvt_pk_bf16_f32 v179, v158, v159
v_mfma_f32_16x16x32_bf16 v[156:159], a[76:79], v[32:35], 0
s_waitcnt lgkmcnt(4)
ds_read_b64_tr_b16 a[92:93], v187 offset:4096
buffer_load_dwordx4 v189, s[20:23], s61 offen offset:1024 lds
v_mfma_f32_16x16x32_bf16 v[128:131], a[80:83], v[4:7], v[128:131]
ds_read_b64_tr_b16 a[94:95], v187 offset:6144
v_cndmask_b32 v213, v213, v209, s[38:39]
v_mfma_f32_16x16x32_bf16 v[132:135], a[80:83], v[36:39], v[132:135]
ds_read_b64_tr_b16 a[64:65], v184 offset:8192
v_cndmask_b32 v214, v214, v210, s[38:39]
v_mfma_f32_16x16x32_bf16 v[160:163], a[80:83], a[4:7], v[160:163]
s_waitcnt lgkmcnt(5)
ds_read_b64_tr_b16 a[66:67], v184 offset:10240
v_cndmask_b32 v215, v215, v211, s[38:39]
v_mfma_f32_16x16x32_bf16 v[136:139], a[84:87], v[4:7], v[136:139]
ds_read_b64_tr_b16 a[68:69], v185 offset:8192
buffer_store_dwordx4 v[164:167], v192, s[24:27], s44 offen sc1
v_mfma_f32_16x16x32_bf16 v[140:143], a[84:87], v[36:39], v[140:143]
s_waitcnt lgkmcnt(5)
ds_read_b64_tr_b16 a[70:71], v185 offset:10240
v_cndmask_b32 v216, v216, v212, s[38:39]
v_mfma_f32_16x16x32_bf16 v[144:147], a[88:91], v[4:7], v[144:147]
ds_read_b64_tr_b16 a[72:73], v186 offset:8192
v_cndmask_b32 v209, v209, v205, s[38:39]
v_mfma_f32_16x16x32_bf16 v[148:151], a[88:91], v[36:39], v[148:151]
s_waitcnt lgkmcnt(5)
ds_read_b64_tr_b16 a[74:75], v186 offset:10240
buffer_load_dwordx4 v190, s[20:23], s61 offen offset:2048 lds
v_mfma_f32_16x16x32_bf16 v[152:155], a[92:95], v[4:7], v[152:155]
ds_read_b64_tr_b16 a[76:77], v187 offset:8192
v_cndmask_b32 v210, v210, v206, s[38:39]
v_mfma_f32_16x16x32_bf16 v[156:159], a[92:95], v[36:39], v[156:159]
s_waitcnt lgkmcnt(5)
ds_read_b64_tr_b16 a[78:79], v187 offset:10240
v_cndmask_b32 v211, v211, v207, s[38:39]
v_mfma_f32_16x16x32_bf16 v[128:131], a[64:67], v[8:11], v[128:131]
ds_read_b64_tr_b16 a[80:81], v184 offset:12288
v_cndmask_b32 v212, v212, v208, s[38:39]
v_mfma_f32_16x16x32_bf16 v[132:135], a[64:67], v[40:43], v[132:135]
ds_read_b64_tr_b16 a[82:83], v184 offset:14336
v_cndmask_b32 v205, v205, v201, s[38:39]
v_mfma_f32_16x16x32_bf16 v[160:163], a[64:67], a[8:11], v[160:163]
s_waitcnt lgkmcnt(5)
ds_read_b64_tr_b16 a[84:85], v185 offset:12288
v_cndmask_b32 v206, v206, v202, s[38:39]
v_mfma_f32_16x16x32_bf16 v[136:139], a[68:71], v[8:11], v[136:139]
ds_read_b64_tr_b16 a[86:87], v185 offset:14336
buffer_load_dwordx4 v191, s[20:23], s61 offen offset:3072 lds
v_mfma_f32_16x16x32_bf16 v[140:143], a[68:71], v[40:43], v[140:143]
s_waitcnt lgkmcnt(5)
ds_read_b64_tr_b16 a[88:89], v186 offset:12288
v_cndmask_b32 v207, v207, v203, s[38:39]
v_mfma_f32_16x16x32_bf16 v[144:147], a[72:75], v[8:11], v[144:147]
ds_read_b64_tr_b16 a[90:91], v186 offset:14336
v_cndmask_b32 v208, v208, v204, s[38:39]
v_mfma_f32_16x16x32_bf16 v[148:151], a[72:75], v[40:43], v[148:151]
s_waitcnt lgkmcnt(5)
ds_read_b64_tr_b16 a[92:93], v187 offset:12288
v_cndmask_b32 v201, v201, v164, s[38:39]
v_mfma_f32_16x16x32_bf16 v[152:155], a[76:79], v[8:11], v[152:155]
ds_read_b64_tr_b16 a[94:95], v187 offset:14336
v_cndmask_b32 v202, v202, v165, s[38:39]
v_mfma_f32_16x16x32_bf16 v[156:159], a[76:79], v[40:43], v[156:159]
s_waitcnt lgkmcnt(5)
ds_read_b64_tr_b16 a[64:65], v184 offset:16384
v_cndmask_b32 v203, v203, v166, s[38:39]
v_mfma_f32_16x16x32_bf16 v[128:131], a[80:83], v[12:15], v[128:131]
s_add_u32 m0, s57, 36864
ds_read_b64_tr_b16 a[66:67], v184 offset:18432
v_cndmask_b32 v204, v204, v167, s[38:39]
v_mfma_f32_16x16x32_bf16 v[132:135], a[80:83], v[44:47], v[132:135]
ds_read_b64_tr_b16 a[68:69], v185 offset:16384
buffer_load_dwordx4 v188, s[20:23], s56 offen offset:0 lds
v_mfma_f32_16x16x32_bf16 v[160:163], a[80:83], a[12:15], v[160:163]
s_waitcnt lgkmcnt(5)
ds_read_b64_tr_b16 a[70:71], v185 offset:18432
v_mfma_f32_16x16x32_bf16 v[136:139], a[84:87], v[12:15], v[136:139]
ds_read_b64_tr_b16 a[72:73], v186 offset:16384
v_mfma_f32_16x16x32_bf16 v[140:143], a[84:87], v[44:47], v[140:143]
ds_read_b64_tr_b16 a[74:75], v186 offset:18432
v_mfma_f32_16x16x32_bf16 v[144:147], a[88:91], v[12:15], v[144:147]
ds_read_b64_tr_b16 a[76:77], v187 offset:16384
v_mfma_f32_16x16x32_bf16 v[148:151], a[88:91], v[44:47], v[148:151]
s_waitcnt lgkmcnt(5)
ds_read_b64_tr_b16 a[78:79], v187 offset:18432
v_mfma_f32_16x16x32_bf16 v[152:155], a[92:95], v[12:15], v[152:155]
ds_read_b64_tr_b16 a[80:81], v184 offset:20480
buffer_load_dwordx4 v189, s[20:23], s56 offen offset:1024 lds
v_mfma_f32_16x16x32_bf16 v[156:159], a[92:95], v[44:47], v[156:159]
ds_read_b64_tr_b16 a[82:83], v184 offset:22528
v_mfma_f32_16x16x32_bf16 v[128:131], a[64:67], v[16:19], v[128:131]
buffer_store_dwordx4 v[168:171], v193, s[24:27], s63 offen sc1
ds_read_b64_tr_b16 a[84:85], v185 offset:20480
v_mfma_f32_16x16x32_bf16 v[132:135], a[64:67], v[48:51], v[132:135]
ds_read_b64_tr_b16 a[86:87], v185 offset:22528
v_mfma_f32_16x16x32_bf16 v[160:163], a[64:67], a[16:19], v[160:163]
s_waitcnt lgkmcnt(5)
ds_read_b64_tr_b16 a[88:89], v186 offset:20480
v_mfma_f32_16x16x32_bf16 v[136:139], a[68:71], v[16:19], v[136:139]
ds_read_b64_tr_b16 a[90:91], v186 offset:22528
v_mfma_f32_16x16x32_bf16 v[140:143], a[68:71], v[48:51], v[140:143]
ds_read_b64_tr_b16 a[92:93], v187 offset:20480
v_mfma_f32_16x16x32_bf16 v[144:147], a[72:75], v[16:19], v[144:147]
ds_read_b64_tr_b16 a[94:95], v187 offset:22528
buffer_load_dwordx4 v190, s[20:23], s56 offen offset:2048 lds
v_mfma_f32_16x16x32_bf16 v[148:151], a[72:75], v[48:51], v[148:151]
s_waitcnt lgkmcnt(5)
ds_read_b64_tr_b16 a[64:65], v184 offset:24576
v_mfma_f32_16x16x32_bf16 v[152:155], a[76:79], v[16:19], v[152:155]
ds_read_b64_tr_b16 a[66:67], v184 offset:26624
v_mfma_f32_16x16x32_bf16 v[156:159], a[76:79], v[48:51], v[156:159]
ds_read_b64_tr_b16 a[68:69], v185 offset:24576
v_mfma_f32_16x16x32_bf16 v[128:131], a[80:83], v[20:23], v[128:131]
ds_read_b64_tr_b16 a[70:71], v185 offset:26624
v_mfma_f32_16x16x32_bf16 v[132:135], a[80:83], v[52:55], v[132:135]
ds_read_b64_tr_b16 a[72:73], v186 offset:24576
v_mfma_f32_16x16x32_bf16 v[160:163], a[80:83], a[20:23], v[160:163]
s_waitcnt lgkmcnt(5)
ds_read_b64_tr_b16 a[74:75], v186 offset:26624
buffer_load_dwordx4 v191, s[20:23], s56 offen offset:3072 lds
v_mfma_f32_16x16x32_bf16 v[136:139], a[84:87], v[20:23], v[136:139]
s_add_u32 s61, s61, 128
ds_read_b64_tr_b16 a[76:77], v187 offset:24576
v_mfma_f32_16x16x32_bf16 v[140:143], a[84:87], v[52:55], v[140:143]
s_cmp_ge_u32 s46, 5
ds_read_b64_tr_b16 a[78:79], v187 offset:26624
v_mfma_f32_16x16x32_bf16 v[144:147], a[88:91], v[20:23], v[144:147]
s_cselect_b32 s61, 0x40000000, s61
ds_read_b64_tr_b16 a[80:81], v184 offset:28672
v_mfma_f32_16x16x32_bf16 v[148:151], a[88:91], v[52:55], v[148:151]
ds_read_b64_tr_b16 a[82:83], v184 offset:30720
v_mfma_f32_16x16x32_bf16 v[152:155], a[92:95], v[20:23], v[152:155]
ds_read_b64_tr_b16 a[84:85], v185 offset:28672
v_mfma_f32_16x16x32_bf16 v[156:159], a[92:95], v[52:55], v[156:159]
s_waitcnt lgkmcnt(5)
ds_read_b64_tr_b16 a[86:87], v185 offset:30720
v_mfma_f32_16x16x32_bf16 v[128:131], a[64:67], v[24:27], v[128:131]
ds_read_b64_tr_b16 a[88:89], v186 offset:28672
v_mfma_f32_16x16x32_bf16 v[132:135], a[64:67], v[56:59], v[132:135]
ds_read_b64_tr_b16 a[90:91], v186 offset:30720
v_mfma_f32_16x16x32_bf16 v[160:163], a[64:67], a[24:27], v[160:163]
ds_read_b64_tr_b16 a[92:93], v187 offset:28672
v_mfma_f32_16x16x32_bf16 v[136:139], a[68:71], v[24:27], v[136:139]
ds_read_b64_tr_b16 a[94:95], v187 offset:30720
v_mfma_f32_16x16x32_bf16 v[140:143], a[68:71], v[56:59], v[140:143]
v_mfma_f32_16x16x32_bf16 v[144:147], a[72:75], v[24:27], v[144:147]
v_mfma_f32_16x16x32_bf16 v[148:151], a[72:75], v[56:59], v[148:151]
s_waitcnt lgkmcnt(3)
v_mfma_f32_16x16x32_bf16 v[152:155], a[76:79], v[24:27], v[152:155]
v_mfma_f32_16x16x32_bf16 v[156:159], a[76:79], v[56:59], v[156:159]
s_waitcnt lgkmcnt(0)
s_waitcnt vmcnt(22)
s_barrier
v_mfma_f32_16x16x32_bf16 v[128:131], a[80:83], v[28:31], v[128:131]
ds_read_b64_tr_b16 a[64:65], v184 offset:32768
v_mfma_f32_16x16x32_bf16 v[132:135], a[80:83], v[60:63], v[132:135]
ds_read_b64_tr_b16 a[66:67], v184 offset:34816
v_mfma_f32_16x16x32_bf16 v[160:163], a[80:83], a[28:31], v[160:163]
ds_read_b64_tr_b16 a[68:69], v185 offset:32768
v_mfma_f32_16x16x32_bf16 v[136:139], a[84:87], v[28:31], v[136:139]
ds_read_b64_tr_b16 a[70:71], v185 offset:34816
v_mfma_f32_16x16x32_bf16 v[140:143], a[84:87], v[60:63], v[140:143]
ds_read_b64_tr_b16 a[72:73], v186 offset:32768
v_mfma_f32_16x16x32_bf16 v[144:147], a[88:91], v[28:31], v[144:147]
ds_read_b64_tr_b16 a[74:75], v186 offset:34816
v_mfma_f32_16x16x32_bf16 v[148:151], a[88:91], v[60:63], v[148:151]
ds_read_b64_tr_b16 a[76:77], v187 offset:32768
v_mfma_f32_16x16x32_bf16 v[152:155], a[92:95], v[28:31], v[152:155]
ds_read_b64_tr_b16 a[78:79], v187 offset:34816
v_mfma_f32_16x16x32_bf16 v[156:159], a[92:95], v[60:63], v[156:159]
ds_read_b64_tr_b16 a[80:81], v184 offset:36864
ds_read_b64_tr_b16 a[82:83], v184 offset:38912
ds_read_b64_tr_b16 a[84:85], v185 offset:36864
s_waitcnt lgkmcnt(8)
v_mfma_f32_16x16x32_bf16 v[128:131], a[64:67], v[64:67], v[128:131]
s_add_u32 s56, s62, 28672
ds_read_b64_tr_b16 a[86:87], v185 offset:38912
v_mfma_f32_16x16x32_bf16 v[132:135], a[64:67], v[96:99], v[132:135]
s_add_u32 m0, s67, 0
ds_read_b64_tr_b16 a[88:89], v186 offset:36864
v_mfma_f32_16x16x32_bf16 v[160:163], a[64:67], a[32:35], v[160:163]
s_waitcnt lgkmcnt(7)
ds_read_b64_tr_b16 a[90:91], v186 offset:38912
buffer_load_dwordx4 v188, s[20:23], s62 offen offset:0 lds
v_mfma_f32_16x16x32_bf16 v[136:139], a[68:71], v[64:67], v[136:139]
ds_read_b64_tr_b16 a[92:93], v187 offset:36864
v_mfma_f32_16x16x32_bf16 v[140:143], a[68:71], v[96:99], v[140:143]
ds_read_b64_tr_b16 a[94:95], v187 offset:38912
v_mfma_f32_16x16x32_bf16 v[144:147], a[72:75], v[64:67], v[144:147]
buffer_store_dwordx4 v[172:175], v194, s[24:27], s63 offen sc1
ds_read_b64_tr_b16 a[64:65], v184 offset:40960
v_mfma_f32_16x16x32_bf16 v[148:151], a[72:75], v[96:99], v[148:151]
s_waitcnt lgkmcnt(5)
ds_read_b64_tr_b16 a[66:67], v184 offset:43008
v_mfma_f32_16x16x32_bf16 v[152:155], a[76:79], v[64:67], v[152:155]
ds_read_b64_tr_b16 a[68:69], v185 offset:40960
v_mfma_f32_16x16x32_bf16 v[156:159], a[76:79], v[96:99], v[156:159]
buffer_load_dwordx4 v189, s[20:23], s62 offen offset:1024 lds
ds_read_b64_tr_b16 a[70:71], v185 offset:43008
v_mfma_f32_16x16x32_bf16 v[128:131], a[80:83], v[68:71], v[128:131]
ds_read_b64_tr_b16 a[72:73], v186 offset:40960
v_mfma_f32_16x16x32_bf16 v[132:135], a[80:83], v[100:103], v[132:135]
ds_read_b64_tr_b16 a[74:75], v186 offset:43008
v_mfma_f32_16x16x32_bf16 v[160:163], a[80:83], a[36:39], v[160:163]
ds_read_b64_tr_b16 a[76:77], v187 offset:40960
v_mfma_f32_16x16x32_bf16 v[136:139], a[84:87], v[68:71], v[136:139]
ds_read_b64_tr_b16 a[78:79], v187 offset:43008
v_mfma_f32_16x16x32_bf16 v[140:143], a[84:87], v[100:103], v[140:143]
s_waitcnt lgkmcnt(5)
ds_read_b64_tr_b16 a[80:81], v184 offset:45056
v_mfma_f32_16x16x32_bf16 v[144:147], a[88:91], v[68:71], v[144:147]
ds_read_b64_tr_b16 a[82:83], v184 offset:47104
v_mfma_f32_16x16x32_bf16 v[148:151], a[88:91], v[100:103], v[148:151]
buffer_load_dwordx4 v190, s[20:23], s62 offen offset:2048 lds
ds_read_b64_tr_b16 a[84:85], v185 offset:45056
v_mfma_f32_16x16x32_bf16 v[152:155], a[92:95], v[68:71], v[152:155]
ds_read_b64_tr_b16 a[86:87], v185 offset:47104
v_mfma_f32_16x16x32_bf16 v[156:159], a[92:95], v[100:103], v[156:159]
ds_read_b64_tr_b16 a[88:89], v186 offset:45056
v_mfma_f32_16x16x32_bf16 v[128:131], a[64:67], v[72:75], v[128:131]
ds_read_b64_tr_b16 a[90:91], v186 offset:47104
v_mfma_f32_16x16x32_bf16 v[132:135], a[64:67], v[104:107], v[132:135]
ds_read_b64_tr_b16 a[92:93], v187 offset:45056
v_mfma_f32_16x16x32_bf16 v[160:163], a[64:67], a[40:43], v[160:163]
s_waitcnt lgkmcnt(5)
ds_read_b64_tr_b16 a[94:95], v187 offset:47104
v_mfma_f32_16x16x32_bf16 v[136:139], a[68:71], v[72:75], v[136:139]
buffer_load_dwordx4 v191, s[20:23], s62 offen offset:3072 lds
ds_read_b64_tr_b16 a[64:65], v184 offset:49152
v_mfma_f32_16x16x32_bf16 v[140:143], a[68:71], v[104:107], v[140:143]
ds_read_b64_tr_b16 a[66:67], v184 offset:51200
v_mfma_f32_16x16x32_bf16 v[144:147], a[72:75], v[72:75], v[144:147]
ds_read_b64_tr_b16 a[68:69], v185 offset:49152
v_mfma_f32_16x16x32_bf16 v[148:151], a[72:75], v[104:107], v[148:151]
ds_read_b64_tr_b16 a[70:71], v185 offset:51200
v_mfma_f32_16x16x32_bf16 v[152:155], a[76:79], v[72:75], v[152:155]
ds_read_b64_tr_b16 a[72:73], v186 offset:49152
v_mfma_f32_16x16x32_bf16 v[156:159], a[76:79], v[104:107], v[156:159]
buffer_store_dwordx4 v[176:179], v195, s[24:27], s63 offen sc1
ds_read_b64_tr_b16 a[74:75], v186 offset:51200
v_mfma_f32_16x16x32_bf16 v[128:131], a[80:83], v[76:79], v[128:131]
s_add_u32 m0, s67, 4096
ds_read_b64_tr_b16 a[76:77], v187 offset:49152
v_mfma_f32_16x16x32_bf16 v[132:135], a[80:83], v[108:111], v[132:135]
buffer_load_dwordx4 v188, s[20:23], s56 offen offset:0 lds
ds_read_b64_tr_b16 a[78:79], v187 offset:51200
v_mfma_f32_16x16x32_bf16 v[160:163], a[80:83], a[44:47], v[160:163]
s_waitcnt lgkmcnt(5)
ds_read_b64_tr_b16 a[80:81], v184 offset:53248
v_mfma_f32_16x16x32_bf16 v[136:139], a[84:87], v[76:79], v[136:139]
ds_read_b64_tr_b16 a[82:83], v184 offset:55296
v_mfma_f32_16x16x32_bf16 v[140:143], a[84:87], v[108:111], v[140:143]
ds_read_b64_tr_b16 a[84:85], v185 offset:53248
v_mfma_f32_16x16x32_bf16 v[144:147], a[88:91], v[76:79], v[144:147]
ds_read_b64_tr_b16 a[86:87], v185 offset:55296
v_mfma_f32_16x16x32_bf16 v[148:151], a[88:91], v[108:111], v[148:151]
ds_read_b64_tr_b16 a[88:89], v186 offset:53248
v_mfma_f32_16x16x32_bf16 v[152:155], a[92:95], v[76:79], v[152:155]
buffer_load_dwordx4 v189, s[20:23], s56 offen offset:1024 lds
ds_read_b64_tr_b16 a[90:91], v186 offset:55296
v_mfma_f32_16x16x32_bf16 v[156:159], a[92:95], v[108:111], v[156:159]
ds_read_b64_tr_b16 a[92:93], v187 offset:53248
v_mfma_f32_16x16x32_bf16 v[128:131], a[64:67], v[80:83], v[128:131]
ds_read_b64_tr_b16 a[94:95], v187 offset:55296
v_mfma_f32_16x16x32_bf16 v[132:135], a[64:67], v[112:115], v[132:135]
v_mfma_f32_16x16x32_bf16 v[160:163], a[64:67], a[48:51], v[160:163]
s_waitcnt lgkmcnt(4)
ds_read_b64_tr_b16 a[64:65], v184 offset:57344
v_mfma_f32_16x16x32_bf16 v[136:139], a[68:71], v[80:83], v[136:139]
ds_read_b64_tr_b16 a[66:67], v184 offset:59392
v_mfma_f32_16x16x32_bf16 v[140:143], a[68:71], v[112:115], v[140:143]
ds_read_b64_tr_b16 a[68:69], v185 offset:57344
v_mfma_f32_16x16x32_bf16 v[144:147], a[72:75], v[80:83], v[144:147]
buffer_load_dwordx4 v190, s[20:23], s56 offen offset:2048 lds
ds_read_b64_tr_b16 a[70:71], v185 offset:59392
v_mfma_f32_16x16x32_bf16 v[148:151], a[72:75], v[112:115], v[148:151]
ds_read_b64_tr_b16 a[72:73], v186 offset:57344
v_mfma_f32_16x16x32_bf16 v[152:155], a[76:79], v[80:83], v[152:155]
ds_read_b64_tr_b16 a[74:75], v186 offset:59392
v_mfma_f32_16x16x32_bf16 v[156:159], a[76:79], v[112:115], v[156:159]
ds_read_b64_tr_b16 a[76:77], v187 offset:57344
v_mfma_f32_16x16x32_bf16 v[128:131], a[80:83], v[84:87], v[128:131]
ds_read_b64_tr_b16 a[78:79], v187 offset:59392
v_mfma_f32_16x16x32_bf16 v[132:135], a[80:83], v[116:119], v[132:135]
v_mfma_f32_16x16x32_bf16 v[160:163], a[80:83], a[52:55], v[160:163]
buffer_store_dwordx2 v[180:181], v196, s[24:27], s63 offen sc1
ds_read_b64_tr_b16 a[80:81], v184 offset:61440
v_mfma_f32_16x16x32_bf16 v[136:139], a[84:87], v[84:87], v[136:139]
s_mov_b32 s63, s72
buffer_load_dwordx4 v191, s[20:23], s56 offen offset:3072 lds
ds_read_b64_tr_b16 a[82:83], v184 offset:63488
v_mfma_f32_16x16x32_bf16 v[140:143], a[84:87], v[116:119], v[140:143]
s_waitcnt lgkmcnt(4)
s_add_u32 s72, s72, 18432
ds_read_b64_tr_b16 a[84:85], v185 offset:61440
v_mfma_f32_16x16x32_bf16 v[144:147], a[88:91], v[84:87], v[144:147]
s_and_b32 s58, s46, 1
ds_read_b64_tr_b16 a[86:87], v185 offset:63488
v_mfma_f32_16x16x32_bf16 v[148:151], a[88:91], v[116:119], v[148:151]
s_cmp_eq_u32 s58, s66
ds_read_b64_tr_b16 a[88:89], v186 offset:61440
v_mfma_f32_16x16x32_bf16 v[152:155], a[92:95], v[84:87], v[152:155]
s_cselect_b32 s44, 0x40000000, s63
ds_read_b64_tr_b16 a[90:91], v186 offset:63488
v_mfma_f32_16x16x32_bf16 v[156:159], a[92:95], v[116:119], v[156:159]
s_cselect_b64 s[38:39], -1, 0
ds_read_b64_tr_b16 a[92:93], v187 offset:61440
v_mfma_f32_16x16x32_bf16 v[128:131], a[64:67], v[88:91], v[128:131]
s_add_u32 s62, s62, 128
ds_read_b64_tr_b16 a[94:95], v187 offset:63488
v_mfma_f32_16x16x32_bf16 v[132:135], a[64:67], v[120:123], v[132:135]
s_cmp_ge_u32 s46, 4
v_xor_b32 v184, 0x10000, v184
v_xor_b32 v185, 0x10000, v185
v_mfma_f32_16x16x32_bf16 v[160:163], a[64:67], a[56:59], v[160:163]
s_cselect_b32 s62, 0x40000000, s62
v_xor_b32 v186, 0x10000, v186
v_xor_b32 v187, 0x10000, v187
v_mfma_f32_16x16x32_bf16 v[136:139], a[68:71], v[88:91], v[136:139]
s_max_u32 s64, s46, 1
v_mfma_f32_16x16x32_bf16 v[140:143], a[68:71], v[120:123], v[140:143]
s_sub_u32 s64, s64, 1
v_mfma_f32_16x16x32_bf16 v[144:147], a[72:75], v[88:91], v[144:147]
s_add_u32 s64, s64, s75
v_mfma_f32_16x16x32_bf16 v[148:151], a[72:75], v[120:123], v[148:151]
s_waitcnt lgkmcnt(0)
v_mov_b32 v200, s64
v_mfma_f32_16x16x32_bf16 v[152:155], a[76:79], v[88:91], v[152:155]
s_waitcnt lgkmcnt(0)
s_waitcnt vmcnt(22)
s_barrier
v_mfma_f32_16x16x32_bf16 v[156:159], a[76:79], v[120:123], v[156:159]
s_xor_b32 s67, s67, 0x10000
buffer_store_dword v200, v199, s[40:43], 0 offen sc1
ds_read_b64_tr_b16 a[64:65], v184 offset:0
v_mfma_f32_16x16x32_bf16 v[128:131], a[80:83], v[92:95], v[128:131]
s_xor_b32 s57, s57, 0x10000
ds_read_b64_tr_b16 a[66:67], v184 offset:2048
v_mfma_f32_16x16x32_bf16 v[132:135], a[80:83], v[124:127], v[132:135]
ds_read_b64_tr_b16 a[68:69], v185 offset:0
v_mfma_f32_16x16x32_bf16 v[160:163], a[80:83], a[60:63], v[160:163]
ds_read_b64_tr_b16 a[70:71], v185 offset:2048
v_mfma_f32_16x16x32_bf16 v[136:139], a[84:87], v[92:95], v[136:139]
ds_read_b64_tr_b16 a[72:73], v186 offset:0
v_mfma_f32_16x16x32_bf16 v[140:143], a[84:87], v[124:127], v[140:143]
ds_read_b64_tr_b16 a[74:75], v186 offset:2048
v_mfma_f32_16x16x32_bf16 v[144:147], a[88:91], v[92:95], v[144:147]
ds_read_b64_tr_b16 a[76:77], v187 offset:0
v_mfma_f32_16x16x32_bf16 v[148:151], a[88:91], v[124:127], v[148:151]
ds_read_b64_tr_b16 a[78:79], v187 offset:2048
v_mfma_f32_16x16x32_bf16 v[152:155], a[92:95], v[92:95], v[152:155]
ds_read_b64_tr_b16 a[80:81], v184 offset:4096
v_mfma_f32_16x16x32_bf16 v[156:159], a[92:95], v[124:127], v[156:159]
ds_read_b64_tr_b16 a[82:83], v184 offset:6144
s_add_u32 s46, s46, 1
s_cmp_lt_u32 s46, 7
s_cbranch_scc1 L_oloop
L_oloop_done:
s_nop 7
v_cvt_pk_bf16_f32 v164, v128, v129
v_cvt_pk_bf16_f32 v165, v130, v131
v_cvt_pk_bf16_f32 v166, v132, v133
v_cvt_pk_bf16_f32 v167, v134, v135
v_cvt_pk_bf16_f32 v168, v136, v137
v_cvt_pk_bf16_f32 v169, v138, v139
v_cvt_pk_bf16_f32 v170, v140, v141
v_cvt_pk_bf16_f32 v171, v142, v143
v_cvt_pk_bf16_f32 v172, v144, v145
v_cvt_pk_bf16_f32 v173, v146, v147
v_cvt_pk_bf16_f32 v174, v148, v149
v_cvt_pk_bf16_f32 v175, v150, v151
v_cvt_pk_bf16_f32 v176, v152, v153
v_cvt_pk_bf16_f32 v177, v154, v155
v_cvt_pk_bf16_f32 v178, v156, v157
v_cvt_pk_bf16_f32 v179, v158, v159
v_cvt_pk_bf16_f32 v180, v160, v161
v_cvt_pk_bf16_f32 v181, v162, v163
s_nop 1
s_load_dwordx2 s[32:33], s[0:1], 80
s_load_dwordx2 s[36:37], s[0:1], 96
v_mbcnt_lo_u32_b32 v2, -1, 0
v_mbcnt_hi_u32_b32 v2, -1, v2
s_lshl_b32 s38, s29, 4
s_add_u32 s38, s38, s30
s_lshl_b32 s39, s31, 2
s_add_u32 s39, s39, s28
s_lshl_b32 s50, s38, 10
v_and_b32 v13, 7, v2
v_lshlrev_b32 v13, 7, v13
v_add_u32 v13, s50, v13
buffer_load_dword v15, v13, s[40:43], 0 offen sc1
buffer_store_dwordx4 v[164:167], v192, s[24:27], s44 offen sc1
buffer_store_dwordx4 v[168:171], v193, s[24:27], s63 offen sc1
buffer_store_dwordx4 v[172:175], v194, s[24:27], s63 offen sc1
buffer_store_dwordx4 v[176:179], v195, s[24:27], s63 offen sc1
v_mov_b32 v213, v209
v_mov_b32 v214, v210
v_mov_b32 v215, v211
v_mov_b32 v216, v212
v_mov_b32 v209, v205
v_mov_b32 v210, v206
v_mov_b32 v211, v207
v_mov_b32 v212, v208
v_mov_b32 v205, v201
v_mov_b32 v206, v202
v_mov_b32 v207, v203
v_mov_b32 v208, v204
v_mov_b32 v201, v164
v_mov_b32 v202, v165
v_mov_b32 v203, v166
v_mov_b32 v204, v167
buffer_store_dwordx2 v[180:181], v196, s[24:27], s63 offen sc1
v_lshlrev_b32 v3, 4, v2
s_waitcnt lgkmcnt(0)
s_mul_i32 s48, s38, 1032192
s_add_u32 s44, s36, s48
s_addc_u32 s45, s37, 0
s_mov_b32 s46, 1032192
s_mov_b32 s47, 0x20000
s_waitcnt vmcnt(0)
v_subrev_u32 v15, s75, v15
v_subrev_u32 v15, 4, v15
v_cmp_ge_u32 vcc, 3, v15
s_nop 1
s_and_b32 s60, vcc_lo, 0xff
s_cmp_eq_u32 s60, 0xff
s_cbranch_scc1 L_tr_waitA
s_cmp_eq_u32 s28, 0
s_cbranch_scc0 L_tr_waitA
s_mov_b32 s61, 0
L_tr_pollA:
buffer_load_dword v14, v13, s[40:43], 0 offen sc1
s_waitcnt vmcnt(0)
v_subrev_u32 v14, s75, v14
v_subrev_u32 v14, 4, v14
v_cmp_ge_u32 vcc, 3, v14
s_add_u32 s61, s61, 1
s_nop 0
s_and_b32 s60, vcc_lo, 0xff
s_cmp_eq_u32 s60, 0xff
s_cbranch_scc1 L_tr_waitA
s_cmp_lt_u32 s61, 0x400000
s_cbranch_scc1 L_tr_pollA
L_tr_waitA:
s_barrier
s_add_u32 s50, s75, 7
v_mov_b32 v200, s50
buffer_store_dword v200, v199, s[40:43], 0 offen sc1
s_mul_i32 s48, s66, 18432
s_lshl_b32 s49, s28, 12
s_add_u32 s48, s48, s49
s_lshl_b32 s49, s74, 10
s_add_u32 s48, s48, s49
s_and_b32 s62, s31, 3
s_lshl_b32 s62, s62, 2
s_add_u32 s62, s62, s28
s_lshr_b32 s63, s62, 1
s_mul_i32 s63, s63, 18432
s_and_b32 s64, s62, 1
s_lshl_b32 s64, s64, 10
s_add_u32 s63, s63, s64
s_add_u32 s63, s63, 16384
s_add_u32 s64, s48, 110592
s_cmp_eq_u32 s66, 1
s_cselect_b32 s63, s63, s64
s_cselect_b32 s64, 0xff, s31
s_add_u32 s49, s48, 0
s_cmp_eq_u32 s31, 0
s_cselect_b32 s49, 0x40000000, s49
buffer_load_dwordx4 v[16:19], v3, s[44:47], s49 offen sc1
s_add_u32 s49, s48, 129024
s_cmp_eq_u32 s31, 1
s_cselect_b32 s49, 0x40000000, s49
buffer_load_dwordx4 v[20:23], v3, s[44:47], s49 offen sc1
s_add_u32 s49, s48, 258048
s_cmp_eq_u32 s31, 2
s_cselect_b32 s49, 0x40000000, s49
buffer_load_dwordx4 v[24:27], v3, s[44:47], s49 offen sc1
s_add_u32 s49, s48, 387072
s_cmp_eq_u32 s31, 3
s_cselect_b32 s49, 0x40000000, s49
buffer_load_dwordx4 v[28:31], v3, s[44:47], s49 offen sc1
s_add_u32 s49, s48, 516096
s_cmp_eq_u32 s31, 4
s_cselect_b32 s49, 0x40000000, s49
buffer_load_dwordx4 v[32:35], v3, s[44:47], s49 offen sc1
s_add_u32 s49, s48, 645120
s_cmp_eq_u32 s31, 5
s_cselect_b32 s49, 0x40000000, s49
buffer_load_dwordx4 v[36:39], v3, s[44:47], s49 offen sc1
s_add_u32 s49, s48, 774144
s_cmp_eq_u32 s31, 6
s_cselect_b32 s49, 0x40000000, s49
buffer_load_dwordx4 v[40:43], v3, s[44:47], s49 offen sc1
s_add_u32 s49, s48, 903168
s_cmp_eq_u32 s31, 7
s_cselect_b32 s49, 0x40000000, s49
buffer_load_dwordx4 v[44:47], v3, s[44:47], s49 offen sc1
s_add_u32 s49, s48, 36864
s_cmp_eq_u32 s31, 0
s_cselect_b32 s49, 0x40000000, s49
buffer_load_dwordx4 v[48:51], v3, s[44:47], s49 offen sc1
s_add_u32 s49, s48, 165888
s_cmp_eq_u32 s31, 1
s_cselect_b32 s49, 0x40000000, s49
buffer_load_dwordx4 v[52:55], v3, s[44:47], s49 offen sc1
s_add_u32 s49, s48, 294912
s_cmp_eq_u32 s31, 2
s_cselect_b32 s49, 0x40000000, s49
buffer_load_dwordx4 v[56:59], v3, s[44:47], s49 offen sc1
s_add_u32 s49, s48, 423936
s_cmp_eq_u32 s31, 3
s_cselect_b32 s49, 0x40000000, s49
buffer_load_dwordx4 v[60:63], v3, s[44:47], s49 offen sc1
s_add_u32 s49, s48, 552960
s_cmp_eq_u32 s31, 4
s_cselect_b32 s49, 0x40000000, s49
buffer_load_dwordx4 v[64:67], v3, s[44:47], s49 offen sc1
s_add_u32 s49, s48, 681984
s_cmp_eq_u32 s31, 5
s_cselect_b32 s49, 0x40000000, s49
buffer_load_dwordx4 v[68:71], v3, s[44:47], s49 offen sc1
s_add_u32 s49, s48, 811008
s_cmp_eq_u32 s31, 6
s_cselect_b32 s49, 0x40000000, s49
buffer_load_dwordx4 v[72:75], v3, s[44:47], s49 offen sc1
s_add_u32 s49, s48, 940032
s_cmp_eq_u32 s31, 7
s_cselect_b32 s49, 0x40000000, s49
buffer_load_dwordx4 v[76:79], v3, s[44:47], s49 offen sc1
s_mul_i32 s51, s30, 258048
s_mul_i32 s49, s29, 896
s_add_u32 s51, s51, s49
s_sub_u32 s54, 4128768, s51
s_add_u32 s52, s32, s51
s_addc_u32 s53, s33, 0
s_mov_b32 s55, 0x20000
v_and_b32 v5, 15, v2
v_mul_u32_u24 v6, 1792, v5
v_lshrrev_b32 v7, 4, v2
v_lshl_add_u32 v6, v7, 3, v6
v_add_u32 v9, 28672, v6
v_and_b32 v7, 31, v2
v_lshlrev_b32 v7, 1, v7
v_and_b32 v8, 15, v7
v_add_u32 v8, 128, v8
v_mul_u32_u24 v8, 1792, v8
v_lshrrev_b32 v7, 4, v7
v_lshl_add_u32 v8, v7, 3, v8
v_lshrrev_b32 v7, 5, v2
v_lshl_add_u32 v8, v7, 5, v8
v_add_u32 v10, 1792, v8
s_cmp_eq_u32 s28, 0
s_cbranch_scc1 L_tr_skip01
s_waitcnt vmcnt(0)
v_lshlrev_b32 v144, 16, v16
v_and_b32 v145, 0xffff0000, v16
v_lshlrev_b32 v146, 16, v17
v_and_b32 v147, 0xffff0000, v17
v_lshlrev_b32 v148, 16, v18
v_and_b32 v149, 0xffff0000, v18
v_lshlrev_b32 v150, 16, v19
v_and_b32 v151, 0xffff0000, v19
v_lshlrev_b32 v12, 16, v20
v_and_b32 v11, 0xffff0000, v20
v_add_f32 v144, v144, v12
v_add_f32 v145, v145, v11
v_lshlrev_b32 v12, 16, v21
v_and_b32 v11, 0xffff0000, v21
v_add_f32 v146, v146, v12
v_add_f32 v147, v147, v11
v_lshlrev_b32 v12, 16, v22
v_and_b32 v11, 0xffff0000, v22
v_add_f32 v148, v148, v12
v_add_f32 v149, v149, v11
v_lshlrev_b32 v12, 16, v23
v_and_b32 v11, 0xffff0000, v23
v_add_f32 v150, v150, v12
v_add_f32 v151, v151, v11
v_lshlrev_b32 v12, 16, v24
v_and_b32 v11, 0xffff0000, v24
v_add_f32 v144, v144, v12
v_add_f32 v145, v145, v11
v_lshlrev_b32 v12, 16, v25
v_and_b32 v11, 0xffff0000, v25
v_add_f32 v146, v146, v12
v_add_f32 v147, v147, v11
v_lshlrev_b32 v12, 16, v26
v_and_b32 v11, 0xffff0000, v26
v_add_f32 v148, v148, v12
v_add_f32 v149, v149, v11
v_lshlrev_b32 v12, 16, v27
v_and_b32 v11, 0xffff0000, v27
v_add_f32 v150, v150, v12
v_add_f32 v151, v151, v11
v_lshlrev_b32 v12, 16, v28
v_and_b32 v11, 0xffff0000, v28
v_add_f32 v144, v144, v12
v_add_f32 v145, v145, v11
v_lshlrev_b32 v12, 16, v29
v_and_b32 v11, 0xffff0000, v29
v_add_f32 v146, v146, v12
v_add_f32 v147, v147, v11
v_lshlrev_b32 v12, 16, v30
v_and_b32 v11, 0xffff0000, v30
v_add_f32 v148, v148, v12
v_add_f32 v149, v149, v11
v_lshlrev_b32 v12, 16, v31
v_and_b32 v11, 0xffff0000, v31
v_add_f32 v150, v150, v12
v_add_f32 v151, v151, v11
v_lshlrev_b32 v12, 16, v32
v_and_b32 v11, 0xffff0000, v32
v_add_f32 v144, v144, v12
v_add_f32 v145, v145, v11
v_lshlrev_b32 v12, 16, v33
v_and_b32 v11, 0xffff0000, v33
v_add_f32 v146, v146, v12
v_add_f32 v147, v147, v11
v_lshlrev_b32 v12, 16, v34
v_and_b32 v11, 0xffff0000, v34
v_add_f32 v148, v148, v12
v_add_f32 v149, v149, v11
v_lshlrev_b32 v12, 16, v35
v_and_b32 v11, 0xffff0000, v35
v_add_f32 v150, v150, v12
v_add_f32 v151, v151, v11
v_lshlrev_b32 v12, 16, v36
v_and_b32 v11, 0xffff0000, v36
v_add_f32 v144, v144, v12
v_add_f32 v145, v145, v11
v_lshlrev_b32 v12, 16, v37
v_and_b32 v11, 0xffff0000, v37
v_add_f32 v146, v146, v12
v_add_f32 v147, v147, v11
v_lshlrev_b32 v12, 16, v38
v_and_b32 v11, 0xffff0000, v38
v_add_f32 v148, v148, v12
v_add_f32 v149, v149, v11
v_lshlrev_b32 v12, 16, v39
v_and_b32 v11, 0xffff0000, v39
v_add_f32 v150, v150, v12
v_add_f32 v151, v151, v11
v_lshlrev_b32 v12, 16, v40
v_and_b32 v11, 0xffff0000, v40
v_add_f32 v144, v144, v12
v_add_f32 v145, v145, v11
v_lshlrev_b32 v12, 16, v41
v_and_b32 v11, 0xffff0000, v41
v_add_f32 v146, v146, v12
v_add_f32 v147, v147, v11
v_lshlrev_b32 v12, 16, v42
v_and_b32 v11, 0xffff0000, v42
v_add_f32 v148, v148, v12
v_add_f32 v149, v149, v11
v_lshlrev_b32 v12, 16, v43
v_and_b32 v11, 0xffff0000, v43
v_add_f32 v150, v150, v12
v_add_f32 v151, v151, v11
v_lshlrev_b32 v12, 16, v44
v_and_b32 v11, 0xffff0000, v44
v_add_f32 v144, v144, v12
v_add_f32 v145, v145, v11
v_lshlrev_b32 v12, 16, v45
v_and_b32 v11, 0xffff0000, v45
v_add_f32 v146, v146, v12
v_add_f32 v147, v147, v11
v_lshlrev_b32 v12, 16, v46
v_and_b32 v11, 0xffff0000, v46
v_add_f32 v148, v148, v12
v_add_f32 v149, v149, v11
v_lshlrev_b32 v12, 16, v47
v_and_b32 v11, 0xffff0000, v47
v_add_f32 v150, v150, v12
v_add_f32 v151, v151, v11
v_lshlrev_b32 v12, 16, v213
v_and_b32 v11, 0xffff0000, v213
v_add_f32 v144, v144, v12
v_add_f32 v145, v145, v11
v_lshlrev_b32 v12, 16, v214
v_and_b32 v11, 0xffff0000, v214
v_add_f32 v146, v146, v12
v_add_f32 v147, v147, v11
v_lshlrev_b32 v12, 16, v215
v_and_b32 v11, 0xffff0000, v215
v_add_f32 v148, v148, v12
v_add_f32 v149, v149, v11
v_lshlrev_b32 v12, 16, v216
v_and_b32 v11, 0xffff0000, v216
v_add_f32 v150, v150, v12
v_add_f32 v151, v151, v11
v_cvt_pk_bf16_f32 v144, v144, v145
v_cvt_pk_bf16_f32 v145, v146, v147
v_cvt_pk_bf16_f32 v146, v148, v149
v_cvt_pk_bf16_f32 v147, v150, v151
s_lshl_b32 s57, s66, 7
s_add_u32 s57, s57, 0
s_mul_i32 s58, s28, 57344
s_add_u32 s57, s57, s58
s_lshl_b32 s58, s74, 5
s_add_u32 s57, s57, s58
buffer_store_dwordx2 v[144:145], v6, s[52:55], s57 offen
buffer_store_dwordx2 v[146:147], v9, s[52:55], s57 offen
v_lshlrev_b32 v152, 16, v48
v_and_b32 v153, 0xffff0000, v48
v_lshlrev_b32 v154, 16, v49
v_and_b32 v155, 0xffff0000, v49
v_lshlrev_b32 v156, 16, v50
v_and_b32 v157, 0xffff0000, v50
v_lshlrev_b32 v158, 16, v51
v_and_b32 v159, 0xffff0000, v51
v_lshlrev_b32 v12, 16, v52
v_and_b32 v11, 0xffff0000, v52
v_add_f32 v152, v152, v12
v_add_f32 v153, v153, v11
v_lshlrev_b32 v12, 16, v53
v_and_b32 v11, 0xffff0000, v53
v_add_f32 v154, v154, v12
v_add_f32 v155, v155, v11
v_lshlrev_b32 v12, 16, v54
v_and_b32 v11, 0xffff0000, v54
v_add_f32 v156, v156, v12
v_add_f32 v157, v157, v11
v_lshlrev_b32 v12, 16, v55
v_and_b32 v11, 0xffff0000, v55
v_add_f32 v158, v158, v12
v_add_f32 v159, v159, v11
v_lshlrev_b32 v12, 16, v56
v_and_b32 v11, 0xffff0000, v56
v_add_f32 v152, v152, v12
v_add_f32 v153, v153, v11
v_lshlrev_b32 v12, 16, v57
v_and_b32 v11, 0xffff0000, v57
v_add_f32 v154, v154, v12
v_add_f32 v155, v155, v11
v_lshlrev_b32 v12, 16, v58
v_and_b32 v11, 0xffff0000, v58
v_add_f32 v156, v156, v12
v_add_f32 v157, v157, v11
v_lshlrev_b32 v12, 16, v59
v_and_b32 v11, 0xffff0000, v59
v_add_f32 v158, v158, v12
v_add_f32 v159, v159, v11
v_lshlrev_b32 v12, 16, v60
v_and_b32 v11, 0xffff0000, v60
v_add_f32 v152, v152, v12
v_add_f32 v153, v153, v11
v_lshlrev_b32 v12, 16, v61
v_and_b32 v11, 0xffff0000, v61
v_add_f32 v154, v154, v12
v_add_f32 v155, v155, v11
v_lshlrev_b32 v12, 16, v62
v_and_b32 v11, 0xffff0000, v62
v_add_f32 v156, v156, v12
v_add_f32 v157, v157, v11
v_lshlrev_b32 v12, 16, v63
v_and_b32 v11, 0xffff0000, v63
v_add_f32 v158, v158, v12
v_add_f32 v159, v159, v11
v_lshlrev_b32 v12, 16, v64
v_and_b32 v11, 0xffff0000, v64
v_add_f32 v152, v152, v12
v_add_f32 v153, v153, v11
v_lshlrev_b32 v12, 16, v65
v_and_b32 v11, 0xffff0000, v65
v_add_f32 v154, v154, v12
v_add_f32 v155, v155, v11
v_lshlrev_b32 v12, 16, v66
v_and_b32 v11, 0xffff0000, v66
v_add_f32 v156, v156, v12
v_add_f32 v157, v157, v11
v_lshlrev_b32 v12, 16, v67
v_and_b32 v11, 0xffff0000, v67
v_add_f32 v158, v158, v12
v_add_f32 v159, v159, v11
v_lshlrev_b32 v12, 16, v68
v_and_b32 v11, 0xffff0000, v68
v_add_f32 v152, v152, v12
v_add_f32 v153, v153, v11
v_lshlrev_b32 v12, 16, v69
v_and_b32 v11, 0xffff0000, v69
v_add_f32 v154, v154, v12
v_add_f32 v155, v155, v11
v_lshlrev_b32 v12, 16, v70
v_and_b32 v11, 0xffff0000, v70
v_add_f32 v156, v156, v12
v_add_f32 v157, v157, v11
v_lshlrev_b32 v12, 16, v71
v_and_b32 v11, 0xffff0000, v71
v_add_f32 v158, v158, v12
v_add_f32 v159, v159, v11
v_lshlrev_b32 v12, 16, v72
v_and_b32 v11, 0xffff0000, v72
v_add_f32 v152, v152, v12
v_add_f32 v153, v153, v11
v_lshlrev_b32 v12, 16, v73
v_and_b32 v11, 0xffff0000, v73
v_add_f32 v154, v154, v12
v_add_f32 v155, v155, v11
v_lshlrev_b32 v12, 16, v74
v_and_b32 v11, 0xffff0000, v74
v_add_f32 v156, v156, v12
v_add_f32 v157, v157, v11
v_lshlrev_b32 v12, 16, v75
v_and_b32 v11, 0xffff0000, v75
v_add_f32 v158, v158, v12
v_add_f32 v159, v159, v11
v_lshlrev_b32 v12, 16, v76
v_and_b32 v11, 0xffff0000, v76
v_add_f32 v152, v152, v12
v_add_f32 v153, v153, v11
v_lshlrev_b32 v12, 16, v77
v_and_b32 v11, 0xffff0000, v77
v_add_f32 v154, v154, v12
v_add_f32 v155, v155, v11
v_lshlrev_b32 v12, 16, v78
v_and_b32 v11, 0xffff0000, v78
v_add_f32 v156, v156, v12
v_add_f32 v157, v157, v11
v_lshlrev_b32 v12, 16, v79
v_and_b32 v11, 0xffff0000, v79
v_add_f32 v158, v158, v12
v_add_f32 v159, v159, v11
v_lshlrev_b32 v12, 16, v209
v_and_b32 v11, 0xffff0000, v209
v_add_f32 v152, v152, v12
v_add_f32 v153, v153, v11
v_lshlrev_b32 v12, 16, v210
v_and_b32 v11, 0xffff0000, v210
v_add_f32 v154, v154, v12
v_add_f32 v155, v155, v11
v_lshlrev_b32 v12, 16, v211
v_and_b32 v11, 0xffff0000, v211
v_add_f32 v156, v156, v12
v_add_f32 v157, v157, v11
v_lshlrev_b32 v12, 16, v212
v_and_b32 v11, 0xffff0000, v212
v_add_f32 v158, v158, v12
v_add_f32 v159, v159, v11
v_cvt_pk_bf16_f32 v152, v152, v153
v_cvt_pk_bf16_f32 v153, v154, v155
v_cvt_pk_bf16_f32 v154, v156, v157
v_cvt_pk_bf16_f32 v155, v158, v159
s_lshl_b32 s57, s66, 7
s_add_u32 s57, s57, 256
s_mul_i32 s58, s28, 57344
s_add_u32 s57, s57, s58
s_lshl_b32 s58, s74, 5
s_add_u32 s57, s57, s58
buffer_store_dwordx2 v[152:153], v6, s[52:55], s57 offen
buffer_store_dwordx2 v[154:155], v9, s[52:55], s57 offen
L_tr_skip01:
s_cmp_eq_u32 s28, 0
s_cbranch_scc0 L_tr_waitB
s_mov_b32 s61, 0
L_tr_pollB:
buffer_load_dword v14, v13, s[40:43], 0 offen sc1
s_waitcnt vmcnt(0)
v_subrev_u32 v14, s75, v14
v_subrev_u32 v14, 7, v14
v_cmp_ge_u32 vcc, 0, v14
s_add_u32 s61, s61, 1
s_nop 0
s_and_b32 s60, vcc_lo, 0xff
s_cmp_eq_u32 s60, 0xff
s_cbranch_scc1 L_tr_waitB
s_cmp_lt_u32 s61, 0x400000
s_cbranch_scc1 L_tr_pollB
L_tr_waitB:
s_barrier
s_add_u32 s49, s48, 73728
s_cmp_eq_u32 s31, 0
s_cselect_b32 s49, 0x40000000, s49
buffer_load_dwordx4 v[80:83], v3, s[44:47], s49 offen sc1
s_add_u32 s49, s48, 202752
s_cmp_eq_u32 s31, 1
s_cselect_b32 s49, 0x40000000, s49
buffer_load_dwordx4 v[84:87], v3, s[44:47], s49 offen sc1
s_add_u32 s49, s48, 331776
s_cmp_eq_u32 s31, 2
s_cselect_b32 s49, 0x40000000, s49
buffer_load_dwordx4 v[88:91], v3, s[44:47], s49 offen sc1
s_add_u32 s49, s48, 460800
s_cmp_eq_u32 s31, 3
s_cselect_b32 s49, 0x40000000, s49
buffer_load_dwordx4 v[92:95], v3, s[44:47], s49 offen sc1
s_add_u32 s49, s48, 589824
s_cmp_eq_u32 s31, 4
s_cselect_b32 s49, 0x40000000, s49
buffer_load_dwordx4 v[96:99], v3, s[44:47], s49 offen sc1
s_add_u32 s49, s48, 718848
s_cmp_eq_u32 s31, 5
s_cselect_b32 s49, 0x40000000, s49
buffer_load_dwordx4 v[100:103], v3, s[44:47], s49 offen sc1
s_add_u32 s49, s48, 847872
s_cmp_eq_u32 s31, 6
s_cselect_b32 s49, 0x40000000, s49
buffer_load_dwordx4 v[104:107], v3, s[44:47], s49 offen sc1
s_add_u32 s49, s48, 976896
s_cmp_eq_u32 s31, 7
s_cselect_b32 s49, 0x40000000, s49
buffer_load_dwordx4 v[108:111], v3, s[44:47], s49 offen sc1
s_add_u32 s49, s63, 0
s_cmp_eq_u32 s64, 0
s_cselect_b32 s49, 0x40000000, s49
buffer_load_dwordx4 v[112:115], v3, s[44:47], s49 offen sc1
s_add_u32 s49, s63, 129024
s_cmp_eq_u32 s64, 1
s_cselect_b32 s49, 0x40000000, s49
buffer_load_dwordx4 v[116:119], v3, s[44:47], s49 offen sc1
s_add_u32 s49, s63, 258048
s_cmp_eq_u32 s64, 2
s_cselect_b32 s49, 0x40000000, s49
buffer_load_dwordx4 v[120:123], v3, s[44:47], s49 offen sc1
s_add_u32 s49, s63, 387072
s_cmp_eq_u32 s64, 3
s_cselect_b32 s49, 0x40000000, s49
buffer_load_dwordx4 v[124:127], v3, s[44:47], s49 offen sc1
s_add_u32 s49, s63, 516096
s_cmp_eq_u32 s64, 4
s_cselect_b32 s49, 0x40000000, s49
buffer_load_dwordx4 v[128:131], v3, s[44:47], s49 offen sc1
s_add_u32 s49, s63, 645120
s_cmp_eq_u32 s64, 5
s_cselect_b32 s49, 0x40000000, s49
buffer_load_dwordx4 v[132:135], v3, s[44:47], s49 offen sc1
s_add_u32 s49, s63, 774144
s_cmp_eq_u32 s64, 6
s_cselect_b32 s49, 0x40000000, s49
buffer_load_dwordx4 v[136:139], v3, s[44:47], s49 offen sc1
s_add_u32 s49, s63, 903168
s_cmp_eq_u32 s64, 7
s_cselect_b32 s49, 0x40000000, s49
buffer_load_dwordx4 v[140:143], v3, s[44:47], s49 offen sc1
s_cmp_eq_u32 s28, 0
s_cbranch_scc0 L_tr_have01
v_lshlrev_b32 v144, 16, v16
v_and_b32 v145, 0xffff0000, v16
v_lshlrev_b32 v146, 16, v17
v_and_b32 v147, 0xffff0000, v17
v_lshlrev_b32 v148, 16, v18
v_and_b32 v149, 0xffff0000, v18
v_lshlrev_b32 v150, 16, v19
v_and_b32 v151, 0xffff0000, v19
v_lshlrev_b32 v12, 16, v20
v_and_b32 v11, 0xffff0000, v20
v_add_f32 v144, v144, v12
v_add_f32 v145, v145, v11
v_lshlrev_b32 v12, 16, v21
v_and_b32 v11, 0xffff0000, v21
v_add_f32 v146, v146, v12
v_add_f32 v147, v147, v11
v_lshlrev_b32 v12, 16, v22
v_and_b32 v11, 0xffff0000, v22
v_add_f32 v148, v148, v12
v_add_f32 v149, v149, v11
v_lshlrev_b32 v12, 16, v23
v_and_b32 v11, 0xffff0000, v23
v_add_f32 v150, v150, v12
v_add_f32 v151, v151, v11
v_lshlrev_b32 v12, 16, v24
v_and_b32 v11, 0xffff0000, v24
v_add_f32 v144, v144, v12
v_add_f32 v145, v145, v11
v_lshlrev_b32 v12, 16, v25
v_and_b32 v11, 0xffff0000, v25
v_add_f32 v146, v146, v12
v_add_f32 v147, v147, v11
v_lshlrev_b32 v12, 16, v26
v_and_b32 v11, 0xffff0000, v26
v_add_f32 v148, v148, v12
v_add_f32 v149, v149, v11
v_lshlrev_b32 v12, 16, v27
v_and_b32 v11, 0xffff0000, v27
v_add_f32 v150, v150, v12
v_add_f32 v151, v151, v11
v_lshlrev_b32 v12, 16, v28
v_and_b32 v11, 0xffff0000, v28
v_add_f32 v144, v144, v12
v_add_f32 v145, v145, v11
v_lshlrev_b32 v12, 16, v29
v_and_b32 v11, 0xffff0000, v29
v_add_f32 v146, v146, v12
v_add_f32 v147, v147, v11
v_lshlrev_b32 v12, 16, v30
v_and_b32 v11, 0xffff0000, v30
v_add_f32 v148, v148, v12
v_add_f32 v149, v149, v11
v_lshlrev_b32 v12, 16, v31
v_and_b32 v11, 0xffff0000, v31
v_add_f32 v150, v150, v12
v_add_f32 v151, v151, v11
v_lshlrev_b32 v12, 16, v32
v_and_b32 v11, 0xffff0000, v32
v_add_f32 v144, v144, v12
v_add_f32 v145, v145, v11
v_lshlrev_b32 v12, 16, v33
v_and_b32 v11, 0xffff0000, v33
v_add_f32 v146, v146, v12
v_add_f32 v147, v147, v11
v_lshlrev_b32 v12, 16, v34
v_and_b32 v11, 0xffff0000, v34
v_add_f32 v148, v148, v12
v_add_f32 v149, v149, v11
v_lshlrev_b32 v12, 16, v35
v_and_b32 v11, 0xffff0000, v35
v_add_f32 v150, v150, v12
v_add_f32 v151, v151, v11
v_lshlrev_b32 v12, 16, v36
v_and_b32 v11, 0xffff0000, v36
v_add_f32 v144, v144, v12
v_add_f32 v145, v145, v11
v_lshlrev_b32 v12, 16, v37
v_and_b32 v11, 0xffff0000, v37
v_add_f32 v146, v146, v12
v_add_f32 v147, v147, v11
v_lshlrev_b32 v12, 16, v38
v_and_b32 v11, 0xffff0000, v38
v_add_f32 v148, v148, v12
v_add_f32 v149, v149, v11
v_lshlrev_b32 v12, 16, v39
v_and_b32 v11, 0xffff0000, v39
v_add_f32 v150, v150, v12
v_add_f32 v151, v151, v11
v_lshlrev_b32 v12, 16, v40
v_and_b32 v11, 0xffff0000, v40
v_add_f32 v144, v144, v12
v_add_f32 v145, v145, v11
v_lshlrev_b32 v12, 16, v41
v_and_b32 v11, 0xffff0000, v41
v_add_f32 v146, v146, v12
v_add_f32 v147, v147, v11
v_lshlrev_b32 v12, 16, v42
v_and_b32 v11, 0xffff0000, v42
v_add_f32 v148, v148, v12
v_add_f32 v149, v149, v11
v_lshlrev_b32 v12, 16, v43
v_and_b32 v11, 0xffff0000, v43
v_add_f32 v150, v150, v12
v_add_f32 v151, v151, v11
v_lshlrev_b32 v12, 16, v44
v_and_b32 v11, 0xffff0000, v44
v_add_f32 v144, v144, v12
v_add_f32 v145, v145, v11
v_lshlrev_b32 v12, 16, v45
v_and_b32 v11, 0xffff0000, v45
v_add_f32 v146, v146, v12
v_add_f32 v147, v147, v11
v_lshlrev_b32 v12, 16, v46
v_and_b32 v11, 0xffff0000, v46
v_add_f32 v148, v148, v12
v_add_f32 v149, v149, v11
v_lshlrev_b32 v12, 16, v47
v_and_b32 v11, 0xffff0000, v47
v_add_f32 v150, v150, v12
v_add_f32 v151, v151, v11
v_lshlrev_b32 v12, 16, v213
v_and_b32 v11, 0xffff0000, v213
v_add_f32 v144, v144, v12
v_add_f32 v145, v145, v11
v_lshlrev_b32 v12, 16, v214
v_and_b32 v11, 0xffff0000, v214
v_add_f32 v146, v146, v12
v_add_f32 v147, v147, v11
v_lshlrev_b32 v12, 16, v215
v_and_b32 v11, 0xffff0000, v215
v_add_f32 v148, v148, v12
v_add_f32 v149, v149, v11
v_lshlrev_b32 v12, 16, v216
v_and_b32 v11, 0xffff0000, v216
v_add_f32 v150, v150, v12
v_add_f32 v151, v151, v11
v_cvt_pk_bf16_f32 v144, v144, v145
v_cvt_pk_bf16_f32 v145, v146, v147
v_cvt_pk_bf16_f32 v146, v148, v149
v_cvt_pk_bf16_f32 v147, v150, v151
s_lshl_b32 s57, s66, 7
s_add_u32 s57, s57, 0
s_mul_i32 s58, s28, 57344
s_add_u32 s57, s57, s58
s_lshl_b32 s58, s74, 5
s_add_u32 s57, s57, s58
buffer_store_dwordx2 v[144:145], v6, s[52:55], s57 offen
buffer_store_dwordx2 v[146:147], v9, s[52:55], s57 offen
v_lshlrev_b32 v152, 16, v48
v_and_b32 v153, 0xffff0000, v48
v_lshlrev_b32 v154, 16, v49
v_and_b32 v155, 0xffff0000, v49
v_lshlrev_b32 v156, 16, v50
v_and_b32 v157, 0xffff0000, v50
v_lshlrev_b32 v158, 16, v51
v_and_b32 v159, 0xffff0000, v51
v_lshlrev_b32 v12, 16, v52
v_and_b32 v11, 0xffff0000, v52
v_add_f32 v152, v152, v12
v_add_f32 v153, v153, v11
v_lshlrev_b32 v12, 16, v53
v_and_b32 v11, 0xffff0000, v53
v_add_f32 v154, v154, v12
v_add_f32 v155, v155, v11
v_lshlrev_b32 v12, 16, v54
v_and_b32 v11, 0xffff0000, v54
v_add_f32 v156, v156, v12
v_add_f32 v157, v157, v11
v_lshlrev_b32 v12, 16, v55
v_and_b32 v11, 0xffff0000, v55
v_add_f32 v158, v158, v12
v_add_f32 v159, v159, v11
v_lshlrev_b32 v12, 16, v56
v_and_b32 v11, 0xffff0000, v56
v_add_f32 v152, v152, v12
v_add_f32 v153, v153, v11
v_lshlrev_b32 v12, 16, v57
v_and_b32 v11, 0xffff0000, v57
v_add_f32 v154, v154, v12
v_add_f32 v155, v155, v11
v_lshlrev_b32 v12, 16, v58
v_and_b32 v11, 0xffff0000, v58
v_add_f32 v156, v156, v12
v_add_f32 v157, v157, v11
v_lshlrev_b32 v12, 16, v59
v_and_b32 v11, 0xffff0000, v59
v_add_f32 v158, v158, v12
v_add_f32 v159, v159, v11
v_lshlrev_b32 v12, 16, v60
v_and_b32 v11, 0xffff0000, v60
v_add_f32 v152, v152, v12
v_add_f32 v153, v153, v11
v_lshlrev_b32 v12, 16, v61
v_and_b32 v11, 0xffff0000, v61
v_add_f32 v154, v154, v12
v_add_f32 v155, v155, v11
v_lshlrev_b32 v12, 16, v62
v_and_b32 v11, 0xffff0000, v62
v_add_f32 v156, v156, v12
v_add_f32 v157, v157, v11
v_lshlrev_b32 v12, 16, v63
v_and_b32 v11, 0xffff0000, v63
v_add_f32 v158, v158, v12
v_add_f32 v159, v159, v11
v_lshlrev_b32 v12, 16, v64
v_and_b32 v11, 0xffff0000, v64
v_add_f32 v152, v152, v12
v_add_f32 v153, v153, v11
v_lshlrev_b32 v12, 16, v65
v_and_b32 v11, 0xffff0000, v65
v_add_f32 v154, v154, v12
v_add_f32 v155, v155, v11
v_lshlrev_b32 v12, 16, v66
v_and_b32 v11, 0xffff0000, v66
v_add_f32 v156, v156, v12
v_add_f32 v157, v157, v11
v_lshlrev_b32 v12, 16, v67
v_and_b32 v11, 0xffff0000, v67
v_add_f32 v158, v158, v12
v_add_f32 v159, v159, v11
v_lshlrev_b32 v12, 16, v68
v_and_b32 v11, 0xffff0000, v68
v_add_f32 v152, v152, v12
v_add_f32 v153, v153, v11
v_lshlrev_b32 v12, 16, v69
v_and_b32 v11, 0xffff0000, v69
v_add_f32 v154, v154, v12
v_add_f32 v155, v155, v11
v_lshlrev_b32 v12, 16, v70
v_and_b32 v11, 0xffff0000, v70
v_add_f32 v156, v156, v12
v_add_f32 v157, v157, v11
v_lshlrev_b32 v12, 16, v71
v_and_b32 v11, 0xffff0000, v71
v_add_f32 v158, v158, v12
v_add_f32 v159, v159, v11
v_lshlrev_b32 v12, 16, v72
v_and_b32 v11, 0xffff0000, v72
v_add_f32 v152, v152, v12
v_add_f32 v153, v153, v11
v_lshlrev_b32 v12, 16, v73
v_and_b32 v11, 0xffff0000, v73
v_add_f32 v154, v154, v12
v_add_f32 v155, v155, v11
v_lshlrev_b32 v12, 16, v74
v_and_b32 v11, 0xffff0000, v74
v_add_f32 v156, v156, v12
v_add_f32 v157, v157, v11
v_lshlrev_b32 v12, 16, v75
v_and_b32 v11, 0xffff0000, v75
v_add_f32 v158, v158, v12
v_add_f32 v159, v159, v11
v_lshlrev_b32 v12, 16, v76
v_and_b32 v11, 0xffff0000, v76
v_add_f32 v152, v152, v12
v_add_f32 v153, v153, v11
v_lshlrev_b32 v12, 16, v77
v_and_b32 v11, 0xffff0000, v77
v_add_f32 v154, v154, v12
v_add_f32 v155, v155, v11
v_lshlrev_b32 v12, 16, v78
v_and_b32 v11, 0xffff0000, v78
v_add_f32 v156, v156, v12
v_add_f32 v157, v157, v11
v_lshlrev_b32 v12, 16, v79
v_and_b32 v11, 0xffff0000, v79
v_add_f32 v158, v158, v12
v_add_f32 v159, v159, v11
v_lshlrev_b32 v12, 16, v209
v_and_b32 v11, 0xffff0000, v209
v_add_f32 v152, v152, v12
v_add_f32 v153, v153, v11
v_lshlrev_b32 v12, 16, v210
v_and_b32 v11, 0xffff0000, v210
v_add_f32 v154, v154, v12
v_add_f32 v155, v155, v11
v_lshlrev_b32 v12, 16, v211
v_and_b32 v11, 0xffff0000, v211
v_add_f32 v156, v156, v12
v_add_f32 v157, v157, v11
v_lshlrev_b32 v12, 16, v212
v_and_b32 v11, 0xffff0000, v212
v_add_f32 v158, v158, v12
v_add_f32 v159, v159, v11
v_cvt_pk_bf16_f32 v152, v152, v153
v_cvt_pk_bf16_f32 v153, v154, v155
v_cvt_pk_bf16_f32 v154, v156, v157
v_cvt_pk_bf16_f32 v155, v158, v159
s_lshl_b32 s57, s66, 7
s_add_u32 s57, s57, 256
s_mul_i32 s58, s28, 57344
s_add_u32 s57, s57, s58
s_lshl_b32 s58, s74, 5
s_add_u32 s57, s57, s58
buffer_store_dwordx2 v[152:153], v6, s[52:55], s57 offen
buffer_store_dwordx2 v[154:155], v9, s[52:55], s57 offen
L_tr_have01:
s_waitcnt vmcnt(0)
v_lshlrev_b32 v160, 16, v80
v_and_b32 v161, 0xffff0000, v80
v_lshlrev_b32 v162, 16, v81
v_and_b32 v163, 0xffff0000, v81
v_lshlrev_b32 v164, 16, v82
v_and_b32 v165, 0xffff0000, v82
v_lshlrev_b32 v166, 16, v83
v_and_b32 v167, 0xffff0000, v83
v_lshlrev_b32 v12, 16, v84
v_and_b32 v11, 0xffff0000, v84
v_add_f32 v160, v160, v12
v_add_f32 v161, v161, v11
v_lshlrev_b32 v12, 16, v85
v_and_b32 v11, 0xffff0000, v85
v_add_f32 v162, v162, v12
v_add_f32 v163, v163, v11
v_lshlrev_b32 v12, 16, v86
v_and_b32 v11, 0xffff0000, v86
v_add_f32 v164, v164, v12
v_add_f32 v165, v165, v11
v_lshlrev_b32 v12, 16, v87
v_and_b32 v11, 0xffff0000, v87
v_add_f32 v166, v166, v12
v_add_f32 v167, v167, v11
v_lshlrev_b32 v12, 16, v88
v_and_b32 v11, 0xffff0000, v88
v_add_f32 v160, v160, v12
v_add_f32 v161, v161, v11
v_lshlrev_b32 v12, 16, v89
v_and_b32 v11, 0xffff0000, v89
v_add_f32 v162, v162, v12
v_add_f32 v163, v163, v11
v_lshlrev_b32 v12, 16, v90
v_and_b32 v11, 0xffff0000, v90
v_add_f32 v164, v164, v12
v_add_f32 v165, v165, v11
v_lshlrev_b32 v12, 16, v91
v_and_b32 v11, 0xffff0000, v91
v_add_f32 v166, v166, v12
v_add_f32 v167, v167, v11
v_lshlrev_b32 v12, 16, v92
v_and_b32 v11, 0xffff0000, v92
v_add_f32 v160, v160, v12
v_add_f32 v161, v161, v11
v_lshlrev_b32 v12, 16, v93
v_and_b32 v11, 0xffff0000, v93
v_add_f32 v162, v162, v12
v_add_f32 v163, v163, v11
v_lshlrev_b32 v12, 16, v94
v_and_b32 v11, 0xffff0000, v94
v_add_f32 v164, v164, v12
v_add_f32 v165, v165, v11
v_lshlrev_b32 v12, 16, v95
v_and_b32 v11, 0xffff0000, v95
v_add_f32 v166, v166, v12
v_add_f32 v167, v167, v11
v_lshlrev_b32 v12, 16, v96
v_and_b32 v11, 0xffff0000, v96
v_add_f32 v160, v160, v12
v_add_f32 v161, v161, v11
v_lshlrev_b32 v12, 16, v97
v_and_b32 v11, 0xffff0000, v97
v_add_f32 v162, v162, v12
v_add_f32 v163, v163, v11
v_lshlrev_b32 v12, 16, v98
v_and_b32 v11, 0xffff0000, v98
v_add_f32 v164, v164, v12
v_add_f32 v165, v165, v11
v_lshlrev_b32 v12, 16, v99
v_and_b32 v11, 0xffff0000, v99
v_add_f32 v166, v166, v12
v_add_f32 v167, v167, v11
v_lshlrev_b32 v12, 16, v100
v_and_b32 v11, 0xffff0000, v100
v_add_f32 v160, v160, v12
v_add_f32 v161, v161, v11
v_lshlrev_b32 v12, 16, v101
v_and_b32 v11, 0xffff0000, v101
v_add_f32 v162, v162, v12
v_add_f32 v163, v163, v11
v_lshlrev_b32 v12, 16, v102
v_and_b32 v11, 0xffff0000, v102
v_add_f32 v164, v164, v12
v_add_f32 v165, v165, v11
v_lshlrev_b32 v12, 16, v103
v_and_b32 v11, 0xffff0000, v103
v_add_f32 v166, v166, v12
v_add_f32 v167, v167, v11
v_lshlrev_b32 v12, 16, v104
v_and_b32 v11, 0xffff0000, v104
v_add_f32 v160, v160, v12
v_add_f32 v161, v161, v11
v_lshlrev_b32 v12, 16, v105
v_and_b32 v11, 0xffff0000, v105
v_add_f32 v162, v162, v12
v_add_f32 v163, v163, v11
v_lshlrev_b32 v12, 16, v106
v_and_b32 v11, 0xffff0000, v106
v_add_f32 v164, v164, v12
v_add_f32 v165, v165, v11
v_lshlrev_b32 v12, 16, v107
v_and_b32 v11, 0xffff0000, v107
v_add_f32 v166, v166, v12
v_add_f32 v167, v167, v11
v_lshlrev_b32 v12, 16, v108
v_and_b32 v11, 0xffff0000, v108
v_add_f32 v160, v160, v12
v_add_f32 v161, v161, v11
v_lshlrev_b32 v12, 16, v109
v_and_b32 v11, 0xffff0000, v109
v_add_f32 v162, v162, v12
v_add_f32 v163, v163, v11
v_lshlrev_b32 v12, 16, v110
v_and_b32 v11, 0xffff0000, v110
v_add_f32 v164, v164, v12
v_add_f32 v165, v165, v11
v_lshlrev_b32 v12, 16, v111
v_and_b32 v11, 0xffff0000, v111
v_add_f32 v166, v166, v12
v_add_f32 v167, v167, v11
v_lshlrev_b32 v12, 16, v205
v_and_b32 v11, 0xffff0000, v205
v_add_f32 v160, v160, v12
v_add_f32 v161, v161, v11
v_lshlrev_b32 v12, 16, v206
v_and_b32 v11, 0xffff0000, v206
v_add_f32 v162, v162, v12
v_add_f32 v163, v163, v11
v_lshlrev_b32 v12, 16, v207
v_and_b32 v11, 0xffff0000, v207
v_add_f32 v164, v164, v12
v_add_f32 v165, v165, v11
v_lshlrev_b32 v12, 16, v208
v_and_b32 v11, 0xffff0000, v208
v_add_f32 v166, v166, v12
v_add_f32 v167, v167, v11
v_cvt_pk_bf16_f32 v160, v160, v161
v_cvt_pk_bf16_f32 v161, v162, v163
v_cvt_pk_bf16_f32 v162, v164, v165
v_cvt_pk_bf16_f32 v163, v166, v167
s_lshl_b32 s57, s66, 7
s_add_u32 s57, s57, 512
s_mul_i32 s58, s28, 57344
s_add_u32 s57, s57, s58
s_lshl_b32 s58, s74, 5
s_add_u32 s57, s57, s58
buffer_store_dwordx2 v[160:161], v6, s[52:55], s57 offen
buffer_store_dwordx2 v[162:163], v9, s[52:55], s57 offen
v_lshlrev_b32 v168, 16, v112
v_and_b32 v169, 0xffff0000, v112
v_lshlrev_b32 v170, 16, v113
v_and_b32 v171, 0xffff0000, v113
v_lshlrev_b32 v172, 16, v114
v_and_b32 v173, 0xffff0000, v114
v_lshlrev_b32 v174, 16, v115
v_and_b32 v175, 0xffff0000, v115
v_lshlrev_b32 v12, 16, v116
v_and_b32 v11, 0xffff0000, v116
v_add_f32 v168, v168, v12
v_add_f32 v169, v169, v11
v_lshlrev_b32 v12, 16, v117
v_and_b32 v11, 0xffff0000, v117
v_add_f32 v170, v170, v12
v_add_f32 v171, v171, v11
v_lshlrev_b32 v12, 16, v118
v_and_b32 v11, 0xffff0000, v118
v_add_f32 v172, v172, v12
v_add_f32 v173, v173, v11
v_lshlrev_b32 v12, 16, v119
v_and_b32 v11, 0xffff0000, v119
v_add_f32 v174, v174, v12
v_add_f32 v175, v175, v11
v_lshlrev_b32 v12, 16, v120
v_and_b32 v11, 0xffff0000, v120
v_add_f32 v168, v168, v12
v_add_f32 v169, v169, v11
v_lshlrev_b32 v12, 16, v121
v_and_b32 v11, 0xffff0000, v121
v_add_f32 v170, v170, v12
v_add_f32 v171, v171, v11
v_lshlrev_b32 v12, 16, v122
v_and_b32 v11, 0xffff0000, v122
v_add_f32 v172, v172, v12
v_add_f32 v173, v173, v11
v_lshlrev_b32 v12, 16, v123
v_and_b32 v11, 0xffff0000, v123
v_add_f32 v174, v174, v12
v_add_f32 v175, v175, v11
v_lshlrev_b32 v12, 16, v124
v_and_b32 v11, 0xffff0000, v124
v_add_f32 v168, v168, v12
v_add_f32 v169, v169, v11
v_lshlrev_b32 v12, 16, v125
v_and_b32 v11, 0xffff0000, v125
v_add_f32 v170, v170, v12
v_add_f32 v171, v171, v11
v_lshlrev_b32 v12, 16, v126
v_and_b32 v11, 0xffff0000, v126
v_add_f32 v172, v172, v12
v_add_f32 v173, v173, v11
v_lshlrev_b32 v12, 16, v127
v_and_b32 v11, 0xffff0000, v127
v_add_f32 v174, v174, v12
v_add_f32 v175, v175, v11
v_lshlrev_b32 v12, 16, v128
v_and_b32 v11, 0xffff0000, v128
v_add_f32 v168, v168, v12
v_add_f32 v169, v169, v11
v_lshlrev_b32 v12, 16, v129
v_and_b32 v11, 0xffff0000, v129
v_add_f32 v170, v170, v12
v_add_f32 v171, v171, v11
v_lshlrev_b32 v12, 16, v130
v_and_b32 v11, 0xffff0000, v130
v_add_f32 v172, v172, v12
v_add_f32 v173, v173, v11
v_lshlrev_b32 v12, 16, v131
v_and_b32 v11, 0xffff0000, v131
v_add_f32 v174, v174, v12
v_add_f32 v175, v175, v11
v_lshlrev_b32 v12, 16, v132
v_and_b32 v11, 0xffff0000, v132
v_add_f32 v168, v168, v12
v_add_f32 v169, v169, v11
v_lshlrev_b32 v12, 16, v133
v_and_b32 v11, 0xffff0000, v133
v_add_f32 v170, v170, v12
v_add_f32 v171, v171, v11
v_lshlrev_b32 v12, 16, v134
v_and_b32 v11, 0xffff0000, v134
v_add_f32 v172, v172, v12
v_add_f32 v173, v173, v11
v_lshlrev_b32 v12, 16, v135
v_and_b32 v11, 0xffff0000, v135
v_add_f32 v174, v174, v12
v_add_f32 v175, v175, v11
v_lshlrev_b32 v12, 16, v136
v_and_b32 v11, 0xffff0000, v136
v_add_f32 v168, v168, v12
v_add_f32 v169, v169, v11
v_lshlrev_b32 v12, 16, v137
v_and_b32 v11, 0xffff0000, v137
v_add_f32 v170, v170, v12
v_add_f32 v171, v171, v11
v_lshlrev_b32 v12, 16, v138
v_and_b32 v11, 0xffff0000, v138
v_add_f32 v172, v172, v12
v_add_f32 v173, v173, v11
v_lshlrev_b32 v12, 16, v139
v_and_b32 v11, 0xffff0000, v139
v_add_f32 v174, v174, v12
v_add_f32 v175, v175, v11
v_lshlrev_b32 v12, 16, v140
v_and_b32 v11, 0xffff0000, v140
v_add_f32 v168, v168, v12
v_add_f32 v169, v169, v11
v_lshlrev_b32 v12, 16, v141
v_and_b32 v11, 0xffff0000, v141
v_add_f32 v170, v170, v12
v_add_f32 v171, v171, v11
v_lshlrev_b32 v12, 16, v142
v_and_b32 v11, 0xffff0000, v142
v_add_f32 v172, v172, v12
v_add_f32 v173, v173, v11
v_lshlrev_b32 v12, 16, v143
v_and_b32 v11, 0xffff0000, v143
v_add_f32 v174, v174, v12
v_add_f32 v175, v175, v11
s_cmp_eq_u32 s66, 1
s_cbranch_scc1 L_tr_nine3
v_lshlrev_b32 v12, 16, v201
v_and_b32 v11, 0xffff0000, v201
v_add_f32 v168, v168, v12
v_add_f32 v169, v169, v11
v_lshlrev_b32 v12, 16, v202
v_and_b32 v11, 0xffff0000, v202
v_add_f32 v170, v170, v12
v_add_f32 v171, v171, v11
v_lshlrev_b32 v12, 16, v203
v_and_b32 v11, 0xffff0000, v203
v_add_f32 v172, v172, v12
v_add_f32 v173, v173, v11
v_lshlrev_b32 v12, 16, v204
v_and_b32 v11, 0xffff0000, v204
v_add_f32 v174, v174, v12
v_add_f32 v175, v175, v11
v_cvt_pk_bf16_f32 v168, v168, v169
v_cvt_pk_bf16_f32 v169, v170, v171
v_cvt_pk_bf16_f32 v170, v172, v173
v_cvt_pk_bf16_f32 v171, v174, v175
s_lshl_b32 s57, s66, 7
s_add_u32 s57, s57, 768
s_mul_i32 s58, s28, 57344
s_add_u32 s57, s57, s58
s_lshl_b32 s58, s74, 5
s_add_u32 s57, s57, s58
buffer_store_dwordx2 v[168:169], v6, s[52:55], s57 offen
buffer_store_dwordx2 v[170:171], v9, s[52:55], s57 offen
s_branch L_tr_next3
L_tr_nine3:
s_cmp_ge_u32 s62, 14
s_cbranch_scc1 L_tr_next3
v_cvt_pk_bf16_f32 v168, v168, v169
v_cvt_pk_bf16_f32 v169, v170, v171
v_cvt_pk_bf16_f32 v170, v172, v173
v_cvt_pk_bf16_f32 v171, v174, v175
s_lshr_b32 s57, s62, 1
s_lshl_b32 s57, s57, 7
s_and_b32 s58, s62, 1
s_lshl_b32 s58, s58, 6
s_add_u32 s57, s57, s58
buffer_store_dwordx2 v[168:169], v8, s[52:55], s57 offen
buffer_store_dwordx2 v[170:171], v10, s[52:55], s57 offen
L_tr_next3:
s_endpgm
L_hot_end:
L_fallback:
s_waitcnt vmcnt(0) lgkmcnt(0)
s_barrier
s_mov_b32 s65, 1
s_getpc_b64 s[32:33]
L_fb_pc:
s_sub_u32 s32, s32, L_fb_pc-L_restart
s_subb_u32 s33, s33, 0
s_setpc_b64 s[32:33]
L_safe:
s_waitcnt vmcnt(0) lgkmcnt(0)
s_barrier
s_cmp_eq_u32 s28, 1
s_cbranch_scc0 L_safe_p1
v_swap_b32 v0, v32
v_swap_b32 v1, v33
v_swap_b32 v2, v34
v_swap_b32 v3, v35
v_swap_b32 v4, v36
v_swap_b32 v5, v37
v_swap_b32 v6, v38
v_swap_b32 v7, v39
v_swap_b32 v8, v40
v_swap_b32 v9, v41
v_swap_b32 v10, v42
v_swap_b32 v11, v43
v_swap_b32 v12, v44
v_swap_b32 v13, v45
v_swap_b32 v14, v46
v_swap_b32 v15, v47
v_swap_b32 v16, v48
v_swap_b32 v17, v49
v_swap_b32 v18, v50
v_swap_b32 v19, v51
v_swap_b32 v20, v52
v_swap_b32 v21, v53
v_swap_b32 v22, v54
v_swap_b32 v23, v55
v_swap_b32 v24, v56
v_swap_b32 v25, v57
v_swap_b32 v26, v58
v_swap_b32 v27, v59
v_swap_b32 v28, v60
v_swap_b32 v29, v61
v_swap_b32 v30, v62
v_swap_b32 v31, v63
v_swap_b32 v64, v96
v_swap_b32 v65, v97
v_swap_b32 v66, v98
v_swap_b32 v67, v99
v_swap_b32 v68, v100
v_swap_b32 v69, v101
v_swap_b32 v70, v102
v_swap_b32 v71, v103
v_swap_b32 v72, v104
v_swap_b32 v73, v105
v_swap_b32 v74, v106
v_swap_b32 v75, v107
v_swap_b32 v76, v108
v_swap_b32 v77, v109
v_swap_b32 v78, v110
v_swap_b32 v79, v111
v_swap_b32 v80, v112
v_swap_b32 v81, v113
v_swap_b32 v82, v114
v_swap_b32 v83, v115
v_swap_b32 v84, v116
v_swap_b32 v85, v117
v_swap_b32 v86, v118
v_swap_b32 v87, v119
v_swap_b32 v88, v120
v_swap_b32 v89, v121
v_swap_b32 v90, v122
v_swap_b32 v91, v123
v_swap_b32 v92, v124
v_swap_b32 v93, v125
v_swap_b32 v94, v126
v_swap_b32 v95, v127
L_safe_p1:
s_cmp_eq_u32 s28, 2
s_cbranch_scc0 L_safe_p2
v_swap_b32 v0, v64
v_swap_b32 v1, v65
v_swap_b32 v2, v66
v_swap_b32 v3, v67
v_swap_b32 v4, v68
v_swap_b32 v5, v69
v_swap_b32 v6, v70
v_swap_b32 v7, v71
v_swap_b32 v8, v72
v_swap_b32 v9, v73
v_swap_b32 v10, v74
v_swap_b32 v11, v75
v_swap_b32 v12, v76
v_swap_b32 v13, v77
v_swap_b32 v14, v78
v_swap_b32 v15, v79
v_swap_b32 v16, v80
v_swap_b32 v17, v81
v_swap_b32 v18, v82
v_swap_b32 v19, v83
v_swap_b32 v20, v84
v_swap_b32 v21, v85
v_swap_b32 v22, v86
v_swap_b32 v23, v87
v_swap_b32 v24, v88
v_swap_b32 v25, v89
v_swap_b32 v26, v90
v_swap_b32 v27, v91
v_swap_b32 v28, v92
v_swap_b32 v29, v93
v_swap_b32 v30, v94
v_swap_b32 v31, v95
v_swap_b32 v32, v96
v_swap_b32 v33, v97
v_swap_b32 v34, v98
v_swap_b32 v35, v99
v_swap_b32 v36, v100
v_swap_b32 v37, v101
v_swap_b32 v38, v102
v_swap_b32 v39, v103
v_swap_b32 v40, v104
v_swap_b32 v41, v105
v_swap_b32 v42, v106
v_swap_b32 v43, v107
v_swap_b32 v44, v108
v_swap_b32 v45, v109
v_swap_b32 v46, v110
v_swap_b32 v47, v111
v_swap_b32 v48, v112
v_swap_b32 v49, v113
v_swap_b32 v50, v114
v_swap_b32 v51, v115
v_swap_b32 v52, v116
v_swap_b32 v53, v117
v_swap_b32 v54, v118
v_swap_b32 v55, v119
v_swap_b32 v56, v120
v_swap_b32 v57, v121
v_swap_b32 v58, v122
v_swap_b32 v59, v123
v_swap_b32 v60, v124
v_swap_b32 v61, v125
v_swap_b32 v62, v126
v_swap_b32 v63, v127
L_safe_p2:
s_cmp_eq_u32 s28, 3
s_cbranch_scc0 L_safe_p3
v_swap_b32 v0, v96
v_swap_b32 v1, v97
v_swap_b32 v2, v98
v_swap_b32 v3, v99
v_swap_b32 v4, v100
v_swap_b32 v5, v101
v_swap_b32 v6, v102
v_swap_b32 v7, v103
v_swap_b32 v8, v104
v_swap_b32 v9, v105
v_swap_b32 v10, v106
v_swap_b32 v11, v107
v_swap_b32 v12, v108
v_swap_b32 v13, v109
v_swap_b32 v14, v110
v_swap_b32 v15, v111
v_swap_b32 v16, v112
v_swap_b32 v17, v113
v_swap_b32 v18, v114
v_swap_b32 v19, v115
v_swap_b32 v20, v116
v_swap_b32 v21, v117
v_swap_b32 v22, v118
v_swap_b32 v23, v119
v_swap_b32 v24, v120
v_swap_b32 v25, v121
v_swap_b32 v26, v122
v_swap_b32 v27, v123
v_swap_b32 v28, v124
v_swap_b32 v29, v125
v_swap_b32 v30, v126
v_swap_b32 v31, v127
v_swap_b32 v32, v64
v_swap_b32 v33, v65
v_swap_b32 v34, v66
v_swap_b32 v35, v67
v_swap_b32 v36, v68
v_swap_b32 v37, v69
v_swap_b32 v38, v70
v_swap_b32 v39, v71
v_swap_b32 v40, v72
v_swap_b32 v41, v73
v_swap_b32 v42, v74
v_swap_b32 v43, v75
v_swap_b32 v44, v76
v_swap_b32 v45, v77
v_swap_b32 v46, v78
v_swap_b32 v47, v79
v_swap_b32 v48, v80
v_swap_b32 v49, v81
v_swap_b32 v50, v82
v_swap_b32 v51, v83
v_swap_b32 v52, v84
v_swap_b32 v53, v85
v_swap_b32 v54, v86
v_swap_b32 v55, v87
v_swap_b32 v56, v88
v_swap_b32 v57, v89
v_swap_b32 v58, v90
v_swap_b32 v59, v91
v_swap_b32 v60, v92
v_swap_b32 v61, v93
v_swap_b32 v62, v94
v_swap_b32 v63, v95
L_safe_p3:
s_and_b32 s56, s28, 1
s_lshr_b32 s57, s28, 1
s_mul_i32 s58, s56, 8448
v_add_u32 v165, s58, v185
v_add_u32 v166, s58, v188
s_lshl_b32 s58, s57, 13
v_add_u32 v167, s58, v187
s_lshl_b32 s58, s57, 10
s_lshl_b32 s59, s56, 3
s_add_u32 s58, s58, s59
v_add_u32 v168, s58, v187
s_cmp_eq_u32 s56, 1
s_cselect_b64 vcc, -1, 0
v_cndmask_b32 v169, v186, v190, vcc
s_lshl_b32 s58, s28, 7
v_add_u32 v169, s58, v169
s_mul_i32 s63, s28, 4224
s_add_u32 s64, s63, 70048
s_add_u32 s63, s63, 130048
v_mov_b32 v160, 0xff800000
v_mov_b32 v161, 0xff800000
v_mov_b32 v162, 0xff800000
v_mov_b32 v163, 0xff800000
v_mov_b32 v164, 0xff800000
s_lshl_b32 s61, s28, 12
s_mov_b32 s46, 0
L_safe_a:
s_add_u32 m0, s63, 0
s_nop 0
buffer_load_dwordx4 v189, s[12:15], s61 offen offset:0 nt lds
s_add_u32 m0, s63, 32
s_nop 0
buffer_load_dwordx4 v189, s[12:15], s61 offen offset:1024 nt lds
s_add_u32 m0, s63, 64
s_nop 0
buffer_load_dwordx4 v189, s[12:15], s61 offen offset:2048 nt lds
s_add_u32 m0, s63, 96
s_nop 0
buffer_load_dwordx4 v189, s[12:15], s61 offen offset:3072 nt lds
s_waitcnt vmcnt(0)
s_barrier
ds_read_b128 a[224:227], v185 offset:0
s_waitcnt lgkmcnt(0)
v_mfma_f32_16x16x32_bf16 v[128:131], a[224:227], v[0:3], 0
v_mfma_f32_16x16x32_bf16 v[132:135], a[224:227], v[4:7], 0
v_mfma_f32_16x16x32_bf16 v[136:139], a[224:227], v[64:67], 0
v_mfma_f32_16x16x32_bf16 v[140:143], a[224:227], v[68:71], 0
ds_read_b128 a[224:227], v185 offset:64
s_waitcnt lgkmcnt(0)
v_mfma_f32_16x16x32_bf16 v[128:131], a[224:227], v[8:11], v[128:131]
v_mfma_f32_16x16x32_bf16 v[132:135], a[224:227], v[12:15], v[132:135]
v_mfma_f32_16x16x32_bf16 v[136:139], a[224:227], v[72:75], v[136:139]
v_mfma_f32_16x16x32_bf16 v[140:143], a[224:227], v[76:79], v[140:143]
ds_read_b128 a[224:227], v188 offset:128
s_waitcnt lgkmcnt(0)
v_mfma_f32_16x16x32_bf16 v[128:131], a[224:227], v[16:19], v[128:131]
v_mfma_f32_16x16x32_bf16 v[132:135], a[224:227], v[20:23], v[132:135]
v_mfma_f32_16x16x32_bf16 v[136:139], a[224:227], v[80:83], v[136:139]
v_mfma_f32_16x16x32_bf16 v[140:143], a[224:227], v[84:87], v[140:143]
ds_read_b128 a[224:227], v188 offset:192
s_waitcnt lgkmcnt(0)
v_mfma_f32_16x16x32_bf16 v[128:131], a[224:227], v[24:27], v[128:131]
v_mfma_f32_16x16x32_bf16 v[132:135], a[224:227], v[28:31], v[132:135]
v_mfma_f32_16x16x32_bf16 v[136:139], a[224:227], v[88:91], v[136:139]
v_mfma_f32_16x16x32_bf16 v[140:143], a[224:227], v[92:95], v[140:143]
ds_read_b128 a[224:227], v185 offset:256
s_waitcnt lgkmcnt(0)
v_mfma_f32_16x16x32_bf16 v[128:131], a[224:227], v[32:35], v[128:131]
v_mfma_f32_16x16x32_bf16 v[132:135], a[224:227], v[36:39], v[132:135]
v_mfma_f32_16x16x32_bf16 v[136:139], a[224:227], v[96:99], v[136:139]
v_mfma_f32_16x16x32_bf16 v[140:143], a[224:227], v[100:103], v[140:143]
ds_read_b128 a[224:227], v185 offset:320
s_waitcnt lgkmcnt(0)
v_mfma_f32_16x16x32_bf16 v[128:131], a[224:227], v[40:43], v[128:131]
v_mfma_f32_16x16x32_bf16 v[132:135], a[224:227], v[44:47], v[132:135]
v_mfma_f32_16x16x32_bf16 v[136:139], a[224:227], v[104:107], v[136:139]
v_mfma_f32_16x16x32_bf16 v[140:143], a[224:227], v[108:111], v[140:143]
ds_read_b128 a[224:227], v188 offset:384
s_waitcnt lgkmcnt(0)
v_mfma_f32_16x16x32_bf16 v[128:131], a[224:227], v[48:51], v[128:131]
v_mfma_f32_16x16x32_bf16 v[132:135], a[224:227], v[52:55], v[132:135]
v_mfma_f32_16x16x32_bf16 v[136:139], a[224:227], v[112:115], v[136:139]
v_mfma_f32_16x16x32_bf16 v[140:143], a[224:227], v[116:119], v[140:143]
ds_read_b128 a[224:227], v188 offset:448
s_waitcnt lgkmcnt(0)
v_mfma_f32_16x16x32_bf16 v[128:131], a[224:227], v[56:59], v[128:131]
v_mfma_f32_16x16x32_bf16 v[132:135], a[224:227], v[60:63], v[132:135]
v_mfma_f32_16x16x32_bf16 v[136:139], a[224:227], v[120:123], v[136:139]
v_mfma_f32_16x16x32_bf16 v[140:143], a[224:227], v[124:127], v[140:143]
ds_read_b128 a[224:227], v185 offset:8448
s_waitcnt lgkmcnt(0)
v_mfma_f32_16x16x32_bf16 v[144:147], a[224:227], v[0:3], 0
v_mfma_f32_16x16x32_bf16 v[148:151], a[224:227], v[4:7], 0
v_mfma_f32_16x16x32_bf16 v[152:155], a[224:227], v[64:67], 0
v_mfma_f32_16x16x32_bf16 v[156:159], a[224:227], v[68:71], 0
ds_read_b128 a[224:227], v185 offset:8512
s_waitcnt lgkmcnt(0)
v_mfma_f32_16x16x32_bf16 v[144:147], a[224:227], v[8:11], v[144:147]
v_mfma_f32_16x16x32_bf16 v[148:151], a[224:227], v[12:15], v[148:151]
v_mfma_f32_16x16x32_bf16 v[152:155], a[224:227], v[72:75], v[152:155]
v_mfma_f32_16x16x32_bf16 v[156:159], a[224:227], v[76:79], v[156:159]
ds_read_b128 a[224:227], v188 offset:8576
s_waitcnt lgkmcnt(0)
v_mfma_f32_16x16x32_bf16 v[144:147], a[224:227], v[16:19], v[144:147]
v_mfma_f32_16x16x32_bf16 v[148:151], a[224:227], v[20:23], v[148:151]
v_mfma_f32_16x16x32_bf16 v[152:155], a[224:227], v[80:83], v[152:155]
v_mfma_f32_16x16x32_bf16 v[156:159], a[224:227], v[84:87], v[156:159]
ds_read_b128 a[224:227], v188 offset:8640
s_waitcnt lgkmcnt(0)
v_mfma_f32_16x16x32_bf16 v[144:147], a[224:227], v[24:27], v[144:147]
v_mfma_f32_16x16x32_bf16 v[148:151], a[224:227], v[28:31], v[148:151]
v_mfma_f32_16x16x32_bf16 v[152:155], a[224:227], v[88:91], v[152:155]
v_mfma_f32_16x16x32_bf16 v[156:159], a[224:227], v[92:95], v[156:159]
ds_read_b128 a[224:227], v185 offset:8704
s_waitcnt lgkmcnt(0)
v_mfma_f32_16x16x32_bf16 v[144:147], a[224:227], v[32:35], v[144:147]
v_mfma_f32_16x16x32_bf16 v[148:151], a[224:227], v[36:39], v[148:151]
v_mfma_f32_16x16x32_bf16 v[152:155], a[224:227], v[96:99], v[152:155]
v_mfma_f32_16x16x32_bf16 v[156:159], a[224:227], v[100:103], v[156:159]
ds_read_b128 a[224:227], v185 offset:8768
s_waitcnt lgkmcnt(0)
v_mfma_f32_16x16x32_bf16 v[144:147], a[224:227], v[40:43], v[144:147]
v_mfma_f32_16x16x32_bf16 v[148:151], a[224:227], v[44:47], v[148:151]
v_mfma_f32_16x16x32_bf16 v[152:155], a[224:227], v[104:107], v[152:155]
v_mfma_f32_16x16x32_bf16 v[156:159], a[224:227], v[108:111], v[156:159]
ds_read_b128 a[224:227], v188 offset:8832
s_waitcnt lgkmcnt(0)
v_mfma_f32_16x16x32_bf16 v[144:147], a[224:227], v[48:51], v[144:147]
v_mfma_f32_16x16x32_bf16 v[148:151], a[224:227], v[52:55], v[148:151]
v_mfma_f32_16x16x32_bf16 v[152:155], a[224:227], v[112:115], v[152:155]
v_mfma_f32_16x16x32_bf16 v[156:159], a[224:227], v[116:119], v[156:159]
ds_read_b128 a[224:227], v188 offset:8896
s_waitcnt lgkmcnt(0)
v_mfma_f32_16x16x32_bf16 v[144:147], a[224:227], v[56:59], v[144:147]
v_mfma_f32_16x16x32_bf16 v[148:151], a[224:227], v[60:63], v[148:151]
v_mfma_f32_16x16x32_bf16 v[152:155], a[224:227], v[120:123], v[152:155]
v_mfma_f32_16x16x32_bf16 v[156:159], a[224:227], v[124:127], v[156:159]
ds_read_b128 a[228:231], v165 offset:0
ds_read_b128 a[232:235], v167 offset:0
s_waitcnt lgkmcnt(0)
v_mfma_f32_16x16x32_bf16 v[176:179], a[228:231], a[232:235], 0
ds_read_b128 a[228:231], v165 offset:64
ds_read_b128 a[232:235], v167 offset:1024
s_waitcnt lgkmcnt(0)
v_mfma_f32_16x16x32_bf16 v[176:179], a[228:231], a[232:235], v[176:179]
ds_read_b128 a[228:231], v166 offset:128
ds_read_b128 a[232:235], v167 offset:2048
s_waitcnt lgkmcnt(0)
v_mfma_f32_16x16x32_bf16 v[176:179], a[228:231], a[232:235], v[176:179]
ds_read_b128 a[228:231], v166 offset:192
ds_read_b128 a[232:235], v167 offset:3072
s_waitcnt lgkmcnt(0)
v_mfma_f32_16x16x32_bf16 v[176:179], a[228:231], a[232:235], v[176:179]
ds_read_b128 a[228:231], v165 offset:256
ds_read_b128 a[232:235], v167 offset:4096
s_waitcnt lgkmcnt(0)
v_mfma_f32_16x16x32_bf16 v[176:179], a[228:231], a[232:235], v[176:179]
ds_read_b128 a[228:231], v165 offset:320
ds_read_b128 a[232:235], v167 offset:5120
s_waitcnt lgkmcnt(0)
v_mfma_f32_16x16x32_bf16 v[176:179], a[228:231], a[232:235], v[176:179]
ds_read_b128 a[228:231], v166 offset:384
ds_read_b128 a[232:235], v167 offset:6144
s_waitcnt lgkmcnt(0)
v_mfma_f32_16x16x32_bf16 v[176:179], a[228:231], a[232:235], v[176:179]
ds_read_b128 a[228:231], v166 offset:448
ds_read_b128 a[232:235], v167 offset:7168
s_waitcnt lgkmcnt(0)
v_mfma_f32_16x16x32_bf16 v[176:179], a[228:231], a[232:235], v[176:179]
s_nop 7
s_nop 7
v_max3_f32 v160, v160, v128, v129
v_max3_f32 v160, v160, v130, v131
v_max3_f32 v160, v160, v144, v145
v_max3_f32 v160, v160, v146, v147
v_max3_f32 v161, v161, v132, v133
v_max3_f32 v161, v161, v134, v135
v_max3_f32 v161, v161, v148, v149
v_max3_f32 v161, v161, v150, v151
v_max3_f32 v162, v162, v136, v137
v_max3_f32 v162, v162, v138, v139
v_max3_f32 v162, v162, v152, v153
v_max3_f32 v162, v162, v154, v155
v_max3_f32 v163, v163, v140, v141
v_max3_f32 v163, v163, v142, v143
v_max3_f32 v163, v163, v156, v157
v_max3_f32 v163, v163, v158, v159
v_max3_f32 v164, v164, v176, v177
v_max3_f32 v164, v164, v178, v179
s_barrier
s_add_u32 s61, s61, 16384
s_add_u32 s46, s46, 1
s_cmp_lt_u32 s46, 32
s_cbranch_scc1 L_safe_a
v_mov_b32 v170, v160
s_nop 1
v_permlane32_swap_b32 v160, v170
s_nop 1
v_max_f32 v160, v160, v170
v_mov_b32 v170, v160
s_nop 1
v_permlane16_swap_b32 v160, v170
s_nop 1
v_max_f32 v160, v160, v170
v_mov_b32 v170, v161
s_nop 1
v_permlane32_swap_b32 v161, v170
s_nop 1
v_max_f32 v161, v161, v170
v_mov_b32 v170, v161
s_nop 1
v_permlane16_swap_b32 v161, v170
s_nop 1
v_max_f32 v161, v161, v170
v_mov_b32 v170, v162
s_nop 1
v_permlane32_swap_b32 v162, v170
s_nop 1
v_max_f32 v162, v162, v170
v_mov_b32 v170, v162
s_nop 1
v_permlane16_swap_b32 v162, v170
s_nop 1
v_max_f32 v162, v162, v170
v_mov_b32 v170, v163
s_nop 1
v_permlane32_swap_b32 v163, v170
s_nop 1
v_max_f32 v163, v163, v170
v_mov_b32 v170, v163
s_nop 1
v_permlane16_swap_b32 v163, v170
s_nop 1
v_max_f32 v163, v163, v170
v_mov_b32 v170, v164
s_nop 1
v_permlane32_swap_b32 v164, v170
s_nop 1
v_max_f32 v164, v164, v170
v_mov_b32 v170, v164
s_nop 1
v_permlane16_swap_b32 v164, v170
s_nop 1
v_max_f32 v164, v164, v170
v_and_b32 v170, 0xf0, v187
v_lshrrev_b32 v170, 2, v170
s_lshl_b32 s58, s28, 6
v_add_u32 v171, s58, v170
ds_write_b32 v171, v164 offset:18432
s_waitcnt lgkmcnt(0)
s_barrier
s_xor_b32 s58, s58, 64
v_add_u32 v171, s58, v170
ds_read_b32 v170, v171 offset:18432
s_waitcnt lgkmcnt(0)
v_max_f32 v164, v164, v170
v_accvgpr_write_b32 a0, 0
v_accvgpr_write_b32 a1, 0
v_accvgpr_write_b32 a2, 0
v_accvgpr_write_b32 a3, 0
v_accvgpr_write_b32 a4, 0
v_accvgpr_write_b32 a5, 0
v_accvgpr_write_b32 a6, 0
v_accvgpr_write_b32 a7, 0
v_accvgpr_write_b32 a8, 0
v_accvgpr_write_b32 a9, 0
v_accvgpr_write_b32 a10, 0
v_accvgpr_write_b32 a11, 0
v_accvgpr_write_b32 a12, 0
v_accvgpr_write_b32 a13, 0
v_accvgpr_write_b32 a14, 0
v_accvgpr_write_b32 a15, 0
v_accvgpr_write_b32 a16, 0
v_accvgpr_write_b32 a17, 0
v_accvgpr_write_b32 a18, 0
v_accvgpr_write_b32 a19, 0
v_accvgpr_write_b32 a20, 0
v_accvgpr_write_b32 a21, 0
v_accvgpr_write_b32 a22, 0
v_accvgpr_write_b32 a23, 0
v_accvgpr_write_b32 a24, 0
v_accvgpr_write_b32 a25, 0
v_accvgpr_write_b32 a26, 0
v_accvgpr_write_b32 a27, 0
v_accvgpr_write_b32 a28, 0
v_accvgpr_write_b32 a29, 0
v_accvgpr_write_b32 a30, 0
v_accvgpr_write_b32 a31, 0
v_accvgpr_write_b32 a32, 0
v_accvgpr_write_b32 a33, 0
v_accvgpr_write_b32 a34, 0
v_accvgpr_write_b32 a35, 0
v_accvgpr_write_b32 a36, 0
v_accvgpr_write_b32 a37, 0
v_accvgpr_write_b32 a38, 0
v_accvgpr_write_b32 a39, 0
v_accvgpr_write_b32 a40, 0
v_accvgpr_write_b32 a41, 0
v_accvgpr_write_b32 a42, 0
v_accvgpr_write_b32 a43, 0
v_accvgpr_write_b32 a44, 0
v_accvgpr_write_b32 a45, 0
v_accvgpr_write_b32 a46, 0
v_accvgpr_write_b32 a47, 0
v_accvgpr_write_b32 a48, 0
v_accvgpr_write_b32 a49, 0
v_accvgpr_write_b32 a50, 0
v_accvgpr_write_b32 a51, 0
v_accvgpr_write_b32 a52, 0
v_accvgpr_write_b32 a53, 0
v_accvgpr_write_b32 a54, 0
v_accvgpr_write_b32 a55, 0
v_accvgpr_write_b32 a56, 0
v_accvgpr_write_b32 a57, 0
v_accvgpr_write_b32 a58, 0
v_accvgpr_write_b32 a59, 0
v_accvgpr_write_b32 a60, 0
v_accvgpr_write_b32 a61, 0
v_accvgpr_write_b32 a62, 0
v_accvgpr_write_b32 a63, 0
v_accvgpr_write_b32 a64, 0
v_accvgpr_write_b32 a65, 0
v_accvgpr_write_b32 a66, 0
v_accvgpr_write_b32 a67, 0
v_accvgpr_write_b32 a68, 0
v_accvgpr_write_b32 a69, 0
v_accvgpr_write_b32 a70, 0
v_accvgpr_write_b32 a71, 0
v_accvgpr_write_b32 a72, 0
v_accvgpr_write_b32 a73, 0
v_accvgpr_write_b32 a74, 0
v_accvgpr_write_b32 a75, 0
v_accvgpr_write_b32 a76, 0
v_accvgpr_write_b32 a77, 0
v_accvgpr_write_b32 a78, 0
v_accvgpr_write_b32 a79, 0
v_accvgpr_write_b32 a80, 0
v_accvgpr_write_b32 a81, 0
v_accvgpr_write_b32 a82, 0
v_accvgpr_write_b32 a83, 0
v_accvgpr_write_b32 a84, 0
v_accvgpr_write_b32 a85, 0
v_accvgpr_write_b32 a86, 0
v_accvgpr_write_b32 a87, 0
v_accvgpr_write_b32 a88, 0
v_accvgpr_write_b32 a89, 0
v_accvgpr_write_b32 a90, 0
v_accvgpr_write_b32 a91, 0
v_accvgpr_write_b32 a92, 0
v_accvgpr_write_b32 a93, 0
v_accvgpr_write_b32 a94, 0
v_accvgpr_write_b32 a95, 0
v_accvgpr_write_b32 a96, 0
v_accvgpr_write_b32 a97, 0
v_accvgpr_write_b32 a98, 0
v_accvgpr_write_b32 a99, 0
v_accvgpr_write_b32 a100, 0
v_accvgpr_write_b32 a101, 0
v_accvgpr_write_b32 a102, 0
v_accvgpr_write_b32 a103, 0
v_accvgpr_write_b32 a104, 0
v_accvgpr_write_b32 a105, 0
v_accvgpr_write_b32 a106, 0
v_accvgpr_write_b32 a107, 0
v_accvgpr_write_b32 a108, 0
v_accvgpr_write_b32 a109, 0
v_accvgpr_write_b32 a110, 0
v_accvgpr_write_b32 a111, 0
v_accvgpr_write_b32 a112, 0
v_accvgpr_write_b32 a113, 0
v_accvgpr_write_b32 a114, 0
v_accvgpr_write_b32 a115, 0
v_accvgpr_write_b32 a116, 0
v_accvgpr_write_b32 a117, 0
v_accvgpr_write_b32 a118, 0
v_accvgpr_write_b32 a119, 0
v_accvgpr_write_b32 a120, 0
v_accvgpr_write_b32 a121, 0
v_accvgpr_write_b32 a122, 0
v_accvgpr_write_b32 a123, 0
v_accvgpr_write_b32 a124, 0
v_accvgpr_write_b32 a125, 0
v_accvgpr_write_b32 a126, 0
v_accvgpr_write_b32 a127, 0
v_accvgpr_write_b32 a128, 0
v_accvgpr_write_b32 a129, 0
v_accvgpr_write_b32 a130, 0
v_accvgpr_write_b32 a131, 0
v_accvgpr_write_b32 a132, 0
v_accvgpr_write_b32 a133, 0
v_accvgpr_write_b32 a134, 0
v_accvgpr_write_b32 a135, 0
v_accvgpr_write_b32 a136, 0
v_accvgpr_write_b32 a137, 0
v_accvgpr_write_b32 a138, 0
v_accvgpr_write_b32 a139, 0
v_accvgpr_write_b32 a140, 0
v_accvgpr_write_b32 a141, 0
v_accvgpr_write_b32 a142, 0
v_accvgpr_write_b32 a143, 0
v_accvgpr_write_b32 a144, 0
v_accvgpr_write_b32 a145, 0
v_accvgpr_write_b32 a146, 0
v_accvgpr_write_b32 a147, 0
v_accvgpr_write_b32 a148, 0
v_accvgpr_write_b32 a149, 0
v_accvgpr_write_b32 a150, 0
v_accvgpr_write_b32 a151, 0
v_accvgpr_write_b32 a152, 0
v_accvgpr_write_b32 a153, 0
v_accvgpr_write_b32 a154, 0
v_accvgpr_write_b32 a155, 0
v_accvgpr_write_b32 a156, 0
v_accvgpr_write_b32 a157, 0
v_accvgpr_write_b32 a158, 0
v_accvgpr_write_b32 a159, 0
v_accvgpr_write_b32 a160, 0
v_accvgpr_write_b32 a161, 0
v_accvgpr_write_b32 a162, 0
v_accvgpr_write_b32 a163, 0
v_accvgpr_write_b32 a164, 0
v_accvgpr_write_b32 a165, 0
v_accvgpr_write_b32 a166, 0
v_accvgpr_write_b32 a167, 0
v_accvgpr_write_b32 a168, 0
v_accvgpr_write_b32 a169, 0
v_accvgpr_write_b32 a170, 0
v_accvgpr_write_b32 a171, 0
v_accvgpr_write_b32 a172, 0
v_accvgpr_write_b32 a173, 0
v_accvgpr_write_b32 a174, 0
v_accvgpr_write_b32 a175, 0
v_accvgpr_write_b32 a176, 0
v_accvgpr_write_b32 a177, 0
v_accvgpr_write_b32 a178, 0
v_accvgpr_write_b32 a179, 0
v_accvgpr_write_b32 a180, 0
v_accvgpr_write_b32 a181, 0
v_accvgpr_write_b32 a182, 0
v_accvgpr_write_b32 a183, 0
v_accvgpr_write_b32 a184, 0
v_accvgpr_write_b32 a185, 0
v_accvgpr_write_b32 a186, 0
v_accvgpr_write_b32 a187, 0
v_accvgpr_write_b32 a188, 0
v_accvgpr_write_b32 a189, 0
v_accvgpr_write_b32 a190, 0
v_accvgpr_write_b32 a191, 0
v_accvgpr_write_b32 a192, 0
v_accvgpr_write_b32 a193, 0
v_accvgpr_write_b32 a194, 0
v_accvgpr_write_b32 a195, 0
v_accvgpr_write_b32 a196, 0
v_accvgpr_write_b32 a197, 0
v_accvgpr_write_b32 a198, 0
v_accvgpr_write_b32 a199, 0
v_accvgpr_write_b32 a200, 0
v_accvgpr_write_b32 a201, 0
v_accvgpr_write_b32 a202, 0
v_accvgpr_write_b32 a203, 0
v_accvgpr_write_b32 a204, 0
v_accvgpr_write_b32 a205, 0
v_accvgpr_write_b32 a206, 0
v_accvgpr_write_b32 a207, 0
v_accvgpr_write_b32 a208, 0
v_accvgpr_write_b32 a209, 0
v_accvgpr_write_b32 a210, 0
v_accvgpr_write_b32 a211, 0
v_accvgpr_write_b32 a212, 0
v_accvgpr_write_b32 a213, 0
v_accvgpr_write_b32 a214, 0
v_accvgpr_write_b32 a215, 0
v_accvgpr_write_b32 a216, 0
v_accvgpr_write_b32 a217, 0
v_accvgpr_write_b32 a218, 0
v_accvgpr_write_b32 a219, 0
v_accvgpr_write_b32 a220, 0
v_accvgpr_write_b32 a221, 0
v_accvgpr_write_b32 a222, 0
v_accvgpr_write_b32 a223, 0
v_mov_b32 v192, 0
v_mov_b32 v193, 0
v_mov_b32 v194, 0
v_mov_b32 v195, 0
v_mov_b32 v196, 0
v_mov_b32 v197, 0
v_mov_b32 v198, 0
v_mov_b32 v199, 0
v_mov_b32 v200, 0
v_mov_b32 v201, 0
v_mov_b32 v202, 0
v_mov_b32 v203, 0
v_mov_b32 v204, 0
v_mov_b32 v205, 0
v_mov_b32 v206, 0
v_mov_b32 v207, 0
v_mov_b32 v208, 0
v_mov_b32 v209, 0
v_mov_b32 v210, 0
v_mov_b32 v211, 0
v_mov_b32 v212, 0
v_mov_b32 v213, 0
v_mov_b32 v214, 0
v_mov_b32 v215, 0
v_mov_b32 v216, 0
v_mov_b32 v217, 0
v_mov_b32 v218, 0
v_mov_b32 v219, 0
v_mov_b32 v220, 0
v_mov_b32 v221, 0
v_mov_b32 v222, 0
v_mov_b32 v223, 0
v_mov_b32 v224, 0
v_mov_b32 v225, 0
v_mov_b32 v226, 0
v_mov_b32 v227, 0
v_mov_b32 v228, 0
v_mov_b32 v229, 0
v_mov_b32 v230, 0
v_mov_b32 v231, 0
v_mov_b32 v232, 0
v_mov_b32 v233, 0
v_mov_b32 v234, 0
v_mov_b32 v235, 0
v_mov_b32 v236, 0
v_mov_b32 v237, 0
v_mov_b32 v238, 0
v_mov_b32 v239, 0
v_mov_b32 v240, 0
v_mov_b32 v241, 0
v_mov_b32 v242, 0
v_mov_b32 v243, 0
v_mov_b32 v244, 0
v_mov_b32 v245, 0
v_mov_b32 v246, 0
v_mov_b32 v247, 0
v_mov_b32 v248, 0
v_mov_b32 v249, 0
v_mov_b32 v250, 0
v_mov_b32 v251, 0
v_mov_b32 v252, 0
v_mov_b32 v253, 0
v_mov_b32 v254, 0
v_mov_b32 v255, 0
v_mov_b32 v180, 0
v_mov_b32 v181, 0
v_mov_b32 v182, 0
v_mov_b32 v183, 0
v_mov_b32 v184, 0
s_lshl_b32 s61, s28, 12
s_mov_b32 s46, 0
L_safe_b:
s_add_u32 m0, s63, 0
s_nop 0
buffer_load_dwordx4 v189, s[12:15], s61 offen offset:0 nt lds
s_add_u32 m0, s63, 32
s_nop 0
buffer_load_dwordx4 v189, s[12:15], s61 offen offset:1024 nt lds
s_add_u32 m0, s63, 64
s_nop 0
buffer_load_dwordx4 v189, s[12:15], s61 offen offset:2048 nt lds
s_add_u32 m0, s63, 96
s_nop 0
buffer_load_dwordx4 v189, s[12:15], s61 offen offset:3072 nt lds
s_add_u32 m0, s64, 0
s_nop 0
buffer_load_dwordx4 v189, s[16:19], s61 offen offset:0 nt lds
s_add_u32 m0, s64, 32
s_nop 0
buffer_load_dwordx4 v189, s[16:19], s61 offen offset:1024 nt lds
s_add_u32 m0, s64, 64
s_nop 0
buffer_load_dwordx4 v189, s[16:19], s61 offen offset:2048 nt lds
s_add_u32 m0, s64, 96
s_nop 0
buffer_load_dwordx4 v189, s[16:19], s61 offen offset:3072 nt lds
s_waitcnt vmcnt(0)
s_barrier
ds_read_b128 a[224:227], v185 offset:0
s_waitcnt lgkmcnt(0)
v_mfma_f32_16x16x32_bf16 v[128:131], a[224:227], v[0:3], 0
v_mfma_f32_16x16x32_bf16 v[132:135], a[224:227], v[4:7], 0
v_mfma_f32_16x16x32_bf16 v[136:139], a[224:227], v[64:67], 0
v_mfma_f32_16x16x32_bf16 v[140:143], a[224:227], v[68:71], 0
ds_read_b128 a[224:227], v185 offset:64
s_waitcnt lgkmcnt(0)
v_mfma_f32_16x16x32_bf16 v[128:131], a[224:227], v[8:11], v[128:131]
v_mfma_f32_16x16x32_bf16 v[132:135], a[224:227], v[12:15], v[132:135]
v_mfma_f32_16x16x32_bf16 v[136:139], a[224:227], v[72:75], v[136:139]
v_mfma_f32_16x16x32_bf16 v[140:143], a[224:227], v[76:79], v[140:143]
ds_read_b128 a[224:227], v188 offset:128
s_waitcnt lgkmcnt(0)
v_mfma_f32_16x16x32_bf16 v[128:131], a[224:227], v[16:19], v[128:131]
v_mfma_f32_16x16x32_bf16 v[132:135], a[224:227], v[20:23], v[132:135]
v_mfma_f32_16x16x32_bf16 v[136:139], a[224:227], v[80:83], v[136:139]
v_mfma_f32_16x16x32_bf16 v[140:143], a[224:227], v[84:87], v[140:143]
ds_read_b128 a[224:227], v188 offset:192
s_waitcnt lgkmcnt(0)
v_mfma_f32_16x16x32_bf16 v[128:131], a[224:227], v[24:27], v[128:131]
v_mfma_f32_16x16x32_bf16 v[132:135], a[224:227], v[28:31], v[132:135]
v_mfma_f32_16x16x32_bf16 v[136:139], a[224:227], v[88:91], v[136:139]
v_mfma_f32_16x16x32_bf16 v[140:143], a[224:227], v[92:95], v[140:143]
ds_read_b128 a[224:227], v185 offset:256
s_waitcnt lgkmcnt(0)
v_mfma_f32_16x16x32_bf16 v[128:131], a[224:227], v[32:35], v[128:131]
v_mfma_f32_16x16x32_bf16 v[132:135], a[224:227], v[36:39], v[132:135]
v_mfma_f32_16x16x32_bf16 v[136:139], a[224:227], v[96:99], v[136:139]
v_mfma_f32_16x16x32_bf16 v[140:143], a[224:227], v[100:103], v[140:143]
ds_read_b128 a[224:227], v185 offset:320
s_waitcnt lgkmcnt(0)
v_mfma_f32_16x16x32_bf16 v[128:131], a[224:227], v[40:43], v[128:131]
v_mfma_f32_16x16x32_bf16 v[132:135], a[224:227], v[44:47], v[132:135]
v_mfma_f32_16x16x32_bf16 v[136:139], a[224:227], v[104:107], v[136:139]
v_mfma_f32_16x16x32_bf16 v[140:143], a[224:227], v[108:111], v[140:143]
ds_read_b128 a[224:227], v188 offset:384
s_waitcnt lgkmcnt(0)
v_mfma_f32_16x16x32_bf16 v[128:131], a[224:227], v[48:51], v[128:131]
v_mfma_f32_16x16x32_bf16 v[132:135], a[224:227], v[52:55], v[132:135]
v_mfma_f32_16x16x32_bf16 v[136:139], a[224:227], v[112:115], v[136:139]
v_mfma_f32_16x16x32_bf16 v[140:143], a[224:227], v[116:119], v[140:143]
ds_read_b128 a[224:227], v188 offset:448
s_waitcnt lgkmcnt(0)
v_mfma_f32_16x16x32_bf16 v[128:131], a[224:227], v[56:59], v[128:131]
v_mfma_f32_16x16x32_bf16 v[132:135], a[224:227], v[60:63], v[132:135]
v_mfma_f32_16x16x32_bf16 v[136:139], a[224:227], v[120:123], v[136:139]
v_mfma_f32_16x16x32_bf16 v[140:143], a[224:227], v[124:127], v[140:143]
ds_read_b128 a[224:227], v185 offset:8448
s_waitcnt lgkmcnt(0)
v_mfma_f32_16x16x32_bf16 v[144:147], a[224:227], v[0:3], 0
v_mfma_f32_16x16x32_bf16 v[148:151], a[224:227], v[4:7], 0
v_mfma_f32_16x16x32_bf16 v[152:155], a[224:227], v[64:67], 0
v_mfma_f32_16x16x32_bf16 v[156:159], a[224:227], v[68:71], 0
ds_read_b128 a[224:227], v185 offset:8512
s_waitcnt lgkmcnt(0)
v_mfma_f32_16x16x32_bf16 v[144:147], a[224:227], v[8:11], v[144:147]
v_mfma_f32_16x16x32_bf16 v[148:151], a[224:227], v[12:15], v[148:151]
v_mfma_f32_16x16x32_bf16 v[152:155], a[224:227], v[72:75], v[152:155]
v_mfma_f32_16x16x32_bf16 v[156:159], a[224:227], v[76:79], v[156:159]
ds_read_b128 a[224:227], v188 offset:8576
s_waitcnt lgkmcnt(0)
v_mfma_f32_16x16x32_bf16 v[144:147], a[224:227], v[16:19], v[144:147]
v_mfma_f32_16x16x32_bf16 v[148:151], a[224:227], v[20:23], v[148:151]
v_mfma_f32_16x16x32_bf16 v[152:155], a[224:227], v[80:83], v[152:155]
v_mfma_f32_16x16x32_bf16 v[156:159], a[224:227], v[84:87], v[156:159]
ds_read_b128 a[224:227], v188 offset:8640
s_waitcnt lgkmcnt(0)
v_mfma_f32_16x16x32_bf16 v[144:147], a[224:227], v[24:27], v[144:147]
v_mfma_f32_16x16x32_bf16 v[148:151], a[224:227], v[28:31], v[148:151]
v_mfma_f32_16x16x32_bf16 v[152:155], a[224:227], v[88:91], v[152:155]
v_mfma_f32_16x16x32_bf16 v[156:159], a[224:227], v[92:95], v[156:159]
ds_read_b128 a[224:227], v185 offset:8704
s_waitcnt lgkmcnt(0)
v_mfma_f32_16x16x32_bf16 v[144:147], a[224:227], v[32:35], v[144:147]
v_mfma_f32_16x16x32_bf16 v[148:151], a[224:227], v[36:39], v[148:151]
v_mfma_f32_16x16x32_bf16 v[152:155], a[224:227], v[96:99], v[152:155]
v_mfma_f32_16x16x32_bf16 v[156:159], a[224:227], v[100:103], v[156:159]
ds_read_b128 a[224:227], v185 offset:8768
s_waitcnt lgkmcnt(0)
v_mfma_f32_16x16x32_bf16 v[144:147], a[224:227], v[40:43], v[144:147]
v_mfma_f32_16x16x32_bf16 v[148:151], a[224:227], v[44:47], v[148:151]
v_mfma_f32_16x16x32_bf16 v[152:155], a[224:227], v[104:107], v[152:155]
v_mfma_f32_16x16x32_bf16 v[156:159], a[224:227], v[108:111], v[156:159]
ds_read_b128 a[224:227], v188 offset:8832
s_waitcnt lgkmcnt(0)
v_mfma_f32_16x16x32_bf16 v[144:147], a[224:227], v[48:51], v[144:147]
v_mfma_f32_16x16x32_bf16 v[148:151], a[224:227], v[52:55], v[148:151]
v_mfma_f32_16x16x32_bf16 v[152:155], a[224:227], v[112:115], v[152:155]
v_mfma_f32_16x16x32_bf16 v[156:159], a[224:227], v[116:119], v[156:159]
ds_read_b128 a[224:227], v188 offset:8896
s_waitcnt lgkmcnt(0)
v_mfma_f32_16x16x32_bf16 v[144:147], a[224:227], v[56:59], v[144:147]
v_mfma_f32_16x16x32_bf16 v[148:151], a[224:227], v[60:63], v[148:151]
v_mfma_f32_16x16x32_bf16 v[152:155], a[224:227], v[120:123], v[152:155]
v_mfma_f32_16x16x32_bf16 v[156:159], a[224:227], v[124:127], v[156:159]
ds_read_b128 a[228:231], v165 offset:0
ds_read_b128 a[232:235], v167 offset:0
s_waitcnt lgkmcnt(0)
v_mfma_f32_16x16x32_bf16 v[176:179], a[228:231], a[232:235], 0
ds_read_b128 a[228:231], v165 offset:64
ds_read_b128 a[232:235], v167 offset:1024
s_waitcnt lgkmcnt(0)
v_mfma_f32_16x16x32_bf16 v[176:179], a[228:231], a[232:235], v[176:179]
ds_read_b128 a[228:231], v166 offset:128
ds_read_b128 a[232:235], v167 offset:2048
s_waitcnt lgkmcnt(0)
v_mfma_f32_16x16x32_bf16 v[176:179], a[228:231], a[232:235], v[176:179]
ds_read_b128 a[228:231], v166 offset:192
ds_read_b128 a[232:235], v167 offset:3072
s_waitcnt lgkmcnt(0)
v_mfma_f32_16x16x32_bf16 v[176:179], a[228:231], a[232:235], v[176:179]
ds_read_b128 a[228:231], v165 offset:256
ds_read_b128 a[232:235], v167 offset:4096
s_waitcnt lgkmcnt(0)
v_mfma_f32_16x16x32_bf16 v[176:179], a[228:231], a[232:235], v[176:179]
ds_read_b128 a[228:231], v165 offset:320
ds_read_b128 a[232:235], v167 offset:5120
s_waitcnt lgkmcnt(0)
v_mfma_f32_16x16x32_bf16 v[176:179], a[228:231], a[232:235], v[176:179]
ds_read_b128 a[228:231], v166 offset:384
ds_read_b128 a[232:235], v167 offset:6144
s_waitcnt lgkmcnt(0)
v_mfma_f32_16x16x32_bf16 v[176:179], a[228:231], a[232:235], v[176:179]
ds_read_b128 a[228:231], v166 offset:448
ds_read_b128 a[232:235], v167 offset:7168
s_waitcnt lgkmcnt(0)
v_mfma_f32_16x16x32_bf16 v[176:179], a[228:231], a[232:235], v[176:179]
s_nop 7
s_nop 7
v_sub_f32 v128, v128, v160
v_sub_f32 v129, v129, v160
v_sub_f32 v130, v130, v160
v_sub_f32 v131, v131, v160
v_exp_f32 v128, v128
v_exp_f32 v129, v129
v_exp_f32 v130, v130
v_exp_f32 v131, v131
s_nop 0
v_add_f32 v180, v180, v128
v_add_f32 v180, v180, v129
v_add_f32 v180, v180, v130
v_add_f32 v180, v180, v131
v_sub_f32 v144, v144, v160
v_sub_f32 v145, v145, v160
v_sub_f32 v146, v146, v160
v_sub_f32 v147, v147, v160
v_exp_f32 v144, v144
v_exp_f32 v145, v145
v_exp_f32 v146, v146
v_exp_f32 v147, v147
s_nop 0
v_add_f32 v180, v180, v144
v_add_f32 v180, v180, v145
v_add_f32 v180, v180, v146
v_add_f32 v180, v180, v147
v_cvt_pk_bf16_f32 v128, v128, v129
v_cvt_pk_bf16_f32 v129, v130, v131
v_cvt_pk_bf16_f32 v130, v144, v145
v_cvt_pk_bf16_f32 v131, v146, v147
v_sub_f32 v132, v132, v161
v_sub_f32 v133, v133, v161
v_sub_f32 v134, v134, v161
v_sub_f32 v135, v135, v161
v_exp_f32 v132, v132
v_exp_f32 v133, v133
v_exp_f32 v134, v134
v_exp_f32 v135, v135
s_nop 0
v_add_f32 v181, v181, v132
v_add_f32 v181, v181, v133
v_add_f32 v181, v181, v134
v_add_f32 v181, v181, v135
v_sub_f32 v148, v148, v161
v_sub_f32 v149, v149, v161
v_sub_f32 v150, v150, v161
v_sub_f32 v151, v151, v161
v_exp_f32 v148, v148
v_exp_f32 v149, v149
v_exp_f32 v150, v150
v_exp_f32 v151, v151
s_nop 0
v_add_f32 v181, v181, v148
v_add_f32 v181, v181, v149
v_add_f32 v181, v181, v150
v_add_f32 v181, v181, v151
v_cvt_pk_bf16_f32 v132, v132, v133
v_cvt_pk_bf16_f32 v133, v134, v135
v_cvt_pk_bf16_f32 v134, v148, v149
v_cvt_pk_bf16_f32 v135, v150, v151
v_sub_f32 v136, v136, v162
v_sub_f32 v137, v137, v162
v_sub_f32 v138, v138, v162
v_sub_f32 v139, v139, v162
v_exp_f32 v136, v136
v_exp_f32 v137, v137
v_exp_f32 v138, v138
v_exp_f32 v139, v139
s_nop 0
v_add_f32 v182, v182, v136
v_add_f32 v182, v182, v137
v_add_f32 v182, v182, v138
v_add_f32 v182, v182, v139
v_sub_f32 v152, v152, v162
v_sub_f32 v153, v153, v162
v_sub_f32 v154, v154, v162
v_sub_f32 v155, v155, v162
v_exp_f32 v152, v152
v_exp_f32 v153, v153
v_exp_f32 v154, v154
v_exp_f32 v155, v155
s_nop 0
v_add_f32 v182, v182, v152
v_add_f32 v182, v182, v153
v_add_f32 v182, v182, v154
v_add_f32 v182, v182, v155
v_cvt_pk_bf16_f32 v136, v136, v137
v_cvt_pk_bf16_f32 v137, v138, v139
v_cvt_pk_bf16_f32 v138, v152, v153
v_cvt_pk_bf16_f32 v139, v154, v155
v_sub_f32 v140, v140, v163
v_sub_f32 v141, v141, v163
v_sub_f32 v142, v142, v163
v_sub_f32 v143, v143, v163
v_exp_f32 v140, v140
v_exp_f32 v141, v141
v_exp_f32 v142, v142
v_exp_f32 v143, v143
s_nop 0
v_add_f32 v183, v183, v140
v_add_f32 v183, v183, v141
v_add_f32 v183, v183, v142
v_add_f32 v183, v183, v143
v_sub_f32 v156, v156, v163
v_sub_f32 v157, v157, v163
v_sub_f32 v158, v158, v163
v_sub_f32 v159, v159, v163
v_exp_f32 v156, v156
v_exp_f32 v157, v157
v_exp_f32 v158, v158
v_exp_f32 v159, v159
s_nop 0
v_add_f32 v183, v183, v156
v_add_f32 v183, v183, v157
v_add_f32 v183, v183, v158
v_add_f32 v183, v183, v159
v_cvt_pk_bf16_f32 v140, v140, v141
v_cvt_pk_bf16_f32 v141, v142, v143
v_cvt_pk_bf16_f32 v142, v156, v157
v_cvt_pk_bf16_f32 v143, v158, v159
v_sub_f32 v176, v176, v164
v_sub_f32 v177, v177, v164
v_sub_f32 v178, v178, v164
v_sub_f32 v179, v179, v164
v_exp_f32 v176, v176
v_exp_f32 v177, v177
v_exp_f32 v178, v178
v_exp_f32 v179, v179
s_nop 0
v_add_f32 v184, v184, v176
v_add_f32 v184, v184, v177
v_add_f32 v184, v184, v178
v_add_f32 v184, v184, v179
v_cvt_pk_bf16_f32 v176, v176, v177
v_cvt_pk_bf16_f32 v177, v178, v179
ds_write_b64 v168, v[176:177] offset:16384
s_waitcnt lgkmcnt(0)
s_barrier
ds_read_b64_tr_b16 a[224:225], v186 offset:0
ds_read_b64_tr_b16 a[226:227], v186 offset:8448
s_waitcnt lgkmcnt(0)
v_mfma_f32_16x16x32_bf16 a[0:3], a[224:227], v[128:131], a[0:3]
v_mfma_f32_16x16x32_bf16 a[64:67], a[224:227], v[132:135], a[64:67]
v_mfma_f32_16x16x32_bf16 a[128:131], a[224:227], v[136:139], a[128:131]
v_mfma_f32_16x16x32_bf16 v[192:195], a[224:227], v[140:143], v[192:195]
ds_read_b64_tr_b16 a[224:225], v186 offset:32
ds_read_b64_tr_b16 a[226:227], v186 offset:8480
s_waitcnt lgkmcnt(0)
v_mfma_f32_16x16x32_bf16 a[4:7], a[224:227], v[128:131], a[4:7]
v_mfma_f32_16x16x32_bf16 a[68:71], a[224:227], v[132:135], a[68:71]
v_mfma_f32_16x16x32_bf16 a[132:135], a[224:227], v[136:139], a[132:135]
v_mfma_f32_16x16x32_bf16 v[196:199], a[224:227], v[140:143], v[196:199]
ds_read_b64_tr_b16 a[224:225], v186 offset:64
ds_read_b64_tr_b16 a[226:227], v186 offset:8512
s_waitcnt lgkmcnt(0)
v_mfma_f32_16x16x32_bf16 a[8:11], a[224:227], v[128:131], a[8:11]
v_mfma_f32_16x16x32_bf16 a[72:75], a[224:227], v[132:135], a[72:75]
v_mfma_f32_16x16x32_bf16 a[136:139], a[224:227], v[136:139], a[136:139]
v_mfma_f32_16x16x32_bf16 v[200:203], a[224:227], v[140:143], v[200:203]
ds_read_b64_tr_b16 a[224:225], v186 offset:96
ds_read_b64_tr_b16 a[226:227], v186 offset:8544
s_waitcnt lgkmcnt(0)
v_mfma_f32_16x16x32_bf16 a[12:15], a[224:227], v[128:131], a[12:15]
v_mfma_f32_16x16x32_bf16 a[76:79], a[224:227], v[132:135], a[76:79]
v_mfma_f32_16x16x32_bf16 a[140:143], a[224:227], v[136:139], a[140:143]
v_mfma_f32_16x16x32_bf16 v[204:207], a[224:227], v[140:143], v[204:207]
ds_read_b64_tr_b16 a[224:225], v190 offset:128
ds_read_b64_tr_b16 a[226:227], v190 offset:8576
s_waitcnt lgkmcnt(0)
v_mfma_f32_16x16x32_bf16 a[16:19], a[224:227], v[128:131], a[16:19]
v_mfma_f32_16x16x32_bf16 a[80:83], a[224:227], v[132:135], a[80:83]
v_mfma_f32_16x16x32_bf16 a[144:147], a[224:227], v[136:139], a[144:147]
v_mfma_f32_16x16x32_bf16 v[208:211], a[224:227], v[140:143], v[208:211]
ds_read_b64_tr_b16 a[224:225], v190 offset:160
ds_read_b64_tr_b16 a[226:227], v190 offset:8608
s_waitcnt lgkmcnt(0)
v_mfma_f32_16x16x32_bf16 a[20:23], a[224:227], v[128:131], a[20:23]
v_mfma_f32_16x16x32_bf16 a[84:87], a[224:227], v[132:135], a[84:87]
v_mfma_f32_16x16x32_bf16 a[148:151], a[224:227], v[136:139], a[148:151]
v_mfma_f32_16x16x32_bf16 v[212:215], a[224:227], v[140:143], v[212:215]
ds_read_b64_tr_b16 a[224:225], v190 offset:192
ds_read_b64_tr_b16 a[226:227], v190 offset:8640
s_waitcnt lgkmcnt(0)
v_mfma_f32_16x16x32_bf16 a[24:27], a[224:227], v[128:131], a[24:27]
v_mfma_f32_16x16x32_bf16 a[88:91], a[224:227], v[132:135], a[88:91]
v_mfma_f32_16x16x32_bf16 a[152:155], a[224:227], v[136:139], a[152:155]
v_mfma_f32_16x16x32_bf16 v[216:219], a[224:227], v[140:143], v[216:219]
ds_read_b64_tr_b16 a[224:225], v190 offset:224
ds_read_b64_tr_b16 a[226:227], v190 offset:8672
s_waitcnt lgkmcnt(0)
v_mfma_f32_16x16x32_bf16 a[28:31], a[224:227], v[128:131], a[28:31]
v_mfma_f32_16x16x32_bf16 a[92:95], a[224:227], v[132:135], a[92:95]
v_mfma_f32_16x16x32_bf16 a[156:159], a[224:227], v[136:139], a[156:159]
v_mfma_f32_16x16x32_bf16 v[220:223], a[224:227], v[140:143], v[220:223]
ds_read_b64_tr_b16 a[224:225], v186 offset:256
ds_read_b64_tr_b16 a[226:227], v186 offset:8704
s_waitcnt lgkmcnt(0)
v_mfma_f32_16x16x32_bf16 a[32:35], a[224:227], v[128:131], a[32:35]
v_mfma_f32_16x16x32_bf16 a[96:99], a[224:227], v[132:135], a[96:99]
v_mfma_f32_16x16x32_bf16 a[160:163], a[224:227], v[136:139], a[160:163]
v_mfma_f32_16x16x32_bf16 v[224:227], a[224:227], v[140:143], v[224:227]
ds_read_b64_tr_b16 a[224:225], v186 offset:288
ds_read_b64_tr_b16 a[226:227], v186 offset:8736
s_waitcnt lgkmcnt(0)
v_mfma_f32_16x16x32_bf16 a[36:39], a[224:227], v[128:131], a[36:39]
v_mfma_f32_16x16x32_bf16 a[100:103], a[224:227], v[132:135], a[100:103]
v_mfma_f32_16x16x32_bf16 a[164:167], a[224:227], v[136:139], a[164:167]
v_mfma_f32_16x16x32_bf16 v[228:231], a[224:227], v[140:143], v[228:231]
ds_read_b64_tr_b16 a[224:225], v186 offset:320
ds_read_b64_tr_b16 a[226:227], v186 offset:8768
s_waitcnt lgkmcnt(0)
v_mfma_f32_16x16x32_bf16 a[40:43], a[224:227], v[128:131], a[40:43]
v_mfma_f32_16x16x32_bf16 a[104:107], a[224:227], v[132:135], a[104:107]
v_mfma_f32_16x16x32_bf16 a[168:171], a[224:227], v[136:139], a[168:171]
v_mfma_f32_16x16x32_bf16 v[232:235], a[224:227], v[140:143], v[232:235]
ds_read_b64_tr_b16 a[224:225], v186 offset:352
ds_read_b64_tr_b16 a[226:227], v186 offset:8800
s_waitcnt lgkmcnt(0)
v_mfma_f32_16x16x32_bf16 a[44:47], a[224:227], v[128:131], a[44:47]
v_mfma_f32_16x16x32_bf16 a[108:111], a[224:227], v[132:135], a[108:111]
v_mfma_f32_16x16x32_bf16 a[172:175], a[224:227], v[136:139], a[172:175]
v_mfma_f32_16x16x32_bf16 v[236:239], a[224:227], v[140:143], v[236:239]
ds_read_b64_tr_b16 a[224:225], v190 offset:384
ds_read_b64_tr_b16 a[226:227], v190 offset:8832
s_waitcnt lgkmcnt(0)
v_mfma_f32_16x16x32_bf16 a[48:51], a[224:227], v[128:131], a[48:51]
v_mfma_f32_16x16x32_bf16 a[112:115], a[224:227], v[132:135], a[112:115]
v_mfma_f32_16x16x32_bf16 a[176:179], a[224:227], v[136:139], a[176:179]
v_mfma_f32_16x16x32_bf16 v[240:243], a[224:227], v[140:143], v[240:243]
ds_read_b64_tr_b16 a[224:225], v190 offset:416
ds_read_b64_tr_b16 a[226:227], v190 offset:8864
s_waitcnt lgkmcnt(0)
v_mfma_f32_16x16x32_bf16 a[52:55], a[224:227], v[128:131], a[52:55]
v_mfma_f32_16x16x32_bf16 a[116:119], a[224:227], v[132:135], a[116:119]
v_mfma_f32_16x16x32_bf16 a[180:183], a[224:227], v[136:139], a[180:183]
v_mfma_f32_16x16x32_bf16 v[244:247], a[224:227], v[140:143], v[244:247]
ds_read_b64_tr_b16 a[224:225], v190 offset:448
ds_read_b64_tr_b16 a[226:227], v190 offset:8896
s_waitcnt lgkmcnt(0)
v_mfma_f32_16x16x32_bf16 a[56:59], a[224:227], v[128:131], a[56:59]
v_mfma_f32_16x16x32_bf16 a[120:123], a[224:227], v[132:135], a[120:123]
v_mfma_f32_16x16x32_bf16 a[184:187], a[224:227], v[136:139], a[184:187]
v_mfma_f32_16x16x32_bf16 v[248:251], a[224:227], v[140:143], v[248:251]
ds_read_b64_tr_b16 a[224:225], v190 offset:480
ds_read_b64_tr_b16 a[226:227], v190 offset:8928
s_waitcnt lgkmcnt(0)
v_mfma_f32_16x16x32_bf16 a[60:63], a[224:227], v[128:131], a[60:63]
v_mfma_f32_16x16x32_bf16 a[124:127], a[224:227], v[132:135], a[124:127]
v_mfma_f32_16x16x32_bf16 a[188:191], a[224:227], v[136:139], a[188:191]
v_mfma_f32_16x16x32_bf16 v[252:255], a[224:227], v[140:143], v[252:255]
ds_read_b128 a[232:235], v187 offset:16384
ds_read_b128 a[236:239], v187 offset:17408
ds_read_b64_tr_b16 a[224:225], v169 offset:0
ds_read_b64_tr_b16 a[226:227], v169 offset:8448
s_waitcnt lgkmcnt(0)
v_mfma_f32_16x16x32_bf16 a[192:195], a[224:227], a[232:235], a[192:195]
v_mfma_f32_16x16x32_bf16 a[196:199], a[224:227], a[236:239], a[196:199]
ds_read_b64_tr_b16 a[224:225], v169 offset:32
ds_read_b64_tr_b16 a[226:227], v169 offset:8480
s_waitcnt lgkmcnt(0)
v_mfma_f32_16x16x32_bf16 a[200:203], a[224:227], a[232:235], a[200:203]
v_mfma_f32_16x16x32_bf16 a[204:207], a[224:227], a[236:239], a[204:207]
ds_read_b64_tr_b16 a[224:225], v169 offset:64
ds_read_b64_tr_b16 a[226:227], v169 offset:8512
s_waitcnt lgkmcnt(0)
v_mfma_f32_16x16x32_bf16 a[208:211], a[224:227], a[232:235], a[208:211]
v_mfma_f32_16x16x32_bf16 a[212:215], a[224:227], a[236:239], a[212:215]
ds_read_b64_tr_b16 a[224:225], v169 offset:96
ds_read_b64_tr_b16 a[226:227], v169 offset:8544
s_waitcnt lgkmcnt(0)
v_mfma_f32_16x16x32_bf16 a[216:219], a[224:227], a[232:235], a[216:219]
v_mfma_f32_16x16x32_bf16 a[220:223], a[224:227], a[236:239], a[220:223]
s_barrier
s_add_u32 s61, s61, 16384
s_add_u32 s46, s46, 1
s_cmp_lt_u32 s46, 32
s_cbranch_scc1 L_safe_b
s_nop 7
s_nop 7
s_getpc_b64 s[32:33]
L_sf_pc:
s_sub_u32 s32, s32, L_sf_pc-L_att_done
s_subb_u32 s33, s33, 0
s_setpc_b64 s[32:33]
L_exit:
s_endpgm
.section .rodata,"a"
.p2align 6
.amdhsa_kernel concat_heads__gqa_block_cached__gqa_block_cached__near_ridge_kernel
  .amdhsa_next_free_vgpr 512
  .amdhsa_next_free_sgpr 102
  .amdhsa_accum_offset 256
  .amdhsa_group_segment_fixed_size 0
  .amdhsa_kernarg_size 104
  .amdhsa_user_sgpr_count 2
  .amdhsa_user_sgpr_kernarg_segment_ptr 1
  .amdhsa_system_sgpr_workgroup_id_x 1
.end_amdhsa_kernel
```
